```python
import torch

def _softmax(x, axis=-1):
    return torch.softmax(x, dim=axis)
def _gelu(x):
    return torch.nn.functional.gelu(x, approximate="tanh")
def _silu(x):
    return torch.nn.functional.silu(x)
def _sigmoid(x):
    return torch.sigmoid(x)
def _layernorm(x, axis=-1, eps=1e-5):
    m = x.mean(dim=axis, keepdim=True)
    v = x.var(dim=axis, keepdim=True, unbiased=False)
    return (x - m) / torch.sqrt(v + eps)
def _scatter_add(tgt, idx, src, axis=0):
    return tgt.clone().index_add_(axis, idx, src)
def _segment_sum(src, seg, n):
    out = torch.zeros((n,) + src.shape[1:], dtype=src.dtype)
    return out.index_add_(0, seg, src)
def _pad(x, pw):
    flat = tuple(v for pair in reversed(pw) for v in pair)
    return torch.nn.functional.pad(x, flat)

kernel_name = 'recurrent_scan__spectral_fnet__glu_gated_geglu__prompt'

def setup_inputs():

    _w = (lambda a: (lambda t: t.to(torch.bfloat16) if t.is_floating_point() else t)(torch.as_tensor(a)))
    def _A_setup():
        B, S, D = 1, 2048, 640
        ns = torch.arange(S)[:, None] * torch.arange(S)[None, :]
        nd = torch.arange(D)[:, None] * torch.arange(D)[None, :]
        Ws_re = torch.cos(-2.0 * torch.pi * ns / S).to(float)
        Ws_im = torch.sin(-2.0 * torch.pi * ns / S).to(float)
        Wd_re = torch.cos(-2.0 * torch.pi * nd / D).to(float)
        Wd_im = torch.sin(-2.0 * torch.pi * nd / D).to(float)
        return {
            "x": _w((lambda *s: torch.randn(*s, dtype=torch.bfloat16) * 0.05)(B, S, D)),
            "dft_seq_re": _w(Ws_re),
            "dft_seq_im": _w(Ws_im),
            "dft_hid_re": _w(Wd_re),
            "dft_hid_im": _w(Wd_im),
        }
    _A_in = _A_setup()

    def _B_setup():
        B, S, Dm, Df = 1, 2048, 640, 1536
        return {
            "x": _w((lambda *s: torch.randn(*s, dtype=torch.bfloat16) * 0.05)(B, S, Dm)),
            "w_gate": _w((lambda *s: torch.randn(*s, dtype=torch.bfloat16) * 0.05)(Dm, Df) * (Dm ** -0.5)),
            "w_up": _w((lambda *s: torch.randn(*s, dtype=torch.bfloat16) * 0.05)(Dm, Df) * (Dm ** -0.5)),
            "w_down": _w((lambda *s: torch.randn(*s, dtype=torch.bfloat16) * 0.05)(Df, Dm) * (Df ** -0.5)),
        }
    _B_in = _B_setup()

    return {
        "A_x": _A_in["x"],
        "A_dft_seq_re": _A_in["dft_seq_re"],
        "A_dft_seq_im": _A_in["dft_seq_im"],
        "A_dft_hid_re": _A_in["dft_hid_re"],
        "A_dft_hid_im": _A_in["dft_hid_im"],
        "B_x": _B_in["x"],
        "B_w_gate": _B_in["w_gate"],
        "B_w_up": _B_in["w_up"],
        "B_w_down": _B_in["w_down"],
    }

def reference(A_x, A_dft_seq_re, A_dft_seq_im, A_dft_hid_re, A_dft_hid_im, B_x, B_w_gate, B_w_up, B_w_down):
    def _A_ref(x, dft_seq_re, dft_seq_im, dft_hid_re, dft_hid_im):
        a = torch.einsum("bsd,ed->bse", x, dft_hid_re)
        b = torch.einsum("bsd,ed->bse", x, dft_hid_im)
        y = torch.einsum("ts,bse->bte", dft_seq_re, a) - torch.einsum("ts,bse->bte", dft_seq_im, b)
        return y

    def _B_ref(x, w_gate, w_up, w_down):
        g = torch.einsum("bsd,df->bsf", x, w_gate)
        u = torch.einsum("bsd,df->bsf", x, w_up)
        h = _gelu(g) * u
        return torch.einsum("bsf,fd->bsd", h, w_down)

    x = A_x
    xn = _layernorm(x, axis=-1)
    s = _A_ref(xn, A_dft_seq_re, A_dft_seq_im, A_dft_hid_re, A_dft_hid_im)
    g = _silu(_B_ref(xn, B_w_gate, B_w_up, B_w_down))
    return x + s * g
```

```asm
; @launch grid=(256,1,1) block=(256,1,1) lds=163840
.amdgcn_target "amdgcn-amd-amdhsa--gfx950"
.text
.globl recurrent_scan__spectral_fnet__glu_gated_geglu__prompt_kernel
.p2align 8
.type recurrent_scan__spectral_fnet__glu_gated_geglu__prompt_kernel,@function
recurrent_scan__spectral_fnet__glu_gated_geglu__prompt_kernel:
  s_load_dwordx16 s[16:31], s[0:1], 0
  s_load_dwordx8 s[32:39], s[0:1], 64
  s_lshr_b32 s46, s2, 1
  s_and_b32 s46, s46, 0x1c
  s_lshr_b32 s47, 0x21BB9821, s46
  s_and_b32 s47, s47, 15
  s_lshl_b32 s47, s47, 3
  s_load_dwordx2 s[52:53], s[0:1], s47
  s_lshr_b32 s46, 0xAAFF32AA, s46
  s_and_b32 s46, s46, 15
  s_mul_i32 s46, s46, 25600
  v_lshrrev_b32 v45, 3, v0
  v_mul_lo_u32 v45, v45, s46
  v_lshrrev_b32 v1, 6, v0
  v_and_b32 v2, 63, v0
  v_readfirstlane_b32 s3, v1
  s_cmp_ge_u32 s2, 256
  s_cbranch_scc1 L_end
  s_getpc_b64 s[4:5]
  s_lshr_b32 s6, s2, 3
  s_lshl2_add_u32 s6, s6, s3
  v_min_u32 v3, 4, v2
  s_mul_i32 s6, s6, 5
  v_add_lshl_u32 v3, v3, s6, 7
  v_min_u32 v3, (L_end-recurrent_scan__spectral_fnet__glu_gated_geglu__prompt_kernel-256), v3
  global_load_dword v43, v3, s[4:5]
  s_bfe_u32 s56, s2, 0x10002
  s_bfe_u32 s57, s2, 0x30003
  s_and_b32 s100, s2, 1
  s_lshl3_add_u32 s57, s100, s57
  s_lshr_b32 s59, s2, 6
  s_bfe_u32 s63, s2, 0x20001
  s_lshr_b32 s58, s2, 7
  s_lshl1_add_u32 s58, s63, s58
  s_and_b32 s76, s58, 3
  s_lshr_b32 s98, s58, 1
  s_lshl2_add_u32 s98, s98, s58
  s_lshl1_add_u32 s60, s57, s56
  s_and_b32 s61, s63, 1
  s_lshl1_add_u32 s61, s59, s61
  s_mov_b32 s65, 30000
  s_lshl_b32 s66, s3, 12
  s_mul_i32 s67, s3, 5120
  s_lshl2_add_u32 s62, s57, s3
  s_mul_i32 s68, s62, 40960
  s_and_b32 s100, s3, 1
  s_mul_i32 s71, s100, 98304
  s_lshl_b32 s100, s100, 6
  v_lshlrev_b32 v1, 4, v2
  v_add_u32 v3, 0x1000, v1
  v_bfe_u32 v81, v2, 4, 1
  v_lshlrev_b32 v81, 1, v81
  v_and_b32 v82, 7, v2
  v_xor_b32 v81, v81, v82
  v_lshlrev_b32 v81, 4, v81
  v_lshrrev_b32 v80, 3, v2
  v_mul_u32_u24 v4, 1280, v80
  v_add_u32 v4, v4, v81
  v_add_u32 v5, 9216, v4
  v_xor_b32 v82, 64, v4
  v_add_u32 v6, 18432, v82
  v_add_u32 v7, 27648, v82
  v_mul_u32_u24 v8, 3072, v80
  v_add_u32 v8, v8, v81
  v_xor_b32 v83, 64, v8
  v_add_u32 v9, 23552, v83
  v_add_u32 v10, 47104, v8
  v_add_u32 v11, 70656, v83
  v_xor_b32 v12, s100, v4
  v_xor_b32 v83, 64, v12
  v_add_u32 v13, 9216, v83
  v_add_u32 v14, 18432, v12
  v_add_u32 v15, 27648, v83
  v_add_u32 v16, 40960, v12
  v_lshl_add_u32 v44, v80, 12, v81
  v_bfe_u32 v82, v2, 2, 2
  v_and_b32 v83, 3, v2
  v_lshrrev_b32 v81, 4, v2
  v_mul_u32_u24 v204, 1280, v82
  v_lshl_add_u32 v204, v83, 6, v204
  v_lshl_add_u32 v204, v81, 4, v204
  v_min_u32 v17, 39, v2
  v_lshlrev_b32 v17, 7, v17
  s_lshl2_add_u32 s101, s57, s59
  s_lshl2_add_u32 s101, s101, s3
  s_mul_i32 s101, s101, 10240
  s_add_u32 s82, s101, 5120
  s_and_b32 s91, s57, 7
  s_and_b32 s88, s3, 1
  s_lshl1_add_u32 s88, s91, s88
  s_mul_i32 s88, s88, 3072
  s_lshl_b32 s83, s98, 7
  s_add_u32 s88, s88, s83
  s_lshl3_add_u32 s83, s76, s91
  s_lshl2_add_u32 s83, s83, s3
  s_mul_i32 s83, s83, 6400
  v_mul_u32_u24 v42, 384, v17
  v_min_u32 v73, 49, v2
  v_lshlrev_b32 v73, 7, v73
  s_waitcnt lgkmcnt(0)
  s_mov_b32 s12, s16
  s_and_b32 s13, s17, 0xffff
  s_mov_b32 s14, 0x280000
  s_mov_b32 s15, 0x20000
  buffer_load_dword v43, v17, s[12:15], s101 offen sc1
  buffer_load_dword v43, v17, s[12:15], s82 offen sc1
  s_mov_b32 s8, s38
  s_and_b32 s9, s39, 0xffff
  s_mov_b32 s10, 0x1a00000
  s_mov_b32 s11, 0x20000
  s_bitcmp1_b32 s2, 6
  s_cbranch_scc1 O_prog
E_prog:
  s_cmp_ge_u32 s3, 2
  s_cselect_b32 s40, s30, s28
  s_cselect_b32 s41, s31, s29
  s_and_b32 s41, s41, 0xffff
  s_mov_b32 s42, 0x1e0000
  s_mov_b32 s43, 0x20000
  buffer_load_dword v43, v42, s[40:43], s88 offen offset:0 sc1
  s_lshl_b32 s69, s98, 7
  s_add_u32 s69, s69, s71
  buffer_load_dword v71, off, s[8:11], 0 sc1
  global_load_dword v43, v45, s[52:53] sc1
  s_mov_b32 s4, s32
  s_and_b32 s5, s33, 0xffff
  s_mov_b32 s6, 0x1e0000
  s_mov_b32 s7, 0x20000
  s_cmp_eq_u32 s56, 1
  s_cselect_b32 s48, s20, s18
  s_cselect_b32 s49, s21, s19
  s_and_b32 s49, s49, 0xffff
  s_mov_b32 s50, 0x800000
  s_mov_b32 s51, 0x20000
  s_mov_b32 s52, s34
  s_and_b32 s53, s35, 0xffff
  s_mov_b32 s54, 0x280000
  s_mov_b32 s55, 0x20000
  s_lshl3_add_u32 s101, s57, s58
  s_lshl2_add_u32 s101, s101, s3
  s_mul_i32 s82, s101, 5120
  s_mov_b32 s83, s101
  s_mul_i32 s33, s83, 205
  s_lshr_b32 s33, s33, 11
  s_mul_i32 s33, s33, 39680
  s_lshl_b32 s81, s83, 7
  s_add_u32 s33, s33, s81
  s_cmp_lt_u32 s83, 480
  s_cselect_b32 s81, 0, 0x7ff00000
  s_lshr_b32 s18, s3, 1
  s_and_b32 s19, s3, 1
  s_lshl_b32 s21, s101, 6
  s_add_u32 s21, s21, 0x8000
  s_lshl_b32 s35, s83, 12
  s_add_u32 s35, s35, s81
  s_add_u32 s35, s35, 0x100000
  s_lshl_b32 s36, s83, 2
  s_add_u32 s36, s36, 0x50000
  s_add_u32 s36, s36, s81
  s_add_u32 s17, s98, 2
  s_lshl_b32 s16, s17, 7
  s_add_u32 s71, s71, s16
  s_lshl_b32 s22, s62, 9
  s_add_u32 s22, s22, 0x8000
  s_lshr_b32 s16, s62, 1
  s_mul_i32 s26, s16, 24
  s_add_u32 s26, s26, s17
  s_lshl2_add_u32 s26, s26, s3
  s_lshl_b32 s26, s26, 11
  s_add_u32 s26, s26, 0x800000
  s_xor_b32 s27, s26, 4096
  s_lshl_b32 s29, s16, 5
  s_add_u32 s29, s29, s17
  s_lshl1_add_u32 s29, s29, s19
  s_lshl_b32 s29, s29, 2
  s_add_u32 s29, s29, 0x60000
  s_sub_u32 s24, s26, 16384
  s_sub_u32 s25, s27, 16384
  s_sub_u32 s28, s29, 16
  s_lshl3_add_u32 s92, s56, s61
  s_lshl_b32 s30, s92, 7
  s_add_u32 s30, s30, 0x40000
  s_lshl_b32 s31, s60, 6
  s_mul_i32 s16, s3, 12
  s_add_u32 s31, s31, s16
  s_lshl_b32 s31, s31, 2
  s_add_u32 s31, s31, 0x60000
  s_mul_i32 s17, s61, 5
  s_lshr_b32 s32, s17, 2
  s_mul_i32 s16, s3, 120
  s_add_u32 s32, s32, s16
  s_lshl_b32 s32, s32, 2
  s_add_u32 s32, s32, 0x50000
  s_lshl_b32 s16, s16, 2
  s_add_u32 s77, s16, s17
  s_lshl_b32 s77, s77, 10
  s_add_u32 s77, s77, 0x100000
  s_lshl2_add_u32 s76, s60, s3
  s_mul_i32 s76, s76, 49152
  s_add_u32 s76, s76, 0x800000
  s_lshl2_add_u32 s16, s57, s59
  s_lshl2_add_u32 s17, s16, s3
  s_lshl2_add_u32 s17, s17, s63
  s_mul_i32 s78, s17, 10240
  s_add_u32 s78, s78, 0xe00000
  s_cmp_eq_u32 s3, s63
  s_cselect_b32 s78, 0x7ff00000, s78
  s_cselect_b32 s37, 0, 10240
  s_lshl2_add_u32 s16, s16, s63
  s_mul_i32 s79, s16, 40960
  s_lshl_b32 s17, s3, 11
  s_add_u32 s79, s79, s17
  s_add_u32 s79, s79, 0xe00000
  s_xor_b32 s96, s63, 1
  s_mul_i32 s96, s96, 10240
  s_add_u32 s96, s96, s79
  s_xor_b32 s97, s63, 2
  s_mul_i32 s97, s97, 10240
  s_add_u32 s97, s97, s79
  s_xor_b32 s99, s63, 3
  s_mul_i32 s99, s99, 10240
  s_add_u32 s99, s99, s79
  s_add_u32 s79, s17, 36864
  s_lshl_b32 s16, s18, 10
  s_sub_u32 s16, s16, s17
  s_add_u32 s16, s16, 8192
  v_add_u32 v0, s16, v1
  s_lshl1_add_u32 s80, s60, s18
  s_lshl3_add_u32 s80, s80, s19
  s_mul_i32 s80, s80, 5120
  s_mul_i32 s16, s61, 160
  s_add_u32 s80, s80, s16
  s_or_b32 s16, s2, s3
  s_cselect_b32 s38, 0x7ff00000, 0
  s_lshl1_add_u32 s70, s59, s57
  s_lshl_b32 s70, s70, 8
  s_and_b32 s70, s70, 0x7ff
  s_add_u32 s90, s70, 256
  s_and_b32 s90, s90, 0x7ff
  s_lshl_b32 s16, s62, 17
  s_and_b32 s17, s63, 1
  s_lshl_b32 s17, s17, 11
  s_add_u32 s16, s16, s17
  v_add_u32 v44, s16, v44
  s_add_u32 s89, s70, s16
  s_add_u32 s90, s90, s16
  v_add_u32 v45, 31744, v44
  v_xor_b32 v47, 64, v44
  v_add_u32 v46, 63488, v47
  v_add_u32 v47, 95232, v47
  s_mul_i32 s16, s92, 327680
  s_add_u32 s16, s16, s67
  s_add_u32 s16, s16, 0x300000
  v_add_u32 v54, s16, v1
  v_add_u32 v55, s16, v3
  s_add_u32 s92, s16, s67
  s_mul_i32 s16, s70, 160
  s_add_u32 s92, s92, s16
  s_add_u32 s93, s92, 5120
  s_mul_i32 s91, s91, 640
  s_add_u32 s91, s91, s77
  s_lshl_b32 s94, s59, 12
  s_lshl1_add_u32 s95, s94, s76
  s_add_u32 s95, s95, 16384
  s_add_u32 s94, s94, s76
  s_mul_i32 s16, s19, 5120
  s_add_u32 s16, s16, 16384
  v_add_u32 v52, s16, v1
  v_add_u32 v53, 73728, v52
  v_bfe_u32 v80, v2, 3, 1
  v_lshlrev_b32 v80, 2, v80
  v_and_b32 v84, 2, v2
  v_or_b32 v80, v80, v84
  v_xor_b32 v80, v80, v81
  v_lshlrev_b32 v80, 4, v80
  v_lshl_add_u32 v75, v82, 3, v83
  v_lshl_add_u32 v48, v75, 7, v80
  v_add_u32 v18, s66, v48
  v_xor_b32 v18, s100, v18
  v_xor_b32 v19, 64, v18
  v_add_u32 v20, 73728, v18
  v_add_u32 v21, 73728, v19
  s_lshl_b32 s16, s18, 13
  v_add_u32 v48, s16, v48
  v_xor_b32 v49, 64, v48
  v_add_u32 v50, 73728, v48
  v_add_u32 v51, 73728, v49
  v_lshl_add_u32 v26, v81, 3, v82
  v_lshlrev_b32 v26, 7, v26
  v_lshl_add_u32 v26, v83, 3, v26
  v_bfe_u32 v27, v2, 3, 2
  v_lshl_add_u32 v26, v27, 5, v26
  s_lshl_b32 s16, s18, 6
  s_lshl_b32 s17, s19, 12
  s_or_b32 s16, s16, s17
  v_xor_b32 v26, s16, v26
  v_xor_b32 v27, 32, v26
  v_xor_b32 v28, 64, v26
  v_xor_b32 v29, 96, v26
  v_xor_b32 v30, 4096, v26
  v_xor_b32 v31, 4128, v26
  v_xor_b32 v32, 4160, v26
  v_xor_b32 v33, 4192, v26
  v_add_u32 v34, 73728, v26
  v_add_u32 v35, 73728, v27
  v_add_u32 v36, 73728, v28
  v_add_u32 v37, 73728, v29
  v_add_u32 v38, 73728, v30
  v_add_u32 v39, 73728, v31
  v_add_u32 v40, 73728, v32
  v_add_u32 v41, 73728, v33
  v_lshl_add_u32 v12, v81, 2, v82
  v_lshlrev_b32 v12, 7, v12
  v_lshl_add_u32 v12, v83, 3, v12
  v_bfe_u32 v13, v2, 3, 1
  v_lshl_add_u32 v12, v13, 5, v12
  v_add_u32 v12, s66, v12
  v_add_u32 v12, 147456, v12
  v_xor_b32 v13, 32, v12
  s_lshl_b32 s16, s18, 8
  s_add_u32 s16, s16, 147456
  v_and_b32 v69, 15, v2
  v_lshl_add_u32 v69, v69, 4, s16
  v_xor_b32 v70, 256, v69
  v_lshl_add_u32 v68, s19, 2, v69
  v_bfe_u32 v84, v2, 5, 1
  v_lshl_add_u32 v68, v84, 9, v68
  v_bfe_u32 v84, v2, 4, 1
  v_lshl_add_u32 v68, v84, 3, v68
  v_mov_b32 v64, 0x3f803f80
  v_mov_b32 v65, 0x3f803f80
  v_mov_b32 v66, 0x3f803f80
  v_mov_b32 v67, 0x3f803f80
  v_cmp_eq_u32 vcc, 0, v82
  s_nop 1
  v_cndmask_b32 v84, 0, v64, vcc
  v_accvgpr_write_b32 a240, v84
  v_accvgpr_write_b32 a241, v84
  v_accvgpr_write_b32 a242, v84
  v_accvgpr_write_b32 a243, v84
  v_cmp_eq_u32 vcc, 1, v82
  s_nop 1
  v_cndmask_b32 v84, 0, v64, vcc
  v_accvgpr_write_b32 a244, v84
  v_accvgpr_write_b32 a245, v84
  v_accvgpr_write_b32 a246, v84
  v_accvgpr_write_b32 a247, v84
  v_cmp_eq_u32 vcc, 2, v82
  s_nop 1
  v_cndmask_b32 v84, 0, v64, vcc
  v_accvgpr_write_b32 a248, v84
  v_accvgpr_write_b32 a249, v84
  v_accvgpr_write_b32 a250, v84
  v_accvgpr_write_b32 a251, v84
  v_cmp_eq_u32 vcc, 3, v82
  s_nop 1
  v_cndmask_b32 v84, 0, v64, vcc
  v_accvgpr_write_b32 a252, v84
  v_accvgpr_write_b32 a253, v84
  v_accvgpr_write_b32 a254, v84
  v_accvgpr_write_b32 a255, v84
  v_mul_u32_u24 v74, 1280, v75
  v_lshl_add_u32 v74, v81, 3, v74
  v_lshlrev_b32 v75, 4, v75
  s_add_u32 s16, s3, 1
  s_and_b32 s16, s16, 3
  v_lshl_add_u32 v76, s16, 10, v1
  s_mul_i32 s16, s16, 15360
  v_add_u32 v92, s16, v1
  s_add_u32 s16, s3, 2
  s_and_b32 s16, s16, 3
  v_lshl_add_u32 v77, s16, 10, v1
  s_mul_i32 s16, s16, 15360
  v_add_u32 v93, s16, v1
  s_add_u32 s16, s3, 3
  s_and_b32 s16, s16, 3
  v_lshl_add_u32 v78, s16, 10, v1
  s_mul_i32 s16, s16, 15360
  v_add_u32 v94, s16, v1
  s_add_u32 s16, s3, 4
  s_and_b32 s16, s16, 3
  v_lshl_add_u32 v79, s16, 10, v1
  s_mul_i32 s16, s16, 15360
  v_add_u32 v95, s16, v1
  v_and_b32 v88, 31, v2
  v_lshlrev_b32 v88, 2, v88
  v_lshlrev_b32 v89, 2, v83
  v_and_b32 v91, 7, v2
  v_add_lshl_u32 v91, v91, 4, 2
  v_lshrrev_b32 v90, 1, v2
  v_min_u32 v90, 11, v90
  v_mul_u32_u24 v90, 10, v90
  v_and_b32 v84, 1, v2
  v_add_lshl_u32 v90, v84, v90, 2
  v_mov_b32 v84, 0x7ff00000
  v_cmp_eq_u32 vcc, 0, v2
  s_nop 1
  v_cndmask_b32 v72, v84, v2, vcc
  v_mul_u32_u24 v85, 20, v81
  v_cmp_eq_u32 vcc, v85, v2
  v_lshlrev_b32 v205, 4, v81
  s_nop 0
  v_cndmask_b32 v205, v84, v205, vcc
  s_and_b32 s91, s57, 7
  s_mul_i32 s91, s91, 5
  s_lshr_b32 s91, s91, 2
  s_mov_b32 s93, s68
  s_mov_b32 s94, s69
  s_mov_b32 s88, s71
  s_lshl_b32 s16, s91, 7
  s_mul_i32 s17, s91, 196608
  s_add_u32 s68, s68, s16
  s_add_u32 s69, s69, s17
  s_add_u32 s71, s71, s17
  s_add_u32 m0, s66, 0
  s_nop 0
  buffer_load_dwordx4 v4, s[12:15], s68 offen offset:0 lds
  buffer_load_dwordx4 v5, s[12:15], s68 offen offset:1024 lds
  buffer_load_dwordx4 v6, s[12:15], s68 offen offset:2048 lds
  buffer_load_dwordx4 v7, s[12:15], s68 offen offset:3072 lds
  s_add_u32 s68, s68, 128
  s_cmp_eq_u32 s91, 9
  s_cselect_b32 s68, s93, s68
  s_add_u32 m0, s66, 16384
  s_nop 0
  buffer_load_dwordx4 v8, s[40:43], s69 offen offset:0 lds
  buffer_load_dwordx4 v9, s[40:43], s69 offen offset:1024 lds
  buffer_load_dwordx4 v10, s[40:43], s69 offen offset:2048 lds
  buffer_load_dwordx4 v11, s[40:43], s69 offen offset:3072 lds
  s_add_u32 s69, s69, 196608
  s_cmp_eq_u32 s91, 9
  s_cselect_b32 s69, s94, s69
  buffer_load_dwordx4 v[176:179], v204, s[12:15], s82 offen offset:0
  buffer_load_dwordx4 v[180:183], v204, s[12:15], s82 offen offset:256
  buffer_load_dwordx4 v[184:187], v204, s[12:15], s82 offen offset:512
  buffer_load_dwordx4 v[188:191], v204, s[12:15], s82 offen offset:768
  buffer_load_dwordx4 v[192:195], v204, s[12:15], s82 offen offset:1024
  s_add_u32 m0, s66, 36864
  s_nop 0
  buffer_load_dwordx4 v4, s[12:15], s68 offen offset:0 lds
  buffer_load_dwordx4 v5, s[12:15], s68 offen offset:1024 lds
  buffer_load_dwordx4 v6, s[12:15], s68 offen offset:2048 lds
  buffer_load_dwordx4 v7, s[12:15], s68 offen offset:3072 lds
  s_add_u32 s68, s68, 128
  s_cmp_eq_u32 s91, 8
  s_cselect_b32 s68, s93, s68
  s_add_u32 m0, s66, 53248
  s_nop 0
  buffer_load_dwordx4 v8, s[40:43], s69 offen offset:0 lds
  buffer_load_dwordx4 v9, s[40:43], s69 offen offset:1024 lds
  buffer_load_dwordx4 v10, s[40:43], s69 offen offset:2048 lds
  buffer_load_dwordx4 v11, s[40:43], s69 offen offset:3072 lds
  s_add_u32 s69, s69, 196608
  s_cmp_eq_u32 s91, 8
  s_cselect_b32 s69, s94, s69
  s_waitcnt vmcnt(21)
  v_readfirstlane_b32 s64, v71
  s_mul_i32 s64, s64, 1664525
  s_add_u32 s64, s64, 1013904223
  v_mov_b32 v71, s64
  s_waitcnt vmcnt(13)
  s_barrier
  ds_read_b128 a[0:3], v18 offset:0
  ds_read_b128 a[4:7], v18 offset:512
  ds_read_b64_tr_b16 a[160:161], v26 offset:16384
  ds_read_b64_tr_b16 a[162:163], v26 offset:16896
  ds_read_b64_tr_b16 a[164:165], v27 offset:16384
  ds_read_b64_tr_b16 a[166:167], v27 offset:16896
  ds_read_b64_tr_b16 a[176:177], v26 offset:24576
  ds_read_b64_tr_b16 a[178:179], v26 offset:25088
  ds_read_b64_tr_b16 a[180:181], v27 offset:24576
  ds_read_b64_tr_b16 a[182:183], v27 offset:25088
  ds_read_b64_tr_b16 a[168:169], v28 offset:16384
  ds_read_b64_tr_b16 a[170:171], v28 offset:16896
  ds_read_b64_tr_b16 a[172:173], v29 offset:16384
  ds_read_b64_tr_b16 a[174:175], v29 offset:16896
  ds_read_b64_tr_b16 a[184:185], v28 offset:24576
  ds_read_b64_tr_b16 a[186:187], v28 offset:25088
  ds_read_b64_tr_b16 a[188:189], v29 offset:24576
  ds_read_b64_tr_b16 a[190:191], v29 offset:25088
  s_waitcnt lgkmcnt(0)
  s_add_u32 m0, s66, 73728
  v_mfma_f32_16x16x32_bf16 v[96:99], a[160:163], a[0:3], 0
  ds_read_b128 a[8:11], v19 offset:0
  ds_read_b128 a[12:15], v19 offset:512
  v_mfma_f32_16x16x32_bf16 v[100:103], a[160:163], a[4:7], 0
  ds_read_b64_tr_b16 a[200:201], v30 offset:16384
  buffer_load_dwordx4 v4, s[12:15], s68 offen offset:0 lds
  v_mfma_f32_16x16x32_bf16 v[160:163], a[240:243], a[160:163], 0
  ds_read_b64_tr_b16 a[202:203], v30 offset:16896
  buffer_load_dwordx4 v5, s[12:15], s68 offen offset:1024 lds
  v_mfma_f32_16x16x32_bf16 v[104:107], a[164:167], a[0:3], 0
  ds_read_b64_tr_b16 a[204:205], v31 offset:16384
  v_mfma_f32_16x16x32_bf16 v[108:111], a[164:167], a[4:7], 0
  ds_read_b64_tr_b16 a[206:207], v31 offset:16896
  v_mfma_f32_16x16x32_bf16 v[160:163], a[244:247], a[164:167], v[160:163]
  ds_read_b64_tr_b16 a[216:217], v30 offset:24576
  buffer_load_dwordx4 v6, s[12:15], s68 offen offset:2048 lds
  v_mfma_f32_16x16x32_bf16 v[128:131], a[176:179], a[0:3], 0
  ds_read_b64_tr_b16 a[218:219], v30 offset:25088
  v_mfma_f32_16x16x32_bf16 v[132:135], a[176:179], a[4:7], 0
  ds_read_b64_tr_b16 a[220:221], v31 offset:24576
  v_mfma_f32_16x16x32_bf16 v[160:163], a[248:251], a[176:179], v[160:163]
  ds_read_b64_tr_b16 a[222:223], v31 offset:25088
  ds_read_b64_tr_b16 a[208:209], v32 offset:16384
  v_mfma_f32_16x16x32_bf16 v[136:139], a[180:183], a[0:3], 0
  ds_read_b64_tr_b16 a[210:211], v32 offset:16896
  buffer_load_dwordx4 v7, s[12:15], s68 offen offset:3072 lds
  v_mfma_f32_16x16x32_bf16 v[140:143], a[180:183], a[4:7], 0
  ds_read_b64_tr_b16 a[212:213], v33 offset:16384
  s_add_u32 s68, s68, 128
  v_mfma_f32_16x16x32_bf16 v[160:163], a[252:255], a[180:183], v[160:163]
  ds_read_b64_tr_b16 a[214:215], v33 offset:16896
  s_cmp_eq_u32 s91, 7
  s_cselect_b32 s68, s93, s68
  v_mfma_f32_16x16x32_bf16 v[112:115], a[168:171], a[0:3], 0
  ds_read_b64_tr_b16 a[224:225], v32 offset:24576
  s_add_u32 m0, s66, 147456
  v_mfma_f32_16x16x32_bf16 v[116:119], a[168:171], a[4:7], 0
  ds_read_b64_tr_b16 a[226:227], v32 offset:25088
  buffer_load_dwordx4 v4, s[4:7], s33 offen offset:0 nt lds
  v_mfma_f32_16x16x32_bf16 v[120:123], a[172:175], a[0:3], 0
  ds_read_b64_tr_b16 a[228:229], v33 offset:24576
  v_mfma_f32_16x16x32_bf16 v[124:127], a[172:175], a[4:7], 0
  ds_read_b64_tr_b16 a[230:231], v33 offset:25088
  v_mfma_f32_16x16x32_bf16 v[144:147], a[184:187], a[0:3], 0
  buffer_load_dwordx4 v5, s[4:7], s33 offen offset:1024 nt lds
  v_mfma_f32_16x16x32_bf16 v[148:151], a[184:187], a[4:7], 0
  v_mfma_f32_16x16x32_bf16 v[152:155], a[188:191], a[0:3], 0
  v_mfma_f32_16x16x32_bf16 v[156:159], a[188:191], a[4:7], 0
  s_waitcnt vmcnt(6) lgkmcnt(0)
  s_barrier
  buffer_load_dwordx4 v6, s[4:7], s33 offen offset:2048 nt lds
  v_mfma_f32_16x16x32_bf16 v[96:99], a[200:203], a[8:11], v[96:99]
  ds_read_b128 a[16:19], v18 offset:36864
  v_mfma_f32_16x16x32_bf16 v[100:103], a[200:203], a[12:15], v[100:103]
  ds_read_b128 a[20:23], v18 offset:37376
  v_mfma_f32_16x16x32_bf16 v[104:107], a[204:207], a[8:11], v[104:107]
  ds_read_b64_tr_b16 a[160:161], v26 offset:53248
  v_mfma_f32_16x16x32_bf16 v[108:111], a[204:207], a[12:15], v[108:111]
  ds_read_b64_tr_b16 a[162:163], v26 offset:53760
  buffer_load_dwordx4 v7, s[4:7], s33 offen offset:3072 nt lds
  v_mfma_f32_16x16x32_bf16 v[128:131], a[216:219], a[8:11], v[128:131]
  ds_read_b64_tr_b16 a[164:165], v27 offset:53248
  s_add_u32 m0, s66, 90112
  v_mfma_f32_16x16x32_bf16 v[132:135], a[216:219], a[12:15], v[132:135]
  ds_read_b64_tr_b16 a[166:167], v27 offset:53760
  v_mfma_f32_16x16x32_bf16 v[136:139], a[220:223], a[8:11], v[136:139]
  ds_read_b64_tr_b16 a[176:177], v26 offset:61440
  buffer_load_dwordx4 v8, s[40:43], s69 offen offset:0 lds
  v_mfma_f32_16x16x32_bf16 v[140:143], a[220:223], a[12:15], v[140:143]
  ds_read_b64_tr_b16 a[178:179], v26 offset:61952
  v_mfma_f32_16x16x32_bf16 v[112:115], a[208:211], a[8:11], v[112:115]
  ds_read_b64_tr_b16 a[180:181], v27 offset:61440
  v_mfma_f32_16x16x32_bf16 v[116:119], a[208:211], a[12:15], v[116:119]
  ds_read_b64_tr_b16 a[182:183], v27 offset:61952
  v_mfma_f32_16x16x32_bf16 v[120:123], a[212:215], a[8:11], v[120:123]
  ds_read_b64_tr_b16 a[168:169], v28 offset:53248
  buffer_load_dwordx4 v9, s[40:43], s69 offen offset:1024 lds
  v_mfma_f32_16x16x32_bf16 v[124:127], a[212:215], a[12:15], v[124:127]
  ds_read_b64_tr_b16 a[170:171], v28 offset:53760
  v_mfma_f32_16x16x32_bf16 v[144:147], a[224:227], a[8:11], v[144:147]
  ds_read_b64_tr_b16 a[172:173], v29 offset:53248
  v_mfma_f32_16x16x32_bf16 v[148:151], a[224:227], a[12:15], v[148:151]
  ds_read_b64_tr_b16 a[174:175], v29 offset:53760
  v_mfma_f32_16x16x32_bf16 v[152:155], a[228:231], a[8:11], v[152:155]
  ds_read_b64_tr_b16 a[184:185], v28 offset:61440
  buffer_load_dwordx4 v10, s[40:43], s69 offen offset:2048 lds
  v_mfma_f32_16x16x32_bf16 v[156:159], a[228:231], a[12:15], v[156:159]
  ds_read_b64_tr_b16 a[186:187], v28 offset:61952
  v_mfma_f32_16x16x32_bf16 v[196:199], v[64:67], v[176:179], 0
  ds_read_b64_tr_b16 a[188:189], v29 offset:61440
  v_mfma_f32_16x16x32_bf16 v[200:203], v[176:179], v[176:179], 0
  ds_read_b64_tr_b16 a[190:191], v29 offset:61952
  buffer_load_dwordx4 v11, s[40:43], s69 offen offset:3072 lds
  v_mfma_f32_16x16x32_bf16 v[196:199], v[64:67], v[180:183], v[196:199]
  s_add_u32 s69, s69, 196608
  s_cmp_eq_u32 s91, 7
  s_cselect_b32 s69, s94, s69
  v_mfma_f32_16x16x32_bf16 v[200:203], v[180:183], v[180:183], v[200:203]
  s_add_u32 m0, s66, 110592
  v_mfma_f32_16x16x32_bf16 v[196:199], v[64:67], v[184:187], v[196:199]
  v_mfma_f32_16x16x32_bf16 v[200:203], v[184:187], v[184:187], v[200:203]
  buffer_load_dwordx4 v4, s[12:15], s68 offen offset:0 lds
  v_mfma_f32_16x16x32_bf16 v[196:199], v[64:67], v[188:191], v[196:199]
  v_mfma_f32_16x16x32_bf16 v[200:203], v[188:191], v[188:191], v[200:203]
  v_mfma_f32_16x16x32_bf16 v[196:199], v[64:67], v[192:195], v[196:199]
  buffer_load_dwordx4 v5, s[12:15], s68 offen offset:1024 lds
  v_mfma_f32_16x16x32_bf16 v[200:203], v[192:195], v[192:195], v[200:203]
  s_waitcnt lgkmcnt(0)
  v_mfma_f32_16x16x32_bf16 v[96:99], a[160:163], a[16:19], v[96:99]
  ds_read_b128 a[24:27], v19 offset:36864
  ds_read_b128 a[28:31], v19 offset:37376
  v_mfma_f32_16x16x32_bf16 v[100:103], a[160:163], a[20:23], v[100:103]
  ds_read_b64_tr_b16 a[200:201], v30 offset:53248
  v_mfma_f32_16x16x32_bf16 v[160:163], a[240:243], a[160:163], v[160:163]
  ds_read_b64_tr_b16 a[202:203], v30 offset:53760
  v_add_f32_dpp v176, v196, v196 quad_perm:[1,0,3,2] row_mask:0xf bank_mask:0xf
  v_mov_b32_dpp v177, v200 quad_perm:[0,0,0,0] row_mask:0xf bank_mask:0xf
  v_mfma_f32_16x16x32_bf16 v[104:107], a[164:167], a[16:19], v[104:107]
  ds_read_b64_tr_b16 a[204:205], v31 offset:53248
  v_add_f32_dpp v177, v201, v177 quad_perm:[1,1,1,1] row_mask:0xf bank_mask:0xf
  v_add_f32_dpp v176, v176, v176 quad_perm:[2,3,0,1] row_mask:0xf bank_mask:0xf
  v_mfma_f32_16x16x32_bf16 v[108:111], a[164:167], a[20:23], v[108:111]
  ds_read_b64_tr_b16 a[206:207], v31 offset:53760
  v_add_f32_dpp v177, v202, v177 quad_perm:[2,2,2,2] row_mask:0xf bank_mask:0xf
  v_mul_f32 v176, 0xbacccccd, v176
  v_mfma_f32_16x16x32_bf16 v[160:163], a[244:247], a[164:167], v[160:163]
  ds_read_b64_tr_b16 a[216:217], v30 offset:61440
  v_add_f32_dpp v177, v203, v177 quad_perm:[3,3,3,3] row_mask:0xf bank_mask:0xf
  v_mul_f32 v177, 0x3acccccd, v177
  v_mfma_f32_16x16x32_bf16 v[128:131], a[176:179], a[16:19], v[128:131]
  ds_read_b64_tr_b16 a[218:219], v30 offset:61952
  v_fma_f32 v177, -v176, v176, v177
  v_max_f32 v177, 0, v177
  v_mfma_f32_16x16x32_bf16 v[132:135], a[176:179], a[20:23], v[132:135]
  ds_read_b64_tr_b16 a[220:221], v31 offset:61440
  v_cvt_pk_bf16_f32 v176, v176, v177
  v_and_b32 v177, 0xffff0000, v176
  v_mfma_f32_16x16x32_bf16 v[160:163], a[248:251], a[176:179], v[160:163]
  ds_read_b64_tr_b16 a[222:223], v31 offset:61952
  ds_read_b64_tr_b16 a[208:209], v32 offset:53248
  v_lshlrev_b32 v176, 16, v176
  v_mfma_f32_16x16x32_bf16 v[136:139], a[180:183], a[16:19], v[136:139]
  ds_read_b64_tr_b16 a[210:211], v32 offset:53760
  v_add_f32 v177, 0x3727c5ac, v177
  v_cvt_pk_bf16_f32 v177, v177, v177
  v_mfma_f32_16x16x32_bf16 v[140:143], a[180:183], a[20:23], v[140:143]
  ds_read_b64_tr_b16 a[212:213], v33 offset:53248
  v_lshlrev_b32 v177, 16, v177
  v_mfma_f32_16x16x32_bf16 v[160:163], a[252:255], a[180:183], v[160:163]
  ds_read_b64_tr_b16 a[214:215], v33 offset:53760
  v_sqrt_f32 v177, v177
  v_mfma_f32_16x16x32_bf16 v[112:115], a[168:171], a[16:19], v[112:115]
  ds_read_b64_tr_b16 a[224:225], v32 offset:61440
  v_mov_b32 v179, v71
  v_cvt_pk_bf16_f32 v177, v177, v177
  v_mfma_f32_16x16x32_bf16 v[116:119], a[168:171], a[20:23], v[116:119]
  ds_read_b64_tr_b16 a[226:227], v32 offset:61952
  v_lshlrev_b32 v177, 16, v177
  v_mul_f32 v178, v177, v177
  v_mfma_f32_16x16x32_bf16 v[120:123], a[172:175], a[16:19], v[120:123]
  ds_read_b64_tr_b16 a[228:229], v33 offset:61440
  v_rcp_f32 v177, v177
  v_mfma_f32_16x16x32_bf16 v[124:127], a[172:175], a[20:23], v[124:127]
  ds_read_b64_tr_b16 a[230:231], v33 offset:61952
  s_nop 0
  v_mfma_f32_16x16x32_bf16 v[144:147], a[184:187], a[16:19], v[144:147]
  buffer_load_dwordx4 v6, s[12:15], s68 offen offset:2048 lds
  buffer_load_dwordx4 v7, s[12:15], s68 offen offset:3072 lds
  v_mfma_f32_16x16x32_bf16 v[148:151], a[184:187], a[20:23], v[148:151]
  s_add_u32 s68, s68, 128
  s_cmp_eq_u32 s91, 6
  s_cselect_b32 s68, s93, s68
  v_mfma_f32_16x16x32_bf16 v[152:155], a[188:191], a[16:19], v[152:155]
  s_waitcnt vmcnt(8)
  ds_read_b64_tr_b16 a[144:145], v12 offset:0
  ds_read_b64_tr_b16 a[146:147], v12 offset:2112
  v_mfma_f32_16x16x32_bf16 v[156:159], a[188:191], a[20:23], v[156:159]
  s_waitcnt vmcnt(4) lgkmcnt(2)
  s_barrier
  ds_read_b64_tr_b16 a[148:149], v13 offset:0
  v_mfma_f32_16x16x32_bf16 v[96:99], a[200:203], a[24:27], v[96:99]
  ds_read_b128 a[32:35], v20 offset:0
  ds_read_b128 a[36:39], v20 offset:512
  v_mfma_f32_16x16x32_bf16 v[100:103], a[200:203], a[28:31], v[100:103]
  ds_read_b64_tr_b16 a[160:161], v34 offset:16384
  ds_read_b64_tr_b16 a[150:151], v13 offset:2112
  v_mfma_f32_16x16x32_bf16 v[104:107], a[204:207], a[24:27], v[104:107]
  ds_read_b64_tr_b16 a[162:163], v34 offset:16896
  ds_read_b64_tr_b16 a[164:165], v35 offset:16384
  v_mfma_f32_16x16x32_bf16 v[108:111], a[204:207], a[28:31], v[108:111]
  ds_read_b64_tr_b16 a[166:167], v35 offset:16896
  ds_read_b64_tr_b16 a[152:153], v12 offset:64
  ds_read_b64_tr_b16 a[154:155], v12 offset:2048
  ds_read_b64_tr_b16 a[156:157], v13 offset:64
  ds_read_b64_tr_b16 a[158:159], v13 offset:2048
  v_mfma_f32_16x16x32_bf16 v[128:131], a[216:219], a[24:27], v[128:131]
  ds_read_b64_tr_b16 a[176:177], v34 offset:24576
  ds_read_b64_tr_b16 a[178:179], v34 offset:25088
  v_mfma_f32_16x16x32_bf16 v[132:135], a[216:219], a[28:31], v[132:135]
  ds_read_b64_tr_b16 a[180:181], v35 offset:24576
  buffer_store_dwordx4 v[176:179], v205, s[8:11], s21 offen sc1
  v_mfma_f32_16x16x32_bf16 v[136:139], a[220:223], a[24:27], v[136:139]
  ds_read_b64_tr_b16 a[182:183], v35 offset:25088
  ds_read_b64_tr_b16 a[168:169], v36 offset:16384
  v_mfma_f32_16x16x32_bf16 v[140:143], a[220:223], a[28:31], v[140:143]
  ds_read_b64_tr_b16 a[170:171], v36 offset:16896
  s_add_u32 m0, s66, 126976
  v_mfma_f32_16x16x32_bf16 v[112:115], a[208:211], a[24:27], v[112:115]
  ds_read_b64_tr_b16 a[172:173], v37 offset:16384
  ds_read_b64_tr_b16 a[174:175], v37 offset:16896
  v_mfma_f32_16x16x32_bf16 v[116:119], a[208:211], a[28:31], v[116:119]
  ds_read_b64_tr_b16 a[184:185], v36 offset:24576
  buffer_load_dwordx4 v8, s[40:43], s69 offen offset:0 lds
  v_mfma_f32_16x16x32_bf16 v[120:123], a[212:215], a[24:27], v[120:123]
  ds_read_b64_tr_b16 a[186:187], v36 offset:25088
  ds_read_b64_tr_b16 a[188:189], v37 offset:24576
  v_mfma_f32_16x16x32_bf16 v[124:127], a[212:215], a[28:31], v[124:127]
  ds_read_b64_tr_b16 a[190:191], v37 offset:25088
  buffer_load_dwordx4 v9, s[40:43], s69 offen offset:1024 lds
  v_mfma_f32_16x16x32_bf16 v[144:147], a[224:227], a[24:27], v[144:147]
  v_mfma_f32_16x16x32_bf16 v[148:151], a[224:227], a[28:31], v[148:151]
  buffer_load_dwordx4 v10, s[40:43], s69 offen offset:2048 lds
  v_mfma_f32_16x16x32_bf16 v[152:155], a[228:231], a[24:27], v[152:155]
  v_mfma_f32_16x16x32_bf16 v[156:159], a[228:231], a[28:31], v[156:159]
  s_waitcnt lgkmcnt(0)
  v_mfma_f32_16x16x32_bf16 v[96:99], a[160:163], a[32:35], v[96:99]
  ds_read_b128 a[40:43], v21 offset:0
  ds_read_b128 a[44:47], v21 offset:512
  v_mfma_f32_16x16x32_bf16 v[100:103], a[160:163], a[36:39], v[100:103]
  ds_read_b64_tr_b16 a[200:201], v38 offset:16384
  buffer_load_dwordx4 v11, s[40:43], s69 offen offset:3072 lds
  v_mfma_f32_16x16x32_bf16 v[160:163], a[240:243], a[160:163], v[160:163]
  ds_read_b64_tr_b16 a[202:203], v38 offset:16896
  s_add_u32 s69, s69, 196608
  v_mfma_f32_16x16x32_bf16 v[104:107], a[164:167], a[32:35], v[104:107]
  ds_read_b64_tr_b16 a[204:205], v39 offset:16384
  s_cmp_eq_u32 s91, 6
  s_cselect_b32 s69, s94, s69
  v_mfma_f32_16x16x32_bf16 v[108:111], a[164:167], a[36:39], v[108:111]
  ds_read_b64_tr_b16 a[206:207], v39 offset:16896
  buffer_store_dwordx4 a[144:147], v1, s[8:11], s35 offen offset:0 sc1
  v_mfma_f32_16x16x32_bf16 v[160:163], a[244:247], a[164:167], v[160:163]
  ds_read_b64_tr_b16 a[216:217], v38 offset:24576
  v_mfma_f32_16x16x32_bf16 v[128:131], a[176:179], a[32:35], v[128:131]
  ds_read_b64_tr_b16 a[218:219], v38 offset:25088
  v_mfma_f32_16x16x32_bf16 v[132:135], a[176:179], a[36:39], v[132:135]
  ds_read_b64_tr_b16 a[220:221], v39 offset:24576
  v_mfma_f32_16x16x32_bf16 v[160:163], a[248:251], a[176:179], v[160:163]
  ds_read_b64_tr_b16 a[222:223], v39 offset:25088
  ds_read_b64_tr_b16 a[208:209], v40 offset:16384
  v_mfma_f32_16x16x32_bf16 v[136:139], a[180:183], a[32:35], v[136:139]
  ds_read_b64_tr_b16 a[210:211], v40 offset:16896
  buffer_store_dwordx4 a[148:151], v1, s[8:11], s35 offen offset:1024 sc1
  v_mfma_f32_16x16x32_bf16 v[140:143], a[180:183], a[36:39], v[140:143]
  ds_read_b64_tr_b16 a[212:213], v41 offset:16384
  v_mfma_f32_16x16x32_bf16 v[160:163], a[252:255], a[180:183], v[160:163]
  ds_read_b64_tr_b16 a[214:215], v41 offset:16896
  buffer_store_dwordx4 a[152:155], v1, s[8:11], s35 offen offset:2048 sc1
  v_mfma_f32_16x16x32_bf16 v[112:115], a[168:171], a[32:35], v[112:115]
  ds_read_b64_tr_b16 a[224:225], v40 offset:24576
  v_mfma_f32_16x16x32_bf16 v[116:119], a[168:171], a[36:39], v[116:119]
  ds_read_b64_tr_b16 a[226:227], v40 offset:25088
  v_mfma_f32_16x16x32_bf16 v[120:123], a[172:175], a[32:35], v[120:123]
  ds_read_b64_tr_b16 a[228:229], v41 offset:24576
  v_mfma_f32_16x16x32_bf16 v[124:127], a[172:175], a[36:39], v[124:127]
  ds_read_b64_tr_b16 a[230:231], v41 offset:25088
  buffer_store_dwordx4 a[156:159], v1, s[8:11], s35 offen offset:3072 sc1
  v_mfma_f32_16x16x32_bf16 v[144:147], a[184:187], a[32:35], v[144:147]
  s_add_u32 m0, s66, 0
  v_mfma_f32_16x16x32_bf16 v[148:151], a[184:187], a[36:39], v[148:151]
  v_mfma_f32_16x16x32_bf16 v[152:155], a[188:191], a[32:35], v[152:155]
  buffer_load_dwordx4 v4, s[12:15], s68 offen offset:0 lds
  buffer_load_dwordx4 v5, s[12:15], s68 offen offset:1024 lds
  v_mfma_f32_16x16x32_bf16 v[156:159], a[188:191], a[36:39], v[156:159]
  s_waitcnt vmcnt(6) lgkmcnt(0)
  s_barrier
  v_mfma_f32_16x16x32_bf16 v[96:99], a[200:203], a[40:43], v[96:99]
  ds_read_b128 a[48:51], v20 offset:36864
  ds_read_b128 a[52:55], v20 offset:37376
  v_mfma_f32_16x16x32_bf16 v[100:103], a[200:203], a[44:47], v[100:103]
  ds_read_b64_tr_b16 a[160:161], v34 offset:53248
  buffer_load_dwordx4 v6, s[12:15], s68 offen offset:2048 lds
  v_mfma_f32_16x16x32_bf16 v[104:107], a[204:207], a[40:43], v[104:107]
  ds_read_b64_tr_b16 a[162:163], v34 offset:53760
  ds_read_b64_tr_b16 a[164:165], v35 offset:53248
  v_mfma_f32_16x16x32_bf16 v[108:111], a[204:207], a[44:47], v[108:111]
  ds_read_b64_tr_b16 a[166:167], v35 offset:53760
  v_mfma_f32_16x16x32_bf16 v[128:131], a[216:219], a[40:43], v[128:131]
  ds_read_b64_tr_b16 a[176:177], v34 offset:61440
  ds_read_b64_tr_b16 a[178:179], v34 offset:61952
  v_mfma_f32_16x16x32_bf16 v[132:135], a[216:219], a[44:47], v[132:135]
  ds_read_b64_tr_b16 a[180:181], v35 offset:61440
  buffer_load_dwordx4 v7, s[12:15], s68 offen offset:3072 lds
  v_mfma_f32_16x16x32_bf16 v[136:139], a[220:223], a[40:43], v[136:139]
  ds_read_b64_tr_b16 a[182:183], v35 offset:61952
  ds_read_b64_tr_b16 a[168:169], v36 offset:53248
  v_mfma_f32_16x16x32_bf16 v[140:143], a[220:223], a[44:47], v[140:143]
  ds_read_b64_tr_b16 a[170:171], v36 offset:53760
  s_add_u32 s68, s68, 128
  v_mfma_f32_16x16x32_bf16 v[112:115], a[208:211], a[40:43], v[112:115]
  ds_read_b64_tr_b16 a[172:173], v37 offset:53248
  ds_read_b64_tr_b16 a[174:175], v37 offset:53760
  v_mfma_f32_16x16x32_bf16 v[116:119], a[208:211], a[44:47], v[116:119]
  ds_read_b64_tr_b16 a[184:185], v36 offset:61440
  s_cmp_eq_u32 s91, 5
  s_cselect_b32 s68, s93, s68
  v_mfma_f32_16x16x32_bf16 v[120:123], a[212:215], a[40:43], v[120:123]
  ds_read_b64_tr_b16 a[186:187], v36 offset:61952
  ds_read_b64_tr_b16 a[188:189], v37 offset:61440
  v_mfma_f32_16x16x32_bf16 v[124:127], a[212:215], a[44:47], v[124:127]
  ds_read_b64_tr_b16 a[190:191], v37 offset:61952
  s_add_u32 m0, s66, 16384
  v_mfma_f32_16x16x32_bf16 v[144:147], a[224:227], a[40:43], v[144:147]
  buffer_load_dwordx4 v8, s[40:43], s69 offen offset:0 lds
  buffer_load_dwordx4 v9, s[40:43], s69 offen offset:1024 lds
  v_mfma_f32_16x16x32_bf16 v[148:151], a[224:227], a[44:47], v[148:151]
  v_mfma_f32_16x16x32_bf16 v[152:155], a[228:231], a[40:43], v[152:155]
  v_mfma_f32_16x16x32_bf16 v[156:159], a[228:231], a[44:47], v[156:159]
  s_waitcnt lgkmcnt(0)
  v_mfma_f32_16x16x32_bf16 v[96:99], a[160:163], a[48:51], v[96:99]
  ds_read_b128 a[56:59], v21 offset:36864
  ds_read_b128 a[60:63], v21 offset:37376
  v_mfma_f32_16x16x32_bf16 v[100:103], a[160:163], a[52:55], v[100:103]
  ds_read_b64_tr_b16 a[200:201], v38 offset:53248
  buffer_load_dwordx4 v10, s[40:43], s69 offen offset:2048 lds
  v_mfma_f32_16x16x32_bf16 v[160:163], a[240:243], a[160:163], v[160:163]
  ds_read_b64_tr_b16 a[202:203], v38 offset:53760
  v_mfma_f32_16x16x32_bf16 v[104:107], a[164:167], a[48:51], v[104:107]
  ds_read_b64_tr_b16 a[204:205], v39 offset:53248
  v_mfma_f32_16x16x32_bf16 v[108:111], a[164:167], a[52:55], v[108:111]
  ds_read_b64_tr_b16 a[206:207], v39 offset:53760
  buffer_load_dwordx4 v11, s[40:43], s69 offen offset:3072 lds
  v_mfma_f32_16x16x32_bf16 v[160:163], a[244:247], a[164:167], v[160:163]
  ds_read_b64_tr_b16 a[216:217], v38 offset:61440
  s_add_u32 s69, s69, 196608
  v_mfma_f32_16x16x32_bf16 v[128:131], a[176:179], a[48:51], v[128:131]
  ds_read_b64_tr_b16 a[218:219], v38 offset:61952
  s_cmp_eq_u32 s91, 5
  s_cselect_b32 s69, s94, s69
  v_mfma_f32_16x16x32_bf16 v[132:135], a[176:179], a[52:55], v[132:135]
  ds_read_b64_tr_b16 a[220:221], v39 offset:61440
  s_add_u32 m0, s66, 36864
  v_mfma_f32_16x16x32_bf16 v[160:163], a[248:251], a[176:179], v[160:163]
  ds_read_b64_tr_b16 a[222:223], v39 offset:61952
  ds_read_b64_tr_b16 a[208:209], v40 offset:53248
  v_mfma_f32_16x16x32_bf16 v[136:139], a[180:183], a[48:51], v[136:139]
  ds_read_b64_tr_b16 a[210:211], v40 offset:53760
  buffer_load_dwordx4 v4, s[12:15], s68 offen offset:0 lds
  v_mfma_f32_16x16x32_bf16 v[140:143], a[180:183], a[52:55], v[140:143]
  ds_read_b64_tr_b16 a[212:213], v41 offset:53248
  v_mfma_f32_16x16x32_bf16 v[160:163], a[252:255], a[180:183], v[160:163]
  ds_read_b64_tr_b16 a[214:215], v41 offset:53760
  buffer_load_dwordx4 v5, s[12:15], s68 offen offset:1024 lds
  v_mfma_f32_16x16x32_bf16 v[112:115], a[168:171], a[48:51], v[112:115]
  ds_read_b64_tr_b16 a[224:225], v40 offset:61440
  v_mfma_f32_16x16x32_bf16 v[116:119], a[168:171], a[52:55], v[116:119]
  ds_read_b64_tr_b16 a[226:227], v40 offset:61952
  v_mfma_f32_16x16x32_bf16 v[120:123], a[172:175], a[48:51], v[120:123]
  ds_read_b64_tr_b16 a[228:229], v41 offset:61440
  buffer_load_dwordx4 v6, s[12:15], s68 offen offset:2048 lds
  v_mfma_f32_16x16x32_bf16 v[124:127], a[172:175], a[52:55], v[124:127]
  ds_read_b64_tr_b16 a[230:231], v41 offset:61952
  v_mfma_f32_16x16x32_bf16 v[144:147], a[184:187], a[48:51], v[144:147]
  v_mfma_f32_16x16x32_bf16 v[148:151], a[184:187], a[52:55], v[148:151]
  v_mfma_f32_16x16x32_bf16 v[152:155], a[188:191], a[48:51], v[152:155]
  buffer_load_dwordx4 v7, s[12:15], s68 offen offset:3072 lds
  s_add_u32 s68, s68, 128
  s_cmp_eq_u32 s91, 4
  s_cselect_b32 s68, s93, s68
  s_add_u32 m0, s66, 53248
  s_nop 0
  buffer_load_dwordx4 v8, s[40:43], s69 offen offset:0 lds
  buffer_load_dwordx4 v9, s[40:43], s69 offen offset:1024 lds
  v_mfma_f32_16x16x32_bf16 v[156:159], a[188:191], a[52:55], v[156:159]
  s_waitcnt vmcnt(6) lgkmcnt(0)
  s_barrier
  v_mfma_f32_16x16x32_bf16 v[96:99], a[200:203], a[56:59], v[96:99]
  ds_read_b128 a[64:67], v18 offset:0
  ds_read_b128 a[68:71], v18 offset:512
  v_mfma_f32_16x16x32_bf16 v[100:103], a[200:203], a[60:63], v[100:103]
  ds_read_b64_tr_b16 a[160:161], v26 offset:16384
  buffer_load_dwordx4 v10, s[40:43], s69 offen offset:2048 lds
  v_mfma_f32_16x16x32_bf16 v[104:107], a[204:207], a[56:59], v[104:107]
  ds_read_b64_tr_b16 a[162:163], v26 offset:16896
  ds_read_b64_tr_b16 a[164:165], v27 offset:16384
  v_mfma_f32_16x16x32_bf16 v[108:111], a[204:207], a[60:63], v[108:111]
  ds_read_b64_tr_b16 a[166:167], v27 offset:16896
  v_mfma_f32_16x16x32_bf16 v[128:131], a[216:219], a[56:59], v[128:131]
  ds_read_b64_tr_b16 a[176:177], v26 offset:24576
  ds_read_b64_tr_b16 a[178:179], v26 offset:25088
  v_mfma_f32_16x16x32_bf16 v[132:135], a[216:219], a[60:63], v[132:135]
  ds_read_b64_tr_b16 a[180:181], v27 offset:24576
  buffer_load_dwordx4 v11, s[40:43], s69 offen offset:3072 lds
  v_mfma_f32_16x16x32_bf16 v[136:139], a[220:223], a[56:59], v[136:139]
  ds_read_b64_tr_b16 a[182:183], v27 offset:25088
  ds_read_b64_tr_b16 a[168:169], v28 offset:16384
  v_mfma_f32_16x16x32_bf16 v[140:143], a[220:223], a[60:63], v[140:143]
  ds_read_b64_tr_b16 a[170:171], v28 offset:16896
  s_add_u32 s69, s69, 196608
  v_mfma_f32_16x16x32_bf16 v[112:115], a[208:211], a[56:59], v[112:115]
  ds_read_b64_tr_b16 a[172:173], v29 offset:16384
  ds_read_b64_tr_b16 a[174:175], v29 offset:16896
  v_mfma_f32_16x16x32_bf16 v[116:119], a[208:211], a[60:63], v[116:119]
  ds_read_b64_tr_b16 a[184:185], v28 offset:24576
  s_cmp_eq_u32 s91, 4
  s_cselect_b32 s69, s94, s69
  v_mfma_f32_16x16x32_bf16 v[120:123], a[212:215], a[56:59], v[120:123]
  ds_read_b64_tr_b16 a[186:187], v28 offset:25088
  ds_read_b64_tr_b16 a[188:189], v29 offset:24576
  v_mfma_f32_16x16x32_bf16 v[124:127], a[212:215], a[60:63], v[124:127]
  ds_read_b64_tr_b16 a[190:191], v29 offset:25088
  s_add_u32 m0, s66, 73728
  v_mfma_f32_16x16x32_bf16 v[144:147], a[224:227], a[56:59], v[144:147]
  buffer_load_dwordx4 v4, s[12:15], s68 offen offset:0 lds
  buffer_load_dwordx4 v5, s[12:15], s68 offen offset:1024 lds
  v_mfma_f32_16x16x32_bf16 v[148:151], a[224:227], a[60:63], v[148:151]
  v_mfma_f32_16x16x32_bf16 v[152:155], a[228:231], a[56:59], v[152:155]
  v_mfma_f32_16x16x32_bf16 v[156:159], a[228:231], a[60:63], v[156:159]
  s_waitcnt lgkmcnt(0)
  v_mfma_f32_16x16x32_bf16 v[96:99], a[160:163], a[64:67], v[96:99]
  ds_read_b128 a[72:75], v19 offset:0
  ds_read_b128 a[76:79], v19 offset:512
  v_mfma_f32_16x16x32_bf16 v[100:103], a[160:163], a[68:71], v[100:103]
  ds_read_b64_tr_b16 a[200:201], v30 offset:16384
  buffer_load_dwordx4 v6, s[12:15], s68 offen offset:2048 lds
  v_mfma_f32_16x16x32_bf16 v[160:163], a[240:243], a[160:163], v[160:163]
  ds_read_b64_tr_b16 a[202:203], v30 offset:16896
  v_mfma_f32_16x16x32_bf16 v[104:107], a[164:167], a[64:67], v[104:107]
  ds_read_b64_tr_b16 a[204:205], v31 offset:16384
  v_mfma_f32_16x16x32_bf16 v[108:111], a[164:167], a[68:71], v[108:111]
  ds_read_b64_tr_b16 a[206:207], v31 offset:16896
  buffer_load_dwordx4 v7, s[12:15], s68 offen offset:3072 lds
  v_mfma_f32_16x16x32_bf16 v[160:163], a[244:247], a[164:167], v[160:163]
  ds_read_b64_tr_b16 a[216:217], v30 offset:24576
  s_add_u32 s68, s68, 128
  v_mfma_f32_16x16x32_bf16 v[128:131], a[176:179], a[64:67], v[128:131]
  ds_read_b64_tr_b16 a[218:219], v30 offset:25088
  s_cmp_eq_u32 s91, 3
  s_cselect_b32 s68, s93, s68
  v_mfma_f32_16x16x32_bf16 v[132:135], a[176:179], a[68:71], v[132:135]
  ds_read_b64_tr_b16 a[220:221], v31 offset:24576
  s_add_u32 m0, s66, 90112
  v_mfma_f32_16x16x32_bf16 v[160:163], a[248:251], a[176:179], v[160:163]
  ds_read_b64_tr_b16 a[222:223], v31 offset:25088
  ds_read_b64_tr_b16 a[208:209], v32 offset:16384
  v_mfma_f32_16x16x32_bf16 v[136:139], a[180:183], a[64:67], v[136:139]
  ds_read_b64_tr_b16 a[210:211], v32 offset:16896
  buffer_load_dwordx4 v8, s[40:43], s69 offen offset:0 lds
  v_mfma_f32_16x16x32_bf16 v[140:143], a[180:183], a[68:71], v[140:143]
  ds_read_b64_tr_b16 a[212:213], v33 offset:16384
  v_mfma_f32_16x16x32_bf16 v[160:163], a[252:255], a[180:183], v[160:163]
  ds_read_b64_tr_b16 a[214:215], v33 offset:16896
  buffer_load_dwordx4 v9, s[40:43], s69 offen offset:1024 lds
  v_mfma_f32_16x16x32_bf16 v[112:115], a[168:171], a[64:67], v[112:115]
  ds_read_b64_tr_b16 a[224:225], v32 offset:24576
  v_mfma_f32_16x16x32_bf16 v[116:119], a[168:171], a[68:71], v[116:119]
  ds_read_b64_tr_b16 a[226:227], v32 offset:25088
  v_mfma_f32_16x16x32_bf16 v[120:123], a[172:175], a[64:67], v[120:123]
  ds_read_b64_tr_b16 a[228:229], v33 offset:24576
  buffer_load_dwordx4 v10, s[40:43], s69 offen offset:2048 lds
  v_mfma_f32_16x16x32_bf16 v[124:127], a[172:175], a[68:71], v[124:127]
  ds_read_b64_tr_b16 a[230:231], v33 offset:25088
  v_mfma_f32_16x16x32_bf16 v[144:147], a[184:187], a[64:67], v[144:147]
  v_mfma_f32_16x16x32_bf16 v[148:151], a[184:187], a[68:71], v[148:151]
  v_mfma_f32_16x16x32_bf16 v[152:155], a[188:191], a[64:67], v[152:155]
  buffer_load_dwordx4 v11, s[40:43], s69 offen offset:3072 lds
  s_add_u32 s69, s69, 196608
  v_mfma_f32_16x16x32_bf16 v[156:159], a[188:191], a[68:71], v[156:159]
  s_waitcnt vmcnt(8) lgkmcnt(0)
  s_barrier
  s_cmp_eq_u32 s91, 3
  s_cselect_b32 s69, s94, s69
  v_mfma_f32_16x16x32_bf16 v[96:99], a[200:203], a[72:75], v[96:99]
  ds_read_b128 a[80:83], v18 offset:36864
  ds_read_b128 a[84:87], v18 offset:37376
  v_mfma_f32_16x16x32_bf16 v[100:103], a[200:203], a[76:79], v[100:103]
  ds_read_b64_tr_b16 a[160:161], v26 offset:53248
  s_add_u32 m0, s66, 110592
  v_mfma_f32_16x16x32_bf16 v[104:107], a[204:207], a[72:75], v[104:107]
  ds_read_b64_tr_b16 a[162:163], v26 offset:53760
  ds_read_b64_tr_b16 a[164:165], v27 offset:53248
  v_mfma_f32_16x16x32_bf16 v[108:111], a[204:207], a[76:79], v[108:111]
  ds_read_b64_tr_b16 a[166:167], v27 offset:53760
  buffer_load_dwordx4 v4, s[12:15], s68 offen offset:0 lds
  v_mfma_f32_16x16x32_bf16 v[128:131], a[216:219], a[72:75], v[128:131]
  ds_read_b64_tr_b16 a[176:177], v26 offset:61440
  ds_read_b64_tr_b16 a[178:179], v26 offset:61952
  v_mfma_f32_16x16x32_bf16 v[132:135], a[216:219], a[76:79], v[132:135]
  ds_read_b64_tr_b16 a[180:181], v27 offset:61440
  buffer_load_dwordx4 v5, s[12:15], s68 offen offset:1024 lds
  v_mfma_f32_16x16x32_bf16 v[136:139], a[220:223], a[72:75], v[136:139]
  ds_read_b64_tr_b16 a[182:183], v27 offset:61952
  ds_read_b64_tr_b16 a[168:169], v28 offset:53248
  v_mfma_f32_16x16x32_bf16 v[140:143], a[220:223], a[76:79], v[140:143]
  ds_read_b64_tr_b16 a[170:171], v28 offset:53760
  v_mfma_f32_16x16x32_bf16 v[112:115], a[208:211], a[72:75], v[112:115]
  ds_read_b64_tr_b16 a[172:173], v29 offset:53248
  ds_read_b64_tr_b16 a[174:175], v29 offset:53760
  v_mfma_f32_16x16x32_bf16 v[116:119], a[208:211], a[76:79], v[116:119]
  ds_read_b64_tr_b16 a[184:185], v28 offset:61440
  buffer_load_dwordx4 v6, s[12:15], s68 offen offset:2048 lds
  v_mfma_f32_16x16x32_bf16 v[120:123], a[212:215], a[72:75], v[120:123]
  ds_read_b64_tr_b16 a[186:187], v28 offset:61952
  ds_read_b64_tr_b16 a[188:189], v29 offset:61440
  v_mfma_f32_16x16x32_bf16 v[124:127], a[212:215], a[76:79], v[124:127]
  ds_read_b64_tr_b16 a[190:191], v29 offset:61952
  v_mfma_f32_16x16x32_bf16 v[144:147], a[224:227], a[72:75], v[144:147]
  buffer_load_dwordx4 v7, s[12:15], s68 offen offset:3072 lds
  s_add_u32 s68, s68, 128
  v_mfma_f32_16x16x32_bf16 v[148:151], a[224:227], a[76:79], v[148:151]
  s_cmp_eq_u32 s91, 2
  s_cselect_b32 s68, s93, s68
  v_mfma_f32_16x16x32_bf16 v[152:155], a[228:231], a[72:75], v[152:155]
  s_add_u32 m0, s66, 126976
  v_mfma_f32_16x16x32_bf16 v[156:159], a[228:231], a[76:79], v[156:159]
  s_waitcnt lgkmcnt(0)
  v_mfma_f32_16x16x32_bf16 v[96:99], a[160:163], a[80:83], v[96:99]
  ds_read_b128 a[88:91], v19 offset:36864
  ds_read_b128 a[92:95], v19 offset:37376
  v_mfma_f32_16x16x32_bf16 v[100:103], a[160:163], a[84:87], v[100:103]
  ds_read_b64_tr_b16 a[200:201], v30 offset:53248
  buffer_load_dwordx4 v8, s[40:43], s69 offen offset:0 lds
  v_mfma_f32_16x16x32_bf16 v[160:163], a[240:243], a[160:163], v[160:163]
  ds_read_b64_tr_b16 a[202:203], v30 offset:53760
  v_mfma_f32_16x16x32_bf16 v[104:107], a[164:167], a[80:83], v[104:107]
  ds_read_b64_tr_b16 a[204:205], v31 offset:53248
  buffer_load_dwordx4 v9, s[40:43], s69 offen offset:1024 lds
  v_mfma_f32_16x16x32_bf16 v[108:111], a[164:167], a[84:87], v[108:111]
  ds_read_b64_tr_b16 a[206:207], v31 offset:53760
  v_mfma_f32_16x16x32_bf16 v[160:163], a[244:247], a[164:167], v[160:163]
  ds_read_b64_tr_b16 a[216:217], v30 offset:61440
  v_mfma_f32_16x16x32_bf16 v[128:131], a[176:179], a[80:83], v[128:131]
  ds_read_b64_tr_b16 a[218:219], v30 offset:61952
  v_mfma_f32_16x16x32_bf16 v[132:135], a[176:179], a[84:87], v[132:135]
  ds_read_b64_tr_b16 a[220:221], v31 offset:61440
  buffer_load_dwordx4 v10, s[40:43], s69 offen offset:2048 lds
  v_mfma_f32_16x16x32_bf16 v[160:163], a[248:251], a[176:179], v[160:163]
  ds_read_b64_tr_b16 a[222:223], v31 offset:61952
  ds_read_b64_tr_b16 a[208:209], v32 offset:53248
  v_mfma_f32_16x16x32_bf16 v[136:139], a[180:183], a[80:83], v[136:139]
  ds_read_b64_tr_b16 a[210:211], v32 offset:53760
  v_mfma_f32_16x16x32_bf16 v[140:143], a[180:183], a[84:87], v[140:143]
  ds_read_b64_tr_b16 a[212:213], v33 offset:53248
  buffer_load_dwordx4 v11, s[40:43], s69 offen offset:3072 lds
  v_mfma_f32_16x16x32_bf16 v[160:163], a[252:255], a[180:183], v[160:163]
  ds_read_b64_tr_b16 a[214:215], v33 offset:53760
  s_add_u32 s69, s69, 196608
  v_mfma_f32_16x16x32_bf16 v[112:115], a[168:171], a[80:83], v[112:115]
  ds_read_b64_tr_b16 a[224:225], v32 offset:61440
  s_cmp_eq_u32 s91, 2
  s_cselect_b32 s69, s94, s69
  v_mfma_f32_16x16x32_bf16 v[116:119], a[168:171], a[84:87], v[116:119]
  ds_read_b64_tr_b16 a[226:227], v32 offset:61952
  s_add_u32 m0, s66, 0
  v_mfma_f32_16x16x32_bf16 v[120:123], a[172:175], a[80:83], v[120:123]
  ds_read_b64_tr_b16 a[228:229], v33 offset:61440
  buffer_load_dwordx4 v4, s[12:15], s68 offen offset:0 lds
  v_mfma_f32_16x16x32_bf16 v[124:127], a[172:175], a[84:87], v[124:127]
  ds_read_b64_tr_b16 a[230:231], v33 offset:61952
  v_mfma_f32_16x16x32_bf16 v[144:147], a[184:187], a[80:83], v[144:147]
  v_mfma_f32_16x16x32_bf16 v[148:151], a[184:187], a[84:87], v[148:151]
  buffer_load_dwordx4 v5, s[12:15], s68 offen offset:1024 lds
  v_mfma_f32_16x16x32_bf16 v[152:155], a[188:191], a[80:83], v[152:155]
  v_mfma_f32_16x16x32_bf16 v[156:159], a[188:191], a[84:87], v[156:159]
  s_waitcnt vmcnt(10) lgkmcnt(0)
  s_barrier
  v_mfma_f32_16x16x32_bf16 v[96:99], a[200:203], a[88:91], v[96:99]
  ds_read_b128 a[96:99], v20 offset:0
  ds_read_b128 a[100:103], v20 offset:512
  v_mfma_f32_16x16x32_bf16 v[100:103], a[200:203], a[92:95], v[100:103]
  ds_read_b64_tr_b16 a[160:161], v34 offset:16384
  buffer_load_dwordx4 v6, s[12:15], s68 offen offset:2048 lds
  v_mfma_f32_16x16x32_bf16 v[104:107], a[204:207], a[88:91], v[104:107]
  ds_read_b64_tr_b16 a[162:163], v34 offset:16896
  ds_read_b64_tr_b16 a[164:165], v35 offset:16384
  v_mfma_f32_16x16x32_bf16 v[108:111], a[204:207], a[92:95], v[108:111]
  ds_read_b64_tr_b16 a[166:167], v35 offset:16896
  v_mfma_f32_16x16x32_bf16 v[128:131], a[216:219], a[88:91], v[128:131]
  ds_read_b64_tr_b16 a[176:177], v34 offset:24576
  ds_read_b64_tr_b16 a[178:179], v34 offset:25088
  v_mfma_f32_16x16x32_bf16 v[132:135], a[216:219], a[92:95], v[132:135]
  ds_read_b64_tr_b16 a[180:181], v35 offset:24576
  buffer_load_dwordx4 v7, s[12:15], s68 offen offset:3072 lds
  v_mfma_f32_16x16x32_bf16 v[136:139], a[220:223], a[88:91], v[136:139]
  ds_read_b64_tr_b16 a[182:183], v35 offset:25088
  ds_read_b64_tr_b16 a[168:169], v36 offset:16384
  v_mfma_f32_16x16x32_bf16 v[140:143], a[220:223], a[92:95], v[140:143]
  ds_read_b64_tr_b16 a[170:171], v36 offset:16896
  s_add_u32 s68, s68, 128
  v_mfma_f32_16x16x32_bf16 v[112:115], a[208:211], a[88:91], v[112:115]
  ds_read_b64_tr_b16 a[172:173], v37 offset:16384
  ds_read_b64_tr_b16 a[174:175], v37 offset:16896
  v_mfma_f32_16x16x32_bf16 v[116:119], a[208:211], a[92:95], v[116:119]
  ds_read_b64_tr_b16 a[184:185], v36 offset:24576
  s_cmp_eq_u32 s91, 1
  s_cselect_b32 s68, s93, s68
  v_mfma_f32_16x16x32_bf16 v[120:123], a[212:215], a[88:91], v[120:123]
  ds_read_b64_tr_b16 a[186:187], v36 offset:25088
  ds_read_b64_tr_b16 a[188:189], v37 offset:24576
  v_mfma_f32_16x16x32_bf16 v[124:127], a[212:215], a[92:95], v[124:127]
  ds_read_b64_tr_b16 a[190:191], v37 offset:25088
  s_add_u32 m0, s66, 16384
  v_mfma_f32_16x16x32_bf16 v[144:147], a[224:227], a[88:91], v[144:147]
  buffer_load_dwordx4 v8, s[40:43], s69 offen offset:0 lds
  buffer_load_dwordx4 v9, s[40:43], s69 offen offset:1024 lds
  v_mfma_f32_16x16x32_bf16 v[148:151], a[224:227], a[92:95], v[148:151]
  v_mfma_f32_16x16x32_bf16 v[152:155], a[228:231], a[88:91], v[152:155]
  v_mfma_f32_16x16x32_bf16 v[156:159], a[228:231], a[92:95], v[156:159]
  s_waitcnt lgkmcnt(0)
  v_mfma_f32_16x16x32_bf16 v[96:99], a[160:163], a[96:99], v[96:99]
  ds_read_b128 a[104:107], v21 offset:0
  ds_read_b128 a[108:111], v21 offset:512
  v_mfma_f32_16x16x32_bf16 v[100:103], a[160:163], a[100:103], v[100:103]
  ds_read_b64_tr_b16 a[200:201], v38 offset:16384
  buffer_load_dwordx4 v10, s[40:43], s69 offen offset:2048 lds
  v_mfma_f32_16x16x32_bf16 v[160:163], a[240:243], a[160:163], v[160:163]
  ds_read_b64_tr_b16 a[202:203], v38 offset:16896
  v_mfma_f32_16x16x32_bf16 v[104:107], a[164:167], a[96:99], v[104:107]
  ds_read_b64_tr_b16 a[204:205], v39 offset:16384
  v_mfma_f32_16x16x32_bf16 v[108:111], a[164:167], a[100:103], v[108:111]
  ds_read_b64_tr_b16 a[206:207], v39 offset:16896
  buffer_load_dwordx4 v11, s[40:43], s69 offen offset:3072 lds
  v_mfma_f32_16x16x32_bf16 v[160:163], a[244:247], a[164:167], v[160:163]
  ds_read_b64_tr_b16 a[216:217], v38 offset:24576
  s_add_u32 s69, s69, 196608
  v_mfma_f32_16x16x32_bf16 v[128:131], a[176:179], a[96:99], v[128:131]
  ds_read_b64_tr_b16 a[218:219], v38 offset:25088
  s_cmp_eq_u32 s91, 1
  s_cselect_b32 s69, s94, s69
  v_mfma_f32_16x16x32_bf16 v[132:135], a[176:179], a[100:103], v[132:135]
  ds_read_b64_tr_b16 a[220:221], v39 offset:24576
  s_add_u32 m0, s66, 36864
  v_mfma_f32_16x16x32_bf16 v[160:163], a[248:251], a[176:179], v[160:163]
  ds_read_b64_tr_b16 a[222:223], v39 offset:25088
  ds_read_b64_tr_b16 a[208:209], v40 offset:16384
  v_mfma_f32_16x16x32_bf16 v[136:139], a[180:183], a[96:99], v[136:139]
  ds_read_b64_tr_b16 a[210:211], v40 offset:16896
  buffer_load_dwordx4 v4, s[12:15], s68 offen offset:0 lds
  v_mfma_f32_16x16x32_bf16 v[140:143], a[180:183], a[100:103], v[140:143]
  ds_read_b64_tr_b16 a[212:213], v41 offset:16384
  v_mfma_f32_16x16x32_bf16 v[160:163], a[252:255], a[180:183], v[160:163]
  ds_read_b64_tr_b16 a[214:215], v41 offset:16896
  buffer_load_dwordx4 v5, s[12:15], s68 offen offset:1024 lds
  v_mfma_f32_16x16x32_bf16 v[112:115], a[168:171], a[96:99], v[112:115]
  ds_read_b64_tr_b16 a[224:225], v40 offset:24576
  v_mfma_f32_16x16x32_bf16 v[116:119], a[168:171], a[100:103], v[116:119]
  ds_read_b64_tr_b16 a[226:227], v40 offset:25088
  v_mfma_f32_16x16x32_bf16 v[120:123], a[172:175], a[96:99], v[120:123]
  ds_read_b64_tr_b16 a[228:229], v41 offset:24576
  buffer_load_dwordx4 v6, s[12:15], s68 offen offset:2048 lds
  v_mfma_f32_16x16x32_bf16 v[124:127], a[172:175], a[100:103], v[124:127]
  ds_read_b64_tr_b16 a[230:231], v41 offset:25088
  v_mfma_f32_16x16x32_bf16 v[144:147], a[184:187], a[96:99], v[144:147]
  v_mfma_f32_16x16x32_bf16 v[148:151], a[184:187], a[100:103], v[148:151]
  v_mfma_f32_16x16x32_bf16 v[152:155], a[188:191], a[96:99], v[152:155]
  buffer_load_dwordx4 v7, s[12:15], s68 offen offset:3072 lds
  s_add_u32 s68, s68, 128
  v_mfma_f32_16x16x32_bf16 v[156:159], a[188:191], a[100:103], v[156:159]
  s_waitcnt vmcnt(12) lgkmcnt(0)
  s_barrier
  s_add_u32 m0, s66, 53248
  v_mfma_f32_16x16x32_bf16 v[96:99], a[200:203], a[104:107], v[96:99]
  ds_read_b128 a[112:115], v20 offset:36864
  ds_read_b128 a[116:119], v20 offset:37376
  v_mfma_f32_16x16x32_bf16 v[100:103], a[200:203], a[108:111], v[100:103]
  ds_read_b64_tr_b16 a[160:161], v34 offset:53248
  buffer_load_dwordx4 v8, s[40:43], s69 offen offset:0 lds
  v_mfma_f32_16x16x32_bf16 v[104:107], a[204:207], a[104:107], v[104:107]
  ds_read_b64_tr_b16 a[162:163], v34 offset:53760
  ds_read_b64_tr_b16 a[164:165], v35 offset:53248
  v_mfma_f32_16x16x32_bf16 v[108:111], a[204:207], a[108:111], v[108:111]
  ds_read_b64_tr_b16 a[166:167], v35 offset:53760
  v_mfma_f32_16x16x32_bf16 v[128:131], a[216:219], a[104:107], v[128:131]
  ds_read_b64_tr_b16 a[176:177], v34 offset:61440
  ds_read_b64_tr_b16 a[178:179], v34 offset:61952
  v_mfma_f32_16x16x32_bf16 v[132:135], a[216:219], a[108:111], v[132:135]
  ds_read_b64_tr_b16 a[180:181], v35 offset:61440
  buffer_load_dwordx4 v9, s[40:43], s69 offen offset:1024 lds
  v_mfma_f32_16x16x32_bf16 v[136:139], a[220:223], a[104:107], v[136:139]
  ds_read_b64_tr_b16 a[182:183], v35 offset:61952
  ds_read_b64_tr_b16 a[168:169], v36 offset:53248
  v_mfma_f32_16x16x32_bf16 v[140:143], a[220:223], a[108:111], v[140:143]
  ds_read_b64_tr_b16 a[170:171], v36 offset:53760
  v_mfma_f32_16x16x32_bf16 v[112:115], a[208:211], a[104:107], v[112:115]
  ds_read_b64_tr_b16 a[172:173], v37 offset:53248
  ds_read_b64_tr_b16 a[174:175], v37 offset:53760
  v_mfma_f32_16x16x32_bf16 v[116:119], a[208:211], a[108:111], v[116:119]
  ds_read_b64_tr_b16 a[184:185], v36 offset:61440
  buffer_load_dwordx4 v10, s[40:43], s69 offen offset:2048 lds
  v_mfma_f32_16x16x32_bf16 v[120:123], a[212:215], a[104:107], v[120:123]
  ds_read_b64_tr_b16 a[186:187], v36 offset:61952
  ds_read_b64_tr_b16 a[188:189], v37 offset:61440
  v_mfma_f32_16x16x32_bf16 v[124:127], a[212:215], a[108:111], v[124:127]
  ds_read_b64_tr_b16 a[190:191], v37 offset:61952
  v_mfma_f32_16x16x32_bf16 v[144:147], a[224:227], a[104:107], v[144:147]
  buffer_load_dwordx4 v11, s[40:43], s69 offen offset:3072 lds
  s_add_u32 s69, s69, 196608
  v_mfma_f32_16x16x32_bf16 v[148:151], a[224:227], a[108:111], v[148:151]
  v_mfma_f32_16x16x32_bf16 v[152:155], a[228:231], a[104:107], v[152:155]
  v_mfma_f32_16x16x32_bf16 v[156:159], a[228:231], a[108:111], v[156:159]
  s_waitcnt lgkmcnt(0)
  v_mfma_f32_16x16x32_bf16 v[96:99], a[160:163], a[112:115], v[96:99]
  ds_read_b128 a[120:123], v21 offset:36864
  ds_read_b128 a[124:127], v21 offset:37376
  v_mfma_f32_16x16x32_bf16 v[100:103], a[160:163], a[116:119], v[100:103]
  ds_read_b64_tr_b16 a[200:201], v38 offset:53248
  buffer_store_dword v71, v72, s[8:11], s36 offen sc1
  v_mfma_f32_16x16x32_bf16 v[160:163], a[240:243], a[160:163], v[160:163]
  ds_read_b64_tr_b16 a[202:203], v38 offset:53760
  v_mfma_f32_16x16x32_bf16 v[104:107], a[164:167], a[112:115], v[104:107]
  ds_read_b64_tr_b16 a[204:205], v39 offset:53248
  buffer_load_dwordx4 v[56:59], v75, s[8:11], s22 offen offset:0 sc1
  v_mfma_f32_16x16x32_bf16 v[108:111], a[164:167], a[116:119], v[108:111]
  ds_read_b64_tr_b16 a[206:207], v39 offset:53760
  buffer_load_dwordx4 v[60:63], v75, s[8:11], s22 offen offset:64 sc1
  v_mfma_f32_16x16x32_bf16 v[160:163], a[244:247], a[164:167], v[160:163]
  ds_read_b64_tr_b16 a[216:217], v38 offset:61440
  s_add_u32 m0, s66, 73728
  v_mfma_f32_16x16x32_bf16 v[128:131], a[176:179], a[112:115], v[128:131]
  ds_read_b64_tr_b16 a[218:219], v38 offset:61952
  buffer_load_dwordx4 v8, s[40:43], s71 offen offset:0 lds
  v_mfma_f32_16x16x32_bf16 v[132:135], a[176:179], a[116:119], v[132:135]
  ds_read_b64_tr_b16 a[220:221], v39 offset:61440
  buffer_load_dwordx4 v9, s[40:43], s71 offen offset:1024 lds
  v_mfma_f32_16x16x32_bf16 v[160:163], a[248:251], a[176:179], v[160:163]
  ds_read_b64_tr_b16 a[222:223], v39 offset:61952
  ds_read_b64_tr_b16 a[208:209], v40 offset:53248
  v_mfma_f32_16x16x32_bf16 v[136:139], a[180:183], a[112:115], v[136:139]
  ds_read_b64_tr_b16 a[210:211], v40 offset:53760
  v_mfma_f32_16x16x32_bf16 v[140:143], a[180:183], a[116:119], v[140:143]
  ds_read_b64_tr_b16 a[212:213], v41 offset:53248
  v_mfma_f32_16x16x32_bf16 v[160:163], a[252:255], a[180:183], v[160:163]
  ds_read_b64_tr_b16 a[214:215], v41 offset:53760
  buffer_load_dwordx4 v10, s[40:43], s71 offen offset:2048 lds
  v_mfma_f32_16x16x32_bf16 v[112:115], a[168:171], a[112:115], v[112:115]
  ds_read_b64_tr_b16 a[224:225], v40 offset:61440
  v_mfma_f32_16x16x32_bf16 v[116:119], a[168:171], a[116:119], v[116:119]
  ds_read_b64_tr_b16 a[226:227], v40 offset:61952
  v_mfma_f32_16x16x32_bf16 v[120:123], a[172:175], a[112:115], v[120:123]
  ds_read_b64_tr_b16 a[228:229], v41 offset:61440
  v_mfma_f32_16x16x32_bf16 v[124:127], a[172:175], a[116:119], v[124:127]
  ds_read_b64_tr_b16 a[230:231], v41 offset:61952
  buffer_load_dwordx4 v11, s[40:43], s71 offen offset:3072 lds
  v_mfma_f32_16x16x32_bf16 v[144:147], a[184:187], a[112:115], v[144:147]
  s_add_u32 s71, s71, 196608
  s_cmp_eq_u32 s91, 9
  s_cselect_b32 s71, s88, s71
  v_mfma_f32_16x16x32_bf16 v[148:151], a[184:187], a[116:119], v[148:151]
  s_add_u32 m0, s66, 90112
  v_mfma_f32_16x16x32_bf16 v[152:155], a[188:191], a[112:115], v[152:155]
  buffer_load_dwordx4 v8, s[40:43], s71 offen offset:0 lds
  v_mfma_f32_16x16x32_bf16 v[156:159], a[188:191], a[116:119], v[156:159]
  s_waitcnt vmcnt(16) lgkmcnt(0)
  s_barrier
  v_mfma_f32_16x16x32_bf16 v[96:99], a[200:203], a[120:123], v[96:99]
  ds_read_b128 a[128:131], v18 offset:0
  ds_read_b128 a[132:135], v18 offset:512
  v_mfma_f32_16x16x32_bf16 v[100:103], a[200:203], a[124:127], v[100:103]
  ds_read_b64_tr_b16 a[160:161], v26 offset:16384
  v_mfma_f32_16x16x32_bf16 v[104:107], a[204:207], a[120:123], v[104:107]
  ds_read_b64_tr_b16 a[162:163], v26 offset:16896
  ds_read_b64_tr_b16 a[164:165], v27 offset:16384
  v_mfma_f32_16x16x32_bf16 v[108:111], a[204:207], a[124:127], v[108:111]
  ds_read_b64_tr_b16 a[166:167], v27 offset:16896
  buffer_load_dwordx4 v9, s[40:43], s71 offen offset:1024 lds
  v_mfma_f32_16x16x32_bf16 v[128:131], a[216:219], a[120:123], v[128:131]
  ds_read_b64_tr_b16 a[176:177], v26 offset:24576
  ds_read_b64_tr_b16 a[178:179], v26 offset:25088
  v_mfma_f32_16x16x32_bf16 v[132:135], a[216:219], a[124:127], v[132:135]
  ds_read_b64_tr_b16 a[180:181], v27 offset:24576
  buffer_load_dwordx4 v10, s[40:43], s71 offen offset:2048 lds
  v_mfma_f32_16x16x32_bf16 v[136:139], a[220:223], a[120:123], v[136:139]
  ds_read_b64_tr_b16 a[182:183], v27 offset:25088
  ds_read_b64_tr_b16 a[168:169], v28 offset:16384
  v_mfma_f32_16x16x32_bf16 v[140:143], a[220:223], a[124:127], v[140:143]
  ds_read_b64_tr_b16 a[170:171], v28 offset:16896
  v_mfma_f32_16x16x32_bf16 v[112:115], a[208:211], a[120:123], v[112:115]
  ds_read_b64_tr_b16 a[172:173], v29 offset:16384
  ds_read_b64_tr_b16 a[174:175], v29 offset:16896
  v_mfma_f32_16x16x32_bf16 v[116:119], a[208:211], a[124:127], v[116:119]
  ds_read_b64_tr_b16 a[184:185], v28 offset:24576
  buffer_load_dwordx4 v11, s[40:43], s71 offen offset:3072 lds
  v_mfma_f32_16x16x32_bf16 v[120:123], a[212:215], a[120:123], v[120:123]
  ds_read_b64_tr_b16 a[186:187], v28 offset:25088
  ds_read_b64_tr_b16 a[188:189], v29 offset:24576
  v_mfma_f32_16x16x32_bf16 v[124:127], a[212:215], a[124:127], v[124:127]
  ds_read_b64_tr_b16 a[190:191], v29 offset:25088
  s_add_u32 s71, s71, 196608
  v_mfma_f32_16x16x32_bf16 v[144:147], a[224:227], a[120:123], v[144:147]
  s_cmp_eq_u32 s91, 8
  s_cselect_b32 s71, s88, s71
  v_mfma_f32_16x16x32_bf16 v[148:151], a[224:227], a[124:127], v[148:151]
  s_add_u32 m0, s66, 110592
  s_nop 0
  buffer_load_dwordx4 v8, s[40:43], s71 offen offset:0 lds
  v_mfma_f32_16x16x32_bf16 v[152:155], a[228:231], a[120:123], v[152:155]
  v_mfma_f32_16x16x32_bf16 v[156:159], a[228:231], a[124:127], v[156:159]
  s_waitcnt lgkmcnt(0)
  v_mfma_f32_16x16x32_bf16 v[96:99], a[160:163], a[128:131], v[96:99]
  ds_read_b128 a[136:139], v19 offset:0
  ds_read_b128 a[140:143], v19 offset:512
  v_mfma_f32_16x16x32_bf16 v[100:103], a[160:163], a[132:135], v[100:103]
  ds_read_b64_tr_b16 a[200:201], v30 offset:16384
  buffer_load_dwordx4 v9, s[40:43], s71 offen offset:1024 lds
  v_mfma_f32_16x16x32_bf16 v[160:163], a[240:243], a[160:163], v[160:163]
  ds_read_b64_tr_b16 a[202:203], v30 offset:16896
  v_mfma_f32_16x16x32_bf16 v[104:107], a[164:167], a[128:131], v[104:107]
  ds_read_b64_tr_b16 a[204:205], v31 offset:16384
  v_mfma_f32_16x16x32_bf16 v[108:111], a[164:167], a[132:135], v[108:111]
  ds_read_b64_tr_b16 a[206:207], v31 offset:16896
  buffer_load_dwordx4 v10, s[40:43], s71 offen offset:2048 lds
  v_mfma_f32_16x16x32_bf16 v[160:163], a[244:247], a[164:167], v[160:163]
  ds_read_b64_tr_b16 a[216:217], v30 offset:24576
  v_mfma_f32_16x16x32_bf16 v[128:131], a[176:179], a[128:131], v[128:131]
  ds_read_b64_tr_b16 a[218:219], v30 offset:25088
  v_mfma_f32_16x16x32_bf16 v[132:135], a[176:179], a[132:135], v[132:135]
  ds_read_b64_tr_b16 a[220:221], v31 offset:24576
  buffer_load_dwordx4 v11, s[40:43], s71 offen offset:3072 lds
  v_mfma_f32_16x16x32_bf16 v[160:163], a[248:251], a[176:179], v[160:163]
  ds_read_b64_tr_b16 a[222:223], v31 offset:25088
  ds_read_b64_tr_b16 a[208:209], v32 offset:16384
  v_mfma_f32_16x16x32_bf16 v[136:139], a[180:183], a[128:131], v[136:139]
  ds_read_b64_tr_b16 a[210:211], v32 offset:16896
  s_add_u32 s71, s71, 196608
  v_mfma_f32_16x16x32_bf16 v[140:143], a[180:183], a[132:135], v[140:143]
  ds_read_b64_tr_b16 a[212:213], v33 offset:16384
  s_cmp_eq_u32 s91, 7
  s_cselect_b32 s71, s88, s71
  v_mfma_f32_16x16x32_bf16 v[160:163], a[252:255], a[180:183], v[160:163]
  ds_read_b64_tr_b16 a[214:215], v33 offset:16896
  s_add_u32 m0, s66, 126976
  v_mfma_f32_16x16x32_bf16 v[112:115], a[168:171], a[128:131], v[112:115]
  ds_read_b64_tr_b16 a[224:225], v32 offset:24576
  buffer_load_dwordx4 v8, s[40:43], s71 offen offset:0 lds
  v_mfma_f32_16x16x32_bf16 v[116:119], a[168:171], a[132:135], v[116:119]
  ds_read_b64_tr_b16 a[226:227], v32 offset:25088
  v_mfma_f32_16x16x32_bf16 v[120:123], a[172:175], a[128:131], v[120:123]
  ds_read_b64_tr_b16 a[228:229], v33 offset:24576
  buffer_load_dwordx4 v9, s[40:43], s71 offen offset:1024 lds
  v_mfma_f32_16x16x32_bf16 v[124:127], a[172:175], a[132:135], v[124:127]
  ds_read_b64_tr_b16 a[230:231], v33 offset:25088
  v_mfma_f32_16x16x32_bf16 v[144:147], a[184:187], a[128:131], v[144:147]
  v_mfma_f32_16x16x32_bf16 v[148:151], a[184:187], a[132:135], v[148:151]
  v_mfma_f32_16x16x32_bf16 v[152:155], a[188:191], a[128:131], v[152:155]
  buffer_load_dwordx4 v10, s[40:43], s71 offen offset:2048 lds
  v_mfma_f32_16x16x32_bf16 v[156:159], a[188:191], a[132:135], v[156:159]
  s_waitcnt vmcnt(18) lgkmcnt(0)
  s_barrier
  v_mfma_f32_16x16x32_bf16 v[96:99], a[200:203], a[136:139], v[96:99]
  ds_read_b128 a[144:147], v18 offset:36864
  ds_read_b128 a[148:151], v18 offset:37376
  v_mfma_f32_16x16x32_bf16 v[100:103], a[200:203], a[140:143], v[100:103]
  ds_read_b64_tr_b16 a[160:161], v26 offset:53248
  buffer_load_dwordx4 v11, s[40:43], s71 offen offset:3072 lds
  v_mfma_f32_16x16x32_bf16 v[104:107], a[204:207], a[136:139], v[104:107]
  ds_read_b64_tr_b16 a[162:163], v26 offset:53760
  ds_read_b64_tr_b16 a[164:165], v27 offset:53248
  v_mfma_f32_16x16x32_bf16 v[108:111], a[204:207], a[140:143], v[108:111]
  ds_read_b64_tr_b16 a[166:167], v27 offset:53760
  s_add_u32 s71, s71, 196608
  v_mfma_f32_16x16x32_bf16 v[128:131], a[216:219], a[136:139], v[128:131]
  ds_read_b64_tr_b16 a[176:177], v26 offset:61440
  ds_read_b64_tr_b16 a[178:179], v26 offset:61952
  v_mfma_f32_16x16x32_bf16 v[132:135], a[216:219], a[140:143], v[132:135]
  ds_read_b64_tr_b16 a[180:181], v27 offset:61440
  s_cmp_eq_u32 s91, 6
  s_cselect_b32 s71, s88, s71
  v_mfma_f32_16x16x32_bf16 v[136:139], a[220:223], a[136:139], v[136:139]
  ds_read_b64_tr_b16 a[182:183], v27 offset:61952
  ds_read_b64_tr_b16 a[168:169], v28 offset:53248
  v_mfma_f32_16x16x32_bf16 v[140:143], a[220:223], a[140:143], v[140:143]
  ds_read_b64_tr_b16 a[170:171], v28 offset:53760
  s_add_u32 m0, s66, 0
  v_mfma_f32_16x16x32_bf16 v[112:115], a[208:211], a[136:139], v[112:115]
  ds_read_b64_tr_b16 a[172:173], v29 offset:53248
  ds_read_b64_tr_b16 a[174:175], v29 offset:53760
  v_mfma_f32_16x16x32_bf16 v[116:119], a[208:211], a[140:143], v[116:119]
  ds_read_b64_tr_b16 a[184:185], v28 offset:61440
  buffer_load_dwordx4 v8, s[40:43], s71 offen offset:0 lds
  v_mfma_f32_16x16x32_bf16 v[120:123], a[212:215], a[136:139], v[120:123]
  ds_read_b64_tr_b16 a[186:187], v28 offset:61952
  ds_read_b64_tr_b16 a[188:189], v29 offset:61440
  v_mfma_f32_16x16x32_bf16 v[124:127], a[212:215], a[140:143], v[124:127]
  ds_read_b64_tr_b16 a[190:191], v29 offset:61952
  buffer_load_dwordx4 v9, s[40:43], s71 offen offset:1024 lds
  v_mfma_f32_16x16x32_bf16 v[144:147], a[224:227], a[136:139], v[144:147]
  v_mfma_f32_16x16x32_bf16 v[148:151], a[224:227], a[140:143], v[148:151]
  buffer_load_dwordx4 v10, s[40:43], s71 offen offset:2048 lds
  v_mfma_f32_16x16x32_bf16 v[152:155], a[228:231], a[136:139], v[152:155]
  v_mfma_f32_16x16x32_bf16 v[156:159], a[228:231], a[140:143], v[156:159]
  s_waitcnt lgkmcnt(0)
  v_mfma_f32_16x16x32_bf16 v[96:99], a[160:163], a[144:147], v[96:99]
  ds_read_b128 a[152:155], v19 offset:36864
  ds_read_b128 a[156:159], v19 offset:37376
  v_mfma_f32_16x16x32_bf16 v[100:103], a[160:163], a[148:151], v[100:103]
  ds_read_b64_tr_b16 a[200:201], v30 offset:53248
  buffer_load_dwordx4 v11, s[40:43], s71 offen offset:3072 lds
  v_mfma_f32_16x16x32_bf16 v[160:163], a[240:243], a[160:163], v[160:163]
  ds_read_b64_tr_b16 a[202:203], v30 offset:53760
  s_add_u32 s71, s71, 196608
  v_mfma_f32_16x16x32_bf16 v[104:107], a[164:167], a[144:147], v[104:107]
  ds_read_b64_tr_b16 a[204:205], v31 offset:53248
  s_cmp_eq_u32 s91, 5
  s_cselect_b32 s71, s88, s71
  v_mfma_f32_16x16x32_bf16 v[108:111], a[164:167], a[148:151], v[108:111]
  ds_read_b64_tr_b16 a[206:207], v31 offset:53760
  s_waitcnt vmcnt(20)
  v_xor_b32 v73, s64, v59
  v_mfma_f32_16x16x32_bf16 v[160:163], a[244:247], a[164:167], v[160:163]
  ds_read_b64_tr_b16 a[216:217], v30 offset:61440
  v_xad_u32 v73, v63, s64, v73
  v_mfma_f32_16x16x32_bf16 v[128:131], a[176:179], a[144:147], v[128:131]
  ds_read_b64_tr_b16 a[218:219], v30 offset:61952
  v_cmp_ne_u32 vcc, 0, v73
  s_cbranch_vccnz E_slow1
E_ok1:
  v_mfma_f32_16x16x32_bf16 v[132:135], a[176:179], a[148:151], v[132:135]
  ds_read_b64_tr_b16 a[220:221], v31 offset:61440
  s_add_u32 m0, s66, 16384
  v_mfma_f32_16x16x32_bf16 v[160:163], a[248:251], a[176:179], v[160:163]
  ds_read_b64_tr_b16 a[222:223], v31 offset:61952
  ds_read_b64_tr_b16 a[208:209], v32 offset:53248
  v_mfma_f32_16x16x32_bf16 v[136:139], a[180:183], a[144:147], v[136:139]
  ds_read_b64_tr_b16 a[210:211], v32 offset:53760
  buffer_load_dwordx4 v8, s[40:43], s71 offen offset:0 lds
  v_mul_f32 v64, 0x3e800000, v56
  v_mfma_f32_16x16x32_bf16 v[140:143], a[180:183], a[148:151], v[140:143]
  ds_read_b64_tr_b16 a[212:213], v33 offset:53248
  buffer_load_dwordx4 v9, s[40:43], s71 offen offset:1024 lds
  v_mul_f32 v59, v57, v57
  v_mfma_f32_16x16x32_bf16 v[160:163], a[252:255], a[180:183], v[160:163]
  ds_read_b64_tr_b16 a[214:215], v33 offset:53760
  v_cvt_pk_bf16_f32 v64, v64, v64
  v_mul_f32 v57, 0xc0135761, v57
  v_mfma_f32_16x16x32_bf16 v[112:115], a[168:171], a[144:147], v[112:115]
  ds_read_b64_tr_b16 a[224:225], v32 offset:61440
  v_mul_f32 v59, 0x3d372713, v59
  v_mov_b32 v65, v64
  v_mfma_f32_16x16x32_bf16 v[116:119], a[168:171], a[148:151], v[116:119]
  ds_read_b64_tr_b16 a[226:227], v32 offset:61952
  v_cvt_pk_bf16_f32 v161, v160, v160
  v_mul_f32 v59, v59, v57
  v_mfma_f32_16x16x32_bf16 v[120:123], a[172:175], a[144:147], v[120:123]
  ds_read_b64_tr_b16 a[228:229], v33 offset:61440
  v_and_b32 v161, 0xffff0000, v161
  v_mul_f32 v66, 0x3e800000, v60
  v_mfma_f32_16x16x32_bf16 v[124:127], a[172:175], a[148:151], v[124:127]
  ds_read_b64_tr_b16 a[230:231], v33 offset:61952
  v_sub_f32 v161, v160, v161
  v_mul_f32 v63, v61, v61
  v_mfma_f32_16x16x32_bf16 v[144:147], a[184:187], a[144:147], v[144:147]
  v_cvt_pk_bf16_f32 v161, v160, v161
  ds_write_b32 v68, v161 offset:0
  v_cvt_pk_bf16_f32 v66, v66, v66
  v_mfma_f32_16x16x32_bf16 v[148:151], a[184:187], a[148:151], v[148:151]
  buffer_load_dwordx4 v10, s[40:43], s71 offen offset:2048 lds
  buffer_load_dwordx4 v11, s[40:43], s71 offen offset:3072 lds
  v_mul_f32 v61, 0xc0135761, v61
  v_mfma_f32_16x16x32_bf16 v[152:155], a[188:191], a[144:147], v[152:155]
  s_add_u32 s71, s71, 196608
  s_cmp_eq_u32 s91, 4
  s_cselect_b32 s71, s88, s71
  v_mfma_f32_16x16x32_bf16 v[156:159], a[188:191], a[148:151], v[156:159]
  s_waitcnt vmcnt(16) lgkmcnt(0)
  s_barrier
  v_mul_f32 v63, 0x3d372713, v63
  v_mov_b32 v67, v66
  v_mfma_f32_16x16x32_bf16 v[96:99], a[200:203], a[152:155], v[96:99]
  ds_read_b128 v[240:243], v69 offset:0
  v_mul_f32 v63, v63, v61
  v_mfma_f32_16x16x32_bf16 v[100:103], a[200:203], a[156:159], v[100:103]
  ds_read_b128 v[244:247], v69 offset:512
  buffer_load_dword v73, v90, s[8:11], s32 offen sc1
  v_mfma_f32_16x16x32_bf16 v[104:107], a[204:207], a[152:155], v[104:107]
  ds_read_b128 v[248:251], v70 offset:0
  s_add_u32 m0, s66, 36864
  v_mfma_f32_16x16x32_bf16 v[108:111], a[204:207], a[156:159], v[108:111]
  ds_read_b128 v[252:255], v70 offset:512
  v_mfma_f32_16x16x32_bf16 v[128:131], a[216:219], a[152:155], v[128:131]
  ds_read_b64_tr_b16 a[160:161], v34 offset:0
  buffer_load_dwordx4 v8, s[40:43], s71 offen offset:0 lds
  v_mfma_f32_16x16x32_bf16 v[132:135], a[216:219], a[156:159], v[132:135]
  ds_read_b64_tr_b16 a[162:163], v34 offset:512
  v_mfma_f32_16x16x32_bf16 v[136:139], a[220:223], a[152:155], v[136:139]
  ds_read_b64_tr_b16 a[164:165], v35 offset:0
  buffer_load_dwordx4 v9, s[40:43], s71 offen offset:1024 lds
  v_mfma_f32_16x16x32_bf16 v[140:143], a[220:223], a[156:159], v[140:143]
  ds_read_b64_tr_b16 a[166:167], v35 offset:512
  v_mfma_f32_16x16x32_bf16 v[112:115], a[208:211], a[152:155], v[112:115]
  ds_read_b64_tr_b16 a[176:177], v34 offset:8192
  v_mfma_f32_16x16x32_bf16 v[116:119], a[208:211], a[156:159], v[116:119]
  ds_read_b64_tr_b16 a[178:179], v34 offset:8704
  v_mfma_f32_16x16x32_bf16 v[120:123], a[212:215], a[152:155], v[120:123]
  ds_read_b64_tr_b16 a[180:181], v35 offset:8192
  buffer_load_dwordx4 v10, s[40:43], s71 offen offset:2048 lds
  v_mfma_f32_16x16x32_bf16 v[124:127], a[212:215], a[156:159], v[124:127]
  ds_read_b64_tr_b16 a[182:183], v35 offset:8704
  v_mfma_f32_16x16x32_bf16 v[144:147], a[224:227], a[152:155], v[144:147]
  ds_read_b64_tr_b16 a[168:169], v36 offset:0
  v_mfma_f32_16x16x32_bf16 v[148:151], a[224:227], a[156:159], v[148:151]
  ds_read_b64_tr_b16 a[170:171], v36 offset:512
  buffer_load_dwordx4 v11, s[40:43], s71 offen offset:3072 lds
  v_mfma_f32_16x16x32_bf16 v[152:155], a[228:231], a[152:155], v[152:155]
  ds_read_b64_tr_b16 a[172:173], v37 offset:0
  s_add_u32 s71, s71, 196608
  v_mfma_f32_16x16x32_bf16 v[156:159], a[228:231], a[156:159], v[156:159]
  ds_read_b64_tr_b16 a[174:175], v37 offset:512
  s_cmp_eq_u32 s91, 3
  s_cselect_b32 s71, s88, s71
  s_waitcnt lgkmcnt(15)
  v_mfma_f32_16x16x16_bf16 v[96:99], v[240:241], v[64:65], v[96:99]
  ds_read_b64_tr_b16 a[184:185], v36 offset:8192
  s_waitcnt lgkmcnt(15)
  v_mfma_f32_16x16x16_bf16 v[128:131], v[244:245], v[64:65], v[128:131]
  ds_read_b64_tr_b16 a[186:187], v36 offset:8704
  buffer_load_dwordx2 v[4:5], v74, s[12:15], s80 offen offset:0
  v_mfma_f32_16x16x16_bf16 v[104:107], v[242:243], v[64:65], v[104:107]
  ds_read_b64_tr_b16 a[188:189], v37 offset:8192
  v_mfma_f32_16x16x16_bf16 v[136:139], v[246:247], v[64:65], v[136:139]
  ds_read_b64_tr_b16 a[190:191], v37 offset:8704
  v_mfma_f32_16x16x16_bf16 v[100:103], v[240:241], v[66:67], v[100:103]
  v_mul_f32 v80, v96, v96
  v_mul_f32 v128, v96, v128
  v_mfma_f32_16x16x16_bf16 v[132:135], v[244:245], v[66:67], v[132:135]
  v_fma_f32 v80, v80, v59, v57
  v_mul_f32 v96, v80, v96
  v_mfma_f32_16x16x16_bf16 v[108:111], v[242:243], v[66:67], v[108:111]
  v_exp_f32 v96, v96
  v_mfma_f32_16x16x16_bf16 v[140:143], v[246:247], v[66:67], v[140:143]
  v_mul_f32 v81, v97, v97
  v_mul_f32 v129, v97, v129
  v_fma_f32 v81, v81, v59, v57
  s_waitcnt lgkmcnt(15)
  v_mfma_f32_16x16x16_bf16 v[112:115], v[248:249], v[64:65], v[112:115]
  buffer_load_dwordx2 v[6:7], v74, s[12:15], s80 offen offset:32
  v_mul_f32 v97, v81, v97
  v_mfma_f32_16x16x16_bf16 v[144:147], v[252:253], v[64:65], v[144:147]
  v_exp_f32 v97, v97
  v_mfma_f32_16x16x16_bf16 v[120:123], v[250:251], v[64:65], v[120:123]
  v_mul_f32 v82, v98, v98
  v_mul_f32 v130, v98, v130
  v_mfma_f32_16x16x16_bf16 v[152:155], v[254:255], v[64:65], v[152:155]
  v_fma_f32 v82, v82, v59, v57
  v_mul_f32 v98, v82, v98
  v_mfma_f32_16x16x16_bf16 v[116:119], v[248:249], v[66:67], v[116:119]
  v_exp_f32 v98, v98
  v_mfma_f32_16x16x16_bf16 v[148:151], v[252:253], v[66:67], v[148:151]
  v_mul_f32 v83, v99, v99
  v_mul_f32 v131, v99, v131
  v_fma_f32 v83, v83, v59, v57
  v_mfma_f32_16x16x16_bf16 v[124:127], v[250:251], v[66:67], v[124:127]
  v_mul_f32 v99, v83, v99
  v_fma_f32 v96, v96, v58, v58
  v_mfma_f32_16x16x16_bf16 v[156:159], v[254:255], v[66:67], v[156:159]
  s_waitcnt lgkmcnt(0)
  buffer_load_dwordx2 v[12:13], v74, s[12:15], s80 offen offset:64
  v_mfma_f32_16x16x32_bf16 v[176:179], a[160:163], a[0:3], 0
  ds_read_b64_tr_b16 a[200:201], v38 offset:0
  v_fma_f32 v97, v97, v58, v58
  v_mfma_f32_16x16x32_bf16 v[180:183], a[160:163], a[4:7], 0
  ds_read_b64_tr_b16 a[202:203], v38 offset:512
  v_fma_f32 v98, v98, v58, v58
  v_mfma_f32_16x16x32_bf16 v[160:163], a[240:243], a[160:163], 0
  ds_read_b64_tr_b16 a[204:205], v39 offset:0
  v_mul_f32 v80, v104, v104
  v_mfma_f32_16x16x32_bf16 v[184:187], a[164:167], a[0:3], 0
  ds_read_b64_tr_b16 a[206:207], v39 offset:512
  v_mul_f32 v136, v104, v136
  v_mfma_f32_16x16x32_bf16 v[188:191], a[164:167], a[4:7], 0
  ds_read_b64_tr_b16 a[216:217], v38 offset:8192
  v_exp_f32 v99, v99
  v_mfma_f32_16x16x32_bf16 v[160:163], a[244:247], a[164:167], v[160:163]
  ds_read_b64_tr_b16 a[218:219], v38 offset:8704
  v_fma_f32 v99, v99, v58, v58
  v_mfma_f32_16x16x32_bf16 v[208:211], a[176:179], a[0:3], 0
  ds_read_b64_tr_b16 a[220:221], v39 offset:8192
  buffer_load_dwordx2 v[14:15], v74, s[12:15], s80 offen offset:96
  v_mfma_f32_16x16x32_bf16 v[212:215], a[176:179], a[4:7], 0
  ds_read_b64_tr_b16 a[222:223], v39 offset:8704
  v_fma_f32 v80, v80, v59, v57
  v_mfma_f32_16x16x32_bf16 v[160:163], a[248:251], a[176:179], v[160:163]
  ds_read_b64_tr_b16 a[208:209], v40 offset:0
  v_mul_f32 v104, v80, v104
  v_mfma_f32_16x16x32_bf16 v[216:219], a[180:183], a[0:3], 0
  ds_read_b64_tr_b16 a[210:211], v40 offset:512
  v_mul_f32 v81, v105, v105
  v_mfma_f32_16x16x32_bf16 v[220:223], a[180:183], a[4:7], 0
  ds_read_b64_tr_b16 a[212:213], v41 offset:0
  v_rcp_f32 v96, v96
  v_mfma_f32_16x16x32_bf16 v[160:163], a[252:255], a[180:183], v[160:163]
  ds_read_b64_tr_b16 a[214:215], v41 offset:512
  v_mul_f32 v128, v128, v96
  v_mfma_f32_16x16x32_bf16 v[192:195], a[168:171], a[0:3], 0
  ds_read_b64_tr_b16 a[224:225], v40 offset:8192
  v_mul_f32 v137, v105, v137
  v_mfma_f32_16x16x32_bf16 v[196:199], a[168:171], a[4:7], 0
  ds_read_b64_tr_b16 a[226:227], v40 offset:8704
  v_fma_f32 v81, v81, v59, v57
  v_mfma_f32_16x16x32_bf16 v[200:203], a[172:175], a[0:3], 0
  ds_read_b64_tr_b16 a[228:229], v41 offset:8192
  buffer_load_dwordx2 v[18:19], v74, s[12:15], s80 offen offset:128
  v_mfma_f32_16x16x32_bf16 v[204:207], a[172:175], a[4:7], 0
  ds_read_b64_tr_b16 a[230:231], v41 offset:8704
  v_mul_f32 v105, v81, v105
  v_mfma_f32_16x16x32_bf16 v[224:227], a[184:187], a[0:3], 0
  v_rcp_f32 v97, v97
  v_mfma_f32_16x16x32_bf16 v[228:231], a[184:187], a[4:7], 0
  v_rcp_f32 v98, v98
  v_mul_f32 v129, v129, v97
  v_mfma_f32_16x16x32_bf16 v[232:235], a[188:191], a[0:3], 0
  v_rcp_f32 v99, v99
  v_mfma_f32_16x16x32_bf16 v[236:239], a[188:191], a[4:7], 0
  s_waitcnt lgkmcnt(0)
  s_add_u32 m0, s66, 53248
  v_mfma_f32_16x16x32_bf16 v[176:179], a[200:203], a[8:11], v[176:179]
  ds_read_b64_tr_b16 a[160:161], v34 offset:16384
  ds_read_b64_tr_b16 a[162:163], v34 offset:16896
  v_mfma_f32_16x16x32_bf16 v[180:183], a[200:203], a[12:15], v[180:183]
  ds_read_b64_tr_b16 a[164:165], v35 offset:16384
  buffer_load_dwordx4 v8, s[40:43], s71 offen offset:0 lds
  v_mfma_f32_16x16x32_bf16 v[184:187], a[204:207], a[8:11], v[184:187]
  ds_read_b64_tr_b16 a[166:167], v35 offset:16896
  v_mul_f32 v130, v130, v98
  v_mfma_f32_16x16x32_bf16 v[188:191], a[204:207], a[12:15], v[188:191]
  ds_read_b64_tr_b16 a[176:177], v34 offset:24576
  ds_read_b64_tr_b16 a[178:179], v34 offset:25088
  v_mul_f32 v131, v131, v99
  v_mfma_f32_16x16x32_bf16 v[208:211], a[216:219], a[8:11], v[208:211]
  ds_read_b64_tr_b16 a[180:181], v35 offset:24576
  buffer_load_dwordx4 v9, s[40:43], s71 offen offset:1024 lds
  v_mfma_f32_16x16x32_bf16 v[212:215], a[216:219], a[12:15], v[212:215]
  ds_read_b64_tr_b16 a[182:183], v35 offset:25088
  v_cvt_pk_bf16_f32 v96, v128, v129
  v_mfma_f32_16x16x32_bf16 v[216:219], a[220:223], a[8:11], v[216:219]
  ds_read_b64_tr_b16 a[168:169], v36 offset:16384
  ds_read_b64_tr_b16 a[170:171], v36 offset:16896
  v_mfma_f32_16x16x32_bf16 v[220:223], a[220:223], a[12:15], v[220:223]
  ds_read_b64_tr_b16 a[172:173], v37 offset:16384
  v_cvt_pk_bf16_f32 v97, v130, v131
  v_mfma_f32_16x16x32_bf16 v[192:195], a[208:211], a[8:11], v[192:195]
  ds_read_b64_tr_b16 a[174:175], v37 offset:16896
  buffer_load_dwordx4 v10, s[40:43], s71 offen offset:2048 lds
  v_mfma_f32_16x16x32_bf16 v[196:199], a[208:211], a[12:15], v[196:199]
  ds_read_b64_tr_b16 a[184:185], v36 offset:24576
  ds_read_b64_tr_b16 a[186:187], v36 offset:25088
  v_mul_f32 v82, v106, v106
  v_mfma_f32_16x16x32_bf16 v[200:203], a[212:215], a[8:11], v[200:203]
  ds_read_b64_tr_b16 a[188:189], v37 offset:24576
  v_mul_f32 v138, v106, v138
  v_mfma_f32_16x16x32_bf16 v[204:207], a[212:215], a[12:15], v[204:207]
  ds_read_b64_tr_b16 a[190:191], v37 offset:25088
  v_fma_f32 v82, v82, v59, v57
  v_mfma_f32_16x16x32_bf16 v[224:227], a[224:227], a[8:11], v[224:227]
  buffer_load_dwordx4 v11, s[40:43], s71 offen offset:3072 lds
  s_add_u32 s71, s71, 196608
  v_mfma_f32_16x16x32_bf16 v[228:231], a[224:227], a[12:15], v[228:231]
  s_cmp_eq_u32 s91, 2
  s_cselect_b32 s71, s88, s71
  v_mfma_f32_16x16x32_bf16 v[232:235], a[228:231], a[8:11], v[232:235]
  v_exp_f32 v104, v104
  v_mfma_f32_16x16x32_bf16 v[236:239], a[228:231], a[12:15], v[236:239]
  s_waitcnt lgkmcnt(0)
  v_mul_f32 v106, v82, v106
  v_mfma_f32_16x16x32_bf16 v[176:179], a[160:163], a[16:19], v[176:179]
  ds_read_b64_tr_b16 a[200:201], v38 offset:16384
  v_exp_f32 v105, v105
  v_mfma_f32_16x16x32_bf16 v[180:183], a[160:163], a[20:23], v[180:183]
  ds_read_b64_tr_b16 a[202:203], v38 offset:16896
  v_mul_f32 v83, v107, v107
  v_mfma_f32_16x16x32_bf16 v[160:163], a[240:243], a[160:163], v[160:163]
  ds_read_b64_tr_b16 a[204:205], v39 offset:16384
  v_mul_f32 v139, v107, v139
  v_mfma_f32_16x16x32_bf16 v[184:187], a[164:167], a[16:19], v[184:187]
  ds_read_b64_tr_b16 a[206:207], v39 offset:16896
  v_fma_f32 v83, v83, v59, v57
  v_mfma_f32_16x16x32_bf16 v[188:191], a[164:167], a[20:23], v[188:191]
  ds_read_b64_tr_b16 a[216:217], v38 offset:24576
  v_mul_f32 v107, v83, v107
  v_mfma_f32_16x16x32_bf16 v[160:163], a[244:247], a[164:167], v[160:163]
  ds_read_b64_tr_b16 a[218:219], v38 offset:25088
  v_fma_f32 v104, v104, v58, v58
  v_mfma_f32_16x16x32_bf16 v[208:211], a[176:179], a[16:19], v[208:211]
  ds_read_b64_tr_b16 a[220:221], v39 offset:24576
  v_exp_f32 v106, v106
  v_mfma_f32_16x16x32_bf16 v[212:215], a[176:179], a[20:23], v[212:215]
  ds_read_b64_tr_b16 a[222:223], v39 offset:25088
  v_fma_f32 v105, v105, v58, v58
  v_mfma_f32_16x16x32_bf16 v[160:163], a[248:251], a[176:179], v[160:163]
  ds_read_b64_tr_b16 a[208:209], v40 offset:16384
  v_fma_f32 v106, v106, v58, v58
  v_mfma_f32_16x16x32_bf16 v[216:219], a[180:183], a[16:19], v[216:219]
  ds_read_b64_tr_b16 a[210:211], v40 offset:16896
  v_mfma_f32_16x16x32_bf16 v[220:223], a[180:183], a[20:23], v[220:223]
  ds_read_b64_tr_b16 a[212:213], v41 offset:16384
  v_mfma_f32_16x16x32_bf16 v[160:163], a[252:255], a[180:183], v[160:163]
  ds_read_b64_tr_b16 a[214:215], v41 offset:16896
  v_mfma_f32_16x16x32_bf16 v[192:195], a[168:171], a[16:19], v[192:195]
  ds_read_b64_tr_b16 a[224:225], v40 offset:24576
  v_mfma_f32_16x16x32_bf16 v[196:199], a[168:171], a[20:23], v[196:199]
  ds_read_b64_tr_b16 a[226:227], v40 offset:25088
  v_exp_f32 v107, v107
  v_mfma_f32_16x16x32_bf16 v[200:203], a[172:175], a[16:19], v[200:203]
  ds_read_b64_tr_b16 a[228:229], v41 offset:24576
  v_fma_f32 v107, v107, v58, v58
  v_mfma_f32_16x16x32_bf16 v[204:207], a[172:175], a[20:23], v[204:207]
  ds_read_b64_tr_b16 a[230:231], v41 offset:25088
  v_mfma_f32_16x16x32_bf16 v[224:227], a[184:187], a[16:19], v[224:227]
  v_rcp_f32 v104, v104
  v_mfma_f32_16x16x32_bf16 v[228:231], a[184:187], a[20:23], v[228:231]
  v_rcp_f32 v105, v105
  v_mfma_f32_16x16x32_bf16 v[232:235], a[188:191], a[16:19], v[232:235]
  v_rcp_f32 v106, v106
  v_mfma_f32_16x16x32_bf16 v[236:239], a[188:191], a[20:23], v[236:239]
  s_waitcnt vmcnt(22) lgkmcnt(0)
  s_barrier
  v_rcp_f32 v107, v107
  v_mfma_f32_16x16x32_bf16 v[176:179], a[200:203], a[24:27], v[176:179]
  ds_read_b64_tr_b16 a[160:161], v34 offset:36864
  ds_read_b64_tr_b16 a[162:163], v34 offset:37376
  v_mfma_f32_16x16x32_bf16 v[180:183], a[200:203], a[28:31], v[180:183]
  ds_read_b64_tr_b16 a[164:165], v35 offset:36864
  s_waitcnt vmcnt(13)
  v_cmp_ne_u32 vcc, s64, v73
  s_cbranch_vccnz E_slow2
E_ok2:
  v_mfma_f32_16x16x32_bf16 v[184:187], a[204:207], a[24:27], v[184:187]
  ds_read_b64_tr_b16 a[166:167], v35 offset:37376
  s_add_u32 m0, s66, 73728
  v_mfma_f32_16x16x32_bf16 v[188:191], a[204:207], a[28:31], v[188:191]
  ds_read_b64_tr_b16 a[176:177], v34 offset:45056
  ds_read_b64_tr_b16 a[178:179], v34 offset:45568
  v_mfma_f32_16x16x32_bf16 v[208:211], a[216:219], a[24:27], v[208:211]
  ds_read_b64_tr_b16 a[180:181], v35 offset:45056
  buffer_load_dwordx4 v8, s[40:43], s71 offen offset:0 lds
  v_mfma_f32_16x16x32_bf16 v[212:215], a[216:219], a[28:31], v[212:215]
  ds_read_b64_tr_b16 a[182:183], v35 offset:45568
  buffer_load_dwordx4 v9, s[40:43], s71 offen offset:1024 lds
  v_mul_f32 v136, v136, v104
  v_mfma_f32_16x16x32_bf16 v[216:219], a[220:223], a[24:27], v[216:219]
  ds_read_b64_tr_b16 a[168:169], v36 offset:36864
  ds_read_b64_tr_b16 a[170:171], v36 offset:37376
  v_mfma_f32_16x16x32_bf16 v[220:223], a[220:223], a[28:31], v[220:223]
  ds_read_b64_tr_b16 a[172:173], v37 offset:36864
  v_mul_f32 v137, v137, v105
  v_mfma_f32_16x16x32_bf16 v[192:195], a[208:211], a[24:27], v[192:195]
  ds_read_b64_tr_b16 a[174:175], v37 offset:37376
  buffer_load_dwordx4 v10, s[40:43], s71 offen offset:2048 lds
  v_mfma_f32_16x16x32_bf16 v[196:199], a[208:211], a[28:31], v[196:199]
  ds_read_b64_tr_b16 a[184:185], v36 offset:45056
  ds_read_b64_tr_b16 a[186:187], v36 offset:45568
  v_mfma_f32_16x16x32_bf16 v[200:203], a[212:215], a[24:27], v[200:203]
  ds_read_b64_tr_b16 a[188:189], v37 offset:45056
  v_mul_f32 v138, v138, v106
  v_mfma_f32_16x16x32_bf16 v[204:207], a[212:215], a[28:31], v[204:207]
  ds_read_b64_tr_b16 a[190:191], v37 offset:45568
  v_mul_f32 v139, v139, v107
  v_mfma_f32_16x16x32_bf16 v[224:227], a[224:227], a[24:27], v[224:227]
  buffer_load_dwordx4 v11, s[40:43], s71 offen offset:3072 lds
  s_add_u32 s71, s71, 196608
  v_cvt_pk_bf16_f32 v98, v136, v137
  v_mfma_f32_16x16x32_bf16 v[228:231], a[224:227], a[28:31], v[228:231]
  s_cmp_eq_u32 s91, 1
  s_cselect_b32 s71, s88, s71
  v_mfma_f32_16x16x32_bf16 v[232:235], a[228:231], a[24:27], v[232:235]
  s_add_u32 m0, s66, 90112
  v_cvt_pk_bf16_f32 v99, v138, v139
  v_mfma_f32_16x16x32_bf16 v[236:239], a[228:231], a[28:31], v[236:239]
  s_waitcnt lgkmcnt(0)
  buffer_load_dwordx4 v8, s[40:43], s71 offen offset:0 lds
  v_mfma_f32_16x16x32_bf16 v[176:179], a[160:163], a[32:35], v[176:179]
  ds_read_b64_tr_b16 a[200:201], v38 offset:36864
  v_mfma_f32_16x16x32_bf16 v[180:183], a[160:163], a[36:39], v[180:183]
  ds_read_b64_tr_b16 a[202:203], v38 offset:37376
  v_mfma_f32_16x16x32_bf16 v[160:163], a[240:243], a[160:163], v[160:163]
  ds_read_b64_tr_b16 a[204:205], v39 offset:36864
  v_mfma_f32_16x16x32_bf16 v[184:187], a[164:167], a[32:35], v[184:187]
  ds_read_b64_tr_b16 a[206:207], v39 offset:37376
  buffer_load_dwordx4 v9, s[40:43], s71 offen offset:1024 lds
  v_mfma_f32_16x16x32_bf16 v[188:191], a[164:167], a[36:39], v[188:191]
  ds_read_b64_tr_b16 a[216:217], v38 offset:45056
  v_mfma_f32_16x16x32_bf16 v[160:163], a[244:247], a[164:167], v[160:163]
  ds_read_b64_tr_b16 a[218:219], v38 offset:45568
  v_mfma_f32_16x16x32_bf16 v[208:211], a[176:179], a[32:35], v[208:211]
  ds_read_b64_tr_b16 a[220:221], v39 offset:45056
  buffer_load_dwordx4 v10, s[40:43], s71 offen offset:2048 lds
  v_mfma_f32_16x16x32_bf16 v[212:215], a[176:179], a[36:39], v[212:215]
  ds_read_b64_tr_b16 a[222:223], v39 offset:45568
  v_mfma_f32_16x16x32_bf16 v[160:163], a[248:251], a[176:179], v[160:163]
  ds_read_b64_tr_b16 a[208:209], v40 offset:36864
  v_mfma_f32_16x16x32_bf16 v[216:219], a[180:183], a[32:35], v[216:219]
  ds_read_b64_tr_b16 a[210:211], v40 offset:37376
  v_mul_f32 v80, v100, v100
  v_mfma_f32_16x16x32_bf16 v[220:223], a[180:183], a[36:39], v[220:223]
  ds_read_b64_tr_b16 a[212:213], v41 offset:36864
  buffer_load_dwordx4 v11, s[40:43], s71 offen offset:3072 lds
  v_mfma_f32_16x16x32_bf16 v[160:163], a[252:255], a[180:183], v[160:163]
  ds_read_b64_tr_b16 a[214:215], v41 offset:37376
  s_add_u32 s71, s71, 196608
  v_mul_f32 v132, v100, v132
  v_mfma_f32_16x16x32_bf16 v[192:195], a[168:171], a[32:35], v[192:195]
  ds_read_b64_tr_b16 a[224:225], v40 offset:45056
  v_fma_f32 v80, v80, v63, v61
  v_mfma_f32_16x16x32_bf16 v[196:199], a[168:171], a[36:39], v[196:199]
  ds_read_b64_tr_b16 a[226:227], v40 offset:45568
  v_mul_f32 v100, v80, v100
  v_mfma_f32_16x16x32_bf16 v[200:203], a[172:175], a[32:35], v[200:203]
  ds_read_b64_tr_b16 a[228:229], v41 offset:45056
  buffer_store_dwordx4 v[96:99], v1, s[8:11], s24 offen offset:0 sc1
  v_mfma_f32_16x16x32_bf16 v[204:207], a[172:175], a[36:39], v[204:207]
  ds_read_b64_tr_b16 a[230:231], v41 offset:45568
  s_add_u32 s81, s77, 0
  v_mfma_f32_16x16x32_bf16 v[224:227], a[184:187], a[32:35], v[224:227]
  v_exp_f32 v100, v100
  v_mul_f32 v81, v101, v101
  v_mfma_f32_16x16x32_bf16 v[228:231], a[184:187], a[36:39], v[228:231]
  buffer_load_dwordx4 a[0:3], v1, s[8:11], s81 offen offset:0 sc1
  v_mul_f32 v133, v101, v133
  v_mfma_f32_16x16x32_bf16 v[232:235], a[188:191], a[32:35], v[232:235]
  v_fma_f32 v81, v81, v63, v61
  v_mul_f32 v101, v81, v101
  v_mfma_f32_16x16x32_bf16 v[236:239], a[188:191], a[36:39], v[236:239]
  s_waitcnt lgkmcnt(0)
  v_mul_f32 v82, v102, v102
  v_mfma_f32_16x16x32_bf16 v[176:179], a[200:203], a[40:43], v[176:179]
  ds_read_b64_tr_b16 a[160:161], v34 offset:53248
  ds_read_b64_tr_b16 a[162:163], v34 offset:53760
  v_mfma_f32_16x16x32_bf16 v[180:183], a[200:203], a[44:47], v[180:183]
  ds_read_b64_tr_b16 a[164:165], v35 offset:53248
  buffer_load_dwordx4 a[4:7], v1, s[8:11], s81 offen offset:1024 sc1
  v_mul_f32 v134, v102, v134
  v_mfma_f32_16x16x32_bf16 v[184:187], a[204:207], a[40:43], v[184:187]
  ds_read_b64_tr_b16 a[166:167], v35 offset:53760
  v_fma_f32 v82, v82, v63, v61
  v_mfma_f32_16x16x32_bf16 v[188:191], a[204:207], a[44:47], v[188:191]
  ds_read_b64_tr_b16 a[176:177], v34 offset:61440
  ds_read_b64_tr_b16 a[178:179], v34 offset:61952
  v_mfma_f32_16x16x32_bf16 v[208:211], a[216:219], a[40:43], v[208:211]
  ds_read_b64_tr_b16 a[180:181], v35 offset:61440
  buffer_load_dwordx4 a[8:11], v1, s[8:11], s81 offen offset:2048 sc1
  v_mfma_f32_16x16x32_bf16 v[212:215], a[216:219], a[44:47], v[212:215]
  ds_read_b64_tr_b16 a[182:183], v35 offset:61952
  v_mul_f32 v102, v82, v102
  v_mfma_f32_16x16x32_bf16 v[216:219], a[220:223], a[40:43], v[216:219]
  ds_read_b64_tr_b16 a[168:169], v36 offset:53248
  ds_read_b64_tr_b16 a[170:171], v36 offset:53760
  v_mfma_f32_16x16x32_bf16 v[220:223], a[220:223], a[44:47], v[220:223]
  ds_read_b64_tr_b16 a[172:173], v37 offset:53248
  v_exp_f32 v101, v101
  v_mfma_f32_16x16x32_bf16 v[192:195], a[208:211], a[40:43], v[192:195]
  ds_read_b64_tr_b16 a[174:175], v37 offset:53760
  buffer_load_dwordx4 a[12:15], v1, s[8:11], s81 offen offset:3072 sc1
  v_mfma_f32_16x16x32_bf16 v[196:199], a[208:211], a[44:47], v[196:199]
  ds_read_b64_tr_b16 a[184:185], v36 offset:61440
  ds_read_b64_tr_b16 a[186:187], v36 offset:61952
  v_mfma_f32_16x16x32_bf16 v[200:203], a[212:215], a[40:43], v[200:203]
  ds_read_b64_tr_b16 a[188:189], v37 offset:61440
  v_mul_f32 v83, v103, v103
  v_mfma_f32_16x16x32_bf16 v[204:207], a[212:215], a[44:47], v[204:207]
  ds_read_b64_tr_b16 a[190:191], v37 offset:61952
  v_mul_f32 v135, v103, v135
  v_mfma_f32_16x16x32_bf16 v[224:227], a[224:227], a[40:43], v[224:227]
  buffer_load_dwordx4 a[16:19], v3, s[8:11], s81 offen offset:0 sc1
  v_exp_f32 v102, v102
  v_mfma_f32_16x16x32_bf16 v[228:231], a[224:227], a[44:47], v[228:231]
  s_add_u32 s81, s77, 40960
  v_fma_f32 v83, v83, v63, v61
  v_mfma_f32_16x16x32_bf16 v[232:235], a[228:231], a[40:43], v[232:235]
  v_mul_f32 v103, v83, v103
  v_fma_f32 v100, v100, v62, v62
  v_mfma_f32_16x16x32_bf16 v[236:239], a[228:231], a[44:47], v[236:239]
  s_waitcnt lgkmcnt(0)
  buffer_load_dwordx4 a[20:23], v1, s[8:11], s81 offen offset:0 sc1
  v_mfma_f32_16x16x32_bf16 v[176:179], a[160:163], a[48:51], v[176:179]
  ds_read_b64_tr_b16 a[200:201], v38 offset:53248
  v_fma_f32 v101, v101, v62, v62
  v_mfma_f32_16x16x32_bf16 v[180:183], a[160:163], a[52:55], v[180:183]
  ds_read_b64_tr_b16 a[202:203], v38 offset:53760
  v_exp_f32 v103, v103
  v_mfma_f32_16x16x32_bf16 v[160:163], a[240:243], a[160:163], v[160:163]
  ds_read_b64_tr_b16 a[204:205], v39 offset:53248
  v_fma_f32 v102, v102, v62, v62
  v_mfma_f32_16x16x32_bf16 v[184:187], a[164:167], a[48:51], v[184:187]
  ds_read_b64_tr_b16 a[206:207], v39 offset:53760
  buffer_load_dwordx4 a[24:27], v1, s[8:11], s81 offen offset:1024 sc1
  v_mfma_f32_16x16x32_bf16 v[188:191], a[164:167], a[52:55], v[188:191]
  ds_read_b64_tr_b16 a[216:217], v38 offset:61440
  v_fma_f32 v103, v103, v62, v62
  v_mfma_f32_16x16x32_bf16 v[160:163], a[244:247], a[164:167], v[160:163]
  ds_read_b64_tr_b16 a[218:219], v38 offset:61952
  v_mul_f32 v80, v108, v108
  v_mfma_f32_16x16x32_bf16 v[208:211], a[176:179], a[48:51], v[208:211]
  ds_read_b64_tr_b16 a[220:221], v39 offset:61440
  buffer_load_dwordx4 a[28:31], v1, s[8:11], s81 offen offset:2048 sc1
  v_mfma_f32_16x16x32_bf16 v[212:215], a[176:179], a[52:55], v[212:215]
  ds_read_b64_tr_b16 a[222:223], v39 offset:61952
  v_rcp_f32 v100, v100
  v_mfma_f32_16x16x32_bf16 v[160:163], a[248:251], a[176:179], v[160:163]
  ds_read_b64_tr_b16 a[208:209], v40 offset:53248
  v_mul_f32 v132, v132, v100
  v_mfma_f32_16x16x32_bf16 v[216:219], a[180:183], a[48:51], v[216:219]
  ds_read_b64_tr_b16 a[210:211], v40 offset:53760
  v_mul_f32 v140, v108, v140
  v_mfma_f32_16x16x32_bf16 v[220:223], a[180:183], a[52:55], v[220:223]
  ds_read_b64_tr_b16 a[212:213], v41 offset:53248
  buffer_load_dwordx4 a[32:35], v1, s[8:11], s81 offen offset:3072 sc1
  v_mfma_f32_16x16x32_bf16 v[160:163], a[252:255], a[180:183], v[160:163]
  ds_read_b64_tr_b16 a[214:215], v41 offset:53760
  v_fma_f32 v80, v80, v63, v61
  v_mfma_f32_16x16x32_bf16 v[192:195], a[168:171], a[48:51], v[192:195]
  ds_read_b64_tr_b16 a[224:225], v40 offset:61440
  v_rcp_f32 v101, v101
  v_mfma_f32_16x16x32_bf16 v[196:199], a[168:171], a[52:55], v[196:199]
  ds_read_b64_tr_b16 a[226:227], v40 offset:61952
  v_mul_f32 v133, v133, v101
  v_mfma_f32_16x16x32_bf16 v[200:203], a[172:175], a[48:51], v[200:203]
  ds_read_b64_tr_b16 a[228:229], v41 offset:61440
  buffer_load_dwordx4 a[36:39], v3, s[8:11], s81 offen offset:0 sc1
  v_mfma_f32_16x16x32_bf16 v[204:207], a[172:175], a[52:55], v[204:207]
  ds_read_b64_tr_b16 a[230:231], v41 offset:61952
  v_cvt_pk_bf16_f32 v100, v132, v133
  v_mfma_f32_16x16x32_bf16 v[224:227], a[184:187], a[48:51], v[224:227]
  v_rcp_f32 v102, v102
  v_mfma_f32_16x16x32_bf16 v[228:231], a[184:187], a[52:55], v[228:231]
  v_rcp_f32 v103, v103
  v_mul_f32 v134, v134, v102
  v_mfma_f32_16x16x32_bf16 v[232:235], a[188:191], a[48:51], v[232:235]
  v_mul_f32 v135, v135, v103
  v_cvt_pk_bf16_f32 v101, v134, v135
  v_mfma_f32_16x16x32_bf16 v[236:239], a[188:191], a[52:55], v[236:239]
  s_waitcnt lgkmcnt(0)
  s_barrier
  v_mul_f32 v108, v80, v108
  v_mfma_f32_16x16x32_bf16 v[176:179], a[200:203], a[56:59], v[176:179]
  ds_read_b64_tr_b16 a[160:161], v26 offset:0
  ds_read_b64_tr_b16 a[162:163], v26 offset:512
  v_mfma_f32_16x16x32_bf16 v[180:183], a[200:203], a[60:63], v[180:183]
  ds_read_b64_tr_b16 a[164:165], v27 offset:0
  s_add_u32 m0, s66, 110592
  v_mfma_f32_16x16x32_bf16 v[184:187], a[204:207], a[56:59], v[184:187]
  ds_read_b64_tr_b16 a[166:167], v27 offset:512
  s_mul_i32 s75, s70, 160
  v_mfma_f32_16x16x32_bf16 v[188:191], a[204:207], a[60:63], v[188:191]
  ds_read_b64_tr_b16 a[176:177], v26 offset:8192
  ds_read_b64_tr_b16 a[178:179], v26 offset:8704
  v_mul_f32 v81, v109, v109
  v_mfma_f32_16x16x32_bf16 v[208:211], a[216:219], a[56:59], v[208:211]
  ds_read_b64_tr_b16 a[180:181], v27 offset:8192
  buffer_load_dwordx4 v44, s[48:51], s70 offen offset:0 lds
  v_mfma_f32_16x16x32_bf16 v[212:215], a[216:219], a[60:63], v[212:215]
  ds_read_b64_tr_b16 a[182:183], v27 offset:8704
  buffer_load_dwordx4 v45, s[48:51], s70 offen offset:1024 lds
  v_mfma_f32_16x16x32_bf16 v[216:219], a[220:223], a[56:59], v[216:219]
  ds_read_b64_tr_b16 a[168:169], v28 offset:0
  ds_read_b64_tr_b16 a[170:171], v28 offset:512
  v_mfma_f32_16x16x32_bf16 v[220:223], a[220:223], a[60:63], v[220:223]
  ds_read_b64_tr_b16 a[172:173], v29 offset:0
  v_mul_f32 v141, v109, v141
  v_mfma_f32_16x16x32_bf16 v[192:195], a[208:211], a[56:59], v[192:195]
  ds_read_b64_tr_b16 a[174:175], v29 offset:512
  buffer_load_dwordx4 v46, s[48:51], s70 offen offset:2048 lds
  v_fma_f32 v81, v81, v63, v61
  v_mfma_f32_16x16x32_bf16 v[196:199], a[208:211], a[60:63], v[196:199]
  ds_read_b64_tr_b16 a[184:185], v28 offset:8192
  ds_read_b64_tr_b16 a[186:187], v28 offset:8704
  v_mfma_f32_16x16x32_bf16 v[200:203], a[212:215], a[56:59], v[200:203]
  ds_read_b64_tr_b16 a[188:189], v29 offset:8192
  v_mul_f32 v109, v81, v109
  v_mfma_f32_16x16x32_bf16 v[204:207], a[212:215], a[60:63], v[204:207]
  ds_read_b64_tr_b16 a[190:191], v29 offset:8704
  v_mul_f32 v82, v110, v110
  v_mfma_f32_16x16x32_bf16 v[224:227], a[224:227], a[56:59], v[224:227]
  buffer_load_dwordx4 v47, s[48:51], s70 offen offset:3072 lds
  s_add_u32 s70, s70, 128
  v_mfma_f32_16x16x32_bf16 v[228:231], a[224:227], a[60:63], v[228:231]
  s_and_b32 s70, s70, 0x7ff
  v_exp_f32 v108, v108
  v_mfma_f32_16x16x32_bf16 v[232:235], a[228:231], a[56:59], v[232:235]
  v_exp_f32 v109, v109
  v_mfma_f32_16x16x32_bf16 v[236:239], a[228:231], a[60:63], v[236:239]
  s_waitcnt lgkmcnt(0)
  s_add_u32 s81, s77, 81920
  v_mfma_f32_16x16x32_bf16 v[176:179], a[160:163], a[64:67], v[176:179]
  ds_read_b64_tr_b16 a[200:201], v30 offset:0
  buffer_load_dwordx4 a[40:43], v1, s[8:11], s81 offen offset:0 sc1
  v_mfma_f32_16x16x32_bf16 v[180:183], a[160:163], a[68:71], v[180:183]
  ds_read_b64_tr_b16 a[202:203], v30 offset:512
  v_mul_f32 v142, v110, v142
  v_mfma_f32_16x16x32_bf16 v[160:163], a[240:243], a[160:163], v[160:163]
  ds_read_b64_tr_b16 a[204:205], v31 offset:0
  v_fma_f32 v82, v82, v63, v61
  v_mfma_f32_16x16x32_bf16 v[184:187], a[164:167], a[64:67], v[184:187]
  ds_read_b64_tr_b16 a[206:207], v31 offset:512
  buffer_load_dwordx4 a[44:47], v1, s[8:11], s81 offen offset:1024 sc1
  v_mul_f32 v110, v82, v110
  v_mfma_f32_16x16x32_bf16 v[188:191], a[164:167], a[68:71], v[188:191]
  ds_read_b64_tr_b16 a[216:217], v30 offset:8192
  v_mul_f32 v83, v111, v111
  v_mfma_f32_16x16x32_bf16 v[160:163], a[244:247], a[164:167], v[160:163]
  ds_read_b64_tr_b16 a[218:219], v30 offset:8704
  v_mul_f32 v143, v111, v143
  v_mfma_f32_16x16x32_bf16 v[208:211], a[176:179], a[64:67], v[208:211]
  ds_read_b64_tr_b16 a[220:221], v31 offset:8192
  buffer_load_dwordx4 a[48:51], v1, s[8:11], s81 offen offset:2048 sc1
  v_mfma_f32_16x16x32_bf16 v[212:215], a[176:179], a[68:71], v[212:215]
  ds_read_b64_tr_b16 a[222:223], v31 offset:8704
  v_fma_f32 v83, v83, v63, v61
  v_mfma_f32_16x16x32_bf16 v[160:163], a[248:251], a[176:179], v[160:163]
  ds_read_b64_tr_b16 a[208:209], v32 offset:0
  v_exp_f32 v110, v110
  v_mfma_f32_16x16x32_bf16 v[216:219], a[180:183], a[64:67], v[216:219]
  ds_read_b64_tr_b16 a[210:211], v32 offset:512
  v_mul_f32 v111, v83, v111
  v_mfma_f32_16x16x32_bf16 v[220:223], a[180:183], a[68:71], v[220:223]
  ds_read_b64_tr_b16 a[212:213], v33 offset:0
  buffer_load_dwordx4 a[52:55], v1, s[8:11], s81 offen offset:3072 sc1
  v_mfma_f32_16x16x32_bf16 v[160:163], a[252:255], a[180:183], v[160:163]
  ds_read_b64_tr_b16 a[214:215], v33 offset:512
  v_fma_f32 v108, v108, v62, v62
  v_mfma_f32_16x16x32_bf16 v[192:195], a[168:171], a[64:67], v[192:195]
  ds_read_b64_tr_b16 a[224:225], v32 offset:8192
  v_fma_f32 v109, v109, v62, v62
  v_mfma_f32_16x16x32_bf16 v[196:199], a[168:171], a[68:71], v[196:199]
  ds_read_b64_tr_b16 a[226:227], v32 offset:8704
  v_exp_f32 v111, v111
  v_mfma_f32_16x16x32_bf16 v[200:203], a[172:175], a[64:67], v[200:203]
  ds_read_b64_tr_b16 a[228:229], v33 offset:8192
  buffer_load_dwordx4 a[56:59], v3, s[8:11], s81 offen offset:0 sc1
  v_mfma_f32_16x16x32_bf16 v[204:207], a[172:175], a[68:71], v[204:207]
  ds_read_b64_tr_b16 a[230:231], v33 offset:8704
  v_fma_f32 v110, v110, v62, v62
  v_mfma_f32_16x16x32_bf16 v[224:227], a[184:187], a[64:67], v[224:227]
  v_rcp_f32 v108, v108
  v_mfma_f32_16x16x32_bf16 v[228:231], a[184:187], a[68:71], v[228:231]
  v_rcp_f32 v109, v109
  v_mfma_f32_16x16x32_bf16 v[232:235], a[188:191], a[64:67], v[232:235]
  v_rcp_f32 v110, v110
  v_mfma_f32_16x16x32_bf16 v[236:239], a[188:191], a[68:71], v[236:239]
  s_waitcnt lgkmcnt(0)
  v_fma_f32 v111, v111, v62, v62
  v_mul_f32 v140, v140, v108
  v_mfma_f32_16x16x32_bf16 v[176:179], a[200:203], a[72:75], v[176:179]
  ds_read_b64_tr_b16 a[160:161], v26 offset:16384
  ds_read_b64_tr_b16 a[162:163], v26 offset:16896
  v_mfma_f32_16x16x32_bf16 v[180:183], a[200:203], a[76:79], v[180:183]
  ds_read_b64_tr_b16 a[164:165], v27 offset:16384
  v_mul_f32 v141, v141, v109
  v_mfma_f32_16x16x32_bf16 v[184:187], a[204:207], a[72:75], v[184:187]
  ds_read_b64_tr_b16 a[166:167], v27 offset:16896
  v_mul_f32 v142, v142, v110
  v_mfma_f32_16x16x32_bf16 v[188:191], a[204:207], a[76:79], v[188:191]
  ds_read_b64_tr_b16 a[176:177], v26 offset:24576
  ds_read_b64_tr_b16 a[178:179], v26 offset:25088
  v_mfma_f32_16x16x32_bf16 v[208:211], a[216:219], a[72:75], v[208:211]
  ds_read_b64_tr_b16 a[180:181], v27 offset:24576
  v_rcp_f32 v111, v111
  v_mfma_f32_16x16x32_bf16 v[212:215], a[216:219], a[76:79], v[212:215]
  ds_read_b64_tr_b16 a[182:183], v27 offset:25088
  v_mul_f32 v143, v143, v111
  v_mfma_f32_16x16x32_bf16 v[216:219], a[220:223], a[72:75], v[216:219]
  ds_read_b64_tr_b16 a[168:169], v28 offset:16384
  ds_read_b64_tr_b16 a[170:171], v28 offset:16896
  v_mfma_f32_16x16x32_bf16 v[220:223], a[220:223], a[76:79], v[220:223]
  ds_read_b64_tr_b16 a[172:173], v29 offset:16384
  v_cvt_pk_bf16_f32 v102, v140, v141
  v_mfma_f32_16x16x32_bf16 v[192:195], a[208:211], a[72:75], v[192:195]
  ds_read_b64_tr_b16 a[174:175], v29 offset:16896
  v_cvt_pk_bf16_f32 v103, v142, v143
  v_mfma_f32_16x16x32_bf16 v[196:199], a[208:211], a[76:79], v[196:199]
  ds_read_b64_tr_b16 a[184:185], v28 offset:24576
  ds_read_b64_tr_b16 a[186:187], v28 offset:25088
  v_mfma_f32_16x16x32_bf16 v[200:203], a[212:215], a[72:75], v[200:203]
  ds_read_b64_tr_b16 a[188:189], v29 offset:24576
  buffer_store_dwordx4 v[100:103], v1, s[8:11], s24 offen offset:1024 sc1
  v_mfma_f32_16x16x32_bf16 v[204:207], a[212:215], a[76:79], v[204:207]
  ds_read_b64_tr_b16 a[190:191], v29 offset:25088
  v_mul_f32 v80, v112, v112
  v_mfma_f32_16x16x32_bf16 v[224:227], a[224:227], a[72:75], v[224:227]
  v_mul_f32 v144, v112, v144
  v_fma_f32 v80, v80, v59, v57
  v_mul_f32 v112, v80, v112
  v_mfma_f32_16x16x32_bf16 v[228:231], a[224:227], a[76:79], v[228:231]
  v_exp_f32 v112, v112
  v_mfma_f32_16x16x32_bf16 v[232:235], a[228:231], a[72:75], v[232:235]
  v_mul_f32 v81, v113, v113
  v_mul_f32 v145, v113, v145
  v_mfma_f32_16x16x32_bf16 v[236:239], a[228:231], a[76:79], v[236:239]
  s_waitcnt lgkmcnt(0)
  s_add_u32 s81, s77, 122880
  v_mfma_f32_16x16x32_bf16 v[176:179], a[160:163], a[80:83], v[176:179]
  ds_read_b64_tr_b16 a[200:201], v30 offset:16384
  buffer_load_dwordx4 a[60:63], v1, s[8:11], s81 offen offset:0 sc1
  v_fma_f32 v81, v81, v59, v57
  v_mfma_f32_16x16x32_bf16 v[180:183], a[160:163], a[84:87], v[180:183]
  ds_read_b64_tr_b16 a[202:203], v30 offset:16896
  buffer_load_dwordx4 a[64:67], v1, s[8:11], s81 offen offset:1024 sc1
  v_mfma_f32_16x16x32_bf16 v[160:163], a[240:243], a[160:163], v[160:163]
  ds_read_b64_tr_b16 a[204:205], v31 offset:16384
  v_mul_f32 v113, v81, v113
  v_mfma_f32_16x16x32_bf16 v[184:187], a[164:167], a[80:83], v[184:187]
  ds_read_b64_tr_b16 a[206:207], v31 offset:16896
  v_mul_f32 v82, v114, v114
  v_mfma_f32_16x16x32_bf16 v[188:191], a[164:167], a[84:87], v[188:191]
  ds_read_b64_tr_b16 a[216:217], v30 offset:24576
  buffer_load_dwordx4 a[68:71], v1, s[8:11], s81 offen offset:2048 sc1
  v_mfma_f32_16x16x32_bf16 v[160:163], a[244:247], a[164:167], v[160:163]
  ds_read_b64_tr_b16 a[218:219], v30 offset:25088
  v_exp_f32 v113, v113
  v_mfma_f32_16x16x32_bf16 v[208:211], a[176:179], a[80:83], v[208:211]
  ds_read_b64_tr_b16 a[220:221], v31 offset:24576
  v_mul_f32 v146, v114, v146
  v_mfma_f32_16x16x32_bf16 v[212:215], a[176:179], a[84:87], v[212:215]
  ds_read_b64_tr_b16 a[222:223], v31 offset:25088
  v_fma_f32 v82, v82, v59, v57
  v_mfma_f32_16x16x32_bf16 v[160:163], a[248:251], a[176:179], v[160:163]
  ds_read_b64_tr_b16 a[208:209], v32 offset:16384
  buffer_load_dwordx4 a[72:75], v1, s[8:11], s81 offen offset:3072 sc1
  v_mfma_f32_16x16x32_bf16 v[216:219], a[180:183], a[80:83], v[216:219]
  ds_read_b64_tr_b16 a[210:211], v32 offset:16896
  v_mul_f32 v114, v82, v114
  v_mul_f32 v83, v115, v115
  v_mfma_f32_16x16x32_bf16 v[220:223], a[180:183], a[84:87], v[220:223]
  ds_read_b64_tr_b16 a[212:213], v33 offset:16384
  v_mul_f32 v147, v115, v147
  v_mfma_f32_16x16x32_bf16 v[160:163], a[252:255], a[180:183], v[160:163]
  ds_read_b64_tr_b16 a[214:215], v33 offset:16896
  buffer_load_dwordx4 a[76:79], v3, s[8:11], s81 offen offset:0 sc1
  v_mfma_f32_16x16x32_bf16 v[192:195], a[168:171], a[80:83], v[192:195]
  ds_read_b64_tr_b16 a[224:225], v32 offset:24576
  v_fma_f32 v83, v83, v59, v57
  v_mfma_f32_16x16x32_bf16 v[196:199], a[168:171], a[84:87], v[196:199]
  ds_read_b64_tr_b16 a[226:227], v32 offset:25088
  v_mul_f32 v115, v83, v115
  v_mfma_f32_16x16x32_bf16 v[200:203], a[172:175], a[80:83], v[200:203]
  ds_read_b64_tr_b16 a[228:229], v33 offset:24576
  v_exp_f32 v114, v114
  v_mfma_f32_16x16x32_bf16 v[204:207], a[172:175], a[84:87], v[204:207]
  ds_read_b64_tr_b16 a[230:231], v33 offset:25088
  buffer_load_dword v73, v88, s[8:11], s30 offen sc1
  v_mfma_f32_16x16x32_bf16 v[224:227], a[184:187], a[80:83], v[224:227]
  v_exp_f32 v115, v115
  v_mfma_f32_16x16x32_bf16 v[228:231], a[184:187], a[84:87], v[228:231]
  v_fma_f32 v112, v112, v58, v58
  v_fma_f32 v113, v113, v58, v58
  v_mfma_f32_16x16x32_bf16 v[232:235], a[188:191], a[80:83], v[232:235]
  v_rcp_f32 v112, v112
  v_mfma_f32_16x16x32_bf16 v[236:239], a[188:191], a[84:87], v[236:239]
  s_waitcnt vmcnt(35) lgkmcnt(0)
  s_barrier
  v_rcp_f32 v113, v113
  v_mfma_f32_16x16x32_bf16 v[176:179], a[200:203], a[88:91], v[176:179]
  ds_read_b64_tr_b16 a[160:161], v26 offset:36864
  ds_read_b64_tr_b16 a[162:163], v26 offset:37376
  v_mfma_f32_16x16x32_bf16 v[180:183], a[200:203], a[92:95], v[180:183]
  ds_read_b64_tr_b16 a[164:165], v27 offset:36864
  s_add_u32 m0, s66, 0
  v_mfma_f32_16x16x32_bf16 v[184:187], a[204:207], a[88:91], v[184:187]
  ds_read_b64_tr_b16 a[166:167], v27 offset:37376
  s_mul_i32 s72, s70, 160
  v_mfma_f32_16x16x32_bf16 v[188:191], a[204:207], a[92:95], v[188:191]
  ds_read_b64_tr_b16 a[176:177], v26 offset:45056
  ds_read_b64_tr_b16 a[178:179], v26 offset:45568
  v_fma_f32 v114, v114, v58, v58
  v_mfma_f32_16x16x32_bf16 v[208:211], a[216:219], a[88:91], v[208:211]
  ds_read_b64_tr_b16 a[180:181], v27 offset:45056
  buffer_load_dwordx4 v44, s[48:51], s70 offen offset:0 lds
  v_mfma_f32_16x16x32_bf16 v[212:215], a[216:219], a[92:95], v[212:215]
  ds_read_b64_tr_b16 a[182:183], v27 offset:45568
  buffer_load_dwordx4 v45, s[48:51], s70 offen offset:1024 lds
  v_mfma_f32_16x16x32_bf16 v[216:219], a[220:223], a[88:91], v[216:219]
  ds_read_b64_tr_b16 a[168:169], v28 offset:36864
  ds_read_b64_tr_b16 a[170:171], v28 offset:37376
  v_mfma_f32_16x16x32_bf16 v[220:223], a[220:223], a[92:95], v[220:223]
  ds_read_b64_tr_b16 a[172:173], v29 offset:36864
  v_fma_f32 v115, v115, v58, v58
  v_mfma_f32_16x16x32_bf16 v[192:195], a[208:211], a[88:91], v[192:195]
  ds_read_b64_tr_b16 a[174:175], v29 offset:37376
  buffer_load_dwordx4 v46, s[48:51], s70 offen offset:2048 lds
  v_mul_f32 v144, v144, v112
  v_mfma_f32_16x16x32_bf16 v[196:199], a[208:211], a[92:95], v[196:199]
  ds_read_b64_tr_b16 a[184:185], v28 offset:45056
  ds_read_b64_tr_b16 a[186:187], v28 offset:45568
  v_mfma_f32_16x16x32_bf16 v[200:203], a[212:215], a[88:91], v[200:203]
  ds_read_b64_tr_b16 a[188:189], v29 offset:45056
  v_mul_f32 v145, v145, v113
  v_mfma_f32_16x16x32_bf16 v[204:207], a[212:215], a[92:95], v[204:207]
  ds_read_b64_tr_b16 a[190:191], v29 offset:45568
  v_cvt_pk_bf16_f32 v112, v144, v145
  v_mfma_f32_16x16x32_bf16 v[224:227], a[224:227], a[88:91], v[224:227]
  buffer_load_dwordx4 v47, s[48:51], s70 offen offset:3072 lds
  s_add_u32 s70, s70, 128
  v_mul_f32 v80, v120, v120
  v_mfma_f32_16x16x32_bf16 v[228:231], a[224:227], a[92:95], v[228:231]
  s_and_b32 s70, s70, 0x7ff
  v_mul_f32 v152, v120, v152
  v_mfma_f32_16x16x32_bf16 v[232:235], a[228:231], a[88:91], v[232:235]
  v_rcp_f32 v114, v114
  v_mfma_f32_16x16x32_bf16 v[236:239], a[228:231], a[92:95], v[236:239]
  s_waitcnt lgkmcnt(0)
  v_mul_f32 v146, v146, v114
  v_mfma_f32_16x16x32_bf16 v[176:179], a[160:163], a[96:99], v[176:179]
  ds_read_b64_tr_b16 a[200:201], v30 offset:36864
  v_fma_f32 v80, v80, v59, v57
  v_mfma_f32_16x16x32_bf16 v[180:183], a[160:163], a[100:103], v[180:183]
  ds_read_b64_tr_b16 a[202:203], v30 offset:37376
  v_rcp_f32 v115, v115
  v_mfma_f32_16x16x32_bf16 v[160:163], a[240:243], a[160:163], v[160:163]
  ds_read_b64_tr_b16 a[204:205], v31 offset:36864
  v_mul_f32 v147, v147, v115
  v_mfma_f32_16x16x32_bf16 v[184:187], a[164:167], a[96:99], v[184:187]
  ds_read_b64_tr_b16 a[206:207], v31 offset:37376
  v_cvt_pk_bf16_f32 v113, v146, v147
  v_mfma_f32_16x16x32_bf16 v[188:191], a[164:167], a[100:103], v[188:191]
  ds_read_b64_tr_b16 a[216:217], v30 offset:45056
  v_mul_f32 v120, v80, v120
  v_mfma_f32_16x16x32_bf16 v[160:163], a[244:247], a[164:167], v[160:163]
  ds_read_b64_tr_b16 a[218:219], v30 offset:45568
  v_exp_f32 v120, v120
  v_mfma_f32_16x16x32_bf16 v[208:211], a[176:179], a[96:99], v[208:211]
  ds_read_b64_tr_b16 a[220:221], v31 offset:45056
  v_mul_f32 v81, v121, v121
  v_mfma_f32_16x16x32_bf16 v[212:215], a[176:179], a[100:103], v[212:215]
  ds_read_b64_tr_b16 a[222:223], v31 offset:45568
  v_mul_f32 v153, v121, v153
  v_mfma_f32_16x16x32_bf16 v[160:163], a[248:251], a[176:179], v[160:163]
  ds_read_b64_tr_b16 a[208:209], v32 offset:36864
  v_fma_f32 v81, v81, v59, v57
  v_mfma_f32_16x16x32_bf16 v[216:219], a[180:183], a[96:99], v[216:219]
  ds_read_b64_tr_b16 a[210:211], v32 offset:37376
  v_mul_f32 v121, v81, v121
  v_mfma_f32_16x16x32_bf16 v[220:223], a[180:183], a[100:103], v[220:223]
  ds_read_b64_tr_b16 a[212:213], v33 offset:36864
  v_exp_f32 v121, v121
  v_mfma_f32_16x16x32_bf16 v[160:163], a[252:255], a[180:183], v[160:163]
  ds_read_b64_tr_b16 a[214:215], v33 offset:37376
  v_mul_f32 v82, v122, v122
  v_mfma_f32_16x16x32_bf16 v[192:195], a[168:171], a[96:99], v[192:195]
  ds_read_b64_tr_b16 a[224:225], v32 offset:45056
  v_mul_f32 v154, v122, v154
  v_mfma_f32_16x16x32_bf16 v[196:199], a[168:171], a[100:103], v[196:199]
  ds_read_b64_tr_b16 a[226:227], v32 offset:45568
  v_fma_f32 v82, v82, v59, v57
  v_mfma_f32_16x16x32_bf16 v[200:203], a[172:175], a[96:99], v[200:203]
  ds_read_b64_tr_b16 a[228:229], v33 offset:45056
  v_mul_f32 v122, v82, v122
  v_mfma_f32_16x16x32_bf16 v[204:207], a[172:175], a[100:103], v[204:207]
  ds_read_b64_tr_b16 a[230:231], v33 offset:45568
  v_exp_f32 v122, v122
  v_mfma_f32_16x16x32_bf16 v[224:227], a[184:187], a[96:99], v[224:227]
  v_mul_f32 v83, v123, v123
  v_mul_f32 v155, v123, v155
  v_mfma_f32_16x16x32_bf16 v[228:231], a[184:187], a[100:103], v[228:231]
  v_fma_f32 v83, v83, v59, v57
  v_mul_f32 v123, v83, v123
  v_mfma_f32_16x16x32_bf16 v[232:235], a[188:191], a[96:99], v[232:235]
  v_exp_f32 v123, v123
  v_mfma_f32_16x16x32_bf16 v[236:239], a[188:191], a[100:103], v[236:239]
  s_waitcnt lgkmcnt(0)
  s_add_u32 s81, s77, 163840
  v_fma_f32 v120, v120, v58, v58
  v_mfma_f32_16x16x32_bf16 v[176:179], a[200:203], a[104:107], v[176:179]
  ds_read_b64_tr_b16 a[160:161], v26 offset:53248
  ds_read_b64_tr_b16 a[162:163], v26 offset:53760
  v_mfma_f32_16x16x32_bf16 v[180:183], a[200:203], a[108:111], v[180:183]
  ds_read_b64_tr_b16 a[164:165], v27 offset:53248
  buffer_load_dwordx4 a[80:83], v1, s[8:11], s81 offen offset:0 sc1
  v_mfma_f32_16x16x32_bf16 v[184:187], a[204:207], a[104:107], v[184:187]
  ds_read_b64_tr_b16 a[166:167], v27 offset:53760
  buffer_load_dwordx4 a[84:87], v1, s[8:11], s81 offen offset:1024 sc1
  v_mfma_f32_16x16x32_bf16 v[188:191], a[204:207], a[108:111], v[188:191]
  ds_read_b64_tr_b16 a[176:177], v26 offset:61440
  ds_read_b64_tr_b16 a[178:179], v26 offset:61952
  v_mfma_f32_16x16x32_bf16 v[208:211], a[216:219], a[104:107], v[208:211]
  ds_read_b64_tr_b16 a[180:181], v27 offset:61440
  v_rcp_f32 v120, v120
  v_mfma_f32_16x16x32_bf16 v[212:215], a[216:219], a[108:111], v[212:215]
  ds_read_b64_tr_b16 a[182:183], v27 offset:61952
  buffer_load_dwordx4 a[88:91], v1, s[8:11], s81 offen offset:2048 sc1
  v_mfma_f32_16x16x32_bf16 v[216:219], a[220:223], a[104:107], v[216:219]
  ds_read_b64_tr_b16 a[168:169], v28 offset:53248
  ds_read_b64_tr_b16 a[170:171], v28 offset:53760
  v_mfma_f32_16x16x32_bf16 v[220:223], a[220:223], a[108:111], v[220:223]
  ds_read_b64_tr_b16 a[172:173], v29 offset:53248
  v_fma_f32 v121, v121, v58, v58
  v_mfma_f32_16x16x32_bf16 v[192:195], a[208:211], a[104:107], v[192:195]
  ds_read_b64_tr_b16 a[174:175], v29 offset:53760
  v_rcp_f32 v121, v121
  v_mfma_f32_16x16x32_bf16 v[196:199], a[208:211], a[108:111], v[196:199]
  ds_read_b64_tr_b16 a[184:185], v28 offset:61440
  ds_read_b64_tr_b16 a[186:187], v28 offset:61952
  v_mfma_f32_16x16x32_bf16 v[200:203], a[212:215], a[104:107], v[200:203]
  ds_read_b64_tr_b16 a[188:189], v29 offset:61440
  buffer_load_dwordx4 a[92:95], v1, s[8:11], s81 offen offset:3072 sc1
  v_mfma_f32_16x16x32_bf16 v[204:207], a[212:215], a[108:111], v[204:207]
  ds_read_b64_tr_b16 a[190:191], v29 offset:61952
  v_fma_f32 v122, v122, v58, v58
  v_mfma_f32_16x16x32_bf16 v[224:227], a[224:227], a[104:107], v[224:227]
  buffer_load_dwordx4 a[96:99], v3, s[8:11], s81 offen offset:0 sc1
  v_fma_f32 v123, v123, v58, v58
  v_mfma_f32_16x16x32_bf16 v[228:231], a[224:227], a[108:111], v[228:231]
  v_rcp_f32 v122, v122
  v_mul_f32 v152, v152, v120
  v_mfma_f32_16x16x32_bf16 v[232:235], a[228:231], a[104:107], v[232:235]
  v_rcp_f32 v123, v123
  v_mfma_f32_16x16x32_bf16 v[236:239], a[228:231], a[108:111], v[236:239]
  s_waitcnt lgkmcnt(0)
  v_mul_f32 v153, v153, v121
  v_mfma_f32_16x16x32_bf16 v[176:179], a[160:163], a[112:115], v[176:179]
  ds_read_b64_tr_b16 a[200:201], v30 offset:53248
  s_waitcnt vmcnt(9)
  v_cmp_ne_u32 vcc, s64, v73
  s_cbranch_vccnz E_slow3
E_ok3:
  v_mfma_f32_16x16x32_bf16 v[180:183], a[160:163], a[116:119], v[180:183]
  ds_read_b64_tr_b16 a[202:203], v30 offset:53760
  s_add_u32 m0, s67, 126976
  v_mul_f32 v154, v154, v122
  v_mfma_f32_16x16x32_bf16 v[160:163], a[240:243], a[160:163], v[160:163]
  ds_read_b64_tr_b16 a[204:205], v31 offset:53248
  buffer_load_dwordx4 v54, s[8:11], s75 offen offset:0 sc1 lds
  v_mfma_f32_16x16x32_bf16 v[184:187], a[164:167], a[112:115], v[184:187]
  ds_read_b64_tr_b16 a[206:207], v31 offset:53760
  buffer_load_dwordx4 v54, s[8:11], s75 offen offset:1024 sc1 lds
  v_mfma_f32_16x16x32_bf16 v[188:191], a[164:167], a[116:119], v[188:191]
  ds_read_b64_tr_b16 a[216:217], v30 offset:61440
  v_mul_f32 v155, v155, v123
  v_mfma_f32_16x16x32_bf16 v[160:163], a[244:247], a[164:167], v[160:163]
  ds_read_b64_tr_b16 a[218:219], v30 offset:61952
  v_cvt_pk_bf16_f32 v114, v152, v153
  v_mfma_f32_16x16x32_bf16 v[208:211], a[176:179], a[112:115], v[208:211]
  ds_read_b64_tr_b16 a[220:221], v31 offset:61440
  v_cvt_pk_bf16_f32 v115, v154, v155
  v_mfma_f32_16x16x32_bf16 v[212:215], a[176:179], a[116:119], v[212:215]
  ds_read_b64_tr_b16 a[222:223], v31 offset:61952
  buffer_load_dwordx4 v54, s[8:11], s75 offen offset:2048 sc1 lds
  v_mfma_f32_16x16x32_bf16 v[160:163], a[248:251], a[176:179], v[160:163]
  ds_read_b64_tr_b16 a[208:209], v32 offset:53248
  v_mfma_f32_16x16x32_bf16 v[216:219], a[180:183], a[112:115], v[216:219]
  ds_read_b64_tr_b16 a[210:211], v32 offset:53760
  v_mfma_f32_16x16x32_bf16 v[220:223], a[180:183], a[116:119], v[220:223]
  ds_read_b64_tr_b16 a[212:213], v33 offset:53248
  buffer_load_dwordx4 v54, s[8:11], s75 offen offset:3072 sc1 lds
  v_mfma_f32_16x16x32_bf16 v[160:163], a[252:255], a[180:183], v[160:163]
  ds_read_b64_tr_b16 a[214:215], v33 offset:53760
  s_add_u32 m0, s67, 131072
  v_mfma_f32_16x16x32_bf16 v[192:195], a[168:171], a[112:115], v[192:195]
  ds_read_b64_tr_b16 a[224:225], v32 offset:61440
  v_mfma_f32_16x16x32_bf16 v[196:199], a[168:171], a[116:119], v[196:199]
  ds_read_b64_tr_b16 a[226:227], v32 offset:61952
  v_mfma_f32_16x16x32_bf16 v[200:203], a[172:175], a[112:115], v[200:203]
  ds_read_b64_tr_b16 a[228:229], v33 offset:61440
  buffer_load_dwordx4 v55, s[8:11], s75 offen sc1 lds
  v_mfma_f32_16x16x32_bf16 v[204:207], a[172:175], a[116:119], v[204:207]
  ds_read_b64_tr_b16 a[230:231], v33 offset:61952
  v_mul_f32 v80, v116, v116
  v_mfma_f32_16x16x32_bf16 v[224:227], a[184:187], a[112:115], v[224:227]
  v_mul_f32 v148, v116, v148
  v_fma_f32 v80, v80, v63, v61
  v_mul_f32 v116, v80, v116
  v_mfma_f32_16x16x32_bf16 v[228:231], a[184:187], a[116:119], v[228:231]
  v_exp_f32 v116, v116
  v_mfma_f32_16x16x32_bf16 v[232:235], a[188:191], a[112:115], v[232:235]
  buffer_store_dwordx4 v[112:115], v1, s[8:11], s25 offen offset:0 sc1
  v_mul_f32 v81, v117, v117
  v_mfma_f32_16x16x32_bf16 v[236:239], a[188:191], a[116:119], v[236:239]
  s_waitcnt lgkmcnt(0)
  s_barrier
  s_add_u32 m0, s67, 16384
  v_mul_f32 v149, v117, v149
  v_mfma_f32_16x16x32_bf16 v[176:179], a[200:203], a[120:123], v[176:179]
  ds_read_b64_tr_b16 a[160:161], v34 offset:0
  ds_read_b64_tr_b16 a[162:163], v34 offset:512
  v_mfma_f32_16x16x32_bf16 v[180:183], a[200:203], a[124:127], v[180:183]
  ds_read_b64_tr_b16 a[164:165], v35 offset:0
  buffer_load_dwordx4 v54, s[8:11], s72 offen offset:0 sc1 lds
  v_mfma_f32_16x16x32_bf16 v[184:187], a[204:207], a[120:123], v[184:187]
  ds_read_b64_tr_b16 a[166:167], v35 offset:512
  v_fma_f32 v81, v81, v63, v61
  v_mul_f32 v117, v81, v117
  v_mfma_f32_16x16x32_bf16 v[188:191], a[204:207], a[124:127], v[188:191]
  ds_read_b64_tr_b16 a[176:177], v34 offset:8192
  ds_read_b64_tr_b16 a[178:179], v34 offset:8704
  v_mfma_f32_16x16x32_bf16 v[208:211], a[216:219], a[120:123], v[208:211]
  ds_read_b64_tr_b16 a[180:181], v35 offset:8192
  v_mul_f32 v82, v118, v118
  v_mfma_f32_16x16x32_bf16 v[212:215], a[216:219], a[124:127], v[212:215]
  ds_read_b64_tr_b16 a[182:183], v35 offset:8704
  buffer_load_dwordx4 v54, s[8:11], s72 offen offset:1024 sc1 lds
  v_mul_f32 v150, v118, v150
  v_mfma_f32_16x16x32_bf16 v[216:219], a[220:223], a[120:123], v[216:219]
  ds_read_b64_tr_b16 a[168:169], v36 offset:0
  ds_read_b64_tr_b16 a[170:171], v36 offset:512
  v_mfma_f32_16x16x32_bf16 v[220:223], a[220:223], a[124:127], v[220:223]
  ds_read_b64_tr_b16 a[172:173], v37 offset:0
  v_fma_f32 v82, v82, v63, v61
  v_mfma_f32_16x16x32_bf16 v[192:195], a[208:211], a[120:123], v[192:195]
  ds_read_b64_tr_b16 a[174:175], v37 offset:512
  buffer_load_dwordx4 v54, s[8:11], s72 offen offset:2048 sc1 lds
  v_mul_f32 v118, v82, v118
  v_mfma_f32_16x16x32_bf16 v[196:199], a[208:211], a[124:127], v[196:199]
  ds_read_b64_tr_b16 a[184:185], v36 offset:8192
  ds_read_b64_tr_b16 a[186:187], v36 offset:8704
  v_mfma_f32_16x16x32_bf16 v[200:203], a[212:215], a[120:123], v[200:203]
  ds_read_b64_tr_b16 a[188:189], v37 offset:8192
  v_mul_f32 v83, v119, v119
  v_mfma_f32_16x16x32_bf16 v[204:207], a[212:215], a[124:127], v[204:207]
  ds_read_b64_tr_b16 a[190:191], v37 offset:8704
  v_exp_f32 v117, v117
  v_mfma_f32_16x16x32_bf16 v[224:227], a[224:227], a[120:123], v[224:227]
  buffer_load_dwordx4 v54, s[8:11], s72 offen offset:3072 sc1 lds
  s_add_u32 m0, s67, 20480
  v_mfma_f32_16x16x32_bf16 v[228:231], a[224:227], a[124:127], v[228:231]
  v_exp_f32 v118, v118
  v_mul_f32 v151, v119, v151
  v_mfma_f32_16x16x32_bf16 v[232:235], a[228:231], a[120:123], v[232:235]
  v_fma_f32 v83, v83, v63, v61
  v_mul_f32 v119, v83, v119
  v_mfma_f32_16x16x32_bf16 v[236:239], a[228:231], a[124:127], v[236:239]
  s_waitcnt lgkmcnt(0)
  v_fma_f32 v116, v116, v62, v62
  v_mfma_f32_16x16x32_bf16 v[176:179], a[160:163], a[128:131], v[176:179]
  ds_read_b64_tr_b16 a[200:201], v38 offset:0
  buffer_load_dwordx4 v55, s[8:11], s72 offen sc1 lds
  v_fma_f32 v117, v117, v62, v62
  v_mfma_f32_16x16x32_bf16 v[180:183], a[160:163], a[132:135], v[180:183]
  ds_read_b64_tr_b16 a[202:203], v38 offset:512
  s_add_u32 m0, s66, 36864
  v_mfma_f32_16x16x32_bf16 v[160:163], a[240:243], a[160:163], v[160:163]
  ds_read_b64_tr_b16 a[204:205], v39 offset:0
  s_mul_i32 s73, s70, 160
  v_mfma_f32_16x16x32_bf16 v[184:187], a[164:167], a[128:131], v[184:187]
  ds_read_b64_tr_b16 a[206:207], v39 offset:512
  buffer_load_dwordx4 v44, s[48:51], s70 offen offset:0 lds
  v_fma_f32 v118, v118, v62, v62
  v_mfma_f32_16x16x32_bf16 v[188:191], a[164:167], a[132:135], v[188:191]
  ds_read_b64_tr_b16 a[216:217], v38 offset:8192
  v_mul_f32 v80, v124, v124
  v_mfma_f32_16x16x32_bf16 v[160:163], a[244:247], a[164:167], v[160:163]
  ds_read_b64_tr_b16 a[218:219], v38 offset:8704
  v_mul_f32 v156, v124, v156
  v_mfma_f32_16x16x32_bf16 v[208:211], a[176:179], a[128:131], v[208:211]
  ds_read_b64_tr_b16 a[220:221], v39 offset:8192
  v_exp_f32 v119, v119
  v_mfma_f32_16x16x32_bf16 v[212:215], a[176:179], a[132:135], v[212:215]
  ds_read_b64_tr_b16 a[222:223], v39 offset:8704
  buffer_load_dwordx4 v45, s[48:51], s70 offen offset:1024 lds
  v_mfma_f32_16x16x32_bf16 v[160:163], a[248:251], a[176:179], v[160:163]
  ds_read_b64_tr_b16 a[208:209], v40 offset:0
  v_fma_f32 v119, v119, v62, v62
  v_mfma_f32_16x16x32_bf16 v[216:219], a[180:183], a[128:131], v[216:219]
  ds_read_b64_tr_b16 a[210:211], v40 offset:512
  v_rcp_f32 v116, v116
  v_mfma_f32_16x16x32_bf16 v[220:223], a[180:183], a[132:135], v[220:223]
  ds_read_b64_tr_b16 a[212:213], v41 offset:0
  buffer_load_dwordx4 v46, s[48:51], s70 offen offset:2048 lds
  v_mfma_f32_16x16x32_bf16 v[160:163], a[252:255], a[180:183], v[160:163]
  ds_read_b64_tr_b16 a[214:215], v41 offset:512
  v_mul_f32 v148, v148, v116
  v_mfma_f32_16x16x32_bf16 v[192:195], a[168:171], a[128:131], v[192:195]
  ds_read_b64_tr_b16 a[224:225], v40 offset:8192
  v_rcp_f32 v117, v117
  v_mfma_f32_16x16x32_bf16 v[196:199], a[168:171], a[132:135], v[196:199]
  ds_read_b64_tr_b16 a[226:227], v40 offset:8704
  v_mul_f32 v149, v149, v117
  v_mfma_f32_16x16x32_bf16 v[200:203], a[172:175], a[128:131], v[200:203]
  ds_read_b64_tr_b16 a[228:229], v41 offset:8192
  buffer_load_dwordx4 v47, s[48:51], s70 offen offset:3072 lds
  v_mfma_f32_16x16x32_bf16 v[204:207], a[172:175], a[132:135], v[204:207]
  ds_read_b64_tr_b16 a[230:231], v41 offset:8704
  s_add_u32 s70, s70, 128
  v_cvt_pk_bf16_f32 v116, v148, v149
  v_mfma_f32_16x16x32_bf16 v[224:227], a[184:187], a[128:131], v[224:227]
  s_and_b32 s70, s70, 0x7ff
  s_add_u32 m0, s67, 53248
  v_mfma_f32_16x16x32_bf16 v[228:231], a[184:187], a[132:135], v[228:231]
  v_rcp_f32 v118, v118
  v_mfma_f32_16x16x32_bf16 v[232:235], a[188:191], a[128:131], v[232:235]
  buffer_load_dwordx4 v54, s[8:11], s73 offen offset:0 sc1 lds
  v_rcp_f32 v119, v119
  v_mfma_f32_16x16x32_bf16 v[236:239], a[188:191], a[132:135], v[236:239]
  s_waitcnt lgkmcnt(0)
  v_mul_f32 v150, v150, v118
  v_mfma_f32_16x16x32_bf16 v[176:179], a[200:203], a[136:139], v[176:179]
  ds_read_b64_tr_b16 a[160:161], v34 offset:16384
  ds_read_b64_tr_b16 a[162:163], v34 offset:16896
  v_mfma_f32_16x16x32_bf16 v[180:183], a[200:203], a[140:143], v[180:183]
  ds_read_b64_tr_b16 a[164:165], v35 offset:16384
  buffer_load_dwordx4 v54, s[8:11], s73 offen offset:1024 sc1 lds
  v_mul_f32 v151, v151, v119
  v_mfma_f32_16x16x32_bf16 v[184:187], a[204:207], a[136:139], v[184:187]
  ds_read_b64_tr_b16 a[166:167], v35 offset:16896
  v_cvt_pk_bf16_f32 v117, v150, v151
  v_mfma_f32_16x16x32_bf16 v[188:191], a[204:207], a[140:143], v[188:191]
  ds_read_b64_tr_b16 a[176:177], v34 offset:24576
  ds_read_b64_tr_b16 a[178:179], v34 offset:25088
  v_mfma_f32_16x16x32_bf16 v[208:211], a[216:219], a[136:139], v[208:211]
  ds_read_b64_tr_b16 a[180:181], v35 offset:24576
  v_fma_f32 v80, v80, v63, v61
  v_mul_f32 v124, v80, v124
  v_mfma_f32_16x16x32_bf16 v[212:215], a[216:219], a[140:143], v[212:215]
  ds_read_b64_tr_b16 a[182:183], v35 offset:25088
  buffer_load_dwordx4 v54, s[8:11], s73 offen offset:2048 sc1 lds
  v_mfma_f32_16x16x32_bf16 v[216:219], a[220:223], a[136:139], v[216:219]
  ds_read_b64_tr_b16 a[168:169], v36 offset:16384
  ds_read_b64_tr_b16 a[170:171], v36 offset:16896
  v_mfma_f32_16x16x32_bf16 v[220:223], a[220:223], a[140:143], v[220:223]
  ds_read_b64_tr_b16 a[172:173], v37 offset:16384
  v_exp_f32 v124, v124
  v_mfma_f32_16x16x32_bf16 v[192:195], a[208:211], a[136:139], v[192:195]
  ds_read_b64_tr_b16 a[174:175], v37 offset:16896
  buffer_load_dwordx4 v54, s[8:11], s73 offen offset:3072 sc1 lds
  v_mfma_f32_16x16x32_bf16 v[196:199], a[208:211], a[140:143], v[196:199]
  ds_read_b64_tr_b16 a[184:185], v36 offset:24576
  ds_read_b64_tr_b16 a[186:187], v36 offset:25088
  v_mul_f32 v81, v125, v125
  v_mfma_f32_16x16x32_bf16 v[200:203], a[212:215], a[136:139], v[200:203]
  ds_read_b64_tr_b16 a[188:189], v37 offset:24576
  s_add_u32 m0, s67, 57344
  v_mfma_f32_16x16x32_bf16 v[204:207], a[212:215], a[140:143], v[204:207]
  ds_read_b64_tr_b16 a[190:191], v37 offset:25088
  v_mul_f32 v157, v125, v157
  v_mfma_f32_16x16x32_bf16 v[224:227], a[224:227], a[136:139], v[224:227]
  buffer_load_dwordx4 v55, s[8:11], s73 offen sc1 lds
  v_fma_f32 v81, v81, v63, v61
  v_mul_f32 v125, v81, v125
  v_mfma_f32_16x16x32_bf16 v[228:231], a[224:227], a[140:143], v[228:231]
  v_exp_f32 v125, v125
  v_mfma_f32_16x16x32_bf16 v[232:235], a[228:231], a[136:139], v[232:235]
  s_add_u32 s81, s77, 204800
  v_mul_f32 v82, v126, v126
  v_mfma_f32_16x16x32_bf16 v[236:239], a[228:231], a[140:143], v[236:239]
  s_waitcnt lgkmcnt(0)
  v_mul_f32 v158, v126, v158
  v_fma_f32 v82, v82, v63, v61
  v_mfma_f32_16x16x32_bf16 v[176:179], a[160:163], a[144:147], v[176:179]
  ds_read_b64_tr_b16 a[200:201], v38 offset:16384
  buffer_load_dwordx4 a[100:103], v1, s[8:11], s81 offen offset:0 sc1
  v_mfma_f32_16x16x32_bf16 v[180:183], a[160:163], a[148:151], v[180:183]
  ds_read_b64_tr_b16 a[202:203], v38 offset:16896
  v_mul_f32 v126, v82, v126
  v_mfma_f32_16x16x32_bf16 v[160:163], a[240:243], a[160:163], v[160:163]
  ds_read_b64_tr_b16 a[204:205], v39 offset:16384
  v_exp_f32 v126, v126
  v_mfma_f32_16x16x32_bf16 v[184:187], a[164:167], a[144:147], v[184:187]
  ds_read_b64_tr_b16 a[206:207], v39 offset:16896
  buffer_load_dwordx4 a[104:107], v1, s[8:11], s81 offen offset:1024 sc1
  v_mfma_f32_16x16x32_bf16 v[188:191], a[164:167], a[148:151], v[188:191]
  ds_read_b64_tr_b16 a[216:217], v38 offset:24576
  v_mul_f32 v83, v127, v127
  v_mfma_f32_16x16x32_bf16 v[160:163], a[244:247], a[164:167], v[160:163]
  ds_read_b64_tr_b16 a[218:219], v38 offset:25088
  v_mul_f32 v159, v127, v159
  v_fma_f32 v83, v83, v63, v61
  v_mfma_f32_16x16x32_bf16 v[208:211], a[176:179], a[144:147], v[208:211]
  ds_read_b64_tr_b16 a[220:221], v39 offset:24576
  v_mul_f32 v127, v83, v127
  v_mfma_f32_16x16x32_bf16 v[212:215], a[176:179], a[148:151], v[212:215]
  ds_read_b64_tr_b16 a[222:223], v39 offset:25088
  buffer_load_dwordx4 a[108:111], v1, s[8:11], s81 offen offset:2048 sc1
  v_mfma_f32_16x16x32_bf16 v[160:163], a[248:251], a[176:179], v[160:163]
  ds_read_b64_tr_b16 a[208:209], v40 offset:16384
  v_exp_f32 v127, v127
  v_mfma_f32_16x16x32_bf16 v[216:219], a[180:183], a[144:147], v[216:219]
  ds_read_b64_tr_b16 a[210:211], v40 offset:16896
  v_fma_f32 v124, v124, v62, v62
  v_mfma_f32_16x16x32_bf16 v[220:223], a[180:183], a[148:151], v[220:223]
  ds_read_b64_tr_b16 a[212:213], v41 offset:16384
  buffer_load_dwordx4 a[112:115], v1, s[8:11], s81 offen offset:3072 sc1
  v_mfma_f32_16x16x32_bf16 v[160:163], a[252:255], a[180:183], v[160:163]
  ds_read_b64_tr_b16 a[214:215], v41 offset:16896
  v_rcp_f32 v124, v124
  v_mfma_f32_16x16x32_bf16 v[192:195], a[168:171], a[144:147], v[192:195]
  ds_read_b64_tr_b16 a[224:225], v40 offset:24576
  v_fma_f32 v125, v125, v62, v62
  v_mfma_f32_16x16x32_bf16 v[196:199], a[168:171], a[148:151], v[196:199]
  ds_read_b64_tr_b16 a[226:227], v40 offset:25088
  s_nop 0
  v_cvt_pk_bf16_f32 v161, v160, v160
  v_mfma_f32_16x16x32_bf16 v[200:203], a[172:175], a[144:147], v[200:203]
  ds_read_b64_tr_b16 a[228:229], v41 offset:24576
  v_and_b32 v161, 0xffff0000, v161
  v_fma_f32 v126, v126, v62, v62
  v_mfma_f32_16x16x32_bf16 v[204:207], a[172:175], a[148:151], v[204:207]
  ds_read_b64_tr_b16 a[230:231], v41 offset:25088
  v_sub_f32 v161, v160, v161
  v_mfma_f32_16x16x32_bf16 v[224:227], a[184:187], a[144:147], v[224:227]
  v_cvt_pk_bf16_f32 v161, v160, v161
  ds_write_b32 v68, v161 offset:4096
  v_mfma_f32_16x16x32_bf16 v[228:231], a[184:187], a[148:151], v[228:231]
  buffer_load_dwordx4 a[116:119], v3, s[8:11], s81 offen offset:0 sc1
  s_add_u32 s81, s77, 245760
  v_fma_f32 v127, v127, v62, v62
  v_mfma_f32_16x16x32_bf16 v[232:235], a[188:191], a[144:147], v[232:235]
  buffer_load_dwordx4 a[120:123], v1, s[8:11], s81 offen offset:0 sc1
  v_mul_f32 v156, v156, v124
  v_mfma_f32_16x16x32_bf16 v[236:239], a[188:191], a[148:151], v[236:239]
  s_waitcnt vmcnt(21) lgkmcnt(0)
  s_barrier
  v_mfma_f32_16x16x32_bf16 v[176:179], a[200:203], a[152:155], v[176:179]
  ds_read_b128 v[240:243], v69 offset:4096
  v_rcp_f32 v125, v125
  v_mfma_f32_16x16x32_bf16 v[180:183], a[200:203], a[156:159], v[180:183]
  ds_read_b128 v[244:247], v69 offset:4608
  buffer_load_dwordx4 a[124:127], v1, s[8:11], s81 offen offset:1024 sc1
  v_mfma_f32_16x16x32_bf16 v[184:187], a[204:207], a[152:155], v[184:187]
  ds_read_b128 v[248:251], v70 offset:4096
  v_mul_f32 v157, v157, v125
  v_mfma_f32_16x16x32_bf16 v[188:191], a[204:207], a[156:159], v[188:191]
  ds_read_b128 v[252:255], v70 offset:4608
  v_rcp_f32 v126, v126
  v_mfma_f32_16x16x32_bf16 v[208:211], a[216:219], a[152:155], v[208:211]
  ds_read_b128 a[176:179], v53 offset:36864
  v_mul_f32 v158, v158, v126
  v_mfma_f32_16x16x32_bf16 v[212:215], a[216:219], a[156:159], v[212:215]
  ds_read_b128 a[160:163], v50 offset:36864
  buffer_load_dwordx4 a[128:131], v1, s[8:11], s81 offen offset:2048 sc1
  v_cvt_pk_bf16_f32 v118, v156, v157
  v_mfma_f32_16x16x32_bf16 v[216:219], a[220:223], a[152:155], v[216:219]
  ds_read_b128 a[164:167], v50 offset:37376
  v_mfma_f32_16x16x32_bf16 v[220:223], a[220:223], a[156:159], v[220:223]
  ds_read_b128 a[168:171], v50 offset:40960
  v_mfma_f32_16x16x32_bf16 v[192:195], a[208:211], a[152:155], v[192:195]
  ds_read_b128 a[172:175], v50 offset:41472
  buffer_load_dwordx4 a[132:135], v1, s[8:11], s81 offen offset:3072 sc1
  v_mfma_f32_16x16x32_bf16 v[196:199], a[208:211], a[156:159], v[196:199]
  ds_read_b128 a[180:183], v53 offset:37888
  v_mfma_f32_16x16x32_bf16 v[200:203], a[212:215], a[152:155], v[200:203]
  ds_read_b128 a[184:187], v53 offset:38912
  v_mfma_f32_16x16x32_bf16 v[204:207], a[212:215], a[156:159], v[204:207]
  ds_read_b128 a[188:191], v53 offset:39936
  v_rcp_f32 v127, v127
  v_mfma_f32_16x16x32_bf16 v[224:227], a[224:227], a[152:155], v[224:227]
  ds_read_b128 a[192:195], v53 offset:40960
  buffer_load_dwordx4 a[136:139], v3, s[8:11], s81 offen offset:0 sc1
  v_mfma_f32_16x16x32_bf16 v[228:231], a[224:227], a[156:159], v[228:231]
  v_mul_f32 v159, v159, v127
  v_cvt_pk_bf16_f32 v119, v158, v159
  v_mfma_f32_16x16x32_bf16 v[232:235], a[228:231], a[152:155], v[232:235]
  s_add_u32 m0, s66, 73728
  s_mul_i32 s74, s70, 160
  v_mfma_f32_16x16x32_bf16 v[236:239], a[228:231], a[156:159], v[236:239]
  s_waitcnt lgkmcnt(12)
  v_mfma_f32_16x16x16_bf16 v[176:179], v[240:241], v[64:65], v[176:179]
  buffer_load_dwordx4 v44, s[48:51], s70 offen offset:0 lds
  s_waitcnt lgkmcnt(11)
  v_mfma_f32_16x16x16_bf16 v[208:211], v[244:245], v[64:65], v[208:211]
  v_mfma_f32_16x16x16_bf16 v[184:187], v[242:243], v[64:65], v[184:187]
  v_mfma_f32_16x16x16_bf16 v[216:219], v[246:247], v[64:65], v[216:219]
  buffer_load_dwordx4 v45, s[48:51], s70 offen offset:1024 lds
  v_mfma_f32_16x16x16_bf16 v[180:183], v[240:241], v[66:67], v[180:183]
  s_nop 0
  v_mul_f32 v80, v176, v176
  s_nop 1
  v_mul_f32 v208, v176, v208
  v_mfma_f32_16x16x16_bf16 v[212:215], v[244:245], v[66:67], v[212:215]
  v_fma_f32 v80, v80, v59, v57
  v_mul_f32 v176, v80, v176
  v_mfma_f32_16x16x16_bf16 v[188:191], v[242:243], v[66:67], v[188:191]
  v_exp_f32 v176, v176
  v_mfma_f32_16x16x16_bf16 v[220:223], v[246:247], v[66:67], v[220:223]
  buffer_load_dwordx4 v46, s[48:51], s70 offen offset:2048 lds
  v_mul_f32 v81, v177, v177
  s_waitcnt lgkmcnt(10)
  v_mfma_f32_16x16x16_bf16 v[192:195], v[248:249], v[64:65], v[192:195]
  v_mul_f32 v209, v177, v209
  v_fma_f32 v81, v81, v59, v57
  s_waitcnt lgkmcnt(9)
  v_mfma_f32_16x16x16_bf16 v[224:227], v[252:253], v[64:65], v[224:227]
  v_mul_f32 v177, v81, v177
  v_mul_f32 v82, v178, v178
  v_mfma_f32_16x16x16_bf16 v[200:203], v[250:251], v[64:65], v[200:203]
  buffer_load_dwordx4 v47, s[48:51], s70 offen offset:3072 lds
  s_add_u32 s70, s70, 128
  v_mfma_f32_16x16x16_bf16 v[232:235], v[254:255], v[64:65], v[232:235]
  s_and_b32 s70, s70, 0x7ff
  v_mul_f32 v210, v178, v210
  v_mfma_f32_16x16x16_bf16 v[196:199], v[248:249], v[66:67], v[196:199]
  buffer_store_dwordx4 v[116:119], v1, s[8:11], s25 offen offset:1024 sc1
  v_fma_f32 v82, v82, v59, v57
  v_mfma_f32_16x16x16_bf16 v[228:231], v[252:253], v[66:67], v[228:231]
  v_exp_f32 v177, v177
  v_mfma_f32_16x16x16_bf16 v[204:207], v[250:251], v[66:67], v[204:207]
  s_add_u32 m0, s67, 90112
  v_mul_f32 v178, v82, v178
  v_mfma_f32_16x16x16_bf16 v[236:239], v[254:255], v[66:67], v[236:239]
  s_waitcnt lgkmcnt(0)
  v_mul_f32 v83, v179, v179
  v_mfma_f32_16x16x32_bf16 v[96:99], a[176:179], a[160:163], 0
  ds_read_b128 a[216:219], v53 offset:47104
  buffer_load_dwordx4 v54, s[8:11], s74 offen offset:0 sc1 lds
  v_mfma_f32_16x16x32_bf16 v[116:119], a[176:179], a[164:167], 0
  ds_read_b128 a[200:203], v51 offset:36864
  v_mul_f32 v211, v179, v211
  v_mfma_f32_16x16x32_bf16 v[136:139], a[176:179], a[168:171], 0
  ds_read_b128 a[204:207], v51 offset:37376
  v_fma_f32 v83, v83, v59, v57
  v_mfma_f32_16x16x32_bf16 v[156:159], a[176:179], a[172:175], 0
  ds_read_b128 a[208:211], v51 offset:40960
  v_mul_f32 v179, v83, v179
  v_mfma_f32_16x16x32_bf16 v[100:103], a[180:183], a[160:163], 0
  ds_read_b128 a[212:215], v51 offset:41472
  buffer_load_dwordx4 v54, s[8:11], s74 offen offset:1024 sc1 lds
  v_mfma_f32_16x16x32_bf16 v[120:123], a[180:183], a[164:167], 0
  ds_read_b128 a[220:223], v53 offset:48128
  v_fma_f32 v176, v176, v58, v58
  v_mfma_f32_16x16x32_bf16 v[140:143], a[180:183], a[168:171], 0
  ds_read_b128 a[224:227], v53 offset:49152
  v_fma_f32 v177, v177, v58, v58
  v_mfma_f32_16x16x32_bf16 v[160:163], a[180:183], a[172:175], 0
  ds_read_b128 a[228:231], v53 offset:50176
  buffer_load_dwordx4 v54, s[8:11], s74 offen offset:2048 sc1 lds
  v_mfma_f32_16x16x32_bf16 v[104:107], a[184:187], a[160:163], 0
  ds_read_b128 a[232:235], v53 offset:51200
  v_mul_f32 v80, v184, v184
  v_mfma_f32_16x16x32_bf16 v[124:127], a[184:187], a[164:167], 0
  v_exp_f32 v178, v178
  v_mfma_f32_16x16x32_bf16 v[144:147], a[184:187], a[168:171], 0
  v_exp_f32 v179, v179
  v_mfma_f32_16x16x32_bf16 v[164:167], a[184:187], a[172:175], 0
  buffer_load_dwordx4 v54, s[8:11], s74 offen offset:3072 sc1 lds
  s_add_u32 m0, s67, 94208
  v_mfma_f32_16x16x32_bf16 v[108:111], a[188:191], a[160:163], 0
  v_rcp_f32 v176, v176
  v_mfma_f32_16x16x32_bf16 v[128:131], a[188:191], a[164:167], 0
  v_rcp_f32 v177, v177
  v_mfma_f32_16x16x32_bf16 v[148:151], a[188:191], a[168:171], 0
  buffer_load_dwordx4 v55, s[8:11], s74 offen sc1 lds
  v_fma_f32 v178, v178, v58, v58
  v_mfma_f32_16x16x32_bf16 v[168:171], a[188:191], a[172:175], 0
  v_rcp_f32 v178, v178
  v_mfma_f32_16x16x32_bf16 v[112:115], a[192:195], a[160:163], 0
  s_add_u32 s81, s77, 286720
  v_fma_f32 v179, v179, v58, v58
  v_mfma_f32_16x16x32_bf16 v[132:135], a[192:195], a[164:167], 0
  v_rcp_f32 v179, v179
  v_mfma_f32_16x16x32_bf16 v[152:155], a[192:195], a[168:171], 0
  buffer_load_dwordx4 a[140:143], v1, s[8:11], s81 offen offset:0 sc1
  v_mul_f32 v208, v208, v176
  v_mfma_f32_16x16x32_bf16 v[172:175], a[192:195], a[172:175], 0
  s_waitcnt vmcnt(30) lgkmcnt(0)
  s_barrier
  v_mul_f32 v209, v209, v177
  v_mfma_f32_16x16x32_bf16 v[96:99], a[216:219], a[200:203], v[96:99]
  ds_read_b128 a[176:179], v52 offset:0
  v_mul_f32 v210, v210, v178
  v_mfma_f32_16x16x32_bf16 v[116:119], a[216:219], a[204:207], v[116:119]
  ds_read_b128 a[160:163], v48 offset:0
  v_mul_f32 v211, v211, v179
  v_mfma_f32_16x16x32_bf16 v[136:139], a[216:219], a[208:211], v[136:139]
  ds_read_b128 a[164:167], v48 offset:512
  buffer_load_dwordx4 a[144:147], v1, s[8:11], s81 offen offset:1024 sc1
  v_mfma_f32_16x16x32_bf16 v[156:159], a[216:219], a[212:215], v[156:159]
  ds_read_b128 a[168:171], v48 offset:4096
  v_cvt_pk_bf16_f32 v176, v208, v209
  v_mfma_f32_16x16x32_bf16 v[100:103], a[220:223], a[200:203], v[100:103]
  ds_read_b128 a[172:175], v48 offset:4608
  v_cvt_pk_bf16_f32 v177, v210, v211
  v_mfma_f32_16x16x32_bf16 v[120:123], a[220:223], a[204:207], v[120:123]
  ds_read_b128 a[180:183], v52 offset:1024
  buffer_load_dwordx4 a[148:151], v1, s[8:11], s81 offen offset:2048 sc1
  v_mfma_f32_16x16x32_bf16 v[140:143], a[220:223], a[208:211], v[140:143]
  ds_read_b128 a[184:187], v52 offset:2048
  v_mul_f32 v216, v184, v216
  v_mfma_f32_16x16x32_bf16 v[160:163], a[220:223], a[212:215], v[160:163]
  ds_read_b128 a[188:191], v52 offset:3072
  v_fma_f32 v80, v80, v59, v57
  v_mfma_f32_16x16x32_bf16 v[104:107], a[224:227], a[200:203], v[104:107]
  ds_read_b128 a[192:195], v52 offset:4096
  v_mul_f32 v184, v80, v184
  v_mfma_f32_16x16x32_bf16 v[124:127], a[224:227], a[204:207], v[124:127]
  buffer_load_dwordx4 a[152:155], v1, s[8:11], s81 offen offset:3072 sc1
  v_mul_f32 v81, v185, v185
  v_mfma_f32_16x16x32_bf16 v[144:147], a[224:227], a[208:211], v[144:147]
  v_exp_f32 v184, v184
  v_mfma_f32_16x16x32_bf16 v[164:167], a[224:227], a[212:215], v[164:167]
  v_mul_f32 v217, v185, v217
  v_fma_f32 v81, v81, v59, v57
  v_mfma_f32_16x16x32_bf16 v[108:111], a[228:231], a[200:203], v[108:111]
  buffer_load_dwordx4 a[156:159], v3, s[8:11], s81 offen offset:0 sc1
  v_mul_f32 v185, v81, v185
  v_mfma_f32_16x16x32_bf16 v[128:131], a[228:231], a[204:207], v[128:131]
  v_exp_f32 v185, v185
  v_mfma_f32_16x16x32_bf16 v[148:151], a[228:231], a[208:211], v[148:151]
  s_add_u32 m0, s66, 110592
  s_mul_i32 s75, s70, 160
  v_mfma_f32_16x16x32_bf16 v[168:171], a[228:231], a[212:215], v[168:171]
  v_mul_f32 v82, v186, v186
  v_mul_f32 v218, v186, v218
  v_mfma_f32_16x16x32_bf16 v[112:115], a[232:235], a[200:203], v[112:115]
  buffer_load_dwordx4 v44, s[48:51], s70 offen offset:0 lds
  v_fma_f32 v82, v82, v59, v57
  v_mfma_f32_16x16x32_bf16 v[132:135], a[232:235], a[204:207], v[132:135]
  v_mul_f32 v186, v82, v186
  v_mul_f32 v83, v187, v187
  v_mfma_f32_16x16x32_bf16 v[152:155], a[232:235], a[208:211], v[152:155]
  v_exp_f32 v186, v186
  v_mfma_f32_16x16x32_bf16 v[172:175], a[232:235], a[212:215], v[172:175]
  s_waitcnt lgkmcnt(0)
  v_mul_f32 v219, v187, v219
  v_mfma_f32_16x16x32_bf16 v[96:99], a[176:179], a[160:163], v[96:99]
  ds_read_b128 a[216:219], v52 offset:10240
  buffer_load_dwordx4 v45, s[48:51], s70 offen offset:1024 lds
  v_mfma_f32_16x16x32_bf16 v[116:119], a[176:179], a[164:167], v[116:119]
  ds_read_b128 a[200:203], v49 offset:0
  v_fma_f32 v83, v83, v59, v57
  v_mfma_f32_16x16x32_bf16 v[136:139], a[176:179], a[168:171], v[136:139]
  ds_read_b128 a[204:207], v49 offset:512
  v_mul_f32 v187, v83, v187
  v_mfma_f32_16x16x32_bf16 v[156:159], a[176:179], a[172:175], v[156:159]
  ds_read_b128 a[208:211], v49 offset:4096
  buffer_load_dwordx4 v46, s[48:51], s70 offen offset:2048 lds
  v_mfma_f32_16x16x32_bf16 v[100:103], a[180:183], a[160:163], v[100:103]
  ds_read_b128 a[212:215], v49 offset:4608
  v_fma_f32 v184, v184, v58, v58
  v_mfma_f32_16x16x32_bf16 v[120:123], a[180:183], a[164:167], v[120:123]
  ds_read_b128 a[220:223], v52 offset:11264
  v_fma_f32 v185, v185, v58, v58
  v_mfma_f32_16x16x32_bf16 v[140:143], a[180:183], a[168:171], v[140:143]
  ds_read_b128 a[224:227], v52 offset:12288
  v_fma_f32 v186, v186, v58, v58
  v_mfma_f32_16x16x32_bf16 v[160:163], a[180:183], a[172:175], v[160:163]
  ds_read_b128 a[228:231], v52 offset:13312
  buffer_load_dwordx4 v47, s[48:51], s70 offen offset:3072 lds
  v_mfma_f32_16x16x32_bf16 v[104:107], a[184:187], a[160:163], v[104:107]
  ds_read_b128 a[232:235], v52 offset:14336
  s_add_u32 s70, s70, 128
  v_mfma_f32_16x16x32_bf16 v[124:127], a[184:187], a[164:167], v[124:127]
  s_and_b32 s70, s70, 0x7ff
  s_add_u32 m0, s67, 126976
  v_mfma_f32_16x16x32_bf16 v[144:147], a[184:187], a[168:171], v[144:147]
  buffer_load_dwordx4 v54, s[8:11], s75 offen offset:0 sc1 lds
  v_mfma_f32_16x16x32_bf16 v[164:167], a[184:187], a[172:175], v[164:167]
  v_exp_f32 v187, v187
  v_mfma_f32_16x16x32_bf16 v[108:111], a[188:191], a[160:163], v[108:111]
  v_rcp_f32 v184, v184
  v_mfma_f32_16x16x32_bf16 v[128:131], a[188:191], a[164:167], v[128:131]
  v_rcp_f32 v185, v185
  v_mfma_f32_16x16x32_bf16 v[148:151], a[188:191], a[168:171], v[148:151]
  buffer_load_dwordx4 v54, s[8:11], s75 offen offset:1024 sc1 lds
  v_fma_f32 v187, v187, v58, v58
  v_mfma_f32_16x16x32_bf16 v[168:171], a[188:191], a[172:175], v[168:171]
  v_rcp_f32 v186, v186
  v_mfma_f32_16x16x32_bf16 v[112:115], a[192:195], a[160:163], v[112:115]
  v_rcp_f32 v187, v187
  v_mfma_f32_16x16x32_bf16 v[132:135], a[192:195], a[164:167], v[132:135]
  v_mul_f32 v216, v216, v184
  v_mul_f32 v217, v217, v185
  v_mfma_f32_16x16x32_bf16 v[152:155], a[192:195], a[168:171], v[152:155]
  buffer_load_dwordx4 v54, s[8:11], s75 offen offset:2048 sc1 lds
  v_mul_f32 v218, v218, v186
  v_mfma_f32_16x16x32_bf16 v[172:175], a[192:195], a[172:175], v[172:175]
  s_waitcnt vmcnt(32) lgkmcnt(0)
  s_barrier
  v_mul_f32 v219, v219, v187
  v_mfma_f32_16x16x32_bf16 v[96:99], a[216:219], a[200:203], v[96:99]
  ds_read_b128 a[176:179], v52 offset:36864
  v_cvt_pk_bf16_f32 v178, v216, v217
  v_mfma_f32_16x16x32_bf16 v[116:119], a[216:219], a[204:207], v[116:119]
  ds_read_b128 a[160:163], v48 offset:36864
  buffer_load_dwordx4 v54, s[8:11], s75 offen offset:3072 sc1 lds
  v_mfma_f32_16x16x32_bf16 v[136:139], a[216:219], a[208:211], v[136:139]
  ds_read_b128 a[164:167], v48 offset:37376
  s_add_u32 m0, s67, 131072
  v_mfma_f32_16x16x32_bf16 v[156:159], a[216:219], a[212:215], v[156:159]
  ds_read_b128 a[168:171], v48 offset:40960
  v_cvt_pk_bf16_f32 v179, v218, v219
  v_mfma_f32_16x16x32_bf16 v[100:103], a[220:223], a[200:203], v[100:103]
  ds_read_b128 a[172:175], v48 offset:41472
  v_mfma_f32_16x16x32_bf16 v[120:123], a[220:223], a[204:207], v[120:123]
  ds_read_b128 a[180:183], v52 offset:37888
  buffer_load_dwordx4 v55, s[8:11], s75 offen sc1 lds
  v_mfma_f32_16x16x32_bf16 v[140:143], a[220:223], a[208:211], v[140:143]
  ds_read_b128 a[184:187], v52 offset:38912
  v_mfma_f32_16x16x32_bf16 v[160:163], a[220:223], a[212:215], v[160:163]
  ds_read_b128 a[188:191], v52 offset:39936
  v_mfma_f32_16x16x32_bf16 v[104:107], a[224:227], a[200:203], v[104:107]
  ds_read_b128 a[192:195], v52 offset:40960
  s_waitcnt vmcnt(19)
  buffer_store_dword v71, v72, s[8:11], s28 offen sc1
  v_mfma_f32_16x16x32_bf16 v[124:127], a[224:227], a[204:207], v[124:127]
  v_mfma_f32_16x16x32_bf16 v[144:147], a[224:227], a[208:211], v[144:147]
  s_add_u32 m0, s66, 0
  s_mul_i32 s72, s70, 160
  v_mfma_f32_16x16x32_bf16 v[164:167], a[224:227], a[212:215], v[164:167]
  v_mfma_f32_16x16x32_bf16 v[108:111], a[228:231], a[200:203], v[108:111]
  buffer_load_dwordx4 v44, s[48:51], s70 offen offset:0 lds
  v_mfma_f32_16x16x32_bf16 v[128:131], a[228:231], a[204:207], v[128:131]
  buffer_load_dwordx4 v45, s[48:51], s70 offen offset:1024 lds
  v_mfma_f32_16x16x32_bf16 v[148:151], a[228:231], a[208:211], v[148:151]
  v_mfma_f32_16x16x32_bf16 v[168:171], a[228:231], a[212:215], v[168:171]
  v_mul_f32 v80, v180, v180
  v_mul_f32 v212, v180, v212
  v_mfma_f32_16x16x32_bf16 v[112:115], a[232:235], a[200:203], v[112:115]
  buffer_load_dwordx4 v46, s[48:51], s70 offen offset:2048 lds
  v_fma_f32 v80, v80, v63, v61
  v_mfma_f32_16x16x32_bf16 v[132:135], a[232:235], a[204:207], v[132:135]
  v_mul_f32 v180, v80, v180
  v_mul_f32 v81, v181, v181
  v_mfma_f32_16x16x32_bf16 v[152:155], a[232:235], a[208:211], v[152:155]
  v_exp_f32 v180, v180
  v_mfma_f32_16x16x32_bf16 v[172:175], a[232:235], a[212:215], v[172:175]
  s_waitcnt lgkmcnt(0)
  v_mul_f32 v213, v181, v213
  v_mfma_f32_16x16x32_bf16 v[96:99], a[176:179], a[160:163], v[96:99]
  ds_read_b128 a[216:219], v52 offset:47104
  buffer_load_dwordx4 v47, s[48:51], s70 offen offset:3072 lds
  v_mfma_f32_16x16x32_bf16 v[116:119], a[176:179], a[164:167], v[116:119]
  ds_read_b128 a[200:203], v49 offset:36864
  s_add_u32 s70, s70, 128
  v_mfma_f32_16x16x32_bf16 v[136:139], a[176:179], a[168:171], v[136:139]
  ds_read_b128 a[204:207], v49 offset:37376
  s_and_b32 s70, s70, 0x7ff
  v_mfma_f32_16x16x32_bf16 v[156:159], a[176:179], a[172:175], v[156:159]
  ds_read_b128 a[208:211], v49 offset:40960
  v_mov_b32 v8, -1
  v_mfma_f32_16x16x32_bf16 v[100:103], a[180:183], a[160:163], v[100:103]
  ds_read_b128 a[212:215], v49 offset:41472
  v_mov_b32 v9, -1
  v_mfma_f32_16x16x32_bf16 v[120:123], a[180:183], a[164:167], v[120:123]
  ds_read_b128 a[220:223], v52 offset:48128
  v_mov_b32 v10, -1
  v_mfma_f32_16x16x32_bf16 v[140:143], a[180:183], a[168:171], v[140:143]
  ds_read_b128 a[224:227], v52 offset:49152
  v_mov_b32 v11, -1
  v_mfma_f32_16x16x32_bf16 v[160:163], a[180:183], a[172:175], v[160:163]
  ds_read_b128 a[228:231], v52 offset:50176
  buffer_store_dwordx4 v[8:11], v1, s[8:11], s78 offen offset:0 sc1
  v_mfma_f32_16x16x32_bf16 v[104:107], a[184:187], a[160:163], v[104:107]
  ds_read_b128 a[232:235], v52 offset:51200
  buffer_store_dwordx4 v[176:179], v1, s[8:11], s26 offen offset:0 sc1
  v_mfma_f32_16x16x32_bf16 v[124:127], a[184:187], a[164:167], v[124:127]
  s_add_u32 m0, s67, 16384
  v_fma_f32 v81, v81, v63, v61
  v_mfma_f32_16x16x32_bf16 v[144:147], a[184:187], a[168:171], v[144:147]
  buffer_load_dwordx4 v54, s[8:11], s72 offen offset:0 sc1 lds
  v_mul_f32 v181, v81, v181
  v_mfma_f32_16x16x32_bf16 v[164:167], a[184:187], a[172:175], v[164:167]
  v_exp_f32 v181, v181
  v_mfma_f32_16x16x32_bf16 v[108:111], a[188:191], a[160:163], v[108:111]
  v_mul_f32 v82, v182, v182
  v_mul_f32 v214, v182, v214
  v_mfma_f32_16x16x32_bf16 v[128:131], a[188:191], a[164:167], v[128:131]
  v_fma_f32 v82, v82, v63, v61
  v_mul_f32 v182, v82, v182
  v_mfma_f32_16x16x32_bf16 v[148:151], a[188:191], a[168:171], v[148:151]
  buffer_load_dwordx4 v54, s[8:11], s72 offen offset:1024 sc1 lds
  v_mul_f32 v83, v183, v183
  v_mfma_f32_16x16x32_bf16 v[168:171], a[188:191], a[172:175], v[168:171]
  v_exp_f32 v182, v182
  v_mfma_f32_16x16x32_bf16 v[112:115], a[192:195], a[160:163], v[112:115]
  v_mul_f32 v215, v183, v215
  v_fma_f32 v83, v83, v63, v61
  v_mfma_f32_16x16x32_bf16 v[132:135], a[192:195], a[164:167], v[132:135]
  buffer_load_dwordx4 v54, s[8:11], s72 offen offset:2048 sc1 lds
  v_mul_f32 v183, v83, v183
  v_mfma_f32_16x16x32_bf16 v[152:155], a[192:195], a[168:171], v[152:155]
  v_exp_f32 v183, v183
  v_mfma_f32_16x16x32_bf16 v[172:175], a[192:195], a[172:175], v[172:175]
  s_waitcnt vmcnt(24) lgkmcnt(0)
  s_barrier
  v_fma_f32 v180, v180, v62, v62
  v_mfma_f32_16x16x32_bf16 v[96:99], a[216:219], a[200:203], v[96:99]
  ds_read_b128 a[176:179], v53 offset:0
  v_fma_f32 v181, v181, v62, v62
  v_mfma_f32_16x16x32_bf16 v[116:119], a[216:219], a[204:207], v[116:119]
  ds_read_b128 a[160:163], v50 offset:0
  buffer_load_dwordx4 v54, s[8:11], s72 offen offset:3072 sc1 lds
  v_mfma_f32_16x16x32_bf16 v[136:139], a[216:219], a[208:211], v[136:139]
  ds_read_b128 a[164:167], v50 offset:512
  s_add_u32 m0, s67, 20480
  v_mfma_f32_16x16x32_bf16 v[156:159], a[216:219], a[212:215], v[156:159]
  ds_read_b128 a[168:171], v50 offset:4096
  v_fma_f32 v182, v182, v62, v62
  v_mfma_f32_16x16x32_bf16 v[100:103], a[220:223], a[200:203], v[100:103]
  ds_read_b128 a[172:175], v50 offset:4608
  v_fma_f32 v183, v183, v62, v62
  v_mfma_f32_16x16x32_bf16 v[120:123], a[220:223], a[204:207], v[120:123]
  ds_read_b128 a[180:183], v53 offset:1024
  buffer_load_dwordx4 v55, s[8:11], s72 offen sc1 lds
  v_mfma_f32_16x16x32_bf16 v[140:143], a[220:223], a[208:211], v[140:143]
  ds_read_b128 a[184:187], v53 offset:2048
  s_add_u32 m0, s66, 36864
  v_mfma_f32_16x16x32_bf16 v[160:163], a[220:223], a[212:215], v[160:163]
  ds_read_b128 a[188:191], v53 offset:3072
  s_mul_i32 s73, s70, 160
  v_mfma_f32_16x16x32_bf16 v[104:107], a[224:227], a[200:203], v[104:107]
  ds_read_b128 a[192:195], v53 offset:4096
  buffer_load_dwordx4 v44, s[48:51], s70 offen offset:0 lds
  v_mfma_f32_16x16x32_bf16 v[124:127], a[224:227], a[204:207], v[124:127]
  v_rcp_f32 v180, v180
  v_mfma_f32_16x16x32_bf16 v[144:147], a[224:227], a[208:211], v[144:147]
  v_rcp_f32 v181, v181
  v_mfma_f32_16x16x32_bf16 v[164:167], a[224:227], a[212:215], v[164:167]
  v_rcp_f32 v182, v182
  v_mfma_f32_16x16x32_bf16 v[108:111], a[228:231], a[200:203], v[108:111]
  buffer_load_dwordx4 v45, s[48:51], s70 offen offset:1024 lds
  v_mul_f32 v212, v212, v180
  v_mfma_f32_16x16x32_bf16 v[128:131], a[228:231], a[204:207], v[128:131]
  v_rcp_f32 v183, v183
  v_mfma_f32_16x16x32_bf16 v[148:151], a[228:231], a[208:211], v[148:151]
  v_mul_f32 v213, v213, v181
  v_mul_f32 v214, v214, v182
  v_mfma_f32_16x16x32_bf16 v[168:171], a[228:231], a[212:215], v[168:171]
  buffer_load_dwordx4 v46, s[48:51], s70 offen offset:2048 lds
  v_mul_f32 v215, v215, v183
  v_mfma_f32_16x16x32_bf16 v[112:115], a[232:235], a[200:203], v[112:115]
  v_cvt_pk_bf16_f32 v180, v212, v213
  v_cvt_pk_bf16_f32 v181, v214, v215
  v_mfma_f32_16x16x32_bf16 v[132:135], a[232:235], a[204:207], v[132:135]
  v_mul_f32 v80, v188, v188
  v_mul_f32 v220, v188, v220
  v_mfma_f32_16x16x32_bf16 v[152:155], a[232:235], a[208:211], v[152:155]
  v_fma_f32 v80, v80, v63, v61
  v_mul_f32 v188, v80, v188
  v_mfma_f32_16x16x32_bf16 v[172:175], a[232:235], a[212:215], v[172:175]
  s_waitcnt lgkmcnt(0)
  buffer_load_dwordx4 v47, s[48:51], s70 offen offset:3072 lds
  v_mfma_f32_16x16x32_bf16 v[96:99], a[176:179], a[160:163], v[96:99]
  ds_read_b128 a[216:219], v53 offset:10240
  s_add_u32 s70, s70, 128
  v_mfma_f32_16x16x32_bf16 v[116:119], a[176:179], a[164:167], v[116:119]
  ds_read_b128 a[200:203], v51 offset:0
  s_and_b32 s70, s70, 0x7ff
  v_mfma_f32_16x16x32_bf16 v[136:139], a[176:179], a[168:171], v[136:139]
  ds_read_b128 a[204:207], v51 offset:512
  v_mul_f32 v81, v189, v189
  v_mfma_f32_16x16x32_bf16 v[156:159], a[176:179], a[172:175], v[156:159]
  ds_read_b128 a[208:211], v51 offset:4096
  buffer_store_dwordx4 v[8:11], v1, s[8:11], s78 offen offset:1024 sc1
  v_mfma_f32_16x16x32_bf16 v[100:103], a[180:183], a[160:163], v[100:103]
  ds_read_b128 a[212:215], v51 offset:4608
  s_add_u32 m0, s67, 53248
  v_mfma_f32_16x16x32_bf16 v[120:123], a[180:183], a[164:167], v[120:123]
  ds_read_b128 a[220:223], v53 offset:11264
  v_mul_f32 v221, v189, v221
  v_mfma_f32_16x16x32_bf16 v[140:143], a[180:183], a[168:171], v[140:143]
  ds_read_b128 a[224:227], v53 offset:12288
  buffer_load_dwordx4 v54, s[8:11], s73 offen offset:0 sc1 lds
  v_mfma_f32_16x16x32_bf16 v[160:163], a[180:183], a[172:175], v[160:163]
  ds_read_b128 a[228:231], v53 offset:13312
  v_fma_f32 v81, v81, v63, v61
  v_mfma_f32_16x16x32_bf16 v[104:107], a[184:187], a[160:163], v[104:107]
  ds_read_b128 a[232:235], v53 offset:14336
  v_mul_f32 v189, v81, v189
  v_mfma_f32_16x16x32_bf16 v[124:127], a[184:187], a[164:167], v[124:127]
  buffer_load_dwordx4 v54, s[8:11], s73 offen offset:1024 sc1 lds
  v_mul_f32 v82, v190, v190
  v_mfma_f32_16x16x32_bf16 v[144:147], a[184:187], a[168:171], v[144:147]
  v_exp_f32 v188, v188
  v_mfma_f32_16x16x32_bf16 v[164:167], a[184:187], a[172:175], v[164:167]
  v_exp_f32 v189, v189
  v_mfma_f32_16x16x32_bf16 v[108:111], a[188:191], a[160:163], v[108:111]
  buffer_load_dwordx4 v54, s[8:11], s73 offen offset:2048 sc1 lds
  v_mul_f32 v222, v190, v222
  v_mfma_f32_16x16x32_bf16 v[128:131], a[188:191], a[164:167], v[128:131]
  v_fma_f32 v82, v82, v63, v61
  v_mul_f32 v190, v82, v190
  v_mfma_f32_16x16x32_bf16 v[148:151], a[188:191], a[168:171], v[148:151]
  v_exp_f32 v190, v190
  v_mfma_f32_16x16x32_bf16 v[168:171], a[188:191], a[172:175], v[168:171]
  v_mul_f32 v83, v191, v191
  v_mul_f32 v223, v191, v223
  v_mfma_f32_16x16x32_bf16 v[112:115], a[192:195], a[160:163], v[112:115]
  buffer_load_dwordx4 v54, s[8:11], s73 offen offset:3072 sc1 lds
  s_add_u32 m0, s67, 57344
  v_mfma_f32_16x16x32_bf16 v[132:135], a[192:195], a[164:167], v[132:135]
  v_fma_f32 v83, v83, v63, v61
  v_mul_f32 v191, v83, v191
  v_mfma_f32_16x16x32_bf16 v[152:155], a[192:195], a[168:171], v[152:155]
  v_exp_f32 v191, v191
  v_mfma_f32_16x16x32_bf16 v[172:175], a[192:195], a[172:175], v[172:175]
  s_waitcnt vmcnt(21) lgkmcnt(0)
  s_barrier
  v_fma_f32 v188, v188, v62, v62
  v_mfma_f32_16x16x32_bf16 v[96:99], a[216:219], a[200:203], v[96:99]
  ds_read_b128 a[176:179], v53 offset:36864
  buffer_load_dwordx4 v55, s[8:11], s73 offen sc1 lds
  v_mfma_f32_16x16x32_bf16 v[116:119], a[216:219], a[204:207], v[116:119]
  ds_read_b128 a[160:163], v50 offset:36864
  v_fma_f32 v189, v189, v62, v62
  v_mfma_f32_16x16x32_bf16 v[136:139], a[216:219], a[208:211], v[136:139]
  ds_read_b128 a[164:167], v50 offset:37376
  v_fma_f32 v190, v190, v62, v62
  v_mfma_f32_16x16x32_bf16 v[156:159], a[216:219], a[212:215], v[156:159]
  ds_read_b128 a[168:171], v50 offset:40960
  buffer_store_dwordx4 v[8:11], v1, s[8:11], s78 offen offset:2048 sc1
  v_mfma_f32_16x16x32_bf16 v[100:103], a[220:223], a[200:203], v[100:103]
  ds_read_b128 a[172:175], v50 offset:41472
  v_fma_f32 v191, v191, v62, v62
  v_mfma_f32_16x16x32_bf16 v[120:123], a[220:223], a[204:207], v[120:123]
  ds_read_b128 a[180:183], v53 offset:37888
  s_add_u32 m0, s66, 73728
  v_mfma_f32_16x16x32_bf16 v[140:143], a[220:223], a[208:211], v[140:143]
  ds_read_b128 a[184:187], v53 offset:38912
  s_mul_i32 s74, s70, 160
  v_mfma_f32_16x16x32_bf16 v[160:163], a[220:223], a[212:215], v[160:163]
  ds_read_b128 a[188:191], v53 offset:39936
  buffer_load_dwordx4 v44, s[48:51], s70 offen offset:0 lds
  v_mfma_f32_16x16x32_bf16 v[104:107], a[224:227], a[200:203], v[104:107]
  ds_read_b128 a[192:195], v53 offset:40960
  v_mfma_f32_16x16x32_bf16 v[124:127], a[224:227], a[204:207], v[124:127]
  v_rcp_f32 v188, v188
  v_mfma_f32_16x16x32_bf16 v[144:147], a[224:227], a[208:211], v[144:147]
  buffer_load_dwordx4 v45, s[48:51], s70 offen offset:1024 lds
  v_mul_f32 v220, v220, v188
  v_mfma_f32_16x16x32_bf16 v[164:167], a[224:227], a[212:215], v[164:167]
  v_rcp_f32 v189, v189
  v_mfma_f32_16x16x32_bf16 v[108:111], a[228:231], a[200:203], v[108:111]
  v_rcp_f32 v190, v190
  v_mfma_f32_16x16x32_bf16 v[128:131], a[228:231], a[204:207], v[128:131]
  buffer_load_dwordx4 v46, s[48:51], s70 offen offset:2048 lds
  v_mul_f32 v221, v221, v189
  v_mfma_f32_16x16x32_bf16 v[148:151], a[228:231], a[208:211], v[148:151]
  v_rcp_f32 v191, v191
  v_mfma_f32_16x16x32_bf16 v[168:171], a[228:231], a[212:215], v[168:171]
  v_mul_f32 v222, v222, v190
  v_mul_f32 v223, v223, v191
  v_mfma_f32_16x16x32_bf16 v[112:115], a[232:235], a[200:203], v[112:115]
  v_cvt_pk_bf16_f32 v182, v220, v221
  v_cvt_pk_bf16_f32 v183, v222, v223
  v_mfma_f32_16x16x32_bf16 v[132:135], a[232:235], a[204:207], v[132:135]
  buffer_load_dwordx4 v47, s[48:51], s70 offen offset:3072 lds
  s_add_u32 s70, s70, 128
  v_mfma_f32_16x16x32_bf16 v[152:155], a[232:235], a[208:211], v[152:155]
  s_and_b32 s70, s70, 0x7ff
  s_add_u32 m0, s67, 90112
  v_mfma_f32_16x16x32_bf16 v[172:175], a[232:235], a[212:215], v[172:175]
  s_waitcnt lgkmcnt(0)
  v_mfma_f32_16x16x32_bf16 v[96:99], a[176:179], a[160:163], v[96:99]
  ds_read_b128 a[216:219], v53 offset:47104
  buffer_load_dwordx4 v54, s[8:11], s74 offen offset:0 sc1 lds
  v_mfma_f32_16x16x32_bf16 v[116:119], a[176:179], a[164:167], v[116:119]
  ds_read_b128 a[200:203], v51 offset:36864
  v_mfma_f32_16x16x32_bf16 v[136:139], a[176:179], a[168:171], v[136:139]
  ds_read_b128 a[204:207], v51 offset:37376
  v_mfma_f32_16x16x32_bf16 v[156:159], a[176:179], a[172:175], v[156:159]
  ds_read_b128 a[208:211], v51 offset:40960
  v_mul_f32 v80, v192, v192
  v_mfma_f32_16x16x32_bf16 v[100:103], a[180:183], a[160:163], v[100:103]
  ds_read_b128 a[212:215], v51 offset:41472
  buffer_load_dwordx4 v54, s[8:11], s74 offen offset:1024 sc1 lds
  v_mfma_f32_16x16x32_bf16 v[120:123], a[180:183], a[164:167], v[120:123]
  ds_read_b128 a[220:223], v53 offset:48128
  v_mul_f32 v224, v192, v224
  v_mfma_f32_16x16x32_bf16 v[140:143], a[180:183], a[168:171], v[140:143]
  ds_read_b128 a[224:227], v53 offset:49152
  v_fma_f32 v80, v80, v59, v57
  v_mfma_f32_16x16x32_bf16 v[160:163], a[180:183], a[172:175], v[160:163]
  ds_read_b128 a[228:231], v53 offset:50176
  v_mul_f32 v192, v80, v192
  v_mfma_f32_16x16x32_bf16 v[104:107], a[184:187], a[160:163], v[104:107]
  ds_read_b128 a[232:235], v53 offset:51200
  buffer_load_dwordx4 v54, s[8:11], s74 offen offset:2048 sc1 lds
  v_mfma_f32_16x16x32_bf16 v[124:127], a[184:187], a[164:167], v[124:127]
  v_exp_f32 v192, v192
  v_mfma_f32_16x16x32_bf16 v[144:147], a[184:187], a[168:171], v[144:147]
  v_mul_f32 v81, v193, v193
  v_mul_f32 v225, v193, v225
  v_mfma_f32_16x16x32_bf16 v[164:167], a[184:187], a[172:175], v[164:167]
  buffer_load_dwordx4 v54, s[8:11], s74 offen offset:3072 sc1 lds
  s_add_u32 m0, s67, 94208
  v_mfma_f32_16x16x32_bf16 v[108:111], a[188:191], a[160:163], v[108:111]
  v_fma_f32 v81, v81, v59, v57
  v_mul_f32 v193, v81, v193
  v_mfma_f32_16x16x32_bf16 v[128:131], a[188:191], a[164:167], v[128:131]
  v_exp_f32 v193, v193
  v_mfma_f32_16x16x32_bf16 v[148:151], a[188:191], a[168:171], v[148:151]
  v_mul_f32 v82, v194, v194
  v_mul_f32 v226, v194, v226
  v_mfma_f32_16x16x32_bf16 v[168:171], a[188:191], a[172:175], v[168:171]
  buffer_load_dwordx4 v55, s[8:11], s74 offen sc1 lds
  v_fma_f32 v82, v82, v59, v57
  v_mfma_f32_16x16x32_bf16 v[112:115], a[192:195], a[160:163], v[112:115]
  v_mul_f32 v194, v82, v194
  v_mul_f32 v83, v195, v195
  v_mfma_f32_16x16x32_bf16 v[132:135], a[192:195], a[164:167], v[132:135]
  v_exp_f32 v194, v194
  v_mfma_f32_16x16x32_bf16 v[152:155], a[192:195], a[168:171], v[152:155]
  buffer_store_dwordx4 v[8:11], v1, s[8:11], s78 offen offset:3072 sc1
  v_mul_f32 v227, v195, v227
  v_mfma_f32_16x16x32_bf16 v[172:175], a[192:195], a[172:175], v[172:175]
  s_waitcnt vmcnt(21) lgkmcnt(0)
  s_barrier
  v_fma_f32 v83, v83, v59, v57
  v_mfma_f32_16x16x32_bf16 v[96:99], a[216:219], a[200:203], v[96:99]
  ds_read_b128 a[176:179], v52 offset:0
  v_mul_f32 v195, v83, v195
  v_mfma_f32_16x16x32_bf16 v[116:119], a[216:219], a[204:207], v[116:119]
  ds_read_b128 a[160:163], v48 offset:0
  v_fma_f32 v192, v192, v58, v58
  v_mfma_f32_16x16x32_bf16 v[136:139], a[216:219], a[208:211], v[136:139]
  ds_read_b128 a[164:167], v48 offset:512
  buffer_store_dwordx4 v[180:183], v1, s[8:11], s26 offen offset:1024 sc1
  v_mfma_f32_16x16x32_bf16 v[156:159], a[216:219], a[212:215], v[156:159]
  ds_read_b128 a[168:171], v48 offset:4096
  s_add_u32 m0, s66, 110592
  v_mfma_f32_16x16x32_bf16 v[100:103], a[220:223], a[200:203], v[100:103]
  ds_read_b128 a[172:175], v48 offset:4608
  s_mul_i32 s75, s70, 160
  v_mfma_f32_16x16x32_bf16 v[120:123], a[220:223], a[204:207], v[120:123]
  ds_read_b128 a[180:183], v52 offset:1024
  buffer_load_dwordx4 v44, s[48:51], s70 offen offset:0 lds
  v_mfma_f32_16x16x32_bf16 v[140:143], a[220:223], a[208:211], v[140:143]
  ds_read_b128 a[184:187], v52 offset:2048
  v_fma_f32 v193, v193, v58, v58
  v_mfma_f32_16x16x32_bf16 v[160:163], a[220:223], a[212:215], v[160:163]
  ds_read_b128 a[188:191], v52 offset:3072
  v_fma_f32 v194, v194, v58, v58
  v_mfma_f32_16x16x32_bf16 v[104:107], a[224:227], a[200:203], v[104:107]
  ds_read_b128 a[192:195], v52 offset:4096
  buffer_load_dwordx4 v45, s[48:51], s70 offen offset:1024 lds
  v_mfma_f32_16x16x32_bf16 v[124:127], a[224:227], a[204:207], v[124:127]
  v_exp_f32 v195, v195
  v_mfma_f32_16x16x32_bf16 v[144:147], a[224:227], a[208:211], v[144:147]
  v_rcp_f32 v192, v192
  v_mfma_f32_16x16x32_bf16 v[164:167], a[224:227], a[212:215], v[164:167]
  v_rcp_f32 v193, v193
  v_mfma_f32_16x16x32_bf16 v[108:111], a[228:231], a[200:203], v[108:111]
  buffer_load_dwordx4 v46, s[48:51], s70 offen offset:2048 lds
  v_fma_f32 v195, v195, v58, v58
  v_mfma_f32_16x16x32_bf16 v[128:131], a[228:231], a[204:207], v[128:131]
  v_rcp_f32 v194, v194
  v_mfma_f32_16x16x32_bf16 v[148:151], a[228:231], a[208:211], v[148:151]
  v_rcp_f32 v195, v195
  v_mfma_f32_16x16x32_bf16 v[168:171], a[228:231], a[212:215], v[168:171]
  buffer_load_dwordx4 v47, s[48:51], s70 offen offset:3072 lds
  s_add_u32 s70, s70, 128
  v_mfma_f32_16x16x32_bf16 v[112:115], a[232:235], a[200:203], v[112:115]
  s_and_b32 s70, s70, 0x7ff
  v_mul_f32 v224, v224, v192
  v_mfma_f32_16x16x32_bf16 v[132:135], a[232:235], a[204:207], v[132:135]
  v_mul_f32 v225, v225, v193
  v_mul_f32 v226, v226, v194
  v_mfma_f32_16x16x32_bf16 v[152:155], a[232:235], a[208:211], v[152:155]
  v_mul_f32 v227, v227, v195
  v_cvt_pk_bf16_f32 v192, v224, v225
  v_mfma_f32_16x16x32_bf16 v[172:175], a[232:235], a[212:215], v[172:175]
  s_waitcnt lgkmcnt(0)
  buffer_store_dwordx4 v[8:11], v3, s[8:11], s78 offen offset:0 sc1
  v_mfma_f32_16x16x32_bf16 v[96:99], a[176:179], a[160:163], v[96:99]
  ds_read_b128 a[216:219], v52 offset:10240
  v_cvt_pk_bf16_f32 v193, v226, v227
  v_mfma_f32_16x16x32_bf16 v[116:119], a[176:179], a[164:167], v[116:119]
  ds_read_b128 a[200:203], v49 offset:0
  s_add_u32 m0, s67, 126976
  v_mfma_f32_16x16x32_bf16 v[136:139], a[176:179], a[168:171], v[136:139]
  ds_read_b128 a[204:207], v49 offset:512
  v_mul_f32 v80, v200, v200
  v_mfma_f32_16x16x32_bf16 v[156:159], a[176:179], a[172:175], v[156:159]
  ds_read_b128 a[208:211], v49 offset:4096
  buffer_load_dwordx4 v54, s[8:11], s75 offen offset:0 sc1 lds
  v_mfma_f32_16x16x32_bf16 v[100:103], a[180:183], a[160:163], v[100:103]
  ds_read_b128 a[212:215], v49 offset:4608
  v_mul_f32 v232, v200, v232
  v_mfma_f32_16x16x32_bf16 v[120:123], a[180:183], a[164:167], v[120:123]
  ds_read_b128 a[220:223], v52 offset:11264
  buffer_load_dwordx4 v54, s[8:11], s75 offen offset:1024 sc1 lds
  v_mfma_f32_16x16x32_bf16 v[140:143], a[180:183], a[168:171], v[140:143]
  ds_read_b128 a[224:227], v52 offset:12288
  v_fma_f32 v80, v80, v59, v57
  v_mfma_f32_16x16x32_bf16 v[160:163], a[180:183], a[172:175], v[160:163]
  ds_read_b128 a[228:231], v52 offset:13312
  v_mul_f32 v200, v80, v200
  v_mfma_f32_16x16x32_bf16 v[104:107], a[184:187], a[160:163], v[104:107]
  ds_read_b128 a[232:235], v52 offset:14336
  v_mul_f32 v81, v201, v201
  v_mfma_f32_16x16x32_bf16 v[124:127], a[184:187], a[164:167], v[124:127]
  buffer_load_dwordx4 v54, s[8:11], s75 offen offset:2048 sc1 lds
  v_mul_f32 v233, v201, v233
  v_mfma_f32_16x16x32_bf16 v[144:147], a[184:187], a[168:171], v[144:147]
  v_exp_f32 v200, v200
  v_mfma_f32_16x16x32_bf16 v[164:167], a[184:187], a[172:175], v[164:167]
  v_fma_f32 v81, v81, v59, v57
  v_mul_f32 v201, v81, v201
  v_mfma_f32_16x16x32_bf16 v[108:111], a[188:191], a[160:163], v[108:111]
  v_exp_f32 v201, v201
  v_mfma_f32_16x16x32_bf16 v[128:131], a[188:191], a[164:167], v[128:131]
  buffer_load_dwordx4 v54, s[8:11], s75 offen offset:3072 sc1 lds
  s_add_u32 m0, s67, 131072
  v_mfma_f32_16x16x32_bf16 v[148:151], a[188:191], a[168:171], v[148:151]
  v_mul_f32 v82, v202, v202
  v_mul_f32 v234, v202, v234
  v_mfma_f32_16x16x32_bf16 v[168:171], a[188:191], a[172:175], v[168:171]
  v_fma_f32 v82, v82, v59, v57
  v_mul_f32 v202, v82, v202
  v_mfma_f32_16x16x32_bf16 v[112:115], a[192:195], a[160:163], v[112:115]
  buffer_load_dwordx4 v55, s[8:11], s75 offen sc1 lds
  v_mul_f32 v83, v203, v203
  v_mfma_f32_16x16x32_bf16 v[132:135], a[192:195], a[164:167], v[132:135]
  v_exp_f32 v202, v202
  v_mfma_f32_16x16x32_bf16 v[152:155], a[192:195], a[168:171], v[152:155]
  v_mul_f32 v235, v203, v235
  v_fma_f32 v83, v83, v59, v57
  v_mfma_f32_16x16x32_bf16 v[172:175], a[192:195], a[172:175], v[172:175]
  s_waitcnt vmcnt(22) lgkmcnt(0)
  s_barrier
  v_mul_f32 v203, v83, v203
  v_mfma_f32_16x16x32_bf16 v[96:99], a[216:219], a[200:203], v[96:99]
  ds_read_b128 a[176:179], v52 offset:36864
  buffer_store_dwordx4 v[8:11], v3, s[8:11], s78 offen offset:1024 sc1
  v_mfma_f32_16x16x32_bf16 v[116:119], a[216:219], a[204:207], v[116:119]
  ds_read_b128 a[160:163], v48 offset:36864
  v_fma_f32 v200, v200, v58, v58
  v_mfma_f32_16x16x32_bf16 v[136:139], a[216:219], a[208:211], v[136:139]
  ds_read_b128 a[164:167], v48 offset:37376
  v_fma_f32 v201, v201, v58, v58
  v_mfma_f32_16x16x32_bf16 v[156:159], a[216:219], a[212:215], v[156:159]
  ds_read_b128 a[168:171], v48 offset:40960
  buffer_load_dword v73, v89, s[8:11], s31 offen sc1
  v_mfma_f32_16x16x32_bf16 v[100:103], a[220:223], a[200:203], v[100:103]
  ds_read_b128 a[172:175], v48 offset:41472
  s_add_u32 m0, s66, 0
  v_mfma_f32_16x16x32_bf16 v[120:123], a[220:223], a[204:207], v[120:123]
  ds_read_b128 a[180:183], v52 offset:37888
  s_mul_i32 s72, s70, 160
  v_mfma_f32_16x16x32_bf16 v[140:143], a[220:223], a[208:211], v[140:143]
  ds_read_b128 a[184:187], v52 offset:38912
  buffer_load_dwordx4 v44, s[48:51], s70 offen offset:0 lds
  v_mfma_f32_16x16x32_bf16 v[160:163], a[220:223], a[212:215], v[160:163]
  ds_read_b128 a[188:191], v52 offset:39936
  buffer_load_dwordx4 v45, s[48:51], s70 offen offset:1024 lds
  v_mfma_f32_16x16x32_bf16 v[104:107], a[224:227], a[200:203], v[104:107]
  ds_read_b128 a[192:195], v52 offset:40960
  v_fma_f32 v202, v202, v58, v58
  v_mfma_f32_16x16x32_bf16 v[124:127], a[224:227], a[204:207], v[124:127]
  v_exp_f32 v203, v203
  v_mfma_f32_16x16x32_bf16 v[144:147], a[224:227], a[208:211], v[144:147]
  buffer_load_dwordx4 v46, s[48:51], s70 offen offset:2048 lds
  v_fma_f32 v203, v203, v58, v58
  v_mfma_f32_16x16x32_bf16 v[164:167], a[224:227], a[212:215], v[164:167]
  v_rcp_f32 v200, v200
  v_mfma_f32_16x16x32_bf16 v[108:111], a[228:231], a[200:203], v[108:111]
  v_rcp_f32 v201, v201
  v_mfma_f32_16x16x32_bf16 v[128:131], a[228:231], a[204:207], v[128:131]
  v_rcp_f32 v202, v202
  v_mfma_f32_16x16x32_bf16 v[148:151], a[228:231], a[208:211], v[148:151]
  buffer_load_dwordx4 v47, s[48:51], s70 offen offset:3072 lds
  s_add_u32 s70, s70, 128
  v_mfma_f32_16x16x32_bf16 v[168:171], a[228:231], a[212:215], v[168:171]
  s_and_b32 s70, s70, 0x7ff
  s_add_u32 m0, s67, 16384
  v_mfma_f32_16x16x32_bf16 v[112:115], a[232:235], a[200:203], v[112:115]
  v_rcp_f32 v203, v203
  v_mfma_f32_16x16x32_bf16 v[132:135], a[232:235], a[204:207], v[132:135]
  buffer_load_dwordx4 v54, s[8:11], s72 offen offset:0 sc1 lds
  v_mul_f32 v232, v232, v200
  v_mfma_f32_16x16x32_bf16 v[152:155], a[232:235], a[208:211], v[152:155]
  v_mul_f32 v233, v233, v201
  v_mul_f32 v234, v234, v202
  v_mfma_f32_16x16x32_bf16 v[172:175], a[232:235], a[212:215], v[172:175]
  s_waitcnt lgkmcnt(0)
  v_mul_f32 v235, v235, v203
  v_mfma_f32_16x16x32_bf16 v[96:99], a[176:179], a[160:163], v[96:99]
  ds_read_b128 a[216:219], v52 offset:47104
  v_cvt_pk_bf16_f32 v194, v232, v233
  v_mfma_f32_16x16x32_bf16 v[116:119], a[176:179], a[164:167], v[116:119]
  ds_read_b128 a[200:203], v49 offset:36864
  buffer_load_dwordx4 v54, s[8:11], s72 offen offset:1024 sc1 lds
  v_mfma_f32_16x16x32_bf16 v[136:139], a[176:179], a[168:171], v[136:139]
  ds_read_b128 a[204:207], v49 offset:37376
  v_cvt_pk_bf16_f32 v195, v234, v235
  v_mfma_f32_16x16x32_bf16 v[156:159], a[176:179], a[172:175], v[156:159]
  ds_read_b128 a[208:211], v49 offset:40960
  v_mfma_f32_16x16x32_bf16 v[100:103], a[180:183], a[160:163], v[100:103]
  ds_read_b128 a[212:215], v49 offset:41472
  v_mfma_f32_16x16x32_bf16 v[120:123], a[180:183], a[164:167], v[120:123]
  ds_read_b128 a[220:223], v52 offset:48128
  buffer_load_dwordx4 v54, s[8:11], s72 offen offset:2048 sc1 lds
  v_mfma_f32_16x16x32_bf16 v[140:143], a[180:183], a[168:171], v[140:143]
  ds_read_b128 a[224:227], v52 offset:49152
  v_mfma_f32_16x16x32_bf16 v[160:163], a[180:183], a[172:175], v[160:163]
  ds_read_b128 a[228:231], v52 offset:50176
  v_mfma_f32_16x16x32_bf16 v[104:107], a[184:187], a[160:163], v[104:107]
  ds_read_b128 a[232:235], v52 offset:51200
  buffer_load_dwordx4 v54, s[8:11], s72 offen offset:3072 sc1 lds
  v_mfma_f32_16x16x32_bf16 v[124:127], a[184:187], a[164:167], v[124:127]
  s_add_u32 m0, s67, 20480
  v_mfma_f32_16x16x32_bf16 v[144:147], a[184:187], a[168:171], v[144:147]
  v_mfma_f32_16x16x32_bf16 v[164:167], a[184:187], a[172:175], v[164:167]
  v_mul_f32 v80, v196, v196
  v_mul_f32 v228, v196, v228
  v_mfma_f32_16x16x32_bf16 v[108:111], a[188:191], a[160:163], v[108:111]
  buffer_load_dwordx4 v55, s[8:11], s72 offen sc1 lds
  v_fma_f32 v80, v80, v63, v61
  v_mfma_f32_16x16x32_bf16 v[128:131], a[188:191], a[164:167], v[128:131]
  v_mul_f32 v196, v80, v196
  v_mul_f32 v81, v197, v197
  v_mfma_f32_16x16x32_bf16 v[148:151], a[188:191], a[168:171], v[148:151]
  v_exp_f32 v196, v196
  v_mfma_f32_16x16x32_bf16 v[168:171], a[188:191], a[172:175], v[168:171]
  buffer_store_dwordx4 v[8:11], v3, s[8:11], s78 offen offset:2048 sc1
  v_mul_f32 v229, v197, v229
  v_mfma_f32_16x16x32_bf16 v[112:115], a[192:195], a[160:163], v[112:115]
  v_fma_f32 v81, v81, v63, v61
  v_mul_f32 v197, v81, v197
  v_mfma_f32_16x16x32_bf16 v[132:135], a[192:195], a[164:167], v[132:135]
  v_exp_f32 v197, v197
  v_mfma_f32_16x16x32_bf16 v[152:155], a[192:195], a[168:171], v[152:155]
  v_mul_f32 v82, v198, v198
  v_mul_f32 v230, v198, v230
  v_mfma_f32_16x16x32_bf16 v[172:175], a[192:195], a[172:175], v[172:175]
  s_waitcnt vmcnt(24) lgkmcnt(0)
  s_barrier
  buffer_store_dwordx4 v[192:195], v1, s[8:11], s27 offen offset:0 sc1
  v_mfma_f32_16x16x32_bf16 v[96:99], a[216:219], a[200:203], v[96:99]
  ds_read_b128 a[176:179], v53 offset:0
  s_add_u32 m0, s66, 36864
  v_mfma_f32_16x16x32_bf16 v[116:119], a[216:219], a[204:207], v[116:119]
  ds_read_b128 a[160:163], v50 offset:0
  s_mul_i32 s73, s70, 160
  v_mfma_f32_16x16x32_bf16 v[136:139], a[216:219], a[208:211], v[136:139]
  ds_read_b128 a[164:167], v50 offset:512
  buffer_load_dwordx4 v44, s[48:51], s70 offen offset:0 lds
  v_mfma_f32_16x16x32_bf16 v[156:159], a[216:219], a[212:215], v[156:159]
  ds_read_b128 a[168:171], v50 offset:4096
  v_fma_f32 v82, v82, v63, v61
  v_mfma_f32_16x16x32_bf16 v[100:103], a[220:223], a[200:203], v[100:103]
  ds_read_b128 a[172:175], v50 offset:4608
  v_mul_f32 v198, v82, v198
  v_mfma_f32_16x16x32_bf16 v[120:123], a[220:223], a[204:207], v[120:123]
  ds_read_b128 a[180:183], v53 offset:1024
  buffer_load_dwordx4 v45, s[48:51], s70 offen offset:1024 lds
  v_mfma_f32_16x16x32_bf16 v[140:143], a[220:223], a[208:211], v[140:143]
  ds_read_b128 a[184:187], v53 offset:2048
  v_mul_f32 v83, v199, v199
  v_mfma_f32_16x16x32_bf16 v[160:163], a[220:223], a[212:215], v[160:163]
  ds_read_b128 a[188:191], v53 offset:3072
  v_mul_f32 v231, v199, v231
  v_mfma_f32_16x16x32_bf16 v[104:107], a[224:227], a[200:203], v[104:107]
  ds_read_b128 a[192:195], v53 offset:4096
  v_fma_f32 v83, v83, v63, v61
  v_mfma_f32_16x16x32_bf16 v[124:127], a[224:227], a[204:207], v[124:127]
  buffer_load_dwordx4 v46, s[48:51], s70 offen offset:2048 lds
  v_mul_f32 v199, v83, v199
  v_mfma_f32_16x16x32_bf16 v[144:147], a[224:227], a[208:211], v[144:147]
  v_exp_f32 v198, v198
  v_mfma_f32_16x16x32_bf16 v[164:167], a[224:227], a[212:215], v[164:167]
  v_exp_f32 v199, v199
  v_mfma_f32_16x16x32_bf16 v[108:111], a[228:231], a[200:203], v[108:111]
  buffer_load_dwordx4 v47, s[48:51], s70 offen offset:3072 lds
  s_add_u32 s70, s70, 128
  v_mfma_f32_16x16x32_bf16 v[128:131], a[228:231], a[204:207], v[128:131]
  s_and_b32 s70, s70, 0x7ff
  v_fma_f32 v196, v196, v62, v62
  v_mfma_f32_16x16x32_bf16 v[148:151], a[228:231], a[208:211], v[148:151]
  v_rcp_f32 v196, v196
  v_mfma_f32_16x16x32_bf16 v[168:171], a[228:231], a[212:215], v[168:171]
  v_fma_f32 v197, v197, v62, v62
  v_fma_f32 v198, v198, v62, v62
  v_mfma_f32_16x16x32_bf16 v[112:115], a[232:235], a[200:203], v[112:115]
  buffer_store_dwordx4 v[8:11], v3, s[8:11], s78 offen offset:3072 sc1
  v_fma_f32 v199, v199, v62, v62
  v_mfma_f32_16x16x32_bf16 v[132:135], a[232:235], a[204:207], v[132:135]
  v_rcp_f32 v197, v197
  v_mfma_f32_16x16x32_bf16 v[152:155], a[232:235], a[208:211], v[152:155]
  s_add_u32 m0, s67, 53248
  v_mul_f32 v228, v228, v196
  v_mfma_f32_16x16x32_bf16 v[172:175], a[232:235], a[212:215], v[172:175]
  s_waitcnt lgkmcnt(0)
  v_mul_f32 v229, v229, v197
  v_mfma_f32_16x16x32_bf16 v[96:99], a[176:179], a[160:163], v[96:99]
  ds_read_b128 a[216:219], v53 offset:10240
  buffer_load_dwordx4 v54, s[8:11], s73 offen offset:0 sc1 lds
  v_mfma_f32_16x16x32_bf16 v[116:119], a[176:179], a[164:167], v[116:119]
  ds_read_b128 a[200:203], v51 offset:0
  v_cvt_pk_bf16_f32 v196, v228, v229
  v_mfma_f32_16x16x32_bf16 v[136:139], a[176:179], a[168:171], v[136:139]
  ds_read_b128 a[204:207], v51 offset:512
  buffer_load_dwordx4 v54, s[8:11], s73 offen offset:1024 sc1 lds
  v_mfma_f32_16x16x32_bf16 v[156:159], a[176:179], a[172:175], v[156:159]
  ds_read_b128 a[208:211], v51 offset:4096
  v_mul_f32 v80, v204, v204
  v_mfma_f32_16x16x32_bf16 v[100:103], a[180:183], a[160:163], v[100:103]
  ds_read_b128 a[212:215], v51 offset:4608
  v_mul_f32 v236, v204, v236
  v_mfma_f32_16x16x32_bf16 v[120:123], a[180:183], a[164:167], v[120:123]
  ds_read_b128 a[220:223], v53 offset:11264
  v_fma_f32 v80, v80, v63, v61
  v_mfma_f32_16x16x32_bf16 v[140:143], a[180:183], a[168:171], v[140:143]
  ds_read_b128 a[224:227], v53 offset:12288
  buffer_load_dwordx4 v54, s[8:11], s73 offen offset:2048 sc1 lds
  v_mfma_f32_16x16x32_bf16 v[160:163], a[180:183], a[172:175], v[160:163]
  ds_read_b128 a[228:231], v53 offset:13312
  v_mul_f32 v204, v80, v204
  v_mfma_f32_16x16x32_bf16 v[104:107], a[184:187], a[160:163], v[104:107]
  ds_read_b128 a[232:235], v53 offset:14336
  v_mul_f32 v81, v205, v205
  v_mfma_f32_16x16x32_bf16 v[124:127], a[184:187], a[164:167], v[124:127]
  v_rcp_f32 v198, v198
  v_mfma_f32_16x16x32_bf16 v[144:147], a[184:187], a[168:171], v[144:147]
  buffer_load_dwordx4 v54, s[8:11], s73 offen offset:3072 sc1 lds
  s_add_u32 m0, s67, 57344
  v_mfma_f32_16x16x32_bf16 v[164:167], a[184:187], a[172:175], v[164:167]
  v_rcp_f32 v199, v199
  v_mfma_f32_16x16x32_bf16 v[108:111], a[188:191], a[160:163], v[108:111]
  v_exp_f32 v204, v204
  v_mfma_f32_16x16x32_bf16 v[128:131], a[188:191], a[164:167], v[128:131]
  buffer_load_dwordx4 v55, s[8:11], s73 offen sc1 lds
  v_mul_f32 v230, v230, v198
  v_mfma_f32_16x16x32_bf16 v[148:151], a[188:191], a[168:171], v[148:151]
  v_mul_f32 v231, v231, v199
  v_cvt_pk_bf16_f32 v197, v230, v231
  v_mfma_f32_16x16x32_bf16 v[168:171], a[188:191], a[172:175], v[168:171]
  s_add_u32 s83, s78, 8192
  v_mul_f32 v237, v205, v237
  v_mfma_f32_16x16x32_bf16 v[112:115], a[192:195], a[160:163], v[112:115]
  v_fma_f32 v81, v81, v63, v61
  v_mul_f32 v205, v81, v205
  v_mfma_f32_16x16x32_bf16 v[132:135], a[192:195], a[164:167], v[132:135]
  buffer_store_dwordx4 v[8:11], v1, s[8:11], s83 offen offset:0 sc1
  v_mul_f32 v82, v206, v206
  v_mfma_f32_16x16x32_bf16 v[152:155], a[192:195], a[168:171], v[152:155]
  v_exp_f32 v205, v205
  v_mfma_f32_16x16x32_bf16 v[172:175], a[192:195], a[172:175], v[172:175]
  s_waitcnt vmcnt(24) lgkmcnt(0)
  s_barrier
  v_mul_f32 v238, v206, v238
  v_mfma_f32_16x16x32_bf16 v[96:99], a[216:219], a[200:203], v[96:99]
  ds_read_b128 a[176:179], v53 offset:36864
  s_waitcnt vmcnt(22)
  v_cmp_ne_u32 vcc, s64, v73
  s_cbranch_vccnz E_slow4
E_ok4:
  v_mfma_f32_16x16x32_bf16 v[116:119], a[216:219], a[204:207], v[116:119]
  ds_read_b128 a[160:163], v50 offset:36864
  s_add_u32 m0, s66, 73728
  v_mfma_f32_16x16x32_bf16 v[136:139], a[216:219], a[208:211], v[136:139]
  ds_read_b128 a[164:167], v50 offset:37376
  s_mul_i32 s74, s70, 160
  v_mfma_f32_16x16x32_bf16 v[156:159], a[216:219], a[212:215], v[156:159]
  ds_read_b128 a[168:171], v50 offset:40960
  buffer_load_dwordx4 v44, s[48:51], s70 offen offset:0 lds
  v_mfma_f32_16x16x32_bf16 v[100:103], a[220:223], a[200:203], v[100:103]
  ds_read_b128 a[172:175], v50 offset:41472
  buffer_load_dwordx4 v45, s[48:51], s70 offen offset:1024 lds
  v_mfma_f32_16x16x32_bf16 v[120:123], a[220:223], a[204:207], v[120:123]
  ds_read_b128 a[180:183], v53 offset:37888
  v_fma_f32 v82, v82, v63, v61
  v_mfma_f32_16x16x32_bf16 v[140:143], a[220:223], a[208:211], v[140:143]
  ds_read_b128 a[184:187], v53 offset:38912
  v_mul_f32 v206, v82, v206
  v_mfma_f32_16x16x32_bf16 v[160:163], a[220:223], a[212:215], v[160:163]
  ds_read_b128 a[188:191], v53 offset:39936
  buffer_load_dwordx4 v46, s[48:51], s70 offen offset:2048 lds
  v_mfma_f32_16x16x32_bf16 v[104:107], a[224:227], a[200:203], v[104:107]
  ds_read_b128 a[192:195], v53 offset:40960
  v_mul_f32 v83, v207, v207
  v_mfma_f32_16x16x32_bf16 v[124:127], a[224:227], a[204:207], v[124:127]
  v_exp_f32 v206, v206
  v_mfma_f32_16x16x32_bf16 v[144:147], a[224:227], a[208:211], v[144:147]
  v_mul_f32 v239, v207, v239
  v_fma_f32 v83, v83, v63, v61
  v_mfma_f32_16x16x32_bf16 v[164:167], a[224:227], a[212:215], v[164:167]
  buffer_load_dwordx4 v47, s[48:51], s70 offen offset:3072 lds
  s_add_u32 s70, s70, 128
  v_mfma_f32_16x16x32_bf16 v[108:111], a[228:231], a[200:203], v[108:111]
  s_and_b32 s70, s70, 0x7ff
  s_add_u32 m0, s67, 90112
  v_mfma_f32_16x16x32_bf16 v[128:131], a[228:231], a[204:207], v[128:131]
  v_mul_f32 v207, v83, v207
  v_fma_f32 v204, v204, v62, v62
  v_mfma_f32_16x16x32_bf16 v[148:151], a[228:231], a[208:211], v[148:151]
  buffer_load_dwordx4 v54, s[8:11], s74 offen offset:0 sc1 lds
  v_fma_f32 v205, v205, v62, v62
  v_mfma_f32_16x16x32_bf16 v[168:171], a[228:231], a[212:215], v[168:171]
  v_exp_f32 v207, v207
  v_mfma_f32_16x16x32_bf16 v[112:115], a[232:235], a[200:203], v[112:115]
  v_rcp_f32 v204, v204
  v_mfma_f32_16x16x32_bf16 v[132:135], a[232:235], a[204:207], v[132:135]
  v_rcp_f32 v205, v205
  v_mfma_f32_16x16x32_bf16 v[152:155], a[232:235], a[208:211], v[152:155]
  buffer_load_dwordx4 v54, s[8:11], s74 offen offset:1024 sc1 lds
  v_fma_f32 v206, v206, v62, v62
  v_mfma_f32_16x16x32_bf16 v[172:175], a[232:235], a[212:215], v[172:175]
  s_waitcnt lgkmcnt(0)
  v_fma_f32 v207, v207, v62, v62
  v_mfma_f32_16x16x32_bf16 v[96:99], a[176:179], a[160:163], v[96:99]
  ds_read_b128 a[216:219], v53 offset:47104
  v_mul_f32 v236, v236, v204
  v_mfma_f32_16x16x32_bf16 v[116:119], a[176:179], a[164:167], v[116:119]
  ds_read_b128 a[200:203], v51 offset:36864
  buffer_load_dwordx4 v54, s[8:11], s74 offen offset:2048 sc1 lds
  v_mfma_f32_16x16x32_bf16 v[136:139], a[176:179], a[168:171], v[136:139]
  ds_read_b128 a[204:207], v51 offset:37376
  v_mul_f32 v237, v237, v205
  v_mfma_f32_16x16x32_bf16 v[156:159], a[176:179], a[172:175], v[156:159]
  ds_read_b128 a[208:211], v51 offset:40960
  v_cvt_pk_bf16_f32 v198, v236, v237
  v_mfma_f32_16x16x32_bf16 v[100:103], a[180:183], a[160:163], v[100:103]
  ds_read_b128 a[212:215], v51 offset:41472
  v_mfma_f32_16x16x32_bf16 v[120:123], a[180:183], a[164:167], v[120:123]
  ds_read_b128 a[220:223], v53 offset:48128
  buffer_load_dwordx4 v54, s[8:11], s74 offen offset:3072 sc1 lds
  v_mfma_f32_16x16x32_bf16 v[140:143], a[180:183], a[168:171], v[140:143]
  ds_read_b128 a[224:227], v53 offset:49152
  s_add_u32 m0, s67, 94208
  v_mfma_f32_16x16x32_bf16 v[160:163], a[180:183], a[172:175], v[160:163]
  ds_read_b128 a[228:231], v53 offset:50176
  v_mfma_f32_16x16x32_bf16 v[104:107], a[184:187], a[160:163], v[104:107]
  ds_read_b128 a[232:235], v53 offset:51200
  v_mfma_f32_16x16x32_bf16 v[124:127], a[184:187], a[164:167], v[124:127]
  buffer_load_dwordx4 v55, s[8:11], s74 offen sc1 lds
  v_mfma_f32_16x16x32_bf16 v[144:147], a[184:187], a[168:171], v[144:147]
  v_rcp_f32 v206, v206
  v_mfma_f32_16x16x32_bf16 v[164:167], a[184:187], a[172:175], v[164:167]
  v_rcp_f32 v207, v207
  v_mfma_f32_16x16x32_bf16 v[108:111], a[188:191], a[160:163], v[108:111]
  buffer_store_dwordx4 v[8:11], v1, s[8:11], s83 offen offset:1024 sc1
  v_mul_f32 v238, v238, v206
  v_mfma_f32_16x16x32_bf16 v[128:131], a[188:191], a[164:167], v[128:131]
  v_mul_f32 v239, v239, v207
  v_cvt_pk_bf16_f32 v199, v238, v239
  v_mfma_f32_16x16x32_bf16 v[148:151], a[188:191], a[168:171], v[148:151]
  v_mfma_f32_16x16x32_bf16 v[168:171], a[188:191], a[172:175], v[168:171]
  v_mfma_f32_16x16x32_bf16 v[112:115], a[192:195], a[160:163], v[112:115]
  v_mfma_f32_16x16x32_bf16 v[132:135], a[192:195], a[164:167], v[132:135]
  v_mfma_f32_16x16x32_bf16 v[152:155], a[192:195], a[168:171], v[152:155]
  v_mfma_f32_16x16x32_bf16 v[172:175], a[192:195], a[172:175], v[172:175]
  s_waitcnt vmcnt(23) lgkmcnt(0)
  s_barrier
  buffer_store_dwordx4 v[196:199], v1, s[8:11], s27 offen offset:1024 sc1
  v_mfma_f32_16x16x32_bf16 v[96:99], a[216:219], a[200:203], v[96:99]
  ds_read_b128 a[176:179], v52 offset:0
  s_add_u32 s82, s76, 0
  v_mfma_f32_16x16x32_bf16 v[116:119], a[216:219], a[204:207], v[116:119]
  ds_read_b128 a[160:163], v48 offset:0
  buffer_load_dwordx4 v[176:179], v76, s[8:11], s82 offen sc1
  v_mfma_f32_16x16x32_bf16 v[136:139], a[216:219], a[208:211], v[136:139]
  ds_read_b128 a[164:167], v48 offset:512
  v_and_b32 v84, 15, v2
  v_mfma_f32_16x16x32_bf16 v[156:159], a[216:219], a[212:215], v[156:159]
  ds_read_b128 a[168:171], v48 offset:4096
  buffer_load_dwordx4 v[180:183], v77, s[8:11], s82 offen sc1
  v_mfma_f32_16x16x32_bf16 v[100:103], a[220:223], a[200:203], v[100:103]
  ds_read_b128 a[172:175], v48 offset:4608
  v_lshrrev_b32 v85, 4, v2
  v_mfma_f32_16x16x32_bf16 v[120:123], a[220:223], a[204:207], v[120:123]
  ds_read_b128 a[180:183], v52 offset:1024
  v_lshlrev_b32 v85, 2, v85
  v_mfma_f32_16x16x32_bf16 v[140:143], a[220:223], a[208:211], v[140:143]
  ds_read_b128 a[184:187], v52 offset:2048
  v_sub_u32 v84, v84, v85
  v_mfma_f32_16x16x32_bf16 v[160:163], a[220:223], a[212:215], v[160:163]
  ds_read_b128 a[188:191], v52 offset:3072
  buffer_load_dwordx4 v[184:187], v78, s[8:11], s82 offen sc1
  v_mfma_f32_16x16x32_bf16 v[104:107], a[224:227], a[200:203], v[104:107]
  ds_read_b128 a[192:195], v52 offset:4096
  v_lshlrev_b32 v85, 4, v84
  v_mfma_f32_16x16x32_bf16 v[124:127], a[224:227], a[204:207], v[124:127]
  v_mov_b32 v86, 0x3f80
  v_lshlrev_b32 v85, v85, v86
  v_mfma_f32_16x16x32_bf16 v[144:147], a[224:227], a[208:211], v[144:147]
  buffer_load_dwordx4 v[188:191], v79, s[8:11], s82 offen sc1
  v_lshrrev_b32 v84, 1, v84
  v_mfma_f32_16x16x32_bf16 v[164:167], a[224:227], a[212:215], v[164:167]
  v_mov_b32 v56, 0
  v_mov_b32 v57, 0
  v_mfma_f32_16x16x32_bf16 v[108:111], a[228:231], a[200:203], v[108:111]
  s_add_u32 m0, s66, 110592
  s_mul_i32 s75, s70, 160
  v_mfma_f32_16x16x32_bf16 v[128:131], a[228:231], a[204:207], v[128:131]
  v_mov_b32 v60, 0
  v_mov_b32 v61, 0
  v_mfma_f32_16x16x32_bf16 v[148:151], a[228:231], a[208:211], v[148:151]
  buffer_load_dwordx4 v44, s[48:51], s70 offen offset:0 lds
  v_mfma_f32_16x16x32_bf16 v[168:171], a[228:231], a[212:215], v[168:171]
  v_cmp_eq_u32 vcc, 0, v84
  s_nop 1
  v_cndmask_b32 v58, 0, v85, vcc
  v_mfma_f32_16x16x32_bf16 v[112:115], a[232:235], a[200:203], v[112:115]
  v_cmp_eq_u32 vcc, 1, v84
  s_nop 1
  v_cndmask_b32 v59, 0, v85, vcc
  v_mfma_f32_16x16x32_bf16 v[132:135], a[232:235], a[204:207], v[132:135]
  buffer_load_dwordx4 v45, s[48:51], s70 offen offset:1024 lds
  v_mfma_f32_16x16x32_bf16 v[152:155], a[232:235], a[208:211], v[152:155]
  s_bitcmp1_b32 s3, 0
  s_cselect_b64 vcc, -1, 0
  v_cndmask_b32 v62, v58, v56, vcc
  v_cndmask_b32 v63, v59, v57, vcc
  v_cndmask_b32 v64, v60, v58, vcc
  v_cndmask_b32 v65, v61, v59, vcc
  v_mfma_f32_16x16x32_bf16 v[172:175], a[232:235], a[212:215], v[172:175]
  s_waitcnt lgkmcnt(0)
  s_add_u32 s4, s76, 32768
  v_mfma_f32_16x16x32_bf16 v[96:99], a[176:179], a[160:163], v[96:99]
  ds_read_b128 a[216:219], v52 offset:10240
  s_add_u32 s5, s76, 36864
  v_mfma_f32_16x16x32_bf16 v[116:119], a[176:179], a[164:167], v[116:119]
  ds_read_b128 a[200:203], v49 offset:0
  buffer_load_dwordx4 v46, s[48:51], s70 offen offset:2048 lds
  v_mfma_f32_16x16x32_bf16 v[136:139], a[176:179], a[168:171], v[136:139]
  ds_read_b128 a[204:207], v49 offset:512
  s_add_u32 s6, s76, 40960
  v_mfma_f32_16x16x32_bf16 v[156:159], a[176:179], a[172:175], v[156:159]
  ds_read_b128 a[208:211], v49 offset:4096
  s_add_u32 s7, s76, 45056
  v_mfma_f32_16x16x32_bf16 v[100:103], a[180:183], a[160:163], v[100:103]
  ds_read_b128 a[212:215], v49 offset:4608
  v_lshlrev_b32 v24, 16, v4
  v_mfma_f32_16x16x32_bf16 v[120:123], a[180:183], a[164:167], v[120:123]
  ds_read_b128 a[220:223], v52 offset:11264
  buffer_load_dwordx4 v47, s[48:51], s70 offen offset:3072 lds
  v_mfma_f32_16x16x32_bf16 v[140:143], a[180:183], a[168:171], v[140:143]
  ds_read_b128 a[224:227], v52 offset:12288
  s_add_u32 s70, s70, 128
  v_mfma_f32_16x16x32_bf16 v[160:163], a[180:183], a[172:175], v[160:163]
  ds_read_b128 a[228:231], v52 offset:13312
  s_and_b32 s70, s70, 0x7ff
  v_mfma_f32_16x16x32_bf16 v[104:107], a[184:187], a[160:163], v[104:107]
  ds_read_b128 a[232:235], v52 offset:14336
  s_add_u32 m0, s67, 126976
  v_mfma_f32_16x16x32_bf16 v[124:127], a[184:187], a[164:167], v[124:127]
  buffer_load_dwordx4 v54, s[8:11], s75 offen offset:0 sc1 lds
  v_and_b32 v25, 0xffff0000, v4
  v_mfma_f32_16x16x32_bf16 v[144:147], a[184:187], a[168:171], v[144:147]
  v_lshlrev_b32 v26, 16, v5
  v_and_b32 v27, 0xffff0000, v5
  v_mfma_f32_16x16x32_bf16 v[164:167], a[184:187], a[172:175], v[164:167]
  v_lshlrev_b32 v28, 16, v6
  v_and_b32 v29, 0xffff0000, v6
  v_mfma_f32_16x16x32_bf16 v[108:111], a[188:191], a[160:163], v[108:111]
  buffer_load_dwordx4 v54, s[8:11], s75 offen offset:1024 sc1 lds
  v_lshlrev_b32 v30, 16, v7
  v_mfma_f32_16x16x32_bf16 v[128:131], a[188:191], a[164:167], v[128:131]
  v_and_b32 v31, 0xffff0000, v7
  v_lshlrev_b32 v32, 16, v12
  v_mfma_f32_16x16x32_bf16 v[148:151], a[188:191], a[168:171], v[148:151]
  v_and_b32 v33, 0xffff0000, v12
  v_lshlrev_b32 v34, 16, v13
  v_mfma_f32_16x16x32_bf16 v[168:171], a[188:191], a[172:175], v[168:171]
  buffer_load_dwordx4 v54, s[8:11], s75 offen offset:2048 sc1 lds
  v_and_b32 v35, 0xffff0000, v13
  v_mfma_f32_16x16x32_bf16 v[112:115], a[192:195], a[160:163], v[112:115]
  v_lshlrev_b32 v36, 16, v14
  v_and_b32 v37, 0xffff0000, v14
  v_mfma_f32_16x16x32_bf16 v[132:135], a[192:195], a[164:167], v[132:135]
  v_lshlrev_b32 v38, 16, v15
  v_and_b32 v39, 0xffff0000, v15
  v_mfma_f32_16x16x32_bf16 v[152:155], a[192:195], a[168:171], v[152:155]
  v_lshlrev_b32 v40, 16, v18
  v_and_b32 v41, 0xffff0000, v18
  v_mfma_f32_16x16x32_bf16 v[172:175], a[192:195], a[172:175], v[172:175]
  s_waitcnt vmcnt(23) lgkmcnt(0)
  s_barrier
  buffer_load_dwordx4 v54, s[8:11], s75 offen offset:3072 sc1 lds
  v_mfma_f32_16x16x32_bf16 v[96:99], a[216:219], a[200:203], v[96:99]
  ds_read_b128 a[176:179], v52 offset:36864
  s_add_u32 m0, s67, 131072
  v_mfma_f32_16x16x32_bf16 v[116:119], a[216:219], a[204:207], v[116:119]
  ds_read_b128 a[160:163], v48 offset:36864
  v_lshlrev_b32 v42, 16, v19
  v_mfma_f32_16x16x32_bf16 v[136:139], a[216:219], a[208:211], v[136:139]
  ds_read_b128 a[164:167], v48 offset:37376
  v_and_b32 v43, 0xffff0000, v19
  v_mfma_f32_16x16x32_bf16 v[156:159], a[216:219], a[212:215], v[156:159]
  ds_read_b128 a[168:171], v48 offset:40960
  buffer_load_dwordx4 v55, s[8:11], s75 offen sc1 lds
  v_mfma_f32_16x16x32_bf16 v[100:103], a[220:223], a[200:203], v[100:103]
  ds_read_b128 a[172:175], v48 offset:41472
  s_add_u32 m0, s66, 0
  v_mfma_f32_16x16x32_bf16 v[120:123], a[220:223], a[204:207], v[120:123]
  ds_read_b128 a[180:183], v52 offset:37888
  s_mul_i32 s72, s70, 160
  v_mfma_f32_16x16x32_bf16 v[140:143], a[220:223], a[208:211], v[140:143]
  ds_read_b128 a[184:187], v52 offset:38912
  buffer_load_dwordx4 v44, s[48:51], s70 offen offset:0 lds
  v_mfma_f32_16x16x32_bf16 v[160:163], a[220:223], a[212:215], v[160:163]
  ds_read_b128 a[188:191], v52 offset:39936
  v_add_u32 v70, s37, v1
  v_mfma_f32_16x16x32_bf16 v[104:107], a[224:227], a[200:203], v[104:107]
  ds_read_b128 a[192:195], v52 offset:40960
  v_mfma_f32_16x16x32_bf16 v[124:127], a[224:227], a[204:207], v[124:127]
  v_mfma_f32_16x16x32_bf16 v[144:147], a[224:227], a[208:211], v[144:147]
  buffer_load_dwordx4 v45, s[48:51], s70 offen offset:1024 lds
  v_mfma_f32_16x16x32_bf16 v[164:167], a[224:227], a[212:215], v[164:167]
  v_mfma_f32_16x16x32_bf16 v[108:111], a[228:231], a[200:203], v[108:111]
  v_mfma_f32_16x16x32_bf16 v[128:131], a[228:231], a[204:207], v[128:131]
  buffer_load_dwordx4 v46, s[48:51], s70 offen offset:2048 lds
  v_mfma_f32_16x16x32_bf16 v[148:151], a[228:231], a[208:211], v[148:151]
  v_mfma_f32_16x16x32_bf16 v[168:171], a[228:231], a[212:215], v[168:171]
  v_mfma_f32_16x16x32_bf16 v[112:115], a[232:235], a[200:203], v[112:115]
  v_mfma_f32_16x16x32_bf16 v[132:135], a[232:235], a[204:207], v[132:135]
  buffer_load_dwordx4 v47, s[48:51], s70 offen offset:3072 lds
  s_add_u32 s70, s70, 128
  v_mfma_f32_16x16x32_bf16 v[152:155], a[232:235], a[208:211], v[152:155]
  s_and_b32 s70, s70, 0x7ff
  v_mfma_f32_16x16x32_bf16 v[172:175], a[232:235], a[212:215], v[172:175]
  s_waitcnt lgkmcnt(0)
  s_add_u32 m0, s67, 16384
  v_mfma_f32_16x16x32_bf16 v[96:99], a[176:179], a[160:163], v[96:99]
  ds_read_b128 a[216:219], v52 offset:47104
  v_mfma_f32_16x16x32_bf16 v[116:119], a[176:179], a[164:167], v[116:119]
  ds_read_b128 a[200:203], v49 offset:36864
  buffer_load_dwordx4 v54, s[8:11], s72 offen offset:0 sc1 lds
  v_mfma_f32_16x16x32_bf16 v[136:139], a[176:179], a[168:171], v[136:139]
  ds_read_b128 a[204:207], v49 offset:37376
  v_mfma_f32_16x16x32_bf16 v[156:159], a[176:179], a[172:175], v[156:159]
  ds_read_b128 a[208:211], v49 offset:40960
  v_mfma_f32_16x16x32_bf16 v[100:103], a[180:183], a[160:163], v[100:103]
  ds_read_b128 a[212:215], v49 offset:41472
  buffer_load_dwordx4 v54, s[8:11], s72 offen offset:1024 sc1 lds
  v_mfma_f32_16x16x32_bf16 v[120:123], a[180:183], a[164:167], v[120:123]
  ds_read_b128 a[220:223], v52 offset:48128
  v_mfma_f32_16x16x32_bf16 v[140:143], a[180:183], a[168:171], v[140:143]
  ds_read_b128 a[224:227], v52 offset:49152
  v_mfma_f32_16x16x32_bf16 v[160:163], a[180:183], a[172:175], v[160:163]
  ds_read_b128 a[228:231], v52 offset:50176
  v_mfma_f32_16x16x32_bf16 v[104:107], a[184:187], a[160:163], v[104:107]
  ds_read_b128 a[232:235], v52 offset:51200
  buffer_load_dwordx4 v54, s[8:11], s72 offen offset:2048 sc1 lds
  v_mfma_f32_16x16x32_bf16 v[124:127], a[184:187], a[164:167], v[124:127]
  v_mfma_f32_16x16x32_bf16 v[144:147], a[184:187], a[168:171], v[144:147]
  v_mfma_f32_16x16x32_bf16 v[164:167], a[184:187], a[172:175], v[164:167]
  buffer_load_dwordx4 v54, s[8:11], s72 offen offset:3072 sc1 lds
  s_add_u32 m0, s67, 20480
  v_mfma_f32_16x16x32_bf16 v[108:111], a[188:191], a[160:163], v[108:111]
  v_mfma_f32_16x16x32_bf16 v[128:131], a[188:191], a[164:167], v[128:131]
  v_mfma_f32_16x16x32_bf16 v[148:151], a[188:191], a[168:171], v[148:151]
  v_mfma_f32_16x16x32_bf16 v[168:171], a[188:191], a[172:175], v[168:171]
  buffer_load_dwordx4 v55, s[8:11], s72 offen sc1 lds
  v_mfma_f32_16x16x32_bf16 v[112:115], a[192:195], a[160:163], v[112:115]
  v_mfma_f32_16x16x32_bf16 v[132:135], a[192:195], a[164:167], v[132:135]
  v_mfma_f32_16x16x32_bf16 v[152:155], a[192:195], a[168:171], v[152:155]
  v_mfma_f32_16x16x32_bf16 v[172:175], a[192:195], a[172:175], v[172:175]
  s_waitcnt vmcnt(24) lgkmcnt(0)
  s_barrier
  s_waitcnt vmcnt(22)
  buffer_store_dword v71, v72, s[8:11], s29 offen sc1
  v_mfma_f32_16x16x32_bf16 v[96:99], a[216:219], a[200:203], v[96:99]
  ds_read_b128 a[176:179], v53 offset:0
  s_add_u32 m0, s66, 36864
  v_mfma_f32_16x16x32_bf16 v[116:119], a[216:219], a[204:207], v[116:119]
  ds_read_b128 a[160:163], v50 offset:0
  s_mul_i32 s73, s70, 160
  v_mfma_f32_16x16x32_bf16 v[136:139], a[216:219], a[208:211], v[136:139]
  ds_read_b128 a[164:167], v50 offset:512
  buffer_load_dwordx4 v44, s[48:51], s70 offen offset:0 lds
  v_mfma_f32_16x16x32_bf16 v[156:159], a[216:219], a[212:215], v[156:159]
  ds_read_b128 a[168:171], v50 offset:4096
  buffer_load_dwordx4 v45, s[48:51], s70 offen offset:1024 lds
  v_mfma_f32_16x16x32_bf16 v[100:103], a[220:223], a[200:203], v[100:103]
  ds_read_b128 a[172:175], v50 offset:4608
  v_mfma_f32_16x16x32_bf16 v[120:123], a[220:223], a[204:207], v[120:123]
  ds_read_b128 a[180:183], v53 offset:1024
  v_mfma_f32_16x16x32_bf16 v[140:143], a[220:223], a[208:211], v[140:143]
  ds_read_b128 a[184:187], v53 offset:2048
  buffer_load_dwordx4 v46, s[48:51], s70 offen offset:2048 lds
  v_mfma_f32_16x16x32_bf16 v[160:163], a[220:223], a[212:215], v[160:163]
  ds_read_b128 a[188:191], v53 offset:3072
  v_mfma_f32_16x16x32_bf16 v[104:107], a[224:227], a[200:203], v[104:107]
  ds_read_b128 a[192:195], v53 offset:4096
  v_mfma_f32_16x16x32_bf16 v[124:127], a[224:227], a[204:207], v[124:127]
  v_mfma_f32_16x16x32_bf16 v[144:147], a[224:227], a[208:211], v[144:147]
  buffer_load_dwordx4 v47, s[48:51], s70 offen offset:3072 lds
  s_add_u32 s70, s70, 128
  v_mfma_f32_16x16x32_bf16 v[164:167], a[224:227], a[212:215], v[164:167]
  s_and_b32 s70, s70, 0x7ff
  v_mfma_f32_16x16x32_bf16 v[108:111], a[228:231], a[200:203], v[108:111]
  s_add_u32 m0, s67, 53248
  v_mfma_f32_16x16x32_bf16 v[128:131], a[228:231], a[204:207], v[128:131]
  v_mfma_f32_16x16x32_bf16 v[148:151], a[228:231], a[208:211], v[148:151]
  buffer_load_dwordx4 v54, s[8:11], s73 offen offset:0 sc1 lds
  v_mfma_f32_16x16x32_bf16 v[168:171], a[228:231], a[212:215], v[168:171]
  v_mfma_f32_16x16x32_bf16 v[112:115], a[232:235], a[200:203], v[112:115]
  v_mfma_f32_16x16x32_bf16 v[132:135], a[232:235], a[204:207], v[132:135]
  buffer_load_dwordx4 v54, s[8:11], s73 offen offset:1024 sc1 lds
  v_mfma_f32_16x16x32_bf16 v[152:155], a[232:235], a[208:211], v[152:155]
  v_mfma_f32_16x16x32_bf16 v[172:175], a[232:235], a[212:215], v[172:175]
  s_waitcnt lgkmcnt(0)
  v_mfma_f32_16x16x32_bf16 v[96:99], a[176:179], a[160:163], v[96:99]
  ds_read_b128 a[216:219], v53 offset:10240
  v_mfma_f32_16x16x32_bf16 v[116:119], a[176:179], a[164:167], v[116:119]
  ds_read_b128 a[200:203], v51 offset:0
  buffer_load_dwordx4 v54, s[8:11], s73 offen offset:2048 sc1 lds
  v_mfma_f32_16x16x32_bf16 v[136:139], a[176:179], a[168:171], v[136:139]
  ds_read_b128 a[204:207], v51 offset:512
  v_mfma_f32_16x16x32_bf16 v[156:159], a[176:179], a[172:175], v[156:159]
  ds_read_b128 a[208:211], v51 offset:4096
  v_mfma_f32_16x16x32_bf16 v[100:103], a[180:183], a[160:163], v[100:103]
  ds_read_b128 a[212:215], v51 offset:4608
  buffer_load_dwordx4 v54, s[8:11], s73 offen offset:3072 sc1 lds
  v_mfma_f32_16x16x32_bf16 v[120:123], a[180:183], a[164:167], v[120:123]
  ds_read_b128 a[220:223], v53 offset:11264
  s_add_u32 m0, s67, 57344
  v_mfma_f32_16x16x32_bf16 v[140:143], a[180:183], a[168:171], v[140:143]
  ds_read_b128 a[224:227], v53 offset:12288
  v_mfma_f32_16x16x32_bf16 v[160:163], a[180:183], a[172:175], v[160:163]
  ds_read_b128 a[228:231], v53 offset:13312
  v_mfma_f32_16x16x32_bf16 v[104:107], a[184:187], a[160:163], v[104:107]
  ds_read_b128 a[232:235], v53 offset:14336
  buffer_load_dwordx4 v55, s[8:11], s73 offen sc1 lds
  v_mfma_f32_16x16x32_bf16 v[124:127], a[184:187], a[164:167], v[124:127]
  v_mfma_f32_16x16x32_bf16 v[144:147], a[184:187], a[168:171], v[144:147]
  s_add_u32 s82, s76, 4096
  v_mfma_f32_16x16x32_bf16 v[164:167], a[184:187], a[172:175], v[164:167]
  v_mfma_f32_16x16x32_bf16 v[108:111], a[188:191], a[160:163], v[108:111]
  buffer_load_dwordx4 v[192:195], v76, s[8:11], s82 offen sc1
  v_mfma_f32_16x16x32_bf16 v[128:131], a[188:191], a[164:167], v[128:131]
  v_mfma_f32_16x16x32_bf16 v[148:151], a[188:191], a[168:171], v[148:151]
  v_mfma_f32_16x16x32_bf16 v[168:171], a[188:191], a[172:175], v[168:171]
  buffer_load_dwordx4 v[196:199], v77, s[8:11], s82 offen sc1
  v_mfma_f32_16x16x32_bf16 v[112:115], a[192:195], a[160:163], v[112:115]
  v_mfma_f32_16x16x32_bf16 v[132:135], a[192:195], a[164:167], v[132:135]
  v_mfma_f32_16x16x32_bf16 v[152:155], a[192:195], a[168:171], v[152:155]
  v_mfma_f32_16x16x32_bf16 v[172:175], a[192:195], a[172:175], v[172:175]
  s_waitcnt vmcnt(21) lgkmcnt(0)
  s_barrier
  buffer_load_dwordx4 v[200:203], v78, s[8:11], s82 offen sc1
  v_mfma_f32_16x16x32_bf16 v[96:99], a[216:219], a[200:203], v[96:99]
  ds_read_b128 a[176:179], v53 offset:36864
  v_mfma_f32_16x16x32_bf16 v[116:119], a[216:219], a[204:207], v[116:119]
  ds_read_b128 a[160:163], v50 offset:36864
  v_mfma_f32_16x16x32_bf16 v[136:139], a[216:219], a[208:211], v[136:139]
  ds_read_b128 a[164:167], v50 offset:37376
  buffer_load_dwordx4 v[204:207], v79, s[8:11], s82 offen sc1
  v_mfma_f32_16x16x32_bf16 v[156:159], a[216:219], a[212:215], v[156:159]
  ds_read_b128 a[168:171], v50 offset:40960
  v_mfma_f32_16x16x32_bf16 v[100:103], a[220:223], a[200:203], v[100:103]
  ds_read_b128 a[172:175], v50 offset:41472
  s_add_u32 m0, s66, 73728
  v_mfma_f32_16x16x32_bf16 v[120:123], a[220:223], a[204:207], v[120:123]
  ds_read_b128 a[180:183], v53 offset:37888
  s_mul_i32 s74, s70, 160
  v_mfma_f32_16x16x32_bf16 v[140:143], a[220:223], a[208:211], v[140:143]
  ds_read_b128 a[184:187], v53 offset:38912
  buffer_load_dwordx4 v44, s[48:51], s70 offen offset:0 lds
  v_mfma_f32_16x16x32_bf16 v[160:163], a[220:223], a[212:215], v[160:163]
  ds_read_b128 a[188:191], v53 offset:39936
  v_mfma_f32_16x16x32_bf16 v[104:107], a[224:227], a[200:203], v[104:107]
  ds_read_b128 a[192:195], v53 offset:40960
  v_mfma_f32_16x16x32_bf16 v[124:127], a[224:227], a[204:207], v[124:127]
  v_mfma_f32_16x16x32_bf16 v[144:147], a[224:227], a[208:211], v[144:147]
  buffer_load_dwordx4 v45, s[48:51], s70 offen offset:1024 lds
  v_mfma_f32_16x16x32_bf16 v[164:167], a[224:227], a[212:215], v[164:167]
  v_mfma_f32_16x16x32_bf16 v[108:111], a[228:231], a[200:203], v[108:111]
  v_mfma_f32_16x16x32_bf16 v[128:131], a[228:231], a[204:207], v[128:131]
  buffer_load_dwordx4 v46, s[48:51], s70 offen offset:2048 lds
  v_mfma_f32_16x16x32_bf16 v[148:151], a[228:231], a[208:211], v[148:151]
  v_mfma_f32_16x16x32_bf16 v[168:171], a[228:231], a[212:215], v[168:171]
  v_mfma_f32_16x16x32_bf16 v[112:115], a[232:235], a[200:203], v[112:115]
  v_mfma_f32_16x16x32_bf16 v[132:135], a[232:235], a[204:207], v[132:135]
  buffer_load_dwordx4 v47, s[48:51], s70 offen offset:3072 lds
  s_add_u32 s70, s70, 128
  v_mfma_f32_16x16x32_bf16 v[152:155], a[232:235], a[208:211], v[152:155]
  s_and_b32 s70, s70, 0x7ff
  s_add_u32 m0, s67, 90112
  v_mfma_f32_16x16x32_bf16 v[172:175], a[232:235], a[212:215], v[172:175]
  s_waitcnt lgkmcnt(0)
  v_add_u32 v44, s66, v1
  v_mfma_f32_16x16x32_bf16 v[96:99], a[176:179], a[160:163], v[96:99]
  ds_read_b128 a[216:219], v53 offset:47104
  buffer_load_dwordx4 v54, s[8:11], s74 offen offset:0 sc1 lds
  v_mfma_f32_16x16x32_bf16 v[116:119], a[176:179], a[164:167], v[116:119]
  ds_read_b128 a[200:203], v51 offset:36864
  v_add_u32 v45, 110592, v44
  v_mfma_f32_16x16x32_bf16 v[136:139], a[176:179], a[168:171], v[136:139]
  ds_read_b128 a[204:207], v51 offset:37376
  v_mfma_f32_16x16x32_bf16 v[156:159], a[176:179], a[172:175], v[156:159]
  ds_read_b128 a[208:211], v51 offset:40960
  v_mfma_f32_16x16x32_bf16 v[100:103], a[180:183], a[160:163], v[100:103]
  ds_read_b128 a[212:215], v51 offset:41472
  buffer_load_dwordx4 v54, s[8:11], s74 offen offset:1024 sc1 lds
  v_mfma_f32_16x16x32_bf16 v[120:123], a[180:183], a[164:167], v[120:123]
  ds_read_b128 a[220:223], v53 offset:48128
  v_mfma_f32_16x16x32_bf16 v[140:143], a[180:183], a[168:171], v[140:143]
  ds_read_b128 a[224:227], v53 offset:49152
  v_mfma_f32_16x16x32_bf16 v[160:163], a[180:183], a[172:175], v[160:163]
  ds_read_b128 a[228:231], v53 offset:50176
  v_mfma_f32_16x16x32_bf16 v[104:107], a[184:187], a[160:163], v[104:107]
  ds_read_b128 a[232:235], v53 offset:51200
  buffer_load_dwordx4 v54, s[8:11], s74 offen offset:2048 sc1 lds
  v_mfma_f32_16x16x32_bf16 v[124:127], a[184:187], a[164:167], v[124:127]
  v_mfma_f32_16x16x32_bf16 v[144:147], a[184:187], a[168:171], v[144:147]
  v_mfma_f32_16x16x32_bf16 v[164:167], a[184:187], a[172:175], v[164:167]
  buffer_load_dwordx4 v54, s[8:11], s74 offen offset:3072 sc1 lds
  s_add_u32 m0, s67, 94208
  v_mfma_f32_16x16x32_bf16 v[108:111], a[188:191], a[160:163], v[108:111]
  v_mfma_f32_16x16x32_bf16 v[128:131], a[188:191], a[164:167], v[128:131]
  v_mfma_f32_16x16x32_bf16 v[148:151], a[188:191], a[168:171], v[148:151]
  v_mfma_f32_16x16x32_bf16 v[168:171], a[188:191], a[172:175], v[168:171]
  buffer_load_dwordx4 v55, s[8:11], s74 offen sc1 lds
  v_mfma_f32_16x16x32_bf16 v[112:115], a[192:195], a[160:163], v[112:115]
  v_lshlrev_b32 v88, 7, v2
  v_mfma_f32_16x16x32_bf16 v[132:135], a[192:195], a[164:167], v[132:135]
  v_mfma_f32_16x16x32_bf16 v[152:155], a[192:195], a[168:171], v[152:155]
  buffer_load_dword v73, v91, s[8:11], s31 offen sc1
  v_mfma_f32_16x16x32_bf16 v[172:175], a[192:195], a[172:175], v[172:175]
  s_waitcnt vmcnt(24) lgkmcnt(0)
  s_barrier
  v_mfma_f32_16x16x32_bf16 v[96:99], a[216:219], a[200:203], v[96:99]
  ds_read_b128 a[176:179], v52 offset:0
  s_add_u32 s82, s76, 8192
  v_mfma_f32_16x16x32_bf16 v[116:119], a[216:219], a[204:207], v[116:119]
  ds_read_b128 a[160:163], v48 offset:0
  v_mfma_f32_16x16x32_bf16 v[136:139], a[216:219], a[208:211], v[136:139]
  ds_read_b128 a[164:167], v48 offset:512
  buffer_load_dwordx4 v[208:211], v76, s[8:11], s82 offen sc1
  v_mfma_f32_16x16x32_bf16 v[156:159], a[216:219], a[212:215], v[156:159]
  ds_read_b128 a[168:171], v48 offset:4096
  buffer_load_dwordx4 v[212:215], v77, s[8:11], s82 offen sc1
  v_mfma_f32_16x16x32_bf16 v[100:103], a[220:223], a[200:203], v[100:103]
  ds_read_b128 a[172:175], v48 offset:4608
  v_mfma_f32_16x16x32_bf16 v[120:123], a[220:223], a[204:207], v[120:123]
  ds_read_b128 a[180:183], v52 offset:1024
  v_mfma_f32_16x16x32_bf16 v[140:143], a[220:223], a[208:211], v[140:143]
  ds_read_b128 a[184:187], v52 offset:2048
  buffer_load_dwordx4 v[216:219], v78, s[8:11], s82 offen sc1
  v_mfma_f32_16x16x32_bf16 v[160:163], a[220:223], a[212:215], v[160:163]
  ds_read_b128 a[188:191], v52 offset:3072
  v_mfma_f32_16x16x32_bf16 v[104:107], a[224:227], a[200:203], v[104:107]
  ds_read_b128 a[192:195], v52 offset:4096
  v_mfma_f32_16x16x32_bf16 v[124:127], a[224:227], a[204:207], v[124:127]
  v_mfma_f32_16x16x32_bf16 v[144:147], a[224:227], a[208:211], v[144:147]
  buffer_load_dwordx4 v[220:223], v79, s[8:11], s82 offen sc1
  v_mfma_f32_16x16x32_bf16 v[164:167], a[224:227], a[212:215], v[164:167]
  s_add_u32 s82, s76, 12288
  v_mfma_f32_16x16x32_bf16 v[108:111], a[228:231], a[200:203], v[108:111]
  v_mfma_f32_16x16x32_bf16 v[128:131], a[228:231], a[204:207], v[128:131]
  buffer_load_dwordx4 v[224:227], v76, s[8:11], s82 offen sc1
  v_mfma_f32_16x16x32_bf16 v[148:151], a[228:231], a[208:211], v[148:151]
  v_mfma_f32_16x16x32_bf16 v[168:171], a[228:231], a[212:215], v[168:171]
  v_mfma_f32_16x16x32_bf16 v[112:115], a[232:235], a[200:203], v[112:115]
  v_mfma_f32_16x16x32_bf16 v[132:135], a[232:235], a[204:207], v[132:135]
  buffer_load_dwordx4 v[228:231], v77, s[8:11], s82 offen sc1
  v_mfma_f32_16x16x32_bf16 v[152:155], a[232:235], a[208:211], v[152:155]
  v_mfma_f32_16x16x32_bf16 v[172:175], a[232:235], a[212:215], v[172:175]
  s_waitcnt lgkmcnt(0)
  v_mfma_f32_16x16x32_bf16 v[96:99], a[176:179], a[160:163], v[96:99]
  ds_read_b128 a[216:219], v52 offset:10240
  buffer_load_dwordx4 v[232:235], v78, s[8:11], s82 offen sc1
  v_mfma_f32_16x16x32_bf16 v[116:119], a[176:179], a[164:167], v[116:119]
  ds_read_b128 a[200:203], v49 offset:0
  v_mfma_f32_16x16x32_bf16 v[136:139], a[176:179], a[168:171], v[136:139]
  ds_read_b128 a[204:207], v49 offset:512
  v_mfma_f32_16x16x32_bf16 v[156:159], a[176:179], a[172:175], v[156:159]
  ds_read_b128 a[208:211], v49 offset:4096
  v_mfma_f32_16x16x32_bf16 v[100:103], a[180:183], a[160:163], v[100:103]
  ds_read_b128 a[212:215], v49 offset:4608
  buffer_load_dwordx4 v[236:239], v79, s[8:11], s82 offen sc1
  v_mfma_f32_16x16x32_bf16 v[120:123], a[180:183], a[164:167], v[120:123]
  ds_read_b128 a[220:223], v52 offset:11264
  v_mfma_f32_16x16x32_bf16 v[140:143], a[180:183], a[168:171], v[140:143]
  ds_read_b128 a[224:227], v52 offset:12288
  s_add_u32 s81, s77, 327680
  v_mfma_f32_16x16x32_bf16 v[160:163], a[180:183], a[172:175], v[160:163]
  ds_read_b128 a[228:231], v52 offset:13312
  s_add_u32 m0, s66, 110592
  v_mfma_f32_16x16x32_bf16 v[104:107], a[184:187], a[160:163], v[104:107]
  ds_read_b128 a[232:235], v52 offset:14336
  buffer_load_dwordx4 v1, s[8:11], s81 offen offset:0 sc1 lds
  v_mfma_f32_16x16x32_bf16 v[124:127], a[184:187], a[164:167], v[124:127]
  v_mfma_f32_16x16x32_bf16 v[144:147], a[184:187], a[168:171], v[144:147]
  v_mfma_f32_16x16x32_bf16 v[164:167], a[184:187], a[172:175], v[164:167]
  buffer_load_dwordx4 v1, s[8:11], s81 offen offset:1024 sc1 lds
  v_mfma_f32_16x16x32_bf16 v[108:111], a[188:191], a[160:163], v[108:111]
  v_mfma_f32_16x16x32_bf16 v[128:131], a[188:191], a[164:167], v[128:131]
  v_mfma_f32_16x16x32_bf16 v[148:151], a[188:191], a[168:171], v[148:151]
  v_mfma_f32_16x16x32_bf16 v[168:171], a[188:191], a[172:175], v[168:171]
  buffer_load_dwordx4 v1, s[8:11], s81 offen offset:2048 sc1 lds
  v_mfma_f32_16x16x32_bf16 v[112:115], a[192:195], a[160:163], v[112:115]
  v_mfma_f32_16x16x32_bf16 v[132:135], a[192:195], a[164:167], v[132:135]
  v_mfma_f32_16x16x32_bf16 v[152:155], a[192:195], a[168:171], v[152:155]
  buffer_load_dwordx4 v1, s[8:11], s81 offen offset:3072 sc1 lds
  s_add_u32 m0, s66, 143360
  v_mfma_f32_16x16x32_bf16 v[172:175], a[192:195], a[172:175], v[172:175]
  s_waitcnt vmcnt(26) lgkmcnt(0)
  s_barrier
  v_mfma_f32_16x16x32_bf16 v[96:99], a[216:219], a[200:203], v[96:99]
  ds_read_b128 a[176:179], v52 offset:36864
  v_mfma_f32_16x16x32_bf16 v[116:119], a[216:219], a[204:207], v[116:119]
  ds_read_b128 a[160:163], v48 offset:36864
  v_mfma_f32_16x16x32_bf16 v[136:139], a[216:219], a[208:211], v[136:139]
  ds_read_b128 a[164:167], v48 offset:37376
  buffer_load_dwordx4 v3, s[8:11], s81 offen sc1 lds
  v_mfma_f32_16x16x32_bf16 v[156:159], a[216:219], a[212:215], v[156:159]
  ds_read_b128 a[168:171], v48 offset:40960
  v_mfma_f32_16x16x32_bf16 v[100:103], a[220:223], a[200:203], v[100:103]
  ds_read_b128 a[172:175], v48 offset:41472
  s_add_u32 s81, s77, 368640
  v_mfma_f32_16x16x32_bf16 v[120:123], a[220:223], a[204:207], v[120:123]
  ds_read_b128 a[180:183], v52 offset:37888
  s_add_u32 m0, s66, 126976
  v_mfma_f32_16x16x32_bf16 v[140:143], a[220:223], a[208:211], v[140:143]
  ds_read_b128 a[184:187], v52 offset:38912
  buffer_load_dwordx4 v1, s[8:11], s81 offen offset:0 sc1 lds
  v_mfma_f32_16x16x32_bf16 v[160:163], a[220:223], a[212:215], v[160:163]
  ds_read_b128 a[188:191], v52 offset:39936
  v_mfma_f32_16x16x32_bf16 v[104:107], a[224:227], a[200:203], v[104:107]
  ds_read_b128 a[192:195], v52 offset:40960
  v_mfma_f32_16x16x32_bf16 v[124:127], a[224:227], a[204:207], v[124:127]
  buffer_load_dwordx4 v1, s[8:11], s81 offen offset:1024 sc1 lds
  v_mfma_f32_16x16x32_bf16 v[144:147], a[224:227], a[208:211], v[144:147]
  v_mfma_f32_16x16x32_bf16 v[164:167], a[224:227], a[212:215], v[164:167]
  v_mfma_f32_16x16x32_bf16 v[108:111], a[228:231], a[200:203], v[108:111]
  v_mfma_f32_16x16x32_bf16 v[128:131], a[228:231], a[204:207], v[128:131]
  buffer_load_dwordx4 v1, s[8:11], s81 offen offset:2048 sc1 lds
  v_mfma_f32_16x16x32_bf16 v[148:151], a[228:231], a[208:211], v[148:151]
  v_mfma_f32_16x16x32_bf16 v[168:171], a[228:231], a[212:215], v[168:171]
  v_mfma_f32_16x16x32_bf16 v[112:115], a[232:235], a[200:203], v[112:115]
  buffer_load_dwordx4 v1, s[8:11], s81 offen offset:3072 sc1 lds
  s_add_u32 m0, s66, 144384
  v_mfma_f32_16x16x32_bf16 v[132:135], a[232:235], a[204:207], v[132:135]
  v_mfma_f32_16x16x32_bf16 v[152:155], a[232:235], a[208:211], v[152:155]
  v_mfma_f32_16x16x32_bf16 v[172:175], a[232:235], a[212:215], v[172:175]
  s_waitcnt lgkmcnt(0)
  v_mfma_f32_16x16x32_bf16 v[96:99], a[176:179], a[160:163], v[96:99]
  ds_read_b128 a[216:219], v52 offset:47104
  buffer_load_dwordx4 v3, s[8:11], s81 offen sc1 lds
  v_mfma_f32_16x16x32_bf16 v[116:119], a[176:179], a[164:167], v[116:119]
  ds_read_b128 a[200:203], v49 offset:36864
  v_mfma_f32_16x16x32_bf16 v[136:139], a[176:179], a[168:171], v[136:139]
  ds_read_b128 a[204:207], v49 offset:37376
  s_add_u32 s81, s77, 409600
  v_mfma_f32_16x16x32_bf16 v[156:159], a[176:179], a[172:175], v[156:159]
  ds_read_b128 a[208:211], v49 offset:40960
  s_add_u32 m0, s66, 0
  v_mfma_f32_16x16x32_bf16 v[100:103], a[180:183], a[160:163], v[100:103]
  ds_read_b128 a[212:215], v49 offset:41472
  buffer_load_dwordx4 v1, s[8:11], s81 offen offset:0 sc1 lds
  v_mfma_f32_16x16x32_bf16 v[120:123], a[180:183], a[164:167], v[120:123]
  ds_read_b128 a[220:223], v52 offset:48128
  v_mfma_f32_16x16x32_bf16 v[140:143], a[180:183], a[168:171], v[140:143]
  ds_read_b128 a[224:227], v52 offset:49152
  v_mfma_f32_16x16x32_bf16 v[160:163], a[180:183], a[172:175], v[160:163]
  ds_read_b128 a[228:231], v52 offset:50176
  buffer_load_dwordx4 v1, s[8:11], s81 offen offset:1024 sc1 lds
  v_mfma_f32_16x16x32_bf16 v[104:107], a[184:187], a[160:163], v[104:107]
  ds_read_b128 a[232:235], v52 offset:51200
  v_mfma_f32_16x16x32_bf16 v[124:127], a[184:187], a[164:167], v[124:127]
  v_mfma_f32_16x16x32_bf16 v[144:147], a[184:187], a[168:171], v[144:147]
  v_mfma_f32_16x16x32_bf16 v[164:167], a[184:187], a[172:175], v[164:167]
  buffer_load_dwordx4 v1, s[8:11], s81 offen offset:2048 sc1 lds
  v_mfma_f32_16x16x32_bf16 v[108:111], a[188:191], a[160:163], v[108:111]
  v_mfma_f32_16x16x32_bf16 v[128:131], a[188:191], a[164:167], v[128:131]
  v_mfma_f32_16x16x32_bf16 v[148:151], a[188:191], a[168:171], v[148:151]
  buffer_load_dwordx4 v1, s[8:11], s81 offen offset:3072 sc1 lds
  s_add_u32 m0, s66, 145408
  v_mfma_f32_16x16x32_bf16 v[168:171], a[188:191], a[172:175], v[168:171]
  v_mfma_f32_16x16x32_bf16 v[112:115], a[192:195], a[160:163], v[112:115]
  v_mfma_f32_16x16x32_bf16 v[132:135], a[192:195], a[164:167], v[132:135]
  v_mfma_f32_16x16x32_bf16 v[152:155], a[192:195], a[168:171], v[152:155]
  buffer_load_dwordx4 v3, s[8:11], s81 offen sc1 lds
  s_waitcnt vmcnt(23)
  v_cmp_ne_u32 vcc, s64, v73
  s_cbranch_vccnz E_slow5
E_ok5:
  v_mfma_f32_16x16x32_bf16 v[172:175], a[192:195], a[172:175], v[172:175]
  s_waitcnt lgkmcnt(0)
  s_barrier
  s_add_u32 s81, s77, 450560
  v_mfma_f32_16x16x32_bf16 v[96:99], a[216:219], a[200:203], v[96:99]
  ds_read_b128 a[176:179], v53 offset:0
  s_add_u32 m0, s66, 16384
  v_mfma_f32_16x16x32_bf16 v[116:119], a[216:219], a[204:207], v[116:119]
  ds_read_b128 a[160:163], v50 offset:0
  buffer_load_dwordx4 v1, s[8:11], s81 offen offset:0 sc1 lds
  v_mfma_f32_16x16x32_bf16 v[136:139], a[216:219], a[208:211], v[136:139]
  ds_read_b128 a[164:167], v50 offset:512
  v_mfma_f32_16x16x32_bf16 v[156:159], a[216:219], a[212:215], v[156:159]
  ds_read_b128 a[168:171], v50 offset:4096
  v_mfma_f32_16x16x32_bf16 v[100:103], a[220:223], a[200:203], v[100:103]
  ds_read_b128 a[172:175], v50 offset:4608
  v_mfma_f32_16x16x32_bf16 v[120:123], a[220:223], a[204:207], v[120:123]
  ds_read_b128 a[180:183], v53 offset:1024
  buffer_load_dwordx4 v1, s[8:11], s81 offen offset:1024 sc1 lds
  v_mfma_f32_16x16x32_bf16 v[140:143], a[220:223], a[208:211], v[140:143]
  ds_read_b128 a[184:187], v53 offset:2048
  v_mfma_f32_16x16x32_bf16 v[160:163], a[220:223], a[212:215], v[160:163]
  ds_read_b128 a[188:191], v53 offset:3072
  v_mfma_f32_16x16x32_bf16 v[104:107], a[224:227], a[200:203], v[104:107]
  ds_read_b128 a[192:195], v53 offset:4096
  v_mfma_f32_16x16x32_bf16 v[124:127], a[224:227], a[204:207], v[124:127]
  buffer_load_dwordx4 v1, s[8:11], s81 offen offset:2048 sc1 lds
  v_mfma_f32_16x16x32_bf16 v[144:147], a[224:227], a[208:211], v[144:147]
  v_mfma_f32_16x16x32_bf16 v[164:167], a[224:227], a[212:215], v[164:167]
  v_mfma_f32_16x16x32_bf16 v[108:111], a[228:231], a[200:203], v[108:111]
  buffer_load_dwordx4 v1, s[8:11], s81 offen offset:3072 sc1 lds
  s_add_u32 m0, s66, 146432
  v_mfma_f32_16x16x32_bf16 v[128:131], a[228:231], a[204:207], v[128:131]
  v_mfma_f32_16x16x32_bf16 v[148:151], a[228:231], a[208:211], v[148:151]
  v_mfma_f32_16x16x32_bf16 v[168:171], a[228:231], a[212:215], v[168:171]
  v_mfma_f32_16x16x32_bf16 v[112:115], a[232:235], a[200:203], v[112:115]
  buffer_load_dwordx4 v3, s[8:11], s81 offen sc1 lds
  v_mfma_f32_16x16x32_bf16 v[132:135], a[232:235], a[204:207], v[132:135]
  s_add_u32 s82, s76, 16384
  v_mfma_f32_16x16x32_bf16 v[152:155], a[232:235], a[208:211], v[152:155]
  v_mfma_f32_16x16x32_bf16 v[172:175], a[232:235], a[212:215], v[172:175]
  s_waitcnt lgkmcnt(0)
  buffer_load_dwordx4 v[240:243], v76, s[8:11], s82 offen sc1
  v_mfma_f32_16x16x32_bf16 v[96:99], a[176:179], a[160:163], v[96:99]
  ds_read_b128 a[216:219], v53 offset:10240
  v_mfma_f32_16x16x32_bf16 v[116:119], a[176:179], a[164:167], v[116:119]
  ds_read_b128 a[200:203], v51 offset:0
  v_mfma_f32_16x16x32_bf16 v[136:139], a[176:179], a[168:171], v[136:139]
  ds_read_b128 a[204:207], v51 offset:512
  v_mfma_f32_16x16x32_bf16 v[156:159], a[176:179], a[172:175], v[156:159]
  ds_read_b128 a[208:211], v51 offset:4096
  buffer_load_dwordx4 v[244:247], v77, s[8:11], s82 offen sc1
  v_mfma_f32_16x16x32_bf16 v[100:103], a[180:183], a[160:163], v[100:103]
  ds_read_b128 a[212:215], v51 offset:4608
  v_mfma_f32_16x16x32_bf16 v[120:123], a[180:183], a[164:167], v[120:123]
  ds_read_b128 a[220:223], v53 offset:11264
  v_mfma_f32_16x16x32_bf16 v[140:143], a[180:183], a[168:171], v[140:143]
  ds_read_b128 a[224:227], v53 offset:12288
  v_mfma_f32_16x16x32_bf16 v[160:163], a[180:183], a[172:175], v[160:163]
  ds_read_b128 a[228:231], v53 offset:13312
  buffer_load_dwordx4 v[248:251], v78, s[8:11], s82 offen sc1
  v_mfma_f32_16x16x32_bf16 v[104:107], a[184:187], a[160:163], v[104:107]
  ds_read_b128 a[232:235], v53 offset:14336
  v_mfma_f32_16x16x32_bf16 v[124:127], a[184:187], a[164:167], v[124:127]
  v_mfma_f32_16x16x32_bf16 v[144:147], a[184:187], a[168:171], v[144:147]
  buffer_load_dwordx4 v[252:255], v79, s[8:11], s82 offen sc1
  v_mfma_f32_16x16x32_bf16 v[164:167], a[184:187], a[172:175], v[164:167]
  v_mfma_f32_16x16x32_bf16 v[108:111], a[188:191], a[160:163], v[108:111]
  s_add_u32 s82, s76, 20480
  v_mfma_f32_16x16x32_bf16 v[128:131], a[188:191], a[164:167], v[128:131]
  v_mfma_f32_16x16x32_bf16 v[148:151], a[188:191], a[168:171], v[148:151]
  buffer_load_dwordx4 a[240:243], v76, s[8:11], s82 offen sc1
  v_mfma_f32_16x16x32_bf16 v[168:171], a[188:191], a[172:175], v[168:171]
  v_mfma_f32_16x16x32_bf16 v[112:115], a[192:195], a[160:163], v[112:115]
  v_mfma_f32_16x16x32_bf16 v[132:135], a[192:195], a[164:167], v[132:135]
  buffer_load_dwordx4 a[244:247], v77, s[8:11], s82 offen sc1
  v_mfma_f32_16x16x32_bf16 v[152:155], a[192:195], a[168:171], v[152:155]
  v_mfma_f32_16x16x32_bf16 v[172:175], a[192:195], a[172:175], v[172:175]
  s_waitcnt lgkmcnt(0)
  v_mfma_f32_16x16x32_bf16 v[96:99], a[216:219], a[200:203], v[96:99]
  v_mfma_f32_16x16x32_bf16 v[116:119], a[216:219], a[204:207], v[116:119]
  buffer_load_dwordx4 a[248:251], v78, s[8:11], s82 offen sc1
  v_mfma_f32_16x16x32_bf16 v[136:139], a[216:219], a[208:211], v[136:139]
  v_mfma_f32_16x16x32_bf16 v[156:159], a[216:219], a[212:215], v[156:159]
  v_mfma_f32_16x16x32_bf16 v[100:103], a[220:223], a[200:203], v[100:103]
  v_mfma_f32_16x16x32_bf16 v[120:123], a[220:223], a[204:207], v[120:123]
  buffer_load_dwordx4 a[252:255], v79, s[8:11], s82 offen sc1
  v_mfma_f32_16x16x32_bf16 v[140:143], a[220:223], a[208:211], v[140:143]
  v_mfma_f32_16x16x32_bf16 v[160:163], a[220:223], a[212:215], v[160:163]
  v_mfma_f32_16x16x32_bf16 v[104:107], a[224:227], a[200:203], v[104:107]
  v_mfma_f32_16x16x32_bf16 v[124:127], a[224:227], a[204:207], v[124:127]
  v_mfma_f32_16x16x32_bf16 v[144:147], a[224:227], a[208:211], v[144:147]
  v_mfma_f32_16x16x32_bf16 v[164:167], a[224:227], a[212:215], v[164:167]
  v_mfma_f32_16x16x32_bf16 v[108:111], a[228:231], a[200:203], v[108:111]
  v_mfma_f32_16x16x32_bf16 v[128:131], a[228:231], a[204:207], v[128:131]
  v_mfma_f32_16x16x32_bf16 v[148:151], a[228:231], a[208:211], v[148:151]
  v_mfma_f32_16x16x32_bf16 v[168:171], a[228:231], a[212:215], v[168:171]
  v_mfma_f32_16x16x32_bf16 v[112:115], a[232:235], a[200:203], v[112:115]
  v_mfma_f32_16x16x32_bf16 v[132:135], a[232:235], a[204:207], v[132:135]
  v_mfma_f32_16x16x32_bf16 v[152:155], a[232:235], a[208:211], v[152:155]
  v_mfma_f32_16x16x32_bf16 v[172:175], a[232:235], a[212:215], v[172:175]
  v_mfma_f32_16x16x32_bf16 a[160:163], a[0:3], v[176:179], 0
  s_add_u32 s83, s78, 8192
  v_cvt_pk_bf16_f32 v96, v96, v97
  v_mfma_f32_16x16x32_bf16 a[180:183], a[0:3], v[180:183], 0
  v_cvt_pk_bf16_f32 v97, v98, v99
  v_cvt_pk_bf16_f32 v98, v100, v101
  v_mfma_f32_16x16x32_bf16 a[200:203], a[0:3], v[184:187], 0
  v_cvt_pk_bf16_f32 v99, v102, v103
  buffer_store_dwordx4 v[96:99], v1, s[8:11], s78 offen offset:0 sc1
  v_mfma_f32_16x16x32_bf16 v[4:7], a[0:3], v[188:191], 0
  ds_write_b128 v70, v[96:99] offset:36864
  v_cvt_pk_bf16_f32 v104, v104, v105
  v_mfma_f32_16x16x32_bf16 a[164:167], a[4:7], v[176:179], 0
  v_cvt_pk_bf16_f32 v105, v106, v107
  v_cvt_pk_bf16_f32 v106, v108, v109
  v_mfma_f32_16x16x32_bf16 a[184:187], a[4:7], v[180:183], 0
  v_cvt_pk_bf16_f32 v107, v110, v111
  buffer_store_dwordx4 v[104:107], v1, s[8:11], s78 offen offset:1024 sc1
  v_mfma_f32_16x16x32_bf16 a[204:207], a[4:7], v[184:187], 0
  ds_write_b128 v70, v[104:107] offset:37888
  v_cvt_pk_bf16_f32 v116, v116, v117
  v_mfma_f32_16x16x32_bf16 v[8:11], a[4:7], v[188:191], 0
  v_cvt_pk_bf16_f32 v117, v118, v119
  v_cvt_pk_bf16_f32 v118, v120, v121
  v_mfma_f32_16x16x32_bf16 a[168:171], a[8:11], v[176:179], 0
  v_cvt_pk_bf16_f32 v119, v122, v123
  buffer_store_dwordx4 v[116:119], v1, s[8:11], s78 offen offset:2048 sc1
  v_mfma_f32_16x16x32_bf16 a[188:191], a[8:11], v[180:183], 0
  ds_write_b128 v70, v[116:119] offset:38912
  v_cvt_pk_bf16_f32 v124, v124, v125
  v_mfma_f32_16x16x32_bf16 a[208:211], a[8:11], v[184:187], 0
  v_cvt_pk_bf16_f32 v125, v126, v127
  v_cvt_pk_bf16_f32 v126, v128, v129
  v_mfma_f32_16x16x32_bf16 v[12:15], a[8:11], v[188:191], 0
  v_cvt_pk_bf16_f32 v127, v130, v131
  buffer_store_dwordx4 v[124:127], v1, s[8:11], s78 offen offset:3072 sc1
  v_mfma_f32_16x16x32_bf16 a[172:175], a[12:15], v[176:179], 0
  ds_write_b128 v70, v[124:127] offset:39936
  v_cvt_pk_bf16_f32 v136, v136, v137
  v_mfma_f32_16x16x32_bf16 a[192:195], a[12:15], v[180:183], 0
  v_cvt_pk_bf16_f32 v137, v138, v139
  v_cvt_pk_bf16_f32 v138, v140, v141
  v_mfma_f32_16x16x32_bf16 a[212:215], a[12:15], v[184:187], 0
  v_cvt_pk_bf16_f32 v139, v142, v143
  buffer_store_dwordx4 v[136:139], v3, s[8:11], s78 offen offset:0 sc1
  v_mfma_f32_16x16x32_bf16 v[16:19], a[12:15], v[188:191], 0
  ds_write_b128 v70, v[136:139] offset:40960
  v_cvt_pk_bf16_f32 v144, v144, v145
  v_mfma_f32_16x16x32_bf16 a[176:179], a[16:19], v[176:179], 0
  v_cvt_pk_bf16_f32 v145, v146, v147
  v_cvt_pk_bf16_f32 v146, v148, v149
  v_mfma_f32_16x16x32_bf16 a[196:199], a[16:19], v[180:183], 0
  v_cvt_pk_bf16_f32 v147, v150, v151
  buffer_store_dwordx4 v[144:147], v3, s[8:11], s78 offen offset:1024 sc1
  v_mfma_f32_16x16x32_bf16 a[216:219], a[16:19], v[184:187], 0
  ds_write_b128 v70, v[144:147] offset:41984
  v_cvt_pk_bf16_f32 v156, v156, v157
  v_mfma_f32_16x16x32_bf16 v[20:23], a[16:19], v[188:191], 0
  v_cvt_pk_bf16_f32 v157, v158, v159
  v_cvt_pk_bf16_f32 v158, v160, v161
  v_mfma_f32_16x16x32_bf16 a[160:163], a[20:23], v[192:195], a[160:163]
  v_cvt_pk_bf16_f32 v159, v162, v163
  buffer_store_dwordx4 v[156:159], v3, s[8:11], s78 offen offset:2048 sc1
  v_mfma_f32_16x16x32_bf16 a[180:183], a[20:23], v[196:199], a[180:183]
  ds_write_b128 v70, v[156:159] offset:43008
  v_cvt_pk_bf16_f32 v164, v164, v165
  v_mfma_f32_16x16x32_bf16 a[200:203], a[20:23], v[200:203], a[200:203]
  v_cvt_pk_bf16_f32 v165, v166, v167
  v_cvt_pk_bf16_f32 v166, v168, v169
  v_mfma_f32_16x16x32_bf16 v[4:7], a[20:23], v[204:207], v[4:7]
  v_cvt_pk_bf16_f32 v167, v170, v171
  buffer_store_dwordx4 v[164:167], v3, s[8:11], s78 offen offset:3072 sc1
  v_mfma_f32_16x16x32_bf16 a[164:167], a[24:27], v[192:195], a[164:167]
  ds_write_b128 v70, v[164:167] offset:44032
  v_cvt_pk_bf16_f32 v112, v112, v113
  v_mfma_f32_16x16x32_bf16 a[184:187], a[24:27], v[196:199], a[184:187]
  v_cvt_pk_bf16_f32 v113, v114, v115
  v_cvt_pk_bf16_f32 v114, v132, v133
  v_mfma_f32_16x16x32_bf16 a[204:207], a[24:27], v[200:203], a[204:207]
  v_cvt_pk_bf16_f32 v115, v134, v135
  buffer_store_dwordx4 v[112:115], v1, s[8:11], s83 offen offset:0 sc1
  v_mfma_f32_16x16x32_bf16 v[8:11], a[24:27], v[204:207], v[8:11]
  ds_write_b128 v70, v[112:115] offset:45056
  v_cvt_pk_bf16_f32 v152, v152, v153
  v_mfma_f32_16x16x32_bf16 a[168:171], a[28:31], v[192:195], a[168:171]
  v_cvt_pk_bf16_f32 v153, v154, v155
  v_cvt_pk_bf16_f32 v154, v172, v173
  v_mfma_f32_16x16x32_bf16 a[188:191], a[28:31], v[196:199], a[188:191]
  v_cvt_pk_bf16_f32 v155, v174, v175
  buffer_store_dwordx4 v[152:155], v1, s[8:11], s83 offen offset:1024 sc1
  v_mfma_f32_16x16x32_bf16 a[208:211], a[28:31], v[200:203], a[208:211]
  ds_write_b128 v70, v[152:155] offset:46080
  s_add_u32 s82, s76, 24576
  v_mfma_f32_16x16x32_bf16 v[12:15], a[28:31], v[204:207], v[12:15]
  buffer_load_dwordx4 v[176:179], v76, s[8:11], s82 offen sc1
  v_mfma_f32_16x16x32_bf16 a[172:175], a[32:35], v[192:195], a[172:175]
  buffer_load_dwordx4 v[180:183], v77, s[8:11], s82 offen sc1
  v_mfma_f32_16x16x32_bf16 a[192:195], a[32:35], v[196:199], a[192:195]
  v_mfma_f32_16x16x32_bf16 a[212:215], a[32:35], v[200:203], a[212:215]
  v_mfma_f32_16x16x32_bf16 v[16:19], a[32:35], v[204:207], v[16:19]
  v_mfma_f32_16x16x32_bf16 a[176:179], a[36:39], v[192:195], a[176:179]
  buffer_load_dwordx4 v[184:187], v78, s[8:11], s82 offen sc1
  v_mfma_f32_16x16x32_bf16 a[196:199], a[36:39], v[196:199], a[196:199]
  v_mfma_f32_16x16x32_bf16 a[216:219], a[36:39], v[200:203], a[216:219]
  v_mfma_f32_16x16x32_bf16 v[20:23], a[36:39], v[204:207], v[20:23]
  s_waitcnt lgkmcnt(0)
  s_barrier
  buffer_load_dwordx4 v[188:191], v79, s[8:11], s82 offen sc1
  s_waitcnt vmcnt(49)
  v_mfma_f32_16x16x32_bf16 a[160:163], a[40:43], v[208:211], a[160:163]
  s_waitcnt vmcnt(48)
  v_mfma_f32_16x16x32_bf16 a[180:183], a[40:43], v[212:215], a[180:183]
  s_add_u32 s82, s76, 28672
  s_waitcnt vmcnt(47)
  v_mfma_f32_16x16x32_bf16 a[200:203], a[40:43], v[216:219], a[200:203]
  s_waitcnt vmcnt(46)
  v_mfma_f32_16x16x32_bf16 v[4:7], a[40:43], v[220:223], v[4:7]
  buffer_load_dwordx4 v[192:195], v76, s[8:11], s82 offen sc1
  v_mfma_f32_16x16x32_bf16 a[164:167], a[44:47], v[208:211], a[164:167]
  v_mfma_f32_16x16x32_bf16 a[184:187], a[44:47], v[212:215], a[184:187]
  v_mfma_f32_16x16x32_bf16 a[204:207], a[44:47], v[216:219], a[204:207]
  v_mfma_f32_16x16x32_bf16 v[8:11], a[44:47], v[220:223], v[8:11]
  buffer_load_dwordx4 v[196:199], v77, s[8:11], s82 offen sc1
  v_mfma_f32_16x16x32_bf16 a[168:171], a[48:51], v[208:211], a[168:171]
  v_mfma_f32_16x16x32_bf16 a[188:191], a[48:51], v[212:215], a[188:191]
  v_mfma_f32_16x16x32_bf16 a[208:211], a[48:51], v[216:219], a[208:211]
  buffer_load_dwordx4 v[200:203], v78, s[8:11], s82 offen sc1
  v_mfma_f32_16x16x32_bf16 v[12:15], a[48:51], v[220:223], v[12:15]
  v_mfma_f32_16x16x32_bf16 a[172:175], a[52:55], v[208:211], a[172:175]
  v_mfma_f32_16x16x32_bf16 a[192:195], a[52:55], v[212:215], a[192:195]
  v_mfma_f32_16x16x32_bf16 a[212:215], a[52:55], v[216:219], a[212:215]
  buffer_load_dwordx4 v[204:207], v79, s[8:11], s82 offen sc1
  v_mfma_f32_16x16x32_bf16 v[16:19], a[52:55], v[220:223], v[16:19]
  v_mfma_f32_16x16x32_bf16 a[176:179], a[56:59], v[208:211], a[176:179]
  v_mfma_f32_16x16x32_bf16 a[196:199], a[56:59], v[212:215], a[196:199]
  buffer_store_dword v71, v72, s[8:11], s38 offen sc1
  v_mfma_f32_16x16x32_bf16 a[216:219], a[56:59], v[216:219], a[216:219]
  v_mfma_f32_16x16x32_bf16 v[20:23], a[56:59], v[220:223], v[20:23]
  s_waitcnt vmcnt(50)
  v_mfma_f32_16x16x32_bf16 a[160:163], a[60:63], v[224:227], a[160:163]
  s_waitcnt vmcnt(49)
  v_mfma_f32_16x16x32_bf16 a[180:183], a[60:63], v[228:231], a[180:183]
  buffer_load_dwordx4 v[208:211], v76, s[8:11], s4 offen sc1
  buffer_load_dwordx4 v[212:215], v76, s[8:11], s5 offen sc1
  s_waitcnt vmcnt(50)
  v_mfma_f32_16x16x32_bf16 a[200:203], a[60:63], v[232:235], a[200:203]
  s_waitcnt vmcnt(49)
  v_mfma_f32_16x16x32_bf16 v[4:7], a[60:63], v[236:239], v[4:7]
  v_mfma_f32_16x16x32_bf16 a[164:167], a[64:67], v[224:227], a[164:167]
  v_mfma_f32_16x16x32_bf16 a[184:187], a[64:67], v[228:231], a[184:187]
  buffer_load_dwordx4 v[216:219], v76, s[8:11], s6 offen sc1
  v_mfma_f32_16x16x32_bf16 a[204:207], a[64:67], v[232:235], a[204:207]
  v_mfma_f32_16x16x32_bf16 v[8:11], a[64:67], v[236:239], v[8:11]
  v_mfma_f32_16x16x32_bf16 a[168:171], a[68:71], v[224:227], a[168:171]
  v_mfma_f32_16x16x32_bf16 a[188:191], a[68:71], v[228:231], a[188:191]
  buffer_load_dwordx4 v[220:223], v76, s[8:11], s7 offen sc1
  v_mfma_f32_16x16x32_bf16 a[208:211], a[68:71], v[232:235], a[208:211]
  v_mfma_f32_16x16x32_bf16 v[12:15], a[68:71], v[236:239], v[12:15]
  v_mfma_f32_16x16x32_bf16 a[172:175], a[72:75], v[224:227], a[172:175]
  v_mfma_f32_16x16x32_bf16 a[192:195], a[72:75], v[228:231], a[192:195]
  v_mfma_f32_16x16x32_bf16 a[212:215], a[72:75], v[232:235], a[212:215]
  v_mfma_f32_16x16x32_bf16 v[16:19], a[72:75], v[236:239], v[16:19]
  v_mfma_f32_16x16x32_bf16 a[176:179], a[76:79], v[224:227], a[176:179]
  v_mfma_f32_16x16x32_bf16 a[196:199], a[76:79], v[228:231], a[196:199]
  v_mfma_f32_16x16x32_bf16 a[216:219], a[76:79], v[232:235], a[216:219]
  v_mfma_f32_16x16x32_bf16 v[20:23], a[76:79], v[236:239], v[20:23]
  buffer_load_dwordx4 v[224:227], v77, s[8:11], s4 offen sc1
  buffer_load_dwordx4 v[228:231], v77, s[8:11], s5 offen sc1
  s_waitcnt vmcnt(32)
  v_mfma_f32_16x16x32_bf16 a[160:163], a[80:83], v[240:243], a[160:163]
  s_waitcnt vmcnt(31)
  v_mfma_f32_16x16x32_bf16 a[180:183], a[80:83], v[244:247], a[180:183]
  s_waitcnt vmcnt(30)
  v_mfma_f32_16x16x32_bf16 a[200:203], a[80:83], v[248:251], a[200:203]
  s_waitcnt vmcnt(29)
  v_mfma_f32_16x16x32_bf16 v[4:7], a[80:83], v[252:255], v[4:7]
  buffer_load_dwordx4 v[232:235], v77, s[8:11], s6 offen sc1
  v_mfma_f32_16x16x32_bf16 a[164:167], a[84:87], v[240:243], a[164:167]
  v_mfma_f32_16x16x32_bf16 a[184:187], a[84:87], v[244:247], a[184:187]
  v_mfma_f32_16x16x32_bf16 a[204:207], a[84:87], v[248:251], a[204:207]
  v_mfma_f32_16x16x32_bf16 v[8:11], a[84:87], v[252:255], v[8:11]
  buffer_load_dwordx4 v[236:239], v77, s[8:11], s7 offen sc1
  v_mfma_f32_16x16x32_bf16 a[168:171], a[88:91], v[240:243], a[168:171]
  v_mfma_f32_16x16x32_bf16 a[188:191], a[88:91], v[244:247], a[188:191]
  v_mfma_f32_16x16x32_bf16 a[208:211], a[88:91], v[248:251], a[208:211]
  buffer_load_dwordx4 a[60:63], v78, s[8:11], s4 offen sc1
  v_mfma_f32_16x16x32_bf16 v[12:15], a[88:91], v[252:255], v[12:15]
  v_mfma_f32_16x16x32_bf16 a[172:175], a[92:95], v[240:243], a[172:175]
  v_mfma_f32_16x16x32_bf16 a[192:195], a[92:95], v[244:247], a[192:195]
  v_mfma_f32_16x16x32_bf16 a[212:215], a[92:95], v[248:251], a[212:215]
  buffer_load_dwordx4 a[64:67], v78, s[8:11], s5 offen sc1
  v_mfma_f32_16x16x32_bf16 v[16:19], a[92:95], v[252:255], v[16:19]
  v_mfma_f32_16x16x32_bf16 a[176:179], a[96:99], v[240:243], a[176:179]
  v_mfma_f32_16x16x32_bf16 a[196:199], a[96:99], v[244:247], a[196:199]
  buffer_load_dwordx4 a[68:71], v78, s[8:11], s6 offen sc1
  v_mfma_f32_16x16x32_bf16 a[216:219], a[96:99], v[248:251], a[216:219]
  v_mfma_f32_16x16x32_bf16 v[20:23], a[96:99], v[252:255], v[20:23]
  v_add_u32 v84, s79, v1
  s_waitcnt vmcnt(33)
  v_mfma_f32_16x16x32_bf16 a[160:163], a[100:103], a[240:243], a[160:163]
  v_add_u32 v85, s79, v0
  s_waitcnt vmcnt(32)
  v_mfma_f32_16x16x32_bf16 a[180:183], a[100:103], a[244:247], a[180:183]
  ds_read_b128 v[132:135], v84 offset:0
  buffer_load_dwordx4 a[72:75], v78, s[8:11], s7 offen sc1
  s_waitcnt vmcnt(32)
  v_mfma_f32_16x16x32_bf16 a[200:203], a[100:103], a[248:251], a[200:203]
  ds_read_b128 v[136:139], v84 offset:1024
  s_waitcnt vmcnt(31)
  v_mfma_f32_16x16x32_bf16 v[4:7], a[100:103], a[252:255], v[4:7]
  ds_read_b128 v[140:143], v85 offset:0
  v_mfma_f32_16x16x32_bf16 a[164:167], a[104:107], a[240:243], a[164:167]
  ds_read_b128 a[220:223], v45 offset:0
  v_mfma_f32_16x16x32_bf16 a[184:187], a[104:107], a[244:247], a[184:187]
  ds_read_b128 a[224:227], v45 offset:1024
  buffer_load_dwordx4 a[80:83], v79, s[8:11], s4 offen sc1
  v_mfma_f32_16x16x32_bf16 a[204:207], a[104:107], a[248:251], a[204:207]
  ds_read_b128 a[228:231], v45 offset:2048
  v_mfma_f32_16x16x32_bf16 v[8:11], a[104:107], a[252:255], v[8:11]
  ds_read_b128 a[232:235], v45 offset:3072
  v_mfma_f32_16x16x32_bf16 a[168:171], a[108:111], a[240:243], a[168:171]
  ds_read_b128 a[236:239], v45 offset:32768
  buffer_load_dwordx4 a[84:87], v79, s[8:11], s5 offen sc1
  v_mfma_f32_16x16x32_bf16 a[188:191], a[108:111], a[244:247], a[188:191]
  ds_read_b128 a[0:3], v45 offset:16384
  v_mfma_f32_16x16x32_bf16 a[208:211], a[108:111], a[248:251], a[208:211]
  ds_read_b128 a[4:7], v45 offset:17408
  v_mfma_f32_16x16x32_bf16 v[12:15], a[108:111], a[252:255], v[12:15]
  ds_read_b128 a[8:11], v45 offset:18432
  v_mfma_f32_16x16x32_bf16 a[172:175], a[112:115], a[240:243], a[172:175]
  ds_read_b128 a[12:15], v45 offset:19456
  buffer_load_dwordx4 a[88:91], v79, s[8:11], s6 offen sc1
  v_mfma_f32_16x16x32_bf16 a[192:195], a[112:115], a[244:247], a[192:195]
  ds_read_b128 a[16:19], v45 offset:33792
  v_mfma_f32_16x16x32_bf16 a[212:215], a[112:115], a[248:251], a[212:215]
  v_mfma_f32_16x16x32_bf16 v[16:19], a[112:115], a[252:255], v[16:19]
  buffer_load_dwordx4 a[92:95], v79, s[8:11], s7 offen sc1
  v_mfma_f32_16x16x32_bf16 a[176:179], a[116:119], a[240:243], a[176:179]
  v_mfma_f32_16x16x32_bf16 a[196:199], a[116:119], a[244:247], a[196:199]
  v_mfma_f32_16x16x32_bf16 a[216:219], a[116:119], a[248:251], a[216:219]
  v_mfma_f32_16x16x32_bf16 v[20:23], a[116:119], a[252:255], v[20:23]
  s_waitcnt vmcnt(24)
  v_mfma_f32_16x16x32_bf16 a[160:163], a[120:123], v[176:179], a[160:163]
  s_waitcnt vmcnt(23)
  v_mfma_f32_16x16x32_bf16 a[180:183], a[120:123], v[180:183], a[180:183]
  s_waitcnt vmcnt(22)
  v_mfma_f32_16x16x32_bf16 a[200:203], a[120:123], v[184:187], a[200:203]
  s_waitcnt vmcnt(21)
  v_mfma_f32_16x16x32_bf16 v[4:7], a[120:123], v[188:191], v[4:7]
  v_mfma_f32_16x16x32_bf16 a[164:167], a[124:127], v[176:179], a[164:167]
  v_mfma_f32_16x16x32_bf16 a[184:187], a[124:127], v[180:183], a[184:187]
  v_mfma_f32_16x16x32_bf16 a[204:207], a[124:127], v[184:187], a[204:207]
  v_mfma_f32_16x16x32_bf16 v[8:11], a[124:127], v[188:191], v[8:11]
  v_mfma_f32_16x16x32_bf16 a[168:171], a[128:131], v[176:179], a[168:171]
  v_mfma_f32_16x16x32_bf16 a[188:191], a[128:131], v[180:183], a[188:191]
  ds_read_b128 a[20:23], v44 offset:0
  v_mfma_f32_16x16x32_bf16 a[208:211], a[128:131], v[184:187], a[208:211]
  ds_read_b128 a[24:27], v44 offset:1024
  v_mfma_f32_16x16x32_bf16 v[12:15], a[128:131], v[188:191], v[12:15]
  ds_read_b128 a[28:31], v44 offset:2048
  v_mfma_f32_16x16x32_bf16 a[172:175], a[132:135], v[176:179], a[172:175]
  ds_read_b128 a[32:35], v44 offset:3072
  v_mfma_f32_16x16x32_bf16 a[192:195], a[132:135], v[180:183], a[192:195]
  ds_read_b128 a[36:39], v45 offset:34816
  v_mfma_f32_16x16x32_bf16 a[212:215], a[132:135], v[184:187], a[212:215]
  ds_read_b128 a[40:43], v44 offset:16384
  v_mfma_f32_16x16x32_bf16 v[16:19], a[132:135], v[188:191], v[16:19]
  ds_read_b128 a[44:47], v44 offset:17408
  v_mfma_f32_16x16x32_bf16 a[176:179], a[136:139], v[176:179], a[176:179]
  ds_read_b128 a[48:51], v44 offset:18432
  v_mfma_f32_16x16x32_bf16 a[196:199], a[136:139], v[180:183], a[196:199]
  ds_read_b128 a[52:55], v44 offset:19456
  v_mfma_f32_16x16x32_bf16 a[216:219], a[136:139], v[184:187], a[216:219]
  ds_read_b128 a[56:59], v45 offset:35840
  v_mfma_f32_16x16x32_bf16 v[20:23], a[136:139], v[188:191], v[20:23]
  s_waitcnt vmcnt(20)
  v_mfma_f32_16x16x32_bf16 a[160:163], a[140:143], v[192:195], a[160:163]
  s_waitcnt vmcnt(19)
  v_mfma_f32_16x16x32_bf16 a[180:183], a[140:143], v[196:199], a[180:183]
  s_waitcnt vmcnt(18)
  v_mfma_f32_16x16x32_bf16 a[200:203], a[140:143], v[200:203], a[200:203]
  s_waitcnt vmcnt(17)
  v_mfma_f32_16x16x32_bf16 v[4:7], a[140:143], v[204:207], v[4:7]
  v_mfma_f32_16x16x32_bf16 a[164:167], a[144:147], v[192:195], a[164:167]
  v_mfma_f32_16x16x32_bf16 a[184:187], a[144:147], v[196:199], a[184:187]
  v_mfma_f32_16x16x32_bf16 a[204:207], a[144:147], v[200:203], a[204:207]
  v_mfma_f32_16x16x32_bf16 v[8:11], a[144:147], v[204:207], v[8:11]
  v_mfma_f32_16x16x32_bf16 a[168:171], a[148:151], v[192:195], a[168:171]
  v_mfma_f32_16x16x32_bf16 a[188:191], a[148:151], v[196:199], a[188:191]
  buffer_load_dwordx4 v[96:99], v1, s[8:11], s96 offen offset:0 sc1
  buffer_load_dwordx4 v[100:103], v1, s[8:11], s96 offen offset:1024 sc1
  v_mfma_f32_16x16x32_bf16 a[208:211], a[148:151], v[200:203], a[208:211]
  v_mfma_f32_16x16x32_bf16 v[12:15], a[148:151], v[204:207], v[12:15]
  v_mfma_f32_16x16x32_bf16 a[172:175], a[152:155], v[192:195], a[172:175]
  v_mfma_f32_16x16x32_bf16 a[192:195], a[152:155], v[196:199], a[192:195]
  buffer_load_dwordx4 v[104:107], v0, s[8:11], s96 offen offset:0 sc1
  v_mfma_f32_16x16x32_bf16 a[212:215], a[152:155], v[200:203], a[212:215]
  v_mfma_f32_16x16x32_bf16 v[16:19], a[152:155], v[204:207], v[16:19]
  v_mfma_f32_16x16x32_bf16 a[176:179], a[156:159], v[192:195], a[176:179]
  v_mfma_f32_16x16x32_bf16 a[196:199], a[156:159], v[196:199], a[196:199]
  buffer_load_dwordx4 v[108:111], v1, s[8:11], s97 offen offset:0 sc1
  v_mfma_f32_16x16x32_bf16 a[216:219], a[156:159], v[200:203], a[216:219]
  v_mfma_f32_16x16x32_bf16 v[20:23], a[156:159], v[204:207], v[20:23]
  s_waitcnt vmcnt(19) lgkmcnt(15)
  v_mfma_f32_16x16x32_bf16 a[160:163], a[220:223], v[208:211], a[160:163]
  buffer_load_dwordx4 v[112:115], v1, s[8:11], s97 offen offset:1024 sc1
  v_mfma_f32_16x16x32_bf16 a[164:167], a[224:227], v[208:211], a[164:167]
  v_mfma_f32_16x16x32_bf16 a[168:171], a[228:231], v[208:211], a[168:171]
  v_mfma_f32_16x16x32_bf16 a[172:175], a[232:235], v[208:211], a[172:175]
  v_mfma_f32_16x16x32_bf16 a[176:179], a[236:239], v[208:211], a[176:179]
  buffer_load_dwordx4 v[116:119], v0, s[8:11], s97 offen offset:0 sc1
  s_waitcnt vmcnt(20) lgkmcnt(14)
  v_mfma_f32_16x16x32_bf16 a[160:163], a[0:3], v[212:215], a[160:163]
  s_waitcnt lgkmcnt(13)
  v_mfma_f32_16x16x32_bf16 a[164:167], a[4:7], v[212:215], a[164:167]
  s_waitcnt lgkmcnt(12)
  v_mfma_f32_16x16x32_bf16 a[168:171], a[8:11], v[212:215], a[168:171]
  buffer_load_dwordx4 v[120:123], v1, s[8:11], s99 offen offset:0 sc1
  s_waitcnt lgkmcnt(11)
  v_mfma_f32_16x16x32_bf16 a[172:175], a[12:15], v[212:215], a[172:175]
  s_waitcnt lgkmcnt(10)
  v_mfma_f32_16x16x32_bf16 a[176:179], a[16:19], v[212:215], a[176:179]
  s_waitcnt vmcnt(20) lgkmcnt(9)
  v_mfma_f32_16x16x32_bf16 a[160:163], a[20:23], v[216:219], a[160:163]
  s_waitcnt lgkmcnt(8)
  v_mfma_f32_16x16x32_bf16 a[164:167], a[24:27], v[216:219], a[164:167]
  buffer_load_dwordx4 v[124:127], v1, s[8:11], s99 offen offset:1024 sc1
  s_waitcnt lgkmcnt(7)
  v_mfma_f32_16x16x32_bf16 a[168:171], a[28:31], v[216:219], a[168:171]
  s_waitcnt lgkmcnt(6)
  v_mfma_f32_16x16x32_bf16 a[172:175], a[32:35], v[216:219], a[172:175]
  s_waitcnt lgkmcnt(5)
  v_mfma_f32_16x16x32_bf16 a[176:179], a[36:39], v[216:219], a[176:179]
  s_waitcnt vmcnt(20) lgkmcnt(4)
  v_mfma_f32_16x16x32_bf16 a[160:163], a[40:43], v[220:223], a[160:163]
  buffer_load_dwordx4 v[128:131], v0, s[8:11], s99 offen offset:0 sc1
  s_waitcnt lgkmcnt(3)
  v_mfma_f32_16x16x32_bf16 a[164:167], a[44:47], v[220:223], a[164:167]
  s_waitcnt lgkmcnt(2)
  v_mfma_f32_16x16x32_bf16 a[168:171], a[48:51], v[220:223], a[168:171]
  s_waitcnt lgkmcnt(1)
  v_mfma_f32_16x16x32_bf16 a[172:175], a[52:55], v[220:223], a[172:175]
  s_waitcnt lgkmcnt(0)
  v_mfma_f32_16x16x32_bf16 a[176:179], a[56:59], v[220:223], a[176:179]
  s_waitcnt vmcnt(20)
  v_mfma_f32_16x16x32_bf16 a[180:183], a[220:223], v[224:227], a[180:183]
  ds_write_b128 v92, a[160:163] offset:47104
  v_mfma_f32_16x16x32_bf16 a[184:187], a[224:227], v[224:227], a[184:187]
  ds_write_b128 v92, a[164:167] offset:48128
  v_mfma_f32_16x16x32_bf16 a[188:191], a[228:231], v[224:227], a[188:191]
  ds_write_b128 v92, a[168:171] offset:49152
  v_mfma_f32_16x16x32_bf16 a[192:195], a[232:235], v[224:227], a[192:195]
  ds_write_b128 v92, a[172:175] offset:50176
  v_mfma_f32_16x16x32_bf16 a[196:199], a[236:239], v[224:227], a[196:199]
  ds_write_b128 v92, a[176:179] offset:51200
  s_waitcnt vmcnt(19)
  v_mfma_f32_16x16x32_bf16 a[180:183], a[0:3], v[228:231], a[180:183]
  v_mfma_f32_16x16x32_bf16 a[184:187], a[4:7], v[228:231], a[184:187]
  v_mfma_f32_16x16x32_bf16 a[188:191], a[8:11], v[228:231], a[188:191]
  v_mfma_f32_16x16x32_bf16 a[192:195], a[12:15], v[228:231], a[192:195]
  v_mfma_f32_16x16x32_bf16 a[196:199], a[16:19], v[228:231], a[196:199]
  s_waitcnt vmcnt(18)
  v_mfma_f32_16x16x32_bf16 a[180:183], a[20:23], v[232:235], a[180:183]
  v_mfma_f32_16x16x32_bf16 a[184:187], a[24:27], v[232:235], a[184:187]
  v_mfma_f32_16x16x32_bf16 a[188:191], a[28:31], v[232:235], a[188:191]
  v_mfma_f32_16x16x32_bf16 a[192:195], a[32:35], v[232:235], a[192:195]
  v_mfma_f32_16x16x32_bf16 a[196:199], a[36:39], v[232:235], a[196:199]
  s_waitcnt vmcnt(17)
  v_mfma_f32_16x16x32_bf16 a[180:183], a[40:43], v[236:239], a[180:183]
  v_mfma_f32_16x16x32_bf16 a[184:187], a[44:47], v[236:239], a[184:187]
  v_mfma_f32_16x16x32_bf16 a[188:191], a[48:51], v[236:239], a[188:191]
  v_mfma_f32_16x16x32_bf16 a[192:195], a[52:55], v[236:239], a[192:195]
  v_mfma_f32_16x16x32_bf16 a[196:199], a[56:59], v[236:239], a[196:199]
  s_waitcnt vmcnt(16)
  v_mfma_f32_16x16x32_bf16 a[200:203], a[220:223], a[60:63], a[200:203]
  s_nop 1
  ds_write_b128 v93, a[180:183] offset:52224
  v_mfma_f32_16x16x32_bf16 a[204:207], a[224:227], a[60:63], a[204:207]
  ds_write_b128 v93, a[184:187] offset:53248
  v_mfma_f32_16x16x32_bf16 a[208:211], a[228:231], a[60:63], a[208:211]
  ds_write_b128 v93, a[188:191] offset:54272
  v_mfma_f32_16x16x32_bf16 a[212:215], a[232:235], a[60:63], a[212:215]
  ds_write_b128 v93, a[192:195] offset:55296
  v_mfma_f32_16x16x32_bf16 a[216:219], a[236:239], a[60:63], a[216:219]
  ds_write_b128 v93, a[196:199] offset:56320
  s_waitcnt vmcnt(15)
  v_mfma_f32_16x16x32_bf16 a[200:203], a[0:3], a[64:67], a[200:203]
  v_mfma_f32_16x16x32_bf16 a[204:207], a[4:7], a[64:67], a[204:207]
  v_mfma_f32_16x16x32_bf16 a[208:211], a[8:11], a[64:67], a[208:211]
  v_mfma_f32_16x16x32_bf16 a[212:215], a[12:15], a[64:67], a[212:215]
  v_mfma_f32_16x16x32_bf16 a[216:219], a[16:19], a[64:67], a[216:219]
  s_waitcnt vmcnt(14)
  v_mfma_f32_16x16x32_bf16 a[200:203], a[20:23], a[68:71], a[200:203]
  v_mfma_f32_16x16x32_bf16 a[204:207], a[24:27], a[68:71], a[204:207]
  v_mfma_f32_16x16x32_bf16 a[208:211], a[28:31], a[68:71], a[208:211]
  v_mfma_f32_16x16x32_bf16 a[212:215], a[32:35], a[68:71], a[212:215]
  v_mfma_f32_16x16x32_bf16 a[216:219], a[36:39], a[68:71], a[216:219]
  s_waitcnt vmcnt(13)
  v_mfma_f32_16x16x32_bf16 a[200:203], a[40:43], a[72:75], a[200:203]
  v_mfma_f32_16x16x32_bf16 a[204:207], a[44:47], a[72:75], a[204:207]
  v_mfma_f32_16x16x32_bf16 a[208:211], a[48:51], a[72:75], a[208:211]
  v_mfma_f32_16x16x32_bf16 a[212:215], a[52:55], a[72:75], a[212:215]
  v_mfma_f32_16x16x32_bf16 a[216:219], a[56:59], a[72:75], a[216:219]
  s_mov_b32 s16, 0xbfb8aa3b
  s_mov_b32 s17, 0xbfb8aa3b
  s_waitcnt vmcnt(12)
  v_mfma_f32_16x16x32_bf16 v[4:7], a[220:223], a[80:83], v[4:7]
  ds_write_b128 v94, a[200:203] offset:57344
  s_mov_b32 s18, 1.0
  s_waitcnt vmcnt(11)
  v_mfma_f32_16x16x32_bf16 v[4:7], a[0:3], a[84:87], v[4:7]
  ds_write_b128 v94, a[204:207] offset:58368
  s_mov_b32 s19, 1.0
  s_waitcnt vmcnt(10)
  v_mfma_f32_16x16x32_bf16 v[4:7], a[20:23], a[88:91], v[4:7]
  ds_write_b128 v94, a[208:211] offset:59392
  s_waitcnt vmcnt(9)
  v_mfma_f32_16x16x32_bf16 v[4:7], a[40:43], a[92:95], v[4:7]
  ds_write_b128 v94, a[212:215] offset:60416
  v_mfma_f32_16x16x32_bf16 v[8:11], a[224:227], a[80:83], v[8:11]
  ds_write_b128 v94, a[216:219] offset:61440
  v_mfma_f32_16x16x32_bf16 v[8:11], a[4:7], a[84:87], v[8:11]
  v_mfma_f32_16x16x32_bf16 v[8:11], a[24:27], a[88:91], v[8:11]
  v_mfma_f32_16x16x32_bf16 v[8:11], a[44:47], a[92:95], v[8:11]
  v_mfma_f32_16x16x32_bf16 v[12:15], a[228:231], a[80:83], v[12:15]
  v_mfma_f32_16x16x32_bf16 v[12:15], a[8:11], a[84:87], v[12:15]
  v_mfma_f32_16x16x32_bf16 v[12:15], a[28:31], a[88:91], v[12:15]
  v_mfma_f32_16x16x32_bf16 v[12:15], a[48:51], a[92:95], v[12:15]
  s_waitcnt lgkmcnt(0)
  s_barrier
  ds_read_b128 v[176:179], v95 offset:47104
  v_mfma_f32_16x16x32_bf16 v[16:19], a[232:235], a[80:83], v[16:19]
  ds_read_b128 v[180:183], v95 offset:52224
  ds_read_b128 v[184:187], v95 offset:57344
  v_mfma_f32_16x16x32_bf16 v[16:19], a[12:15], a[84:87], v[16:19]
  ds_read_b128 v[188:191], v95 offset:48128
  ds_read_b128 v[192:195], v95 offset:53248
  v_mfma_f32_16x16x32_bf16 v[16:19], a[32:35], a[88:91], v[16:19]
  ds_read_b128 v[196:199], v95 offset:58368
  ds_read_b128 v[200:203], v95 offset:49152
  v_mfma_f32_16x16x32_bf16 v[16:19], a[52:55], a[92:95], v[16:19]
  ds_read_b128 v[204:207], v95 offset:54272
  ds_read_b128 v[208:211], v95 offset:59392
  v_mfma_f32_16x16x32_bf16 v[20:23], a[236:239], a[80:83], v[20:23]
  ds_read_b128 v[212:215], v95 offset:50176
  ds_read_b128 v[216:219], v95 offset:55296
  v_mfma_f32_16x16x32_bf16 v[20:23], a[16:19], a[84:87], v[20:23]
  ds_read_b128 v[220:223], v95 offset:60416
  ds_read_b128 v[224:227], v95 offset:51200
  v_mfma_f32_16x16x32_bf16 v[20:23], a[36:39], a[88:91], v[20:23]
  ds_read_b128 v[228:231], v95 offset:56320
  ds_read_b128 v[232:235], v95 offset:61440
  v_mfma_f32_16x16x32_bf16 v[20:23], a[56:59], a[92:95], v[20:23]
  s_waitcnt lgkmcnt(13)
  v_pk_add_f32 v[176:177], v[176:177], v[180:181]
  v_pk_add_f32 v[178:179], v[178:179], v[182:183]
  s_waitcnt lgkmcnt(12)
  v_pk_add_f32 v[4:5], v[4:5], v[184:185]
  v_pk_add_f32 v[6:7], v[6:7], v[186:187]
  v_pk_add_f32 v[4:5], v[4:5], v[176:177]
  v_pk_add_f32 v[6:7], v[6:7], v[178:179]
  v_pk_mul_f32 v[176:177], v[4:5], s[16:17]
  v_pk_mul_f32 v[178:179], v[6:7], s[16:17]
  v_exp_f32 v176, v176
  v_exp_f32 v177, v177
  v_exp_f32 v178, v178
  v_exp_f32 v179, v179
  s_waitcnt lgkmcnt(10)
  v_pk_add_f32 v[188:189], v[188:189], v[192:193]
  v_pk_add_f32 v[190:191], v[190:191], v[194:195]
  s_waitcnt lgkmcnt(9)
  v_pk_add_f32 v[8:9], v[8:9], v[196:197]
  v_pk_add_f32 v[10:11], v[10:11], v[198:199]
  v_pk_add_f32 v[8:9], v[8:9], v[188:189]
  v_pk_add_f32 v[10:11], v[10:11], v[190:191]
  v_pk_mul_f32 v[188:189], v[8:9], s[16:17]
  v_pk_mul_f32 v[190:191], v[10:11], s[16:17]
  v_exp_f32 v188, v188
  v_exp_f32 v189, v189
  v_exp_f32 v190, v190
  v_exp_f32 v191, v191
  s_waitcnt lgkmcnt(7)
  v_pk_add_f32 v[200:201], v[200:201], v[204:205]
  v_pk_add_f32 v[202:203], v[202:203], v[206:207]
  s_waitcnt lgkmcnt(6)
  v_pk_add_f32 v[12:13], v[12:13], v[208:209]
  v_pk_add_f32 v[14:15], v[14:15], v[210:211]
  v_pk_add_f32 v[12:13], v[12:13], v[200:201]
  v_pk_add_f32 v[14:15], v[14:15], v[202:203]
  v_pk_mul_f32 v[200:201], v[12:13], s[16:17]
  v_pk_mul_f32 v[202:203], v[14:15], s[16:17]
  v_exp_f32 v200, v200
  v_exp_f32 v201, v201
  v_exp_f32 v202, v202
  v_exp_f32 v203, v203
  s_waitcnt lgkmcnt(4)
  v_pk_add_f32 v[212:213], v[212:213], v[216:217]
  v_pk_add_f32 v[214:215], v[214:215], v[218:219]
  s_waitcnt lgkmcnt(3)
  v_pk_add_f32 v[16:17], v[16:17], v[220:221]
  v_pk_add_f32 v[18:19], v[18:19], v[222:223]
  v_pk_add_f32 v[16:17], v[16:17], v[212:213]
  v_pk_add_f32 v[18:19], v[18:19], v[214:215]
  v_pk_mul_f32 v[212:213], v[16:17], s[16:17]
  v_pk_mul_f32 v[214:215], v[18:19], s[16:17]
  v_exp_f32 v212, v212
  v_exp_f32 v213, v213
  v_exp_f32 v214, v214
  v_exp_f32 v215, v215
  s_waitcnt lgkmcnt(1)
  v_pk_add_f32 v[224:225], v[224:225], v[228:229]
  v_pk_add_f32 v[226:227], v[226:227], v[230:231]
  s_waitcnt lgkmcnt(0)
  v_pk_add_f32 v[20:21], v[20:21], v[232:233]
  v_pk_add_f32 v[22:23], v[22:23], v[234:235]
  v_pk_add_f32 v[20:21], v[20:21], v[224:225]
  v_pk_add_f32 v[22:23], v[22:23], v[226:227]
  v_pk_mul_f32 v[224:225], v[20:21], s[16:17]
  v_pk_mul_f32 v[226:227], v[22:23], s[16:17]
  v_exp_f32 v224, v224
  v_exp_f32 v225, v225
  v_exp_f32 v226, v226
  v_exp_f32 v227, v227
  v_pk_add_f32 v[176:177], v[176:177], s[18:19]
  v_pk_add_f32 v[178:179], v[178:179], s[18:19]
  v_rcp_f32 v176, v176
  v_rcp_f32 v177, v177
  v_rcp_f32 v178, v178
  v_rcp_f32 v179, v179
  v_pk_add_f32 v[188:189], v[188:189], s[18:19]
  v_pk_add_f32 v[190:191], v[190:191], s[18:19]
  v_rcp_f32 v188, v188
  v_rcp_f32 v189, v189
  v_rcp_f32 v190, v190
  v_rcp_f32 v191, v191
  v_pk_add_f32 v[200:201], v[200:201], s[18:19]
  v_pk_add_f32 v[202:203], v[202:203], s[18:19]
  v_rcp_f32 v200, v200
  v_rcp_f32 v201, v201
  v_rcp_f32 v202, v202
  v_rcp_f32 v203, v203
  v_pk_add_f32 v[212:213], v[212:213], s[18:19]
  v_pk_add_f32 v[214:215], v[214:215], s[18:19]
  v_rcp_f32 v212, v212
  v_rcp_f32 v213, v213
  v_rcp_f32 v214, v214
  v_rcp_f32 v215, v215
  v_pk_add_f32 v[224:225], v[224:225], s[18:19]
  v_pk_add_f32 v[226:227], v[226:227], s[18:19]
  v_rcp_f32 v224, v224
  v_rcp_f32 v225, v225
  v_rcp_f32 v226, v226
  v_rcp_f32 v227, v227
  v_pk_mul_f32 v[4:5], v[4:5], v[176:177]
  v_pk_mul_f32 v[6:7], v[6:7], v[178:179]
  v_pk_mul_f32 v[8:9], v[8:9], v[188:189]
  v_pk_mul_f32 v[10:11], v[10:11], v[190:191]
  v_pk_mul_f32 v[12:13], v[12:13], v[200:201]
  v_pk_mul_f32 v[14:15], v[14:15], v[202:203]
  v_pk_mul_f32 v[16:17], v[16:17], v[212:213]
  v_pk_mul_f32 v[18:19], v[18:19], v[214:215]
  v_pk_mul_f32 v[20:21], v[20:21], v[224:225]
  v_pk_mul_f32 v[22:23], v[22:23], v[226:227]
  s_waitcnt vmcnt(6)
  v_max3_u32 v73, v96, v100, v104
  s_waitcnt vmcnt(4)
  v_max3_u32 v73, v73, v108, v112
  s_waitcnt vmcnt(2)
  v_max3_u32 v73, v73, v116, v120
  s_waitcnt vmcnt(0)
  v_max3_u32 v73, v73, v124, v128
  v_cmp_eq_u32 vcc, -1, v73
  s_cbranch_vccnz E_slow0
E_ok0:
  v_mfma_f32_16x16x32_bf16 v[144:147], v[58:61], v[96:99], 0
  v_mfma_f32_16x16x32_bf16 v[144:147], v[58:61], v[108:111], v[144:147]
  v_mfma_f32_16x16x32_bf16 v[144:147], v[58:61], v[120:123], v[144:147]
  v_mfma_f32_16x16x32_bf16 v[144:147], v[58:61], v[132:135], v[144:147]
  v_mfma_f32_16x16x32_bf16 v[148:151], v[56:59], v[96:99], 0
  v_mfma_f32_16x16x32_bf16 v[148:151], v[56:59], v[108:111], v[148:151]
  s_nop 5
  v_fma_f32 v4, v4, v144, v24
  v_fma_f32 v5, v5, v145, v25
  v_mfma_f32_16x16x32_bf16 v[148:151], v[56:59], v[120:123], v[148:151]
  v_fma_f32 v6, v6, v146, v26
  v_fma_f32 v7, v7, v147, v27
  v_mfma_f32_16x16x32_bf16 v[148:151], v[56:59], v[132:135], v[148:151]
  v_cvt_pk_bf16_f32 v4, v4, v5
  v_cvt_pk_bf16_f32 v5, v6, v7
  v_mfma_f32_16x16x32_bf16 v[152:155], v[58:61], v[100:103], 0
  buffer_store_dwordx2 v[4:5], v74, s[52:55], s80 offen offset:0
  v_mfma_f32_16x16x32_bf16 v[152:155], v[58:61], v[112:115], v[152:155]
  s_nop 2
  v_fma_f32 v8, v8, v148, v28
  v_fma_f32 v9, v9, v149, v29
  v_mfma_f32_16x16x32_bf16 v[152:155], v[58:61], v[124:127], v[152:155]
  v_fma_f32 v10, v10, v150, v30
  v_fma_f32 v11, v11, v151, v31
  v_mfma_f32_16x16x32_bf16 v[152:155], v[58:61], v[136:139], v[152:155]
  v_cvt_pk_bf16_f32 v8, v8, v9
  v_cvt_pk_bf16_f32 v9, v10, v11
  v_mfma_f32_16x16x32_bf16 v[156:159], v[56:59], v[100:103], 0
  buffer_store_dwordx2 v[8:9], v74, s[52:55], s80 offen offset:32
  v_mfma_f32_16x16x32_bf16 v[156:159], v[56:59], v[112:115], v[156:159]
  s_nop 2
  v_fma_f32 v12, v12, v152, v32
  v_fma_f32 v13, v13, v153, v33
  v_mfma_f32_16x16x32_bf16 v[156:159], v[56:59], v[124:127], v[156:159]
  v_fma_f32 v14, v14, v154, v34
  v_fma_f32 v15, v15, v155, v35
  v_mfma_f32_16x16x32_bf16 v[156:159], v[56:59], v[136:139], v[156:159]
  v_cvt_pk_bf16_f32 v12, v12, v13
  v_cvt_pk_bf16_f32 v13, v14, v15
  v_mfma_f32_16x16x32_bf16 v[160:163], v[62:65], v[104:107], 0
  buffer_store_dwordx2 v[12:13], v74, s[52:55], s80 offen offset:64
  v_mfma_f32_16x16x32_bf16 v[160:163], v[62:65], v[116:119], v[160:163]
  s_nop 2
  v_fma_f32 v16, v16, v156, v36
  v_fma_f32 v17, v17, v157, v37
  v_fma_f32 v18, v18, v158, v38
  v_mfma_f32_16x16x32_bf16 v[160:163], v[62:65], v[128:131], v[160:163]
  v_fma_f32 v19, v19, v159, v39
  v_cvt_pk_bf16_f32 v16, v16, v17
  v_cvt_pk_bf16_f32 v17, v18, v19
  v_mfma_f32_16x16x32_bf16 v[160:163], v[62:65], v[140:143], v[160:163]
  buffer_store_dwordx2 v[16:17], v74, s[52:55], s80 offen offset:96
  s_nop 6
  v_fma_f32 v20, v20, v160, v40
  v_fma_f32 v21, v21, v161, v41
  v_fma_f32 v22, v22, v162, v42
  v_fma_f32 v23, v23, v163, v43
  v_cvt_pk_bf16_f32 v20, v20, v21
  v_cvt_pk_bf16_f32 v21, v22, v23
  buffer_store_dwordx2 v[20:21], v74, s[52:55], s80 offen offset:128
  s_endpgm
E_slow0:
  buffer_load_dwordx4 v[96:99], v1, s[8:11], s96 offen offset:0 sc1
  buffer_load_dwordx4 v[100:103], v1, s[8:11], s96 offen offset:1024 sc1
  buffer_load_dwordx4 v[104:107], v0, s[8:11], s96 offen offset:0 sc1
  buffer_load_dwordx4 v[108:111], v1, s[8:11], s97 offen offset:0 sc1
  buffer_load_dwordx4 v[112:115], v1, s[8:11], s97 offen offset:1024 sc1
  buffer_load_dwordx4 v[116:119], v0, s[8:11], s97 offen offset:0 sc1
  buffer_load_dwordx4 v[120:123], v1, s[8:11], s99 offen offset:0 sc1
  buffer_load_dwordx4 v[124:127], v1, s[8:11], s99 offen offset:1024 sc1
  buffer_load_dwordx4 v[128:131], v0, s[8:11], s99 offen offset:0 sc1
  s_waitcnt vmcnt(0)
  v_max3_u32 v73, v96, v100, v104
  v_max3_u32 v73, v73, v108, v112
  v_max3_u32 v73, v73, v116, v120
  v_max3_u32 v73, v73, v124, v128
  v_cmp_eq_u32 vcc, -1, v73
  s_cbranch_vccz E_ok0
  s_sub_u32 s65, s65, 1
  s_cmp_gt_i32 s65, 0
  s_cbranch_scc1 E_slow0
  s_branch E_ok0
E_slow1:
  buffer_load_dwordx4 v[56:59], v75, s[8:11], s22 offen offset:0 sc1
  buffer_load_dwordx4 v[60:63], v75, s[8:11], s22 offen offset:64 sc1
  s_waitcnt vmcnt(0)
  v_xor_b32 v73, s64, v59
  v_xad_u32 v73, v63, s64, v73
  v_cmp_ne_u32 vcc, 0, v73
  s_cbranch_vccz E_ok1
  s_sub_u32 s65, s65, 1
  s_cmp_gt_i32 s65, 0
  s_cbranch_scc1 E_slow1
  s_branch E_ok1
E_slow2:
  buffer_load_dword v73, v90, s[8:11], s32 offen sc1
  s_waitcnt vmcnt(0)
  v_cmp_ne_u32 vcc, s64, v73
  s_cbranch_vccz E_ok2
  s_sub_u32 s65, s65, 1
  s_cmp_gt_i32 s65, 0
  s_cbranch_scc1 E_slow2
  s_branch E_ok2
E_slow3:
  buffer_load_dword v73, v88, s[8:11], s30 offen sc1
  s_waitcnt vmcnt(0)
  v_cmp_ne_u32 vcc, s64, v73
  s_cbranch_vccz E_ok3
  s_sub_u32 s65, s65, 1
  s_cmp_gt_i32 s65, 0
  s_cbranch_scc1 E_slow3
  s_branch E_ok3
E_slow4:
  buffer_load_dword v73, v89, s[8:11], s31 offen sc1
  s_waitcnt vmcnt(0)
  v_cmp_ne_u32 vcc, s64, v73
  s_cbranch_vccz E_ok4
  s_sub_u32 s65, s65, 1
  s_cmp_gt_i32 s65, 0
  s_cbranch_scc1 E_slow4
  s_branch E_ok4
E_slow5:
  buffer_load_dword v73, v91, s[8:11], s31 offen sc1
  s_waitcnt vmcnt(0)
  v_cmp_ne_u32 vcc, s64, v73
  s_cbranch_vccz E_ok5
  s_sub_u32 s65, s65, 1
  s_cmp_gt_i32 s65, 0
  s_cbranch_scc1 E_slow5
  s_branch E_ok5
O_prog:
  s_cmp_eq_u32 s56, 1
  s_cselect_b32 s44, s24, s22
  s_cselect_b32 s45, s25, s23
  s_and_b32 s45, s45, 0xffff
  s_mov_b32 s46, 0xc8000
  s_mov_b32 s47, 0x20000
  buffer_load_dword v43, v73, s[44:47], s83 offen offset:0 sc1
  s_lshl2_add_u32 s69, s76, s3
  s_mul_i32 s69, s69, 51200
  buffer_load_dword v71, off, s[8:11], 0 sc1
  global_load_dword v43, v45, s[52:53] sc1
  s_cmp_ge_u32 s3, 2
  s_cselect_b32 s40, s30, s28
  s_cselect_b32 s41, s31, s29
  s_and_b32 s41, s41, 0xffff
  s_mov_b32 s42, 0x1e0000
  s_mov_b32 s43, 0x20000
  s_cmp_eq_u32 s56, 1
  s_cselect_b32 s48, s20, s18
  s_cselect_b32 s49, s21, s19
  s_and_b32 s49, s49, 0xffff
  s_mov_b32 s50, 0x800000
  s_mov_b32 s51, 0x20000
  s_mov_b32 s52, s34
  s_and_b32 s53, s35, 0xffff
  s_mov_b32 s54, 0x280000
  s_mov_b32 s55, 0x20000
  s_mul_i32 s101, s76, 40
  s_add_u32 s101, s101, s62
  s_cmp_lt_u32 s62, 40
  s_cselect_b32 s81, 0, 0x7ff00000
  s_mul_i32 s82, s101, 5120
  s_add_u32 s82, s82, s81
  s_lshr_b32 s18, s3, 1
  s_and_b32 s19, s3, 1
  s_mul_i32 s23, s58, 1280
  s_add_u32 s23, s23, 0x10000
  s_lshr_b32 s16, s57, 1
  s_lshl2_add_u32 s16, s16, s3
  s_and_b32 s17, s57, 1
  s_lshl3_add_u32 s16, s16, s17
  s_lshl3_add_u32 s21, s16, s23
  s_add_u32 s21, s21, s81
  s_lshl_b32 s16, s58, 6
  s_add_u32 s16, s16, s62
  s_mul_i32 s24, s16, 10240
  s_add_u32 s24, s24, 0x300000
  s_add_u32 s25, s24, 8192
  s_lshl_b32 s28, s16, 2
  s_add_u32 s28, s28, 0x40000
  s_lshl_b32 s39, s56, 31
  s_add_u32 s17, s98, 4
  s_lshl_b32 s16, s17, 7
  s_add_u32 s71, s71, s16
  s_lshl_b32 s22, s62, 9
  s_add_u32 s22, s22, 0x8000
  s_lshr_b32 s16, s62, 1
  s_mul_i32 s26, s16, 24
  s_add_u32 s26, s26, s17
  s_lshl2_add_u32 s26, s26, s3
  s_lshl_b32 s26, s26, 11
  s_add_u32 s26, s26, 0x800000
  s_xor_b32 s27, s26, 4096
  s_lshl_b32 s29, s16, 5
  s_add_u32 s29, s29, s17
  s_lshl1_add_u32 s29, s29, s19
  s_lshl_b32 s29, s29, 2
  s_add_u32 s29, s29, 0x60000
  s_lshl3_add_u32 s92, s56, s61
  s_lshl_b32 s30, s92, 7
  s_add_u32 s30, s30, 0x40000
  s_lshl_b32 s31, s60, 6
  s_mul_i32 s16, s3, 12
  s_add_u32 s31, s31, s16
  s_lshl_b32 s31, s31, 2
  s_add_u32 s31, s31, 0x60000
  s_mul_i32 s17, s61, 5
  s_lshr_b32 s32, s17, 2
  s_mul_i32 s16, s3, 120
  s_add_u32 s32, s32, s16
  s_lshl_b32 s32, s32, 2
  s_add_u32 s32, s32, 0x50000
  s_lshl_b32 s16, s16, 2
  s_add_u32 s77, s16, s17
  s_lshl_b32 s77, s77, 10
  s_add_u32 s77, s77, 0x100000
  s_lshl2_add_u32 s76, s60, s3
  s_mul_i32 s76, s76, 49152
  s_add_u32 s76, s76, 0x800000
  s_lshl2_add_u32 s16, s57, s59
  s_lshl2_add_u32 s17, s16, s3
  s_lshl2_add_u32 s17, s17, s63
  s_mul_i32 s78, s17, 10240
  s_add_u32 s78, s78, 0xe00000
  s_cmp_eq_u32 s3, s63
  s_cselect_b32 s78, 0x7ff00000, s78
  s_cselect_b32 s37, 0, 10240
  s_lshl2_add_u32 s16, s16, s63
  s_mul_i32 s79, s16, 40960
  s_lshl_b32 s17, s3, 11
  s_add_u32 s79, s79, s17
  s_add_u32 s79, s79, 0xe00000
  s_xor_b32 s96, s63, 1
  s_mul_i32 s96, s96, 10240
  s_add_u32 s96, s96, s79
  s_xor_b32 s97, s63, 2
  s_mul_i32 s97, s97, 10240
  s_add_u32 s97, s97, s79
  s_xor_b32 s99, s63, 3
  s_mul_i32 s99, s99, 10240
  s_add_u32 s99, s99, s79
  s_add_u32 s79, s17, 36864
  s_lshl_b32 s16, s18, 10
  s_sub_u32 s16, s16, s17
  s_add_u32 s16, s16, 8192
  v_add_u32 v0, s16, v1
  s_lshl1_add_u32 s80, s60, s18
  s_lshl3_add_u32 s80, s80, s19
  s_mul_i32 s80, s80, 5120
  s_mul_i32 s16, s61, 160
  s_add_u32 s80, s80, s16
  s_or_b32 s16, s2, s3
  s_cselect_b32 s38, 0x7ff00000, 0
  s_lshl1_add_u32 s70, s59, s57
  s_lshl_b32 s70, s70, 8
  s_and_b32 s70, s70, 0x7ff
  s_add_u32 s90, s70, 256
  s_and_b32 s90, s90, 0x7ff
  s_lshl_b32 s16, s62, 17
  s_and_b32 s17, s63, 1
  s_lshl_b32 s17, s17, 11
  s_add_u32 s16, s16, s17
  v_add_u32 v44, s16, v44
  s_add_u32 s89, s70, s16
  s_add_u32 s90, s90, s16
  v_add_u32 v45, 31744, v44
  v_xor_b32 v47, 64, v44
  v_add_u32 v46, 63488, v47
  v_add_u32 v47, 95232, v47
  s_mul_i32 s16, s92, 327680
  s_add_u32 s16, s16, s67
  s_add_u32 s16, s16, 0x300000
  v_add_u32 v54, s16, v1
  v_add_u32 v55, s16, v3
  s_add_u32 s92, s16, s67
  s_mul_i32 s16, s70, 160
  s_add_u32 s92, s92, s16
  s_add_u32 s93, s92, 5120
  s_mul_i32 s91, s91, 640
  s_add_u32 s91, s91, s77
  s_lshl_b32 s94, s59, 12
  s_lshl1_add_u32 s95, s94, s76
  s_add_u32 s95, s95, 16384
  s_add_u32 s94, s94, s76
  s_mul_i32 s16, s19, 5120
  s_add_u32 s16, s16, 16384
  v_add_u32 v52, s16, v1
  v_add_u32 v53, 73728, v52
  v_bfe_u32 v80, v2, 3, 1
  v_lshlrev_b32 v80, 2, v80
  v_and_b32 v84, 2, v2
  v_or_b32 v80, v80, v84
  v_xor_b32 v80, v80, v81
  v_lshlrev_b32 v80, 4, v80
  v_lshl_add_u32 v75, v82, 3, v83
  v_lshl_add_u32 v48, v75, 7, v80
  v_add_u32 v18, s66, v48
  v_xor_b32 v18, s100, v18
  v_xor_b32 v19, 64, v18
  v_add_u32 v20, 73728, v18
  v_add_u32 v21, 73728, v19
  s_lshl_b32 s16, s18, 13
  v_add_u32 v48, s16, v48
  v_xor_b32 v49, 64, v48
  v_add_u32 v50, 73728, v48
  v_add_u32 v51, 73728, v49
  v_and_b32 v22, 15, v2
  v_lshl_add_u32 v22, v22, 7, v80
  v_add_u32 v22, 16384, v22
  v_xor_b32 v22, s100, v22
  v_xor_b32 v23, 64, v22
  v_add_u32 v24, 73728, v22
  v_add_u32 v25, 73728, v23
  v_lshl_add_u32 v26, v81, 3, v82
  v_lshlrev_b32 v26, 7, v26
  v_lshl_add_u32 v26, v83, 3, v26
  v_bfe_u32 v27, v2, 3, 2
  v_lshl_add_u32 v26, v27, 5, v26
  s_lshl_b32 s16, s18, 6
  s_lshl_b32 s17, s19, 12
  s_or_b32 s16, s16, s17
  v_xor_b32 v26, s16, v26
  v_xor_b32 v27, 32, v26
  v_xor_b32 v28, 64, v26
  v_xor_b32 v29, 96, v26
  v_xor_b32 v30, 4096, v26
  v_xor_b32 v31, 4128, v26
  v_xor_b32 v32, 4160, v26
  v_xor_b32 v33, 4192, v26
  v_add_u32 v34, 73728, v26
  v_add_u32 v35, 73728, v27
  v_add_u32 v36, 73728, v28
  v_add_u32 v37, 73728, v29
  v_add_u32 v38, 73728, v30
  v_add_u32 v39, 73728, v31
  v_add_u32 v40, 73728, v32
  v_add_u32 v41, 73728, v33
  s_add_u32 s16, s66, 148480
  v_lshl_add_u32 v236, v75, 2, s16
  v_lshl_add_u32 v237, v81, 5, s16
  v_and_b32 v238, 15, v2
  v_mul_u32_u24 v207, 80, v238
  v_add_u32 v207, s16, v207
  v_lshl_add_u32 v206, v81, 3, v207
  v_lshlrev_b32 v238, 4, v238
  s_lshl_b32 s16, s18, 8
  s_add_u32 s16, s16, 147456
  v_and_b32 v69, 15, v2
  v_lshl_add_u32 v69, v69, 4, s16
  v_xor_b32 v70, 256, v69
  v_lshl_add_u32 v68, s19, 2, v69
  v_bfe_u32 v84, v2, 5, 1
  v_lshl_add_u32 v68, v84, 9, v68
  v_bfe_u32 v84, v2, 4, 1
  v_lshl_add_u32 v68, v84, 3, v68
  v_mov_b32 v64, 0x3f803f80
  v_mov_b32 v65, 0x3f803f80
  v_mov_b32 v66, 0x3f803f80
  v_mov_b32 v67, 0x3f803f80
  v_cmp_eq_u32 vcc, 0, v82
  s_nop 1
  v_cndmask_b32 v84, 0, v64, vcc
  v_accvgpr_write_b32 a240, v84
  v_accvgpr_write_b32 a241, v84
  v_accvgpr_write_b32 a242, v84
  v_accvgpr_write_b32 a243, v84
  v_cmp_eq_u32 vcc, 1, v82
  s_nop 1
  v_cndmask_b32 v84, 0, v64, vcc
  v_accvgpr_write_b32 a244, v84
  v_accvgpr_write_b32 a245, v84
  v_accvgpr_write_b32 a246, v84
  v_accvgpr_write_b32 a247, v84
  v_cmp_eq_u32 vcc, 2, v82
  s_nop 1
  v_cndmask_b32 v84, 0, v64, vcc
  v_accvgpr_write_b32 a248, v84
  v_accvgpr_write_b32 a249, v84
  v_accvgpr_write_b32 a250, v84
  v_accvgpr_write_b32 a251, v84
  v_cmp_eq_u32 vcc, 3, v82
  s_nop 1
  v_cndmask_b32 v84, 0, v64, vcc
  v_accvgpr_write_b32 a252, v84
  v_accvgpr_write_b32 a253, v84
  v_accvgpr_write_b32 a254, v84
  v_accvgpr_write_b32 a255, v84
  v_mul_u32_u24 v74, 1280, v75
  v_lshl_add_u32 v74, v81, 3, v74
  v_lshlrev_b32 v75, 4, v75
  s_add_u32 s16, s3, 1
  s_and_b32 s16, s16, 3
  v_lshl_add_u32 v76, s16, 10, v1
  s_mul_i32 s16, s16, 15360
  v_add_u32 v92, s16, v1
  s_add_u32 s16, s3, 2
  s_and_b32 s16, s16, 3
  v_lshl_add_u32 v77, s16, 10, v1
  s_mul_i32 s16, s16, 15360
  v_add_u32 v93, s16, v1
  s_add_u32 s16, s3, 3
  s_and_b32 s16, s16, 3
  v_lshl_add_u32 v78, s16, 10, v1
  s_mul_i32 s16, s16, 15360
  v_add_u32 v94, s16, v1
  s_add_u32 s16, s3, 4
  s_and_b32 s16, s16, 3
  v_lshl_add_u32 v79, s16, 10, v1
  s_mul_i32 s16, s16, 15360
  v_add_u32 v95, s16, v1
  v_and_b32 v88, 31, v2
  v_lshlrev_b32 v88, 2, v88
  v_lshlrev_b32 v89, 2, v83
  v_and_b32 v91, 7, v2
  v_add_lshl_u32 v91, v91, 4, 2
  v_lshrrev_b32 v90, 1, v2
  v_min_u32 v90, 11, v90
  v_mul_u32_u24 v90, 10, v90
  v_and_b32 v84, 1, v2
  v_add_lshl_u32 v90, v84, v90, 2
  v_mov_b32 v84, 0x7ff00000
  v_cmp_eq_u32 vcc, 0, v2
  s_nop 1
  v_cndmask_b32 v72, v84, v2, vcc
  v_mul_u32_u24 v85, 20, v81
  v_cmp_eq_u32 vcc, v85, v2
  v_lshlrev_b32 v205, 4, v81
  s_nop 0
  v_cndmask_b32 v205, v84, v205, vcc
  s_and_b32 s91, s57, 7
  s_mul_i32 s91, s91, 5
  s_lshr_b32 s91, s91, 2
  s_mov_b32 s93, s68
  s_mov_b32 s94, s69
  s_mov_b32 s88, s71
  s_lshl_b32 s16, s91, 7
  s_mul_i32 s17, s91, 196608
  s_add_u32 s68, s68, s16
  s_add_u32 s69, s69, s16
  s_add_u32 s71, s71, s17
  s_add_u32 m0, s66, 0
  s_nop 0
  buffer_load_dwordx4 v4, s[12:15], s68 offen offset:0 lds
  buffer_load_dwordx4 v5, s[12:15], s68 offen offset:1024 lds
  buffer_load_dwordx4 v6, s[12:15], s68 offen offset:2048 lds
  buffer_load_dwordx4 v7, s[12:15], s68 offen offset:3072 lds
  s_add_u32 s68, s68, 128
  s_cmp_eq_u32 s91, 9
  s_cselect_b32 s68, s93, s68
  s_add_u32 m0, s67, 16384
  s_nop 0
  buffer_load_dwordx4 v12, s[44:47], s69 offen offset:0 lds
  buffer_load_dwordx4 v13, s[44:47], s69 offen offset:1024 lds
  buffer_load_dwordx4 v14, s[44:47], s69 offen offset:2048 lds
  buffer_load_dwordx4 v15, s[44:47], s69 offen offset:3072 lds
  s_add_u32 m0, s67, 20480
  s_nop 0
  buffer_load_dwordx4 v16, s[44:47], s69 offen lds
  s_add_u32 s69, s69, 128
  s_cmp_eq_u32 s91, 9
  s_cselect_b32 s69, s94, s69
  buffer_load_dwordx4 v[176:179], v204, s[44:47], s82 offen offset:0
  buffer_load_dwordx4 v[180:183], v204, s[44:47], s82 offen offset:256
  buffer_load_dwordx4 v[184:187], v204, s[44:47], s82 offen offset:512
  buffer_load_dwordx4 v[188:191], v204, s[44:47], s82 offen offset:768
  buffer_load_dwordx4 v[192:195], v204, s[44:47], s82 offen offset:1024
  s_add_u32 m0, s66, 36864
  s_nop 0
  buffer_load_dwordx4 v4, s[12:15], s68 offen offset:0 lds
  buffer_load_dwordx4 v5, s[12:15], s68 offen offset:1024 lds
  buffer_load_dwordx4 v6, s[12:15], s68 offen offset:2048 lds
  buffer_load_dwordx4 v7, s[12:15], s68 offen offset:3072 lds
  s_add_u32 s68, s68, 128
  s_cmp_eq_u32 s91, 8
  s_cselect_b32 s68, s93, s68
  s_add_u32 m0, s67, 53248
  s_nop 0
  buffer_load_dwordx4 v12, s[44:47], s69 offen offset:0 lds
  buffer_load_dwordx4 v13, s[44:47], s69 offen offset:1024 lds
  buffer_load_dwordx4 v14, s[44:47], s69 offen offset:2048 lds
  buffer_load_dwordx4 v15, s[44:47], s69 offen offset:3072 lds
  s_add_u32 m0, s67, 57344
  s_nop 0
  buffer_load_dwordx4 v16, s[44:47], s69 offen lds
  s_add_u32 s69, s69, 128
  s_cmp_eq_u32 s91, 8
  s_cselect_b32 s69, s94, s69
  s_waitcnt vmcnt(23)
  v_readfirstlane_b32 s64, v71
  s_mul_i32 s64, s64, 1664525
  s_add_u32 s64, s64, 1013904223
  v_mov_b32 v71, s64
  s_waitcnt vmcnt(14)
  s_barrier
  ds_read_b128 a[0:3], v18 offset:0
  ds_read_b128 a[4:7], v18 offset:512
  ds_read_b128 a[160:163], v22 offset:0
  ds_read_b128 a[164:167], v22 offset:2048
  ds_read_b128 a[168:171], v22 offset:4096
  ds_read_b128 a[172:175], v22 offset:6144
  ds_read_b128 a[176:179], v22 offset:8192
  ds_read_b128 a[180:183], v22 offset:10240
  ds_read_b128 a[184:187], v22 offset:12288
  ds_read_b128 a[188:191], v22 offset:14336
  ds_read_b128 a[192:195], v22 offset:16384
  ds_read_b128 a[196:199], v22 offset:18432
  s_waitcnt lgkmcnt(0)
  s_add_u32 m0, s66, 73728
  v_mfma_f32_16x16x32_bf16 v[96:99], a[0:3], a[160:163], 0
  ds_read_b128 a[8:11], v19 offset:0
  buffer_load_dwordx4 v4, s[12:15], s68 offen offset:0 lds
  v_mfma_f32_16x16x32_bf16 v[100:103], a[4:7], a[160:163], 0
  ds_read_b128 a[12:15], v19 offset:512
  buffer_load_dwordx4 v5, s[12:15], s68 offen offset:1024 lds
  v_mfma_f32_16x16x32_bf16 v[104:107], a[0:3], a[164:167], 0
  ds_read_b128 a[200:203], v23 offset:0
  v_mfma_f32_16x16x32_bf16 v[108:111], a[4:7], a[164:167], 0
  ds_read_b128 a[204:207], v23 offset:2048
  v_mfma_f32_16x16x32_bf16 v[112:115], a[0:3], a[168:171], 0
  ds_read_b128 a[208:211], v23 offset:4096
  v_mfma_f32_16x16x32_bf16 v[116:119], a[4:7], a[168:171], 0
  ds_read_b128 a[212:215], v23 offset:6144
  buffer_load_dwordx4 v6, s[12:15], s68 offen offset:2048 lds
  v_mfma_f32_16x16x32_bf16 v[120:123], a[0:3], a[172:175], 0
  ds_read_b128 a[216:219], v23 offset:8192
  v_mfma_f32_16x16x32_bf16 v[124:127], a[4:7], a[172:175], 0
  ds_read_b128 a[220:223], v23 offset:10240
  v_mfma_f32_16x16x32_bf16 v[128:131], a[0:3], a[176:179], 0
  ds_read_b128 a[224:227], v23 offset:12288
  v_mfma_f32_16x16x32_bf16 v[132:135], a[4:7], a[176:179], 0
  ds_read_b128 a[228:231], v23 offset:14336
  buffer_load_dwordx4 v7, s[12:15], s68 offen offset:3072 lds
  v_mfma_f32_16x16x32_bf16 v[136:139], a[0:3], a[180:183], 0
  ds_read_b128 a[232:235], v23 offset:16384
  s_add_u32 s68, s68, 128
  v_mfma_f32_16x16x32_bf16 v[140:143], a[4:7], a[180:183], 0
  ds_read_b128 a[236:239], v23 offset:18432
  s_cmp_eq_u32 s91, 7
  s_cselect_b32 s68, s93, s68
  v_mfma_f32_16x16x32_bf16 v[144:147], a[0:3], a[184:187], 0
  s_add_u32 m0, s67, 90112
  s_nop 0
  buffer_load_dwordx4 v12, s[44:47], s69 offen offset:0 lds
  v_mfma_f32_16x16x32_bf16 v[148:151], a[4:7], a[184:187], 0
  v_mfma_f32_16x16x32_bf16 v[152:155], a[0:3], a[188:191], 0
  v_mfma_f32_16x16x32_bf16 v[156:159], a[4:7], a[188:191], 0
  v_mfma_f32_16x16x32_bf16 v[160:163], a[0:3], a[192:195], 0
  buffer_load_dwordx4 v13, s[44:47], s69 offen offset:1024 lds
  v_mfma_f32_16x16x32_bf16 v[164:167], a[4:7], a[192:195], 0
  v_mfma_f32_16x16x32_bf16 v[168:171], a[0:3], a[196:199], 0
  v_mfma_f32_16x16x32_bf16 v[172:175], a[4:7], a[196:199], 0
  s_waitcnt vmcnt(6) lgkmcnt(0)
  s_barrier
  buffer_load_dwordx4 v14, s[44:47], s69 offen offset:2048 lds
  v_mfma_f32_16x16x32_bf16 v[96:99], a[8:11], a[200:203], v[96:99]
  ds_read_b128 a[16:19], v18 offset:36864
  v_mfma_f32_16x16x32_bf16 v[100:103], a[12:15], a[200:203], v[100:103]
  ds_read_b128 a[20:23], v18 offset:37376
  v_mfma_f32_16x16x32_bf16 v[104:107], a[8:11], a[204:207], v[104:107]
  ds_read_b128 a[160:163], v22 offset:36864
  v_mfma_f32_16x16x32_bf16 v[108:111], a[12:15], a[204:207], v[108:111]
  ds_read_b128 a[164:167], v22 offset:38912
  buffer_load_dwordx4 v15, s[44:47], s69 offen offset:3072 lds
  v_mfma_f32_16x16x32_bf16 v[112:115], a[8:11], a[208:211], v[112:115]
  ds_read_b128 a[168:171], v22 offset:40960
  s_add_u32 m0, s67, 94208
  v_mfma_f32_16x16x32_bf16 v[116:119], a[12:15], a[208:211], v[116:119]
  ds_read_b128 a[172:175], v22 offset:43008
  v_mfma_f32_16x16x32_bf16 v[120:123], a[8:11], a[212:215], v[120:123]
  ds_read_b128 a[176:179], v22 offset:45056
  buffer_load_dwordx4 v16, s[44:47], s69 offen lds
  v_mfma_f32_16x16x32_bf16 v[124:127], a[12:15], a[212:215], v[124:127]
  ds_read_b128 a[180:183], v22 offset:47104
  s_add_u32 s69, s69, 128
  v_mfma_f32_16x16x32_bf16 v[128:131], a[8:11], a[216:219], v[128:131]
  ds_read_b128 a[184:187], v22 offset:49152
  s_cmp_eq_u32 s91, 7
  s_cselect_b32 s69, s94, s69
  v_mfma_f32_16x16x32_bf16 v[132:135], a[12:15], a[216:219], v[132:135]
  ds_read_b128 a[188:191], v22 offset:51200
  s_add_u32 m0, s66, 110592
  v_mfma_f32_16x16x32_bf16 v[136:139], a[8:11], a[220:223], v[136:139]
  ds_read_b128 a[192:195], v22 offset:53248
  buffer_load_dwordx4 v4, s[12:15], s68 offen offset:0 lds
  v_mfma_f32_16x16x32_bf16 v[140:143], a[12:15], a[220:223], v[140:143]
  ds_read_b128 a[196:199], v22 offset:55296
  v_mfma_f32_16x16x32_bf16 v[144:147], a[8:11], a[224:227], v[144:147]
  v_mfma_f32_16x16x32_bf16 v[148:151], a[12:15], a[224:227], v[148:151]
  buffer_load_dwordx4 v5, s[12:15], s68 offen offset:1024 lds
  v_mfma_f32_16x16x32_bf16 v[152:155], a[8:11], a[228:231], v[152:155]
  v_mfma_f32_16x16x32_bf16 v[156:159], a[12:15], a[228:231], v[156:159]
  v_mfma_f32_16x16x32_bf16 v[160:163], a[8:11], a[232:235], v[160:163]
  v_mfma_f32_16x16x32_bf16 v[164:167], a[12:15], a[232:235], v[164:167]
  buffer_load_dwordx4 v6, s[12:15], s68 offen offset:2048 lds
  v_mfma_f32_16x16x32_bf16 v[168:171], a[8:11], a[236:239], v[168:171]
  v_mfma_f32_16x16x32_bf16 v[172:175], a[12:15], a[236:239], v[172:175]
  v_mfma_f32_16x16x32_bf16 v[196:199], v[64:67], v[176:179], 0
  v_mfma_f32_16x16x32_bf16 v[196:199], v[64:67], v[180:183], v[196:199]
  buffer_load_dwordx4 v7, s[12:15], s68 offen offset:3072 lds
  s_add_u32 s68, s68, 128
  v_mfma_f32_16x16x32_bf16 v[196:199], v[64:67], v[184:187], v[196:199]
  s_cmp_eq_u32 s91, 6
  s_cselect_b32 s68, s93, s68
  v_mfma_f32_16x16x32_bf16 v[196:199], v[64:67], v[188:191], v[196:199]
  s_add_u32 m0, s67, 126976
  v_mfma_f32_16x16x32_bf16 v[196:199], v[64:67], v[192:195], v[196:199]
  s_waitcnt lgkmcnt(0)
  buffer_load_dwordx4 v12, s[44:47], s69 offen offset:0 lds
  v_mfma_f32_16x16x32_bf16 v[96:99], a[16:19], a[160:163], v[96:99]
  ds_read_b128 a[24:27], v19 offset:36864
  v_mfma_f32_16x16x32_bf16 v[100:103], a[20:23], a[160:163], v[100:103]
  ds_read_b128 a[28:31], v19 offset:37376
  v_mfma_f32_16x16x32_bf16 v[104:107], a[16:19], a[164:167], v[104:107]
  ds_read_b128 a[200:203], v23 offset:36864
  v_add_f32_dpp v176, v196, v196 quad_perm:[1,0,3,2] row_mask:0xf bank_mask:0xf
  v_mfma_f32_16x16x32_bf16 v[108:111], a[20:23], a[164:167], v[108:111]
  ds_read_b128 a[204:207], v23 offset:38912
  v_mov_b32 v177, v71
  v_mfma_f32_16x16x32_bf16 v[112:115], a[16:19], a[168:171], v[112:115]
  ds_read_b128 a[208:211], v23 offset:40960
  v_add_f32_dpp v176, v176, v176 quad_perm:[2,3,0,1] row_mask:0xf bank_mask:0xf
  v_mfma_f32_16x16x32_bf16 v[116:119], a[20:23], a[168:171], v[116:119]
  ds_read_b128 a[212:215], v23 offset:43008
  buffer_load_dwordx4 v13, s[44:47], s69 offen offset:1024 lds
  v_mfma_f32_16x16x32_bf16 v[120:123], a[16:19], a[172:175], v[120:123]
  ds_read_b128 a[216:219], v23 offset:45056
  buffer_load_dwordx4 v14, s[44:47], s69 offen offset:2048 lds
  v_mfma_f32_16x16x32_bf16 v[124:127], a[20:23], a[172:175], v[124:127]
  ds_read_b128 a[220:223], v23 offset:47104
  v_mfma_f32_16x16x32_bf16 v[128:131], a[16:19], a[176:179], v[128:131]
  ds_read_b128 a[224:227], v23 offset:49152
  v_mfma_f32_16x16x32_bf16 v[132:135], a[20:23], a[176:179], v[132:135]
  ds_read_b128 a[228:231], v23 offset:51200
  v_mfma_f32_16x16x32_bf16 v[136:139], a[16:19], a[180:183], v[136:139]
  ds_read_b128 a[232:235], v23 offset:53248
  buffer_load_dwordx4 v15, s[44:47], s69 offen offset:3072 lds
  v_mfma_f32_16x16x32_bf16 v[140:143], a[20:23], a[180:183], v[140:143]
  ds_read_b128 a[236:239], v23 offset:55296
  s_add_u32 m0, s67, 131072
  v_mfma_f32_16x16x32_bf16 v[144:147], a[16:19], a[184:187], v[144:147]
  v_mfma_f32_16x16x32_bf16 v[148:151], a[20:23], a[184:187], v[148:151]
  v_mfma_f32_16x16x32_bf16 v[152:155], a[16:19], a[188:191], v[152:155]
  buffer_load_dwordx4 v16, s[44:47], s69 offen lds
  s_add_u32 s69, s69, 128
  v_mfma_f32_16x16x32_bf16 v[156:159], a[20:23], a[188:191], v[156:159]
  s_cmp_eq_u32 s91, 6
  s_cselect_b32 s69, s94, s69
  v_mfma_f32_16x16x32_bf16 v[160:163], a[16:19], a[192:195], v[160:163]
  v_mfma_f32_16x16x32_bf16 v[164:167], a[20:23], a[192:195], v[164:167]
  buffer_store_dwordx2 v[176:177], v205, s[8:11], s21 offen sc1
  v_mfma_f32_16x16x32_bf16 v[168:171], a[16:19], a[196:199], v[168:171]
  v_mfma_f32_16x16x32_bf16 v[172:175], a[20:23], a[196:199], v[172:175]
  s_waitcnt vmcnt(10) lgkmcnt(0)
  s_barrier
  s_add_u32 m0, s66, 0
  v_mfma_f32_16x16x32_bf16 v[96:99], a[24:27], a[200:203], v[96:99]
  ds_read_b128 a[32:35], v20 offset:0
  v_mfma_f32_16x16x32_bf16 v[100:103], a[28:31], a[200:203], v[100:103]
  ds_read_b128 a[36:39], v20 offset:512
  buffer_load_dwordx4 v4, s[12:15], s68 offen offset:0 lds
  v_mfma_f32_16x16x32_bf16 v[104:107], a[24:27], a[204:207], v[104:107]
  ds_read_b128 a[160:163], v24 offset:0
  buffer_load_dwordx4 v5, s[12:15], s68 offen offset:1024 lds
  v_mfma_f32_16x16x32_bf16 v[108:111], a[28:31], a[204:207], v[108:111]
  ds_read_b128 a[164:167], v24 offset:2048
  v_mfma_f32_16x16x32_bf16 v[112:115], a[24:27], a[208:211], v[112:115]
  ds_read_b128 a[168:171], v24 offset:4096
  v_mfma_f32_16x16x32_bf16 v[116:119], a[28:31], a[208:211], v[116:119]
  ds_read_b128 a[172:175], v24 offset:6144
  buffer_load_dwordx4 v6, s[12:15], s68 offen offset:2048 lds
  v_mfma_f32_16x16x32_bf16 v[120:123], a[24:27], a[212:215], v[120:123]
  ds_read_b128 a[176:179], v24 offset:8192
  v_mfma_f32_16x16x32_bf16 v[124:127], a[28:31], a[212:215], v[124:127]
  ds_read_b128 a[180:183], v24 offset:10240
  v_mfma_f32_16x16x32_bf16 v[128:131], a[24:27], a[216:219], v[128:131]
  ds_read_b128 a[184:187], v24 offset:12288
  v_mfma_f32_16x16x32_bf16 v[132:135], a[28:31], a[216:219], v[132:135]
  ds_read_b128 a[188:191], v24 offset:14336
  buffer_load_dwordx4 v7, s[12:15], s68 offen offset:3072 lds
  v_mfma_f32_16x16x32_bf16 v[136:139], a[24:27], a[220:223], v[136:139]
  ds_read_b128 a[192:195], v24 offset:16384
  s_add_u32 s68, s68, 128
  v_mfma_f32_16x16x32_bf16 v[140:143], a[28:31], a[220:223], v[140:143]
  ds_read_b128 a[196:199], v24 offset:18432
  s_cmp_eq_u32 s91, 5
  s_cselect_b32 s68, s93, s68
  v_mfma_f32_16x16x32_bf16 v[144:147], a[24:27], a[224:227], v[144:147]
  s_add_u32 m0, s67, 16384
  s_nop 0
  buffer_load_dwordx4 v12, s[44:47], s69 offen offset:0 lds
  v_mfma_f32_16x16x32_bf16 v[148:151], a[28:31], a[224:227], v[148:151]
  v_mfma_f32_16x16x32_bf16 v[152:155], a[24:27], a[228:231], v[152:155]
  v_mfma_f32_16x16x32_bf16 v[156:159], a[28:31], a[228:231], v[156:159]
  v_mfma_f32_16x16x32_bf16 v[160:163], a[24:27], a[232:235], v[160:163]
  buffer_load_dwordx4 v13, s[44:47], s69 offen offset:1024 lds
  v_mfma_f32_16x16x32_bf16 v[164:167], a[28:31], a[232:235], v[164:167]
  v_mfma_f32_16x16x32_bf16 v[168:171], a[24:27], a[236:239], v[168:171]
  v_mfma_f32_16x16x32_bf16 v[172:175], a[28:31], a[236:239], v[172:175]
  s_waitcnt lgkmcnt(0)
  buffer_load_dwordx4 v14, s[44:47], s69 offen offset:2048 lds
  v_mfma_f32_16x16x32_bf16 v[96:99], a[32:35], a[160:163], v[96:99]
  ds_read_b128 a[40:43], v21 offset:0
  v_mfma_f32_16x16x32_bf16 v[100:103], a[36:39], a[160:163], v[100:103]
  ds_read_b128 a[44:47], v21 offset:512
  v_mfma_f32_16x16x32_bf16 v[104:107], a[32:35], a[164:167], v[104:107]
  ds_read_b128 a[200:203], v25 offset:0
  v_mfma_f32_16x16x32_bf16 v[108:111], a[36:39], a[164:167], v[108:111]
  ds_read_b128 a[204:207], v25 offset:2048
  buffer_load_dwordx4 v15, s[44:47], s69 offen offset:3072 lds
  v_mfma_f32_16x16x32_bf16 v[112:115], a[32:35], a[168:171], v[112:115]
  ds_read_b128 a[208:211], v25 offset:4096
  s_add_u32 m0, s67, 20480
  v_mfma_f32_16x16x32_bf16 v[116:119], a[36:39], a[168:171], v[116:119]
  ds_read_b128 a[212:215], v25 offset:6144
  v_mfma_f32_16x16x32_bf16 v[120:123], a[32:35], a[172:175], v[120:123]
  ds_read_b128 a[216:219], v25 offset:8192
  buffer_load_dwordx4 v16, s[44:47], s69 offen lds
  v_mfma_f32_16x16x32_bf16 v[124:127], a[36:39], a[172:175], v[124:127]
  ds_read_b128 a[220:223], v25 offset:10240
  s_add_u32 s69, s69, 128
  v_mfma_f32_16x16x32_bf16 v[128:131], a[32:35], a[176:179], v[128:131]
  ds_read_b128 a[224:227], v25 offset:12288
  s_cmp_eq_u32 s91, 5
  s_cselect_b32 s69, s94, s69
  v_mfma_f32_16x16x32_bf16 v[132:135], a[36:39], a[176:179], v[132:135]
  ds_read_b128 a[228:231], v25 offset:14336
  s_add_u32 m0, s66, 36864
  v_mfma_f32_16x16x32_bf16 v[136:139], a[32:35], a[180:183], v[136:139]
  ds_read_b128 a[232:235], v25 offset:16384
  buffer_load_dwordx4 v4, s[12:15], s68 offen offset:0 lds
  v_mfma_f32_16x16x32_bf16 v[140:143], a[36:39], a[180:183], v[140:143]
  ds_read_b128 a[236:239], v25 offset:18432
  v_mfma_f32_16x16x32_bf16 v[144:147], a[32:35], a[184:187], v[144:147]
  v_mfma_f32_16x16x32_bf16 v[148:151], a[36:39], a[184:187], v[148:151]
  buffer_load_dwordx4 v5, s[12:15], s68 offen offset:1024 lds
  v_mfma_f32_16x16x32_bf16 v[152:155], a[32:35], a[188:191], v[152:155]
  v_mfma_f32_16x16x32_bf16 v[156:159], a[36:39], a[188:191], v[156:159]
  v_mfma_f32_16x16x32_bf16 v[160:163], a[32:35], a[192:195], v[160:163]
  v_mfma_f32_16x16x32_bf16 v[164:167], a[36:39], a[192:195], v[164:167]
  buffer_load_dwordx4 v6, s[12:15], s68 offen offset:2048 lds
  v_mfma_f32_16x16x32_bf16 v[168:171], a[32:35], a[196:199], v[168:171]
  v_mfma_f32_16x16x32_bf16 v[172:175], a[36:39], a[196:199], v[172:175]
  s_waitcnt vmcnt(13) lgkmcnt(0)
  s_barrier
  v_mfma_f32_16x16x32_bf16 v[96:99], a[40:43], a[200:203], v[96:99]
  ds_read_b128 a[48:51], v20 offset:36864
  v_mfma_f32_16x16x32_bf16 v[100:103], a[44:47], a[200:203], v[100:103]
  ds_read_b128 a[52:55], v20 offset:37376
  buffer_load_dwordx4 v7, s[12:15], s68 offen offset:3072 lds
  v_mfma_f32_16x16x32_bf16 v[104:107], a[40:43], a[204:207], v[104:107]
  ds_read_b128 a[160:163], v24 offset:36864
  s_add_u32 s68, s68, 128
  v_mfma_f32_16x16x32_bf16 v[108:111], a[44:47], a[204:207], v[108:111]
  ds_read_b128 a[164:167], v24 offset:38912
  s_cmp_eq_u32 s91, 4
  s_cselect_b32 s68, s93, s68
  v_mfma_f32_16x16x32_bf16 v[112:115], a[40:43], a[208:211], v[112:115]
  ds_read_b128 a[168:171], v24 offset:40960
  s_add_u32 m0, s67, 53248
  v_mfma_f32_16x16x32_bf16 v[116:119], a[44:47], a[208:211], v[116:119]
  ds_read_b128 a[172:175], v24 offset:43008
  buffer_load_dwordx4 v12, s[44:47], s69 offen offset:0 lds
  v_mfma_f32_16x16x32_bf16 v[120:123], a[40:43], a[212:215], v[120:123]
  ds_read_b128 a[176:179], v24 offset:45056
  v_mfma_f32_16x16x32_bf16 v[124:127], a[44:47], a[212:215], v[124:127]
  ds_read_b128 a[180:183], v24 offset:47104
  v_mfma_f32_16x16x32_bf16 v[128:131], a[40:43], a[216:219], v[128:131]
  ds_read_b128 a[184:187], v24 offset:49152
  buffer_load_dwordx4 v13, s[44:47], s69 offen offset:1024 lds
  v_mfma_f32_16x16x32_bf16 v[132:135], a[44:47], a[216:219], v[132:135]
  ds_read_b128 a[188:191], v24 offset:51200
  v_mfma_f32_16x16x32_bf16 v[136:139], a[40:43], a[220:223], v[136:139]
  ds_read_b128 a[192:195], v24 offset:53248
  v_mfma_f32_16x16x32_bf16 v[140:143], a[44:47], a[220:223], v[140:143]
  ds_read_b128 a[196:199], v24 offset:55296
  buffer_load_dwordx4 v14, s[44:47], s69 offen offset:2048 lds
  v_mfma_f32_16x16x32_bf16 v[144:147], a[40:43], a[224:227], v[144:147]
  v_mfma_f32_16x16x32_bf16 v[148:151], a[44:47], a[224:227], v[148:151]
  v_mfma_f32_16x16x32_bf16 v[152:155], a[40:43], a[228:231], v[152:155]
  v_mfma_f32_16x16x32_bf16 v[156:159], a[44:47], a[228:231], v[156:159]
  buffer_load_dwordx4 v15, s[44:47], s69 offen offset:3072 lds
  s_add_u32 m0, s67, 57344
  v_mfma_f32_16x16x32_bf16 v[160:163], a[40:43], a[232:235], v[160:163]
  v_mfma_f32_16x16x32_bf16 v[164:167], a[44:47], a[232:235], v[164:167]
  v_mfma_f32_16x16x32_bf16 v[168:171], a[40:43], a[236:239], v[168:171]
  buffer_load_dwordx4 v16, s[44:47], s69 offen lds
  s_add_u32 s69, s69, 128
  v_mfma_f32_16x16x32_bf16 v[172:175], a[44:47], a[236:239], v[172:175]
  s_waitcnt lgkmcnt(0)
  s_cmp_eq_u32 s91, 4
  s_cselect_b32 s69, s94, s69
  v_mfma_f32_16x16x32_bf16 v[96:99], a[48:51], a[160:163], v[96:99]
  ds_read_b128 a[56:59], v21 offset:36864
  s_add_u32 m0, s66, 73728
  v_mfma_f32_16x16x32_bf16 v[100:103], a[52:55], a[160:163], v[100:103]
  ds_read_b128 a[60:63], v21 offset:37376
  v_mfma_f32_16x16x32_bf16 v[104:107], a[48:51], a[164:167], v[104:107]
  ds_read_b128 a[200:203], v25 offset:36864
  buffer_load_dwordx4 v4, s[12:15], s68 offen offset:0 lds
  v_mfma_f32_16x16x32_bf16 v[108:111], a[52:55], a[164:167], v[108:111]
  ds_read_b128 a[204:207], v25 offset:38912
  v_mfma_f32_16x16x32_bf16 v[112:115], a[48:51], a[168:171], v[112:115]
  ds_read_b128 a[208:211], v25 offset:40960
  v_mfma_f32_16x16x32_bf16 v[116:119], a[52:55], a[168:171], v[116:119]
  ds_read_b128 a[212:215], v25 offset:43008
  buffer_load_dwordx4 v5, s[12:15], s68 offen offset:1024 lds
  v_mfma_f32_16x16x32_bf16 v[120:123], a[48:51], a[172:175], v[120:123]
  ds_read_b128 a[216:219], v25 offset:45056
  v_mfma_f32_16x16x32_bf16 v[124:127], a[52:55], a[172:175], v[124:127]
  ds_read_b128 a[220:223], v25 offset:47104
  v_mfma_f32_16x16x32_bf16 v[128:131], a[48:51], a[176:179], v[128:131]
  ds_read_b128 a[224:227], v25 offset:49152
  v_mfma_f32_16x16x32_bf16 v[132:135], a[52:55], a[176:179], v[132:135]
  ds_read_b128 a[228:231], v25 offset:51200
  buffer_load_dwordx4 v6, s[12:15], s68 offen offset:2048 lds
  v_mfma_f32_16x16x32_bf16 v[136:139], a[48:51], a[180:183], v[136:139]
  ds_read_b128 a[232:235], v25 offset:53248
  v_mfma_f32_16x16x32_bf16 v[140:143], a[52:55], a[180:183], v[140:143]
  ds_read_b128 a[236:239], v25 offset:55296
  v_mfma_f32_16x16x32_bf16 v[144:147], a[48:51], a[184:187], v[144:147]
  buffer_load_dwordx4 v7, s[12:15], s68 offen offset:3072 lds
  s_add_u32 s68, s68, 128
  v_mfma_f32_16x16x32_bf16 v[148:151], a[52:55], a[184:187], v[148:151]
  s_cmp_eq_u32 s91, 3
  s_cselect_b32 s68, s93, s68
  v_mfma_f32_16x16x32_bf16 v[152:155], a[48:51], a[188:191], v[152:155]
  s_add_u32 m0, s67, 90112
  v_mfma_f32_16x16x32_bf16 v[156:159], a[52:55], a[188:191], v[156:159]
  v_mfma_f32_16x16x32_bf16 v[160:163], a[48:51], a[192:195], v[160:163]
  buffer_load_dwordx4 v12, s[44:47], s69 offen offset:0 lds
  v_mfma_f32_16x16x32_bf16 v[164:167], a[52:55], a[192:195], v[164:167]
  v_mfma_f32_16x16x32_bf16 v[168:171], a[48:51], a[196:199], v[168:171]
  v_mfma_f32_16x16x32_bf16 v[172:175], a[52:55], a[196:199], v[172:175]
  s_waitcnt vmcnt(14) lgkmcnt(0)
  s_barrier
  v_mfma_f32_16x16x32_bf16 v[96:99], a[56:59], a[200:203], v[96:99]
  ds_read_b128 a[64:67], v18 offset:0
  buffer_load_dwordx4 v13, s[44:47], s69 offen offset:1024 lds
  v_mfma_f32_16x16x32_bf16 v[100:103], a[60:63], a[200:203], v[100:103]
  ds_read_b128 a[68:71], v18 offset:512
  v_mfma_f32_16x16x32_bf16 v[104:107], a[56:59], a[204:207], v[104:107]
  ds_read_b128 a[160:163], v22 offset:0
  v_mfma_f32_16x16x32_bf16 v[108:111], a[60:63], a[204:207], v[108:111]
  ds_read_b128 a[164:167], v22 offset:2048
  buffer_load_dwordx4 v14, s[44:47], s69 offen offset:2048 lds
  v_mfma_f32_16x16x32_bf16 v[112:115], a[56:59], a[208:211], v[112:115]
  ds_read_b128 a[168:171], v22 offset:4096
  v_mfma_f32_16x16x32_bf16 v[116:119], a[60:63], a[208:211], v[116:119]
  ds_read_b128 a[172:175], v22 offset:6144
  v_mfma_f32_16x16x32_bf16 v[120:123], a[56:59], a[212:215], v[120:123]
  ds_read_b128 a[176:179], v22 offset:8192
  v_mfma_f32_16x16x32_bf16 v[124:127], a[60:63], a[212:215], v[124:127]
  ds_read_b128 a[180:183], v22 offset:10240
  buffer_load_dwordx4 v15, s[44:47], s69 offen offset:3072 lds
  v_mfma_f32_16x16x32_bf16 v[128:131], a[56:59], a[216:219], v[128:131]
  ds_read_b128 a[184:187], v22 offset:12288
  s_add_u32 m0, s67, 94208
  v_mfma_f32_16x16x32_bf16 v[132:135], a[60:63], a[216:219], v[132:135]
  ds_read_b128 a[188:191], v22 offset:14336
  v_mfma_f32_16x16x32_bf16 v[136:139], a[56:59], a[220:223], v[136:139]
  ds_read_b128 a[192:195], v22 offset:16384
  buffer_load_dwordx4 v16, s[44:47], s69 offen lds
  v_mfma_f32_16x16x32_bf16 v[140:143], a[60:63], a[220:223], v[140:143]
  ds_read_b128 a[196:199], v22 offset:18432
  s_add_u32 s69, s69, 128
  v_mfma_f32_16x16x32_bf16 v[144:147], a[56:59], a[224:227], v[144:147]
  s_cmp_eq_u32 s91, 3
  s_cselect_b32 s69, s94, s69
  v_mfma_f32_16x16x32_bf16 v[148:151], a[60:63], a[224:227], v[148:151]
  s_add_u32 m0, s66, 110592
  v_mfma_f32_16x16x32_bf16 v[152:155], a[56:59], a[228:231], v[152:155]
  buffer_load_dwordx4 v4, s[12:15], s68 offen offset:0 lds
  v_mfma_f32_16x16x32_bf16 v[156:159], a[60:63], a[228:231], v[156:159]
  v_mfma_f32_16x16x32_bf16 v[160:163], a[56:59], a[232:235], v[160:163]
  v_mfma_f32_16x16x32_bf16 v[164:167], a[60:63], a[232:235], v[164:167]
  v_mfma_f32_16x16x32_bf16 v[168:171], a[56:59], a[236:239], v[168:171]
  buffer_load_dwordx4 v5, s[12:15], s68 offen offset:1024 lds
  v_mfma_f32_16x16x32_bf16 v[172:175], a[60:63], a[236:239], v[172:175]
  s_waitcnt lgkmcnt(0)
  v_mfma_f32_16x16x32_bf16 v[96:99], a[64:67], a[160:163], v[96:99]
  ds_read_b128 a[72:75], v19 offset:0
  v_mfma_f32_16x16x32_bf16 v[100:103], a[68:71], a[160:163], v[100:103]
  ds_read_b128 a[76:79], v19 offset:512
  buffer_load_dwordx4 v6, s[12:15], s68 offen offset:2048 lds
  v_mfma_f32_16x16x32_bf16 v[104:107], a[64:67], a[164:167], v[104:107]
  ds_read_b128 a[200:203], v23 offset:0
  v_mfma_f32_16x16x32_bf16 v[108:111], a[68:71], a[164:167], v[108:111]
  ds_read_b128 a[204:207], v23 offset:2048
  v_mfma_f32_16x16x32_bf16 v[112:115], a[64:67], a[168:171], v[112:115]
  ds_read_b128 a[208:211], v23 offset:4096
  v_mfma_f32_16x16x32_bf16 v[116:119], a[68:71], a[168:171], v[116:119]
  ds_read_b128 a[212:215], v23 offset:6144
  buffer_load_dwordx4 v7, s[12:15], s68 offen offset:3072 lds
  v_mfma_f32_16x16x32_bf16 v[120:123], a[64:67], a[172:175], v[120:123]
  ds_read_b128 a[216:219], v23 offset:8192
  s_add_u32 s68, s68, 128
  v_mfma_f32_16x16x32_bf16 v[124:127], a[68:71], a[172:175], v[124:127]
  ds_read_b128 a[220:223], v23 offset:10240
  s_cmp_eq_u32 s91, 2
  s_cselect_b32 s68, s93, s68
  v_mfma_f32_16x16x32_bf16 v[128:131], a[64:67], a[176:179], v[128:131]
  ds_read_b128 a[224:227], v23 offset:12288
  s_add_u32 m0, s67, 126976
  v_mfma_f32_16x16x32_bf16 v[132:135], a[68:71], a[176:179], v[132:135]
  ds_read_b128 a[228:231], v23 offset:14336
  buffer_load_dwordx4 v12, s[44:47], s69 offen offset:0 lds
  v_mfma_f32_16x16x32_bf16 v[136:139], a[64:67], a[180:183], v[136:139]
  ds_read_b128 a[232:235], v23 offset:16384
  v_mfma_f32_16x16x32_bf16 v[140:143], a[68:71], a[180:183], v[140:143]
  ds_read_b128 a[236:239], v23 offset:18432
  v_mfma_f32_16x16x32_bf16 v[144:147], a[64:67], a[184:187], v[144:147]
  buffer_load_dwordx4 v13, s[44:47], s69 offen offset:1024 lds
  v_mfma_f32_16x16x32_bf16 v[148:151], a[68:71], a[184:187], v[148:151]
  v_mfma_f32_16x16x32_bf16 v[152:155], a[64:67], a[188:191], v[152:155]
  v_mfma_f32_16x16x32_bf16 v[156:159], a[68:71], a[188:191], v[156:159]
  buffer_load_dwordx4 v14, s[44:47], s69 offen offset:2048 lds
  v_mfma_f32_16x16x32_bf16 v[160:163], a[64:67], a[192:195], v[160:163]
  v_mfma_f32_16x16x32_bf16 v[164:167], a[68:71], a[192:195], v[164:167]
  v_mfma_f32_16x16x32_bf16 v[168:171], a[64:67], a[196:199], v[168:171]
  v_mfma_f32_16x16x32_bf16 v[172:175], a[68:71], a[196:199], v[172:175]
  s_waitcnt vmcnt(16) lgkmcnt(0)
  s_barrier
  buffer_load_dwordx4 v15, s[44:47], s69 offen offset:3072 lds
  v_mfma_f32_16x16x32_bf16 v[96:99], a[72:75], a[200:203], v[96:99]
  ds_read_b128 a[80:83], v18 offset:36864
  s_add_u32 m0, s67, 131072
  v_mfma_f32_16x16x32_bf16 v[100:103], a[76:79], a[200:203], v[100:103]
  ds_read_b128 a[84:87], v18 offset:37376
  v_mfma_f32_16x16x32_bf16 v[104:107], a[72:75], a[204:207], v[104:107]
  ds_read_b128 a[160:163], v22 offset:36864
  v_mfma_f32_16x16x32_bf16 v[108:111], a[76:79], a[204:207], v[108:111]
  ds_read_b128 a[164:167], v22 offset:38912
  buffer_load_dwordx4 v16, s[44:47], s69 offen lds
  v_mfma_f32_16x16x32_bf16 v[112:115], a[72:75], a[208:211], v[112:115]
  ds_read_b128 a[168:171], v22 offset:40960
  s_add_u32 s69, s69, 128
  v_mfma_f32_16x16x32_bf16 v[116:119], a[76:79], a[208:211], v[116:119]
  ds_read_b128 a[172:175], v22 offset:43008
  s_cmp_eq_u32 s91, 2
  s_cselect_b32 s69, s94, s69
  v_mfma_f32_16x16x32_bf16 v[120:123], a[72:75], a[212:215], v[120:123]
  ds_read_b128 a[176:179], v22 offset:45056
  buffer_load_dwordx4 v[56:59], v75, s[8:11], s22 offen offset:0 sc1
  v_mfma_f32_16x16x32_bf16 v[124:127], a[76:79], a[212:215], v[124:127]
  ds_read_b128 a[180:183], v22 offset:47104
  v_mfma_f32_16x16x32_bf16 v[128:131], a[72:75], a[216:219], v[128:131]
  ds_read_b128 a[184:187], v22 offset:49152
  v_mfma_f32_16x16x32_bf16 v[132:135], a[76:79], a[216:219], v[132:135]
  ds_read_b128 a[188:191], v22 offset:51200
  v_mfma_f32_16x16x32_bf16 v[136:139], a[72:75], a[220:223], v[136:139]
  ds_read_b128 a[192:195], v22 offset:53248
  buffer_load_dwordx4 v[60:63], v75, s[8:11], s22 offen offset:64 sc1
  v_mfma_f32_16x16x32_bf16 v[140:143], a[76:79], a[220:223], v[140:143]
  ds_read_b128 a[196:199], v22 offset:55296
  buffer_load_dwordx4 v[208:211], v1, s[8:11], s23 offen sc1
  v_mfma_f32_16x16x32_bf16 v[144:147], a[72:75], a[224:227], v[144:147]
  v_mfma_f32_16x16x32_bf16 v[148:151], a[76:79], a[224:227], v[148:151]
  buffer_load_dwordx4 v[212:215], v238, s[8:11], s23 offen offset:1024 sc1
  s_add_u32 m0, s66, 0
  v_mfma_f32_16x16x32_bf16 v[152:155], a[72:75], a[228:231], v[152:155]
  v_mfma_f32_16x16x32_bf16 v[156:159], a[76:79], a[228:231], v[156:159]
  buffer_load_dwordx4 v4, s[12:15], s68 offen offset:0 lds
  v_mfma_f32_16x16x32_bf16 v[160:163], a[72:75], a[232:235], v[160:163]
  v_mfma_f32_16x16x32_bf16 v[164:167], a[76:79], a[232:235], v[164:167]
  buffer_load_dwordx4 v5, s[12:15], s68 offen offset:1024 lds
  v_mfma_f32_16x16x32_bf16 v[168:171], a[72:75], a[236:239], v[168:171]
  v_mfma_f32_16x16x32_bf16 v[172:175], a[76:79], a[236:239], v[172:175]
  s_waitcnt lgkmcnt(0)
  v_mfma_f32_16x16x32_bf16 v[96:99], a[80:83], a[160:163], v[96:99]
  ds_read_b128 a[88:91], v19 offset:36864
  buffer_load_dwordx4 v6, s[12:15], s68 offen offset:2048 lds
  v_mfma_f32_16x16x32_bf16 v[100:103], a[84:87], a[160:163], v[100:103]
  ds_read_b128 a[92:95], v19 offset:37376
  v_mfma_f32_16x16x32_bf16 v[104:107], a[80:83], a[164:167], v[104:107]
  ds_read_b128 a[200:203], v23 offset:36864
  v_mfma_f32_16x16x32_bf16 v[108:111], a[84:87], a[164:167], v[108:111]
  ds_read_b128 a[204:207], v23 offset:38912
  v_mfma_f32_16x16x32_bf16 v[112:115], a[80:83], a[168:171], v[112:115]
  ds_read_b128 a[208:211], v23 offset:40960
  buffer_load_dwordx4 v7, s[12:15], s68 offen offset:3072 lds
  v_mfma_f32_16x16x32_bf16 v[116:119], a[84:87], a[168:171], v[116:119]
  ds_read_b128 a[212:215], v23 offset:43008
  s_add_u32 s68, s68, 128
  v_mfma_f32_16x16x32_bf16 v[120:123], a[80:83], a[172:175], v[120:123]
  ds_read_b128 a[216:219], v23 offset:45056
  s_cmp_eq_u32 s91, 1
  s_cselect_b32 s68, s93, s68
  v_mfma_f32_16x16x32_bf16 v[124:127], a[84:87], a[172:175], v[124:127]
  ds_read_b128 a[220:223], v23 offset:47104
  s_add_u32 m0, s67, 16384
  v_mfma_f32_16x16x32_bf16 v[128:131], a[80:83], a[176:179], v[128:131]
  ds_read_b128 a[224:227], v23 offset:49152
  buffer_load_dwordx4 v12, s[44:47], s69 offen offset:0 lds
  v_mfma_f32_16x16x32_bf16 v[132:135], a[84:87], a[176:179], v[132:135]
  ds_read_b128 a[228:231], v23 offset:51200
  v_mfma_f32_16x16x32_bf16 v[136:139], a[80:83], a[180:183], v[136:139]
  ds_read_b128 a[232:235], v23 offset:53248
  v_mfma_f32_16x16x32_bf16 v[140:143], a[84:87], a[180:183], v[140:143]
  ds_read_b128 a[236:239], v23 offset:55296
  buffer_load_dwordx4 v13, s[44:47], s69 offen offset:1024 lds
  v_mfma_f32_16x16x32_bf16 v[144:147], a[80:83], a[184:187], v[144:147]
  v_mfma_f32_16x16x32_bf16 v[148:151], a[84:87], a[184:187], v[148:151]
  v_mfma_f32_16x16x32_bf16 v[152:155], a[80:83], a[188:191], v[152:155]
  v_mfma_f32_16x16x32_bf16 v[156:159], a[84:87], a[188:191], v[156:159]
  buffer_load_dwordx4 v14, s[44:47], s69 offen offset:2048 lds
  v_mfma_f32_16x16x32_bf16 v[160:163], a[80:83], a[192:195], v[160:163]
  v_mfma_f32_16x16x32_bf16 v[164:167], a[84:87], a[192:195], v[164:167]
  v_mfma_f32_16x16x32_bf16 v[168:171], a[80:83], a[196:199], v[168:171]
  buffer_load_dwordx4 v15, s[44:47], s69 offen offset:3072 lds
  s_add_u32 m0, s67, 20480
  v_mfma_f32_16x16x32_bf16 v[172:175], a[84:87], a[196:199], v[172:175]
  s_waitcnt vmcnt(21) lgkmcnt(0)
  s_barrier
  v_mfma_f32_16x16x32_bf16 v[96:99], a[88:91], a[200:203], v[96:99]
  ds_read_b128 a[96:99], v20 offset:0
  v_mfma_f32_16x16x32_bf16 v[100:103], a[92:95], a[200:203], v[100:103]
  ds_read_b128 a[100:103], v20 offset:512
  v_mfma_f32_16x16x32_bf16 v[104:107], a[88:91], a[204:207], v[104:107]
  ds_read_b128 a[160:163], v24 offset:0
  buffer_load_dwordx4 v16, s[44:47], s69 offen lds
  v_mfma_f32_16x16x32_bf16 v[108:111], a[92:95], a[204:207], v[108:111]
  ds_read_b128 a[164:167], v24 offset:2048
  s_add_u32 s69, s69, 128
  v_mfma_f32_16x16x32_bf16 v[112:115], a[88:91], a[208:211], v[112:115]
  ds_read_b128 a[168:171], v24 offset:4096
  s_cmp_eq_u32 s91, 1
  s_cselect_b32 s69, s94, s69
  v_mfma_f32_16x16x32_bf16 v[116:119], a[92:95], a[208:211], v[116:119]
  ds_read_b128 a[172:175], v24 offset:6144
  s_add_u32 m0, s66, 36864
  v_mfma_f32_16x16x32_bf16 v[120:123], a[88:91], a[212:215], v[120:123]
  ds_read_b128 a[176:179], v24 offset:8192
  buffer_load_dwordx4 v4, s[12:15], s68 offen offset:0 lds
  v_mfma_f32_16x16x32_bf16 v[124:127], a[92:95], a[212:215], v[124:127]
  ds_read_b128 a[180:183], v24 offset:10240
  v_mfma_f32_16x16x32_bf16 v[128:131], a[88:91], a[216:219], v[128:131]
  ds_read_b128 a[184:187], v24 offset:12288
  v_mfma_f32_16x16x32_bf16 v[132:135], a[92:95], a[216:219], v[132:135]
  ds_read_b128 a[188:191], v24 offset:14336
  buffer_load_dwordx4 v5, s[12:15], s68 offen offset:1024 lds
  v_mfma_f32_16x16x32_bf16 v[136:139], a[88:91], a[220:223], v[136:139]
  ds_read_b128 a[192:195], v24 offset:16384
  v_mfma_f32_16x16x32_bf16 v[140:143], a[92:95], a[220:223], v[140:143]
  ds_read_b128 a[196:199], v24 offset:18432
  v_mfma_f32_16x16x32_bf16 v[144:147], a[88:91], a[224:227], v[144:147]
  buffer_load_dwordx4 v6, s[12:15], s68 offen offset:2048 lds
  v_mfma_f32_16x16x32_bf16 v[148:151], a[92:95], a[224:227], v[148:151]
  v_mfma_f32_16x16x32_bf16 v[152:155], a[88:91], a[228:231], v[152:155]
  v_mfma_f32_16x16x32_bf16 v[156:159], a[92:95], a[228:231], v[156:159]
  v_mfma_f32_16x16x32_bf16 v[160:163], a[88:91], a[232:235], v[160:163]
  buffer_load_dwordx4 v7, s[12:15], s68 offen offset:3072 lds
  s_add_u32 s68, s68, 128
  v_mfma_f32_16x16x32_bf16 v[164:167], a[92:95], a[232:235], v[164:167]
  s_add_u32 m0, s67, 53248
  v_mfma_f32_16x16x32_bf16 v[168:171], a[88:91], a[236:239], v[168:171]
  v_mfma_f32_16x16x32_bf16 v[172:175], a[92:95], a[236:239], v[172:175]
  s_waitcnt lgkmcnt(0)
  buffer_load_dwordx4 v12, s[44:47], s69 offen offset:0 lds
  v_mfma_f32_16x16x32_bf16 v[96:99], a[96:99], a[160:163], v[96:99]
  ds_read_b128 a[104:107], v21 offset:0
  v_mfma_f32_16x16x32_bf16 v[100:103], a[100:103], a[160:163], v[100:103]
  ds_read_b128 a[108:111], v21 offset:512
  v_mfma_f32_16x16x32_bf16 v[104:107], a[96:99], a[164:167], v[104:107]
  ds_read_b128 a[200:203], v25 offset:0
  v_mfma_f32_16x16x32_bf16 v[108:111], a[100:103], a[164:167], v[108:111]
  ds_read_b128 a[204:207], v25 offset:2048
  buffer_load_dwordx4 v13, s[44:47], s69 offen offset:1024 lds
  v_mfma_f32_16x16x32_bf16 v[112:115], a[96:99], a[168:171], v[112:115]
  ds_read_b128 a[208:211], v25 offset:4096
  v_mfma_f32_16x16x32_bf16 v[116:119], a[100:103], a[168:171], v[116:119]
  ds_read_b128 a[212:215], v25 offset:6144
  v_mfma_f32_16x16x32_bf16 v[120:123], a[96:99], a[172:175], v[120:123]
  ds_read_b128 a[216:219], v25 offset:8192
  v_mfma_f32_16x16x32_bf16 v[124:127], a[100:103], a[172:175], v[124:127]
  ds_read_b128 a[220:223], v25 offset:10240
  buffer_load_dwordx4 v14, s[44:47], s69 offen offset:2048 lds
  v_mfma_f32_16x16x32_bf16 v[128:131], a[96:99], a[176:179], v[128:131]
  ds_read_b128 a[224:227], v25 offset:12288
  v_mfma_f32_16x16x32_bf16 v[132:135], a[100:103], a[176:179], v[132:135]
  ds_read_b128 a[228:231], v25 offset:14336
  v_mfma_f32_16x16x32_bf16 v[136:139], a[96:99], a[180:183], v[136:139]
  ds_read_b128 a[232:235], v25 offset:16384
  buffer_load_dwordx4 v15, s[44:47], s69 offen offset:3072 lds
  v_mfma_f32_16x16x32_bf16 v[140:143], a[100:103], a[180:183], v[140:143]
  ds_read_b128 a[236:239], v25 offset:18432
  s_add_u32 m0, s67, 57344
  v_mfma_f32_16x16x32_bf16 v[144:147], a[96:99], a[184:187], v[144:147]
  v_mfma_f32_16x16x32_bf16 v[148:151], a[100:103], a[184:187], v[148:151]
  v_mfma_f32_16x16x32_bf16 v[152:155], a[96:99], a[188:191], v[152:155]
  buffer_load_dwordx4 v16, s[44:47], s69 offen lds
  s_add_u32 s69, s69, 128
  v_mfma_f32_16x16x32_bf16 v[156:159], a[100:103], a[188:191], v[156:159]
  v_mfma_f32_16x16x32_bf16 v[160:163], a[96:99], a[192:195], v[160:163]
  v_mfma_f32_16x16x32_bf16 v[164:167], a[100:103], a[192:195], v[164:167]
  v_mfma_f32_16x16x32_bf16 v[168:171], a[96:99], a[196:199], v[168:171]
  v_mfma_f32_16x16x32_bf16 v[172:175], a[100:103], a[196:199], v[172:175]
  s_waitcnt vmcnt(22) lgkmcnt(0)
  s_barrier
  v_mfma_f32_16x16x32_bf16 v[96:99], a[104:107], a[200:203], v[96:99]
  ds_read_b128 a[112:115], v20 offset:36864
  s_add_u32 m0, s66, 73728
  v_mfma_f32_16x16x32_bf16 v[100:103], a[108:111], a[200:203], v[100:103]
  ds_read_b128 a[116:119], v20 offset:37376
  buffer_load_dwordx4 v8, s[40:43], s71 offen offset:0 lds
  v_mfma_f32_16x16x32_bf16 v[104:107], a[104:107], a[204:207], v[104:107]
  ds_read_b128 a[160:163], v24 offset:36864
  buffer_load_dwordx4 v9, s[40:43], s71 offen offset:1024 lds
  v_mfma_f32_16x16x32_bf16 v[108:111], a[108:111], a[204:207], v[108:111]
  ds_read_b128 a[164:167], v24 offset:38912
  v_mfma_f32_16x16x32_bf16 v[112:115], a[104:107], a[208:211], v[112:115]
  ds_read_b128 a[168:171], v24 offset:40960
  v_mfma_f32_16x16x32_bf16 v[116:119], a[108:111], a[208:211], v[116:119]
  ds_read_b128 a[172:175], v24 offset:43008
  buffer_load_dwordx4 v10, s[40:43], s71 offen offset:2048 lds
  v_mfma_f32_16x16x32_bf16 v[120:123], a[104:107], a[212:215], v[120:123]
  ds_read_b128 a[176:179], v24 offset:45056
  v_mfma_f32_16x16x32_bf16 v[124:127], a[108:111], a[212:215], v[124:127]
  ds_read_b128 a[180:183], v24 offset:47104
  v_mfma_f32_16x16x32_bf16 v[128:131], a[104:107], a[216:219], v[128:131]
  ds_read_b128 a[184:187], v24 offset:49152
  v_mfma_f32_16x16x32_bf16 v[132:135], a[108:111], a[216:219], v[132:135]
  ds_read_b128 a[188:191], v24 offset:51200
  buffer_load_dwordx4 v11, s[40:43], s71 offen offset:3072 lds
  v_mfma_f32_16x16x32_bf16 v[136:139], a[104:107], a[220:223], v[136:139]
  ds_read_b128 a[192:195], v24 offset:53248
  s_add_u32 s71, s71, 196608
  v_mfma_f32_16x16x32_bf16 v[140:143], a[108:111], a[220:223], v[140:143]
  ds_read_b128 a[196:199], v24 offset:55296
  s_cmp_eq_u32 s91, 9
  s_cselect_b32 s71, s88, s71
  v_mfma_f32_16x16x32_bf16 v[144:147], a[104:107], a[224:227], v[144:147]
  s_waitcnt vmcnt(22)
  v_xor_b32 v73, s64, v59
  v_xad_u32 v73, v63, s64, v73
  v_mfma_f32_16x16x32_bf16 v[148:151], a[108:111], a[224:227], v[148:151]
  v_xad_u32 v73, v209, s64, v73
  v_xad_u32 v73, v211, s64, v73
  v_mfma_f32_16x16x32_bf16 v[152:155], a[104:107], a[228:231], v[152:155]
  v_xad_u32 v73, v213, s64, v73
  v_xad_u32 v73, v215, s64, v73
  v_mfma_f32_16x16x32_bf16 v[156:159], a[108:111], a[228:231], v[156:159]
  v_cmp_ne_u32 vcc, 0, v73
  s_cbranch_vccnz O_slow1
O_ok1:
  v_mfma_f32_16x16x32_bf16 v[160:163], a[104:107], a[232:235], v[160:163]
  s_add_u32 m0, s66, 90112
  s_nop 0
  buffer_load_dwordx4 v8, s[40:43], s71 offen offset:0 lds
  v_mfma_f32_16x16x32_bf16 v[164:167], a[108:111], a[232:235], v[164:167]
  buffer_load_dwordx4 v9, s[40:43], s71 offen offset:1024 lds
  v_mfma_f32_16x16x32_bf16 v[168:171], a[104:107], a[236:239], v[168:171]
  v_mfma_f32_16x16x32_bf16 v[172:175], a[108:111], a[236:239], v[172:175]
  s_waitcnt lgkmcnt(0)
  ds_write2_b32 v206, v208, v210 offset0:64 offset1:65
  ds_write2_b32 v206, v212, v214 offset0:72 offset1:73
  v_mfma_f32_16x16x32_bf16 v[96:99], a[112:115], a[160:163], v[96:99]
  ds_read_b128 a[120:123], v21 offset:36864
  buffer_load_dwordx4 v10, s[40:43], s71 offen offset:2048 lds
  v_xor_b32 v59, s39, v57
  v_mfma_f32_16x16x32_bf16 v[100:103], a[116:119], a[160:163], v[100:103]
  ds_read_b128 a[124:127], v21 offset:37376
  ds_write2_b32 v236, v56, v59 offset0:0 offset1:32
  v_xor_b32 v63, s39, v61
  v_mfma_f32_16x16x32_bf16 v[104:107], a[112:115], a[164:167], v[104:107]
  ds_read_b128 a[200:203], v25 offset:36864
  ds_write2_b32 v236, v60, v63 offset0:4 offset1:36
  ds_read_b128 v[216:219], v207 offset:256
  v_mfma_f32_16x16x32_bf16 v[108:111], a[116:119], a[164:167], v[108:111]
  ds_read_b128 a[204:207], v25 offset:38912
  ds_read_b128 v[220:223], v207 offset:272
  ds_read_b64 v[224:225], v207 offset:288
  v_mfma_f32_16x16x32_bf16 v[112:115], a[112:115], a[168:171], v[112:115]
  ds_read_b128 a[208:211], v25 offset:40960
  buffer_load_dwordx4 v11, s[40:43], s71 offen offset:3072 lds
  ds_read_b128 v[228:231], v237 offset:0
  v_mfma_f32_16x16x32_bf16 v[116:119], a[116:119], a[168:171], v[116:119]
  ds_read_b128 a[212:215], v25 offset:43008
  s_add_u32 s71, s71, 196608
  ds_read_b128 v[232:235], v237 offset:16
  v_mfma_f32_16x16x32_bf16 v[120:123], a[112:115], a[172:175], v[120:123]
  ds_read_b128 a[216:219], v25 offset:45056
  s_cmp_eq_u32 s91, 8
  s_cselect_b32 s71, s88, s71
  v_mfma_f32_16x16x32_bf16 v[124:127], a[116:119], a[172:175], v[124:127]
  ds_read_b128 a[220:223], v25 offset:47104
  ds_read_b128 v[240:243], v237 offset:128
  ds_read_b128 v[244:247], v237 offset:144
  v_mfma_f32_16x16x32_bf16 v[128:131], a[112:115], a[176:179], v[128:131]
  ds_read_b128 a[224:227], v25 offset:49152
  v_mul_f32 v64, 0x3e800000, v56
  s_waitcnt lgkmcnt(13)
  v_mul_f32 v59, v57, v57
  v_mfma_f32_16x16x32_bf16 v[132:135], a[116:119], a[176:179], v[132:135]
  ds_read_b128 a[228:231], v25 offset:51200
  v_cvt_pk_bf16_f32 v64, v64, v64
  v_mul_f32 v57, 0xc0135761, v57
  v_mfma_f32_16x16x32_bf16 v[136:139], a[112:115], a[180:183], v[136:139]
  ds_read_b128 a[232:235], v25 offset:53248
  v_mul_f32 v59, 0x3d372713, v59
  v_mov_b32 v65, v64
  v_mfma_f32_16x16x32_bf16 v[140:143], a[116:119], a[180:183], v[140:143]
  ds_read_b128 a[236:239], v25 offset:55296
  v_mul_f32 v59, v59, v57
  v_mul_f32 v66, 0x3e800000, v60
  v_mfma_f32_16x16x32_bf16 v[144:147], a[112:115], a[184:187], v[144:147]
  v_mul_f32 v63, v61, v61
  v_cvt_pk_bf16_f32 v66, v66, v66
  v_mul_f32 v61, 0xc0135761, v61
  v_mfma_f32_16x16x32_bf16 v[148:151], a[116:119], a[184:187], v[148:151]
  v_mul_f32 v63, 0x3d372713, v63
  v_mov_b32 v67, v66
  v_mul_f32 v63, v63, v61
  v_mfma_f32_16x16x32_bf16 v[152:155], a[112:115], a[188:191], v[152:155]
  v_mfma_f32_16x16x32_bf16 v[156:159], a[116:119], a[188:191], v[156:159]
  v_mfma_f32_16x16x32_bf16 v[160:163], a[112:115], a[192:195], v[160:163]
  v_mfma_f32_16x16x32_bf16 v[164:167], a[116:119], a[192:195], v[164:167]
  v_mfma_f32_16x16x32_bf16 v[168:171], a[112:115], a[196:199], v[168:171]
  v_mfma_f32_16x16x32_bf16 v[172:175], a[116:119], a[196:199], v[172:175]
  s_waitcnt vmcnt(17) lgkmcnt(0)
  s_barrier
  v_mfma_f32_16x16x32_bf16 v[96:99], a[120:123], a[200:203], v[96:99]
  ds_read_b128 a[128:131], v18 offset:0
  s_add_u32 m0, s66, 110592
  v_fmac_f32 v144, v228, v222
  v_mfma_f32_16x16x32_bf16 v[100:103], a[124:127], a[200:203], v[100:103]
  ds_read_b128 a[132:135], v18 offset:512
  buffer_load_dwordx4 v8, s[40:43], s71 offen offset:0 lds
  v_fmac_f32 v145, v229, v222
  v_mfma_f32_16x16x32_bf16 v[104:107], a[120:123], a[204:207], v[104:107]
  ds_read_b128 a[160:163], v22 offset:0
  buffer_load_dwordx4 v9, s[40:43], s71 offen offset:1024 lds
  v_fmac_f32 v146, v230, v222
  v_mfma_f32_16x16x32_bf16 v[108:111], a[124:127], a[204:207], v[108:111]
  ds_read_b128 a[164:167], v22 offset:2048
  v_fmac_f32 v147, v231, v222
  v_fmac_f32 v160, v228, v224
  v_mfma_f32_16x16x32_bf16 v[112:115], a[120:123], a[208:211], v[112:115]
  ds_read_b128 a[168:171], v22 offset:4096
  v_fmac_f32 v96, v228, v216
  v_fmac_f32 v161, v229, v224
  v_mfma_f32_16x16x32_bf16 v[116:119], a[124:127], a[208:211], v[116:119]
  ds_read_b128 a[172:175], v22 offset:6144
  buffer_load_dwordx4 v10, s[40:43], s71 offen offset:2048 lds
  v_fmac_f32 v162, v230, v224
  v_mfma_f32_16x16x32_bf16 v[120:123], a[120:123], a[212:215], v[120:123]
  ds_read_b128 a[176:179], v22 offset:8192
  v_fmac_f32 v97, v229, v216
  v_fmac_f32 v163, v231, v224
  v_mfma_f32_16x16x32_bf16 v[124:127], a[124:127], a[212:215], v[124:127]
  ds_read_b128 a[180:183], v22 offset:10240
  v_fmac_f32 v98, v230, v216
  v_mfma_f32_16x16x32_bf16 v[128:131], a[120:123], a[216:219], v[128:131]
  ds_read_b128 a[184:187], v22 offset:12288
  v_fmac_f32 v99, v231, v216
  v_mfma_f32_16x16x32_bf16 v[132:135], a[124:127], a[216:219], v[132:135]
  ds_read_b128 a[188:191], v22 offset:14336
  buffer_load_dwordx4 v11, s[40:43], s71 offen offset:3072 lds
  v_mfma_f32_16x16x32_bf16 v[136:139], a[120:123], a[220:223], v[136:139]
  ds_read_b128 a[192:195], v22 offset:16384
  s_add_u32 s71, s71, 196608
  v_mfma_f32_16x16x32_bf16 v[140:143], a[124:127], a[220:223], v[140:143]
  ds_read_b128 a[196:199], v22 offset:18432
  s_cmp_eq_u32 s91, 7
  s_cselect_b32 s71, s88, s71
  v_mfma_f32_16x16x32_bf16 v[144:147], a[120:123], a[224:227], v[144:147]
  s_add_u32 m0, s66, 126976
  s_nop 0
  buffer_load_dwordx4 v8, s[40:43], s71 offen offset:0 lds
  v_mfma_f32_16x16x32_bf16 v[148:151], a[124:127], a[224:227], v[148:151]
  v_fmac_f32 v112, v228, v218
  v_fmac_f32 v113, v229, v218
  v_mfma_f32_16x16x32_bf16 v[152:155], a[120:123], a[228:231], v[152:155]
  v_fmac_f32 v114, v230, v218
  v_fmac_f32 v115, v231, v218
  v_mfma_f32_16x16x32_bf16 v[156:159], a[124:127], a[228:231], v[156:159]
  v_fmac_f32 v128, v228, v220
  v_fmac_f32 v129, v229, v220
  v_mfma_f32_16x16x32_bf16 v[160:163], a[120:123], a[232:235], v[160:163]
  buffer_load_dwordx4 v9, s[40:43], s71 offen offset:1024 lds
  v_fmac_f32 v130, v230, v220
  v_mfma_f32_16x16x32_bf16 v[164:167], a[124:127], a[232:235], v[164:167]
  v_fmac_f32 v131, v231, v220
  v_mfma_f32_16x16x32_bf16 v[168:171], a[120:123], a[236:239], v[168:171]
  v_mfma_f32_16x16x32_bf16 v[172:175], a[124:127], a[236:239], v[172:175]
  s_waitcnt lgkmcnt(0)
  buffer_load_dwordx4 v10, s[40:43], s71 offen offset:2048 lds
  v_mfma_f32_16x16x32_bf16 v[96:99], a[128:131], a[160:163], v[96:99]
  ds_read_b128 a[136:139], v19 offset:0
  v_fmac_f32 v148, v232, v222
  v_fmac_f32 v149, v233, v222
  v_mfma_f32_16x16x32_bf16 v[100:103], a[132:135], a[160:163], v[100:103]
  ds_read_b128 a[140:143], v19 offset:512
  v_fmac_f32 v150, v234, v222
  v_fmac_f32 v151, v235, v222
  v_mfma_f32_16x16x32_bf16 v[104:107], a[128:131], a[164:167], v[104:107]
  ds_read_b128 a[200:203], v23 offset:0
  v_mfma_f32_16x16x32_bf16 v[108:111], a[132:135], a[164:167], v[108:111]
  ds_read_b128 a[204:207], v23 offset:2048
  buffer_load_dwordx4 v11, s[40:43], s71 offen offset:3072 lds
  v_fmac_f32 v164, v232, v224
  v_mfma_f32_16x16x32_bf16 v[112:115], a[128:131], a[168:171], v[112:115]
  ds_read_b128 a[208:211], v23 offset:4096
  s_add_u32 s71, s71, 196608
  v_fmac_f32 v165, v233, v224
  v_mfma_f32_16x16x32_bf16 v[116:119], a[132:135], a[168:171], v[116:119]
  ds_read_b128 a[212:215], v23 offset:6144
  s_cmp_eq_u32 s91, 6
  s_cselect_b32 s71, s88, s71
  v_mfma_f32_16x16x32_bf16 v[120:123], a[128:131], a[172:175], v[120:123]
  ds_read_b128 a[216:219], v23 offset:8192
  v_fmac_f32 v100, v232, v216
  v_fmac_f32 v166, v234, v224
  v_mfma_f32_16x16x32_bf16 v[124:127], a[132:135], a[172:175], v[124:127]
  ds_read_b128 a[220:223], v23 offset:10240
  v_fmac_f32 v101, v233, v216
  v_fmac_f32 v167, v235, v224
  v_mfma_f32_16x16x32_bf16 v[128:131], a[128:131], a[176:179], v[128:131]
  ds_read_b128 a[224:227], v23 offset:12288
  v_fmac_f32 v102, v234, v216
  v_mfma_f32_16x16x32_bf16 v[132:135], a[132:135], a[176:179], v[132:135]
  ds_read_b128 a[228:231], v23 offset:14336
  v_fmac_f32 v103, v235, v216
  v_mfma_f32_16x16x32_bf16 v[136:139], a[128:131], a[180:183], v[136:139]
  ds_read_b128 a[232:235], v23 offset:16384
  v_fmac_f32 v116, v232, v218
  v_mfma_f32_16x16x32_bf16 v[140:143], a[132:135], a[180:183], v[140:143]
  ds_read_b128 a[236:239], v23 offset:18432
  v_fmac_f32 v117, v233, v218
  v_mfma_f32_16x16x32_bf16 v[144:147], a[128:131], a[184:187], v[144:147]
  v_fmac_f32 v118, v234, v218
  v_fmac_f32 v119, v235, v218
  v_mfma_f32_16x16x32_bf16 v[148:151], a[132:135], a[184:187], v[148:151]
  v_fmac_f32 v132, v232, v220
  v_fmac_f32 v133, v233, v220
  v_mfma_f32_16x16x32_bf16 v[152:155], a[128:131], a[188:191], v[152:155]
  v_fmac_f32 v134, v234, v220
  v_fmac_f32 v135, v235, v220
  v_mfma_f32_16x16x32_bf16 v[156:159], a[132:135], a[188:191], v[156:159]
  v_mfma_f32_16x16x32_bf16 v[160:163], a[128:131], a[192:195], v[160:163]
  v_mfma_f32_16x16x32_bf16 v[164:167], a[132:135], a[192:195], v[164:167]
  v_mfma_f32_16x16x32_bf16 v[168:171], a[128:131], a[196:199], v[168:171]
  v_mfma_f32_16x16x32_bf16 v[172:175], a[132:135], a[196:199], v[172:175]
  s_waitcnt vmcnt(16) lgkmcnt(0)
  s_barrier
  v_mfma_f32_16x16x32_bf16 v[96:99], a[136:139], a[200:203], v[96:99]
  ds_read_b128 a[144:147], v18 offset:36864
  s_add_u32 m0, s66, 0
  v_fmac_f32 v136, v228, v221
  v_mfma_f32_16x16x32_bf16 v[100:103], a[140:143], a[200:203], v[100:103]
  ds_read_b128 a[148:151], v18 offset:37376
  buffer_load_dwordx4 v8, s[40:43], s71 offen offset:0 lds
  v_fmac_f32 v137, v229, v221
  v_mfma_f32_16x16x32_bf16 v[104:107], a[136:139], a[204:207], v[104:107]
  ds_read_b128 a[160:163], v22 offset:36864
  buffer_load_dwordx4 v9, s[40:43], s71 offen offset:1024 lds
  v_fmac_f32 v138, v230, v221
  v_mfma_f32_16x16x32_bf16 v[108:111], a[140:143], a[204:207], v[108:111]
  ds_read_b128 a[164:167], v22 offset:38912
  v_fmac_f32 v139, v231, v221
  v_fmac_f32 v152, v228, v223
  v_mfma_f32_16x16x32_bf16 v[112:115], a[136:139], a[208:211], v[112:115]
  ds_read_b128 a[168:171], v22 offset:40960
  v_fmac_f32 v153, v229, v223
  v_fmac_f32 v154, v230, v223
  v_mfma_f32_16x16x32_bf16 v[116:119], a[140:143], a[208:211], v[116:119]
  ds_read_b128 a[172:175], v22 offset:43008
  buffer_load_dwordx4 v10, s[40:43], s71 offen offset:2048 lds
  v_fmac_f32 v155, v231, v223
  v_mfma_f32_16x16x32_bf16 v[120:123], a[136:139], a[212:215], v[120:123]
  ds_read_b128 a[176:179], v22 offset:45056
  v_fmac_f32 v104, v228, v217
  v_fmac_f32 v168, v228, v225
  v_mfma_f32_16x16x32_bf16 v[124:127], a[140:143], a[212:215], v[124:127]
  ds_read_b128 a[180:183], v22 offset:47104
  v_fmac_f32 v105, v229, v217
  v_fmac_f32 v169, v229, v225
  v_mfma_f32_16x16x32_bf16 v[128:131], a[136:139], a[216:219], v[128:131]
  ds_read_b128 a[184:187], v22 offset:49152
  v_fmac_f32 v106, v230, v217
  v_fmac_f32 v170, v230, v225
  v_mfma_f32_16x16x32_bf16 v[132:135], a[140:143], a[216:219], v[132:135]
  ds_read_b128 a[188:191], v22 offset:51200
  buffer_load_dwordx4 v11, s[40:43], s71 offen offset:3072 lds
  v_fmac_f32 v171, v231, v225
  v_mfma_f32_16x16x32_bf16 v[136:139], a[136:139], a[220:223], v[136:139]
  ds_read_b128 a[192:195], v22 offset:53248
  s_add_u32 s71, s71, 196608
  v_mfma_f32_16x16x32_bf16 v[140:143], a[140:143], a[220:223], v[140:143]
  ds_read_b128 a[196:199], v22 offset:55296
  s_cmp_eq_u32 s91, 5
  s_cselect_b32 s71, s88, s71
  v_mfma_f32_16x16x32_bf16 v[144:147], a[136:139], a[224:227], v[144:147]
  s_add_u32 m0, s66, 16384
  s_nop 0
  buffer_load_dwordx4 v8, s[40:43], s71 offen offset:0 lds
  v_mfma_f32_16x16x32_bf16 v[148:151], a[140:143], a[224:227], v[148:151]
  v_fmac_f32 v107, v231, v217
  v_fmac_f32 v120, v228, v219
  v_mfma_f32_16x16x32_bf16 v[152:155], a[136:139], a[228:231], v[152:155]
  v_fmac_f32 v121, v229, v219
  v_fmac_f32 v122, v230, v219
  v_mfma_f32_16x16x32_bf16 v[156:159], a[140:143], a[228:231], v[156:159]
  v_fmac_f32 v123, v231, v219
  v_mfma_f32_16x16x32_bf16 v[160:163], a[136:139], a[232:235], v[160:163]
  buffer_load_dwordx4 v9, s[40:43], s71 offen offset:1024 lds
  v_mfma_f32_16x16x32_bf16 v[164:167], a[140:143], a[232:235], v[164:167]
  v_mfma_f32_16x16x32_bf16 v[168:171], a[136:139], a[236:239], v[168:171]
  v_mfma_f32_16x16x32_bf16 v[172:175], a[140:143], a[236:239], v[172:175]
  s_waitcnt lgkmcnt(0)
  buffer_load_dwordx4 v10, s[40:43], s71 offen offset:2048 lds
  v_mfma_f32_16x16x32_bf16 v[96:99], a[144:147], a[160:163], v[96:99]
  ds_read_b128 a[152:155], v19 offset:36864
  v_fmac_f32 v140, v232, v221
  v_mfma_f32_16x16x32_bf16 v[100:103], a[148:151], a[160:163], v[100:103]
  ds_read_b128 a[156:159], v19 offset:37376
  v_fmac_f32 v141, v233, v221
  v_fmac_f32 v156, v232, v223
  v_mfma_f32_16x16x32_bf16 v[104:107], a[144:147], a[164:167], v[104:107]
  ds_read_b128 a[200:203], v23 offset:36864
  v_fmac_f32 v142, v234, v221
  v_fmac_f32 v157, v233, v223
  v_mfma_f32_16x16x32_bf16 v[108:111], a[148:151], a[164:167], v[108:111]
  ds_read_b128 a[204:207], v23 offset:38912
  buffer_load_dwordx4 v11, s[40:43], s71 offen offset:3072 lds
  v_fmac_f32 v158, v234, v223
  v_mfma_f32_16x16x32_bf16 v[112:115], a[144:147], a[168:171], v[112:115]
  ds_read_b128 a[208:211], v23 offset:40960
  s_add_u32 s71, s71, 196608
  v_fmac_f32 v159, v235, v223
  v_mfma_f32_16x16x32_bf16 v[116:119], a[148:151], a[168:171], v[116:119]
  ds_read_b128 a[212:215], v23 offset:43008
  s_cmp_eq_u32 s91, 4
  s_cselect_b32 s71, s88, s71
  v_mfma_f32_16x16x32_bf16 v[120:123], a[144:147], a[172:175], v[120:123]
  ds_read_b128 a[216:219], v23 offset:45056
  v_fmac_f32 v143, v235, v221
  v_mfma_f32_16x16x32_bf16 v[124:127], a[148:151], a[172:175], v[124:127]
  ds_read_b128 a[220:223], v23 offset:47104
  v_fmac_f32 v108, v232, v217
  v_mfma_f32_16x16x32_bf16 v[128:131], a[144:147], a[176:179], v[128:131]
  ds_read_b128 a[224:227], v23 offset:49152
  v_fmac_f32 v109, v233, v217
  v_mfma_f32_16x16x32_bf16 v[132:135], a[148:151], a[176:179], v[132:135]
  ds_read_b128 a[228:231], v23 offset:51200
  v_fmac_f32 v110, v234, v217
  v_mfma_f32_16x16x32_bf16 v[136:139], a[144:147], a[180:183], v[136:139]
  ds_read_b128 a[232:235], v23 offset:53248
  v_fmac_f32 v111, v235, v217
  v_mfma_f32_16x16x32_bf16 v[140:143], a[148:151], a[180:183], v[140:143]
  ds_read_b128 a[236:239], v23 offset:55296
  v_fmac_f32 v124, v232, v219
  v_mfma_f32_16x16x32_bf16 v[144:147], a[144:147], a[184:187], v[144:147]
  v_fmac_f32 v125, v233, v219
  v_fmac_f32 v126, v234, v219
  v_mfma_f32_16x16x32_bf16 v[148:151], a[148:151], a[184:187], v[148:151]
  v_fmac_f32 v127, v235, v219
  v_fmac_f32 v172, v232, v225
  v_mfma_f32_16x16x32_bf16 v[152:155], a[144:147], a[188:191], v[152:155]
  v_fmac_f32 v173, v233, v225
  v_fmac_f32 v174, v234, v225
  v_mfma_f32_16x16x32_bf16 v[156:159], a[148:151], a[188:191], v[156:159]
  v_fmac_f32 v175, v235, v225
  v_mfma_f32_16x16x32_bf16 v[160:163], a[144:147], a[192:195], v[160:163]
  v_mfma_f32_16x16x32_bf16 v[164:167], a[148:151], a[192:195], v[164:167]
  v_mfma_f32_16x16x32_bf16 v[168:171], a[144:147], a[196:199], v[168:171]
  v_mfma_f32_16x16x32_bf16 v[172:175], a[148:151], a[196:199], v[172:175]
  s_waitcnt vmcnt(16) lgkmcnt(0)
  s_barrier
  v_mfma_f32_16x16x32_bf16 v[96:99], a[152:155], a[200:203], v[96:99]
  ds_read_b64_tr_b16 a[160:161], v34 offset:0
  buffer_load_dword v73, v90, s[8:11], s32 offen sc1
  v_mfma_f32_16x16x32_bf16 v[100:103], a[156:159], a[200:203], v[100:103]
  ds_read_b64_tr_b16 a[162:163], v34 offset:512
  s_add_u32 m0, s66, 36864
  v_mfma_f32_16x16x32_bf16 v[104:107], a[152:155], a[204:207], v[104:107]
  ds_read_b64_tr_b16 a[164:165], v35 offset:0
  buffer_load_dwordx4 v8, s[40:43], s71 offen offset:0 lds
  v_mfma_f32_16x16x32_bf16 v[108:111], a[156:159], a[204:207], v[108:111]
  ds_read_b64_tr_b16 a[166:167], v35 offset:512
  buffer_load_dwordx4 v9, s[40:43], s71 offen offset:1024 lds
  v_mfma_f32_16x16x32_bf16 v[112:115], a[152:155], a[208:211], v[112:115]
  ds_read_b64_tr_b16 a[176:177], v34 offset:8192
  v_mul_f32 v96, v96, v240
  v_mul_f32 v97, v97, v241
  v_mfma_f32_16x16x32_bf16 v[116:119], a[156:159], a[208:211], v[116:119]
  ds_read_b64_tr_b16 a[178:179], v34 offset:8704
  v_mul_f32 v98, v98, v242
  v_mfma_f32_16x16x32_bf16 v[120:123], a[152:155], a[212:215], v[120:123]
  ds_read_b64_tr_b16 a[180:181], v35 offset:8192
  buffer_load_dwordx4 v10, s[40:43], s71 offen offset:2048 lds
  v_mul_f32 v99, v99, v243
  v_mfma_f32_16x16x32_bf16 v[124:127], a[156:159], a[212:215], v[124:127]
  ds_read_b64_tr_b16 a[182:183], v35 offset:8704
  v_mul_f32 v100, v100, v244
  v_mul_f32 v101, v101, v245
  v_mfma_f32_16x16x32_bf16 v[128:131], a[152:155], a[216:219], v[128:131]
  ds_read_b64_tr_b16 a[168:169], v36 offset:0
  v_mul_f32 v102, v102, v246
  v_mfma_f32_16x16x32_bf16 v[132:135], a[156:159], a[216:219], v[132:135]
  ds_read_b64_tr_b16 a[170:171], v36 offset:512
  v_mul_f32 v103, v103, v247
  v_cvt_pk_bf16_f32 v96, v96, v97
  v_mfma_f32_16x16x32_bf16 v[136:139], a[152:155], a[220:223], v[136:139]
  ds_read_b64_tr_b16 a[172:173], v37 offset:0
  buffer_load_dwordx4 v11, s[40:43], s71 offen offset:3072 lds
  v_mfma_f32_16x16x32_bf16 v[140:143], a[156:159], a[220:223], v[140:143]
  ds_read_b64_tr_b16 a[174:175], v37 offset:512
  s_add_u32 s71, s71, 196608
  v_cvt_pk_bf16_f32 v97, v98, v99
  v_mfma_f32_16x16x32_bf16 v[144:147], a[152:155], a[224:227], v[144:147]
  ds_read_b64_tr_b16 a[184:185], v36 offset:8192
  s_cmp_eq_u32 s91, 3
  s_cselect_b32 s71, s88, s71
  v_mfma_f32_16x16x32_bf16 v[148:151], a[156:159], a[224:227], v[148:151]
  ds_read_b64_tr_b16 a[186:187], v36 offset:8704
  buffer_load_dwordx2 v[4:5], v74, s[12:15], s80 offen offset:0
  v_cvt_pk_bf16_f32 v98, v100, v101
  v_mfma_f32_16x16x32_bf16 v[152:155], a[152:155], a[228:231], v[152:155]
  ds_read_b64_tr_b16 a[188:189], v37 offset:8192
  v_cvt_pk_bf16_f32 v99, v102, v103
  v_mul_f32 v104, v104, v240
  v_mfma_f32_16x16x32_bf16 v[156:159], a[156:159], a[228:231], v[156:159]
  ds_read_b64_tr_b16 a[190:191], v37 offset:8704
  v_mul_f32 v105, v105, v241
  v_mfma_f32_16x16x32_bf16 v[160:163], a[152:155], a[232:235], v[160:163]
  v_mul_f32 v106, v106, v242
  v_mul_f32 v107, v107, v243
  v_mul_f32 v108, v108, v244
  v_mfma_f32_16x16x32_bf16 v[164:167], a[156:159], a[232:235], v[164:167]
  v_mul_f32 v109, v109, v245
  v_mul_f32 v110, v110, v246
  v_mfma_f32_16x16x32_bf16 v[168:171], a[152:155], a[236:239], v[168:171]
  v_mul_f32 v111, v111, v247
  v_cvt_pk_bf16_f32 v104, v104, v105
  v_cvt_pk_bf16_f32 v105, v106, v107
  v_mfma_f32_16x16x32_bf16 v[172:175], a[156:159], a[236:239], v[172:175]
  s_waitcnt lgkmcnt(0)
  v_cvt_pk_bf16_f32 v106, v108, v109
  v_mfma_f32_16x16x32_bf16 v[176:179], a[160:163], a[0:3], 0
  ds_read_b64_tr_b16 a[200:201], v38 offset:0
  buffer_load_dwordx2 v[6:7], v74, s[12:15], s80 offen offset:32
  v_cvt_pk_bf16_f32 v107, v110, v111
  v_mfma_f32_16x16x32_bf16 v[180:183], a[160:163], a[4:7], 0
  ds_read_b64_tr_b16 a[202:203], v38 offset:512
  v_mul_f32 v112, v112, v240
  v_mul_f32 v113, v113, v241
  v_mfma_f32_16x16x32_bf16 v[20:23], a[240:243], a[160:163], 0
  ds_read_b64_tr_b16 a[204:205], v39 offset:0
  v_mul_f32 v114, v114, v242
  v_mfma_f32_16x16x32_bf16 v[184:187], a[164:167], a[0:3], 0
  ds_read_b64_tr_b16 a[206:207], v39 offset:512
  v_mul_f32 v115, v115, v243
  v_mul_f32 v116, v116, v244
  v_mfma_f32_16x16x32_bf16 v[188:191], a[164:167], a[4:7], 0
  ds_read_b64_tr_b16 a[216:217], v38 offset:8192
  v_mul_f32 v117, v117, v245
  v_mfma_f32_16x16x32_bf16 v[20:23], a[244:247], a[164:167], v[20:23]
  ds_read_b64_tr_b16 a[218:219], v38 offset:8704
  v_mul_f32 v118, v118, v246
  v_mfma_f32_16x16x32_bf16 v[208:211], a[176:179], a[0:3], 0
  ds_read_b64_tr_b16 a[220:221], v39 offset:8192
  v_mul_f32 v119, v119, v247
  v_cvt_pk_bf16_f32 v112, v112, v113
  v_mfma_f32_16x16x32_bf16 v[212:215], a[176:179], a[4:7], 0
  ds_read_b64_tr_b16 a[222:223], v39 offset:8704
  buffer_load_dwordx2 v[12:13], v74, s[12:15], s80 offen offset:64
  v_mfma_f32_16x16x32_bf16 v[20:23], a[248:251], a[176:179], v[20:23]
  ds_read_b64_tr_b16 a[208:209], v40 offset:0
  v_cvt_pk_bf16_f32 v113, v114, v115
  v_cvt_pk_bf16_f32 v114, v116, v117
  v_mfma_f32_16x16x32_bf16 v[216:219], a[180:183], a[0:3], 0
  ds_read_b64_tr_b16 a[210:211], v40 offset:512
  v_cvt_pk_bf16_f32 v115, v118, v119
  v_mfma_f32_16x16x32_bf16 v[220:223], a[180:183], a[4:7], 0
  ds_read_b64_tr_b16 a[212:213], v41 offset:0
  v_mul_f32 v120, v120, v240
  v_mul_f32 v121, v121, v241
  v_mfma_f32_16x16x32_bf16 v[20:23], a[252:255], a[180:183], v[20:23]
  ds_read_b64_tr_b16 a[214:215], v41 offset:512
  v_mul_f32 v122, v122, v242
  v_mfma_f32_16x16x32_bf16 v[192:195], a[168:171], a[0:3], 0
  ds_read_b64_tr_b16 a[224:225], v40 offset:8192
  v_mul_f32 v123, v123, v243
  v_mfma_f32_16x16x32_bf16 v[196:199], a[168:171], a[4:7], 0
  ds_read_b64_tr_b16 a[226:227], v40 offset:8704
  v_mul_f32 v124, v124, v244
  v_mul_f32 v125, v125, v245
  v_mfma_f32_16x16x32_bf16 v[200:203], a[172:175], a[0:3], 0
  ds_read_b64_tr_b16 a[228:229], v41 offset:8192
  v_mul_f32 v126, v126, v246
  v_mfma_f32_16x16x32_bf16 v[204:207], a[172:175], a[4:7], 0
  ds_read_b64_tr_b16 a[230:231], v41 offset:8704
  buffer_load_dwordx2 v[14:15], v74, s[12:15], s80 offen offset:96
  v_mul_f32 v127, v127, v247
  v_mfma_f32_16x16x32_bf16 v[224:227], a[184:187], a[0:3], 0
  v_cvt_pk_bf16_f32 v120, v120, v121
  v_cvt_pk_bf16_f32 v121, v122, v123
  v_mfma_f32_16x16x32_bf16 v[228:231], a[184:187], a[4:7], 0
  v_cvt_pk_bf16_f32 v122, v124, v125
  v_cvt_pk_bf16_f32 v123, v126, v127
  v_mfma_f32_16x16x32_bf16 v[232:235], a[188:191], a[0:3], 0
  v_mul_f32 v128, v128, v240
  v_mul_f32 v129, v129, v241
  v_mul_f32 v130, v130, v242
  v_mfma_f32_16x16x32_bf16 v[236:239], a[188:191], a[4:7], 0
  s_waitcnt lgkmcnt(0)
  v_mul_f32 v131, v131, v243
  v_mfma_f32_16x16x32_bf16 v[176:179], a[200:203], a[8:11], v[176:179]
  ds_read_b64_tr_b16 a[160:161], v34 offset:16384
  ds_read_b64_tr_b16 a[162:163], v34 offset:16896
  v_mul_f32 v132, v132, v244
  v_mfma_f32_16x16x32_bf16 v[180:183], a[200:203], a[12:15], v[180:183]
  ds_read_b64_tr_b16 a[164:165], v35 offset:16384
  v_mul_f32 v133, v133, v245
  v_mfma_f32_16x16x32_bf16 v[184:187], a[204:207], a[8:11], v[184:187]
  ds_read_b64_tr_b16 a[166:167], v35 offset:16896
  buffer_load_dwordx2 v[18:19], v74, s[12:15], s80 offen offset:128
  v_mul_f32 v134, v134, v246
  v_mfma_f32_16x16x32_bf16 v[188:191], a[204:207], a[12:15], v[188:191]
  ds_read_b64_tr_b16 a[176:177], v34 offset:24576
  ds_read_b64_tr_b16 a[178:179], v34 offset:25088
  v_mfma_f32_16x16x32_bf16 v[208:211], a[216:219], a[8:11], v[208:211]
  ds_read_b64_tr_b16 a[180:181], v35 offset:24576
  v_mul_f32 v135, v135, v247
  v_cvt_pk_bf16_f32 v128, v128, v129
  v_mfma_f32_16x16x32_bf16 v[212:215], a[216:219], a[12:15], v[212:215]
  ds_read_b64_tr_b16 a[182:183], v35 offset:25088
  v_cvt_pk_bf16_f32 v129, v130, v131
  v_mfma_f32_16x16x32_bf16 v[216:219], a[220:223], a[8:11], v[216:219]
  ds_read_b64_tr_b16 a[168:169], v36 offset:16384
  ds_read_b64_tr_b16 a[170:171], v36 offset:16896
  v_cvt_pk_bf16_f32 v130, v132, v133
  v_mfma_f32_16x16x32_bf16 v[220:223], a[220:223], a[12:15], v[220:223]
  ds_read_b64_tr_b16 a[172:173], v37 offset:16384
  v_cvt_pk_bf16_f32 v131, v134, v135
  v_mfma_f32_16x16x32_bf16 v[192:195], a[208:211], a[8:11], v[192:195]
  ds_read_b64_tr_b16 a[174:175], v37 offset:16896
  v_mul_f32 v136, v136, v240
  v_mul_f32 v137, v137, v241
  v_mfma_f32_16x16x32_bf16 v[196:199], a[208:211], a[12:15], v[196:199]
  ds_read_b64_tr_b16 a[184:185], v36 offset:24576
  ds_read_b64_tr_b16 a[186:187], v36 offset:25088
  v_mfma_f32_16x16x32_bf16 v[200:203], a[212:215], a[8:11], v[200:203]
  ds_read_b64_tr_b16 a[188:189], v37 offset:24576
  buffer_store_dwordx4 v[96:99], v1, s[8:11], s24 offen offset:0 sc1
  v_mul_f32 v138, v138, v242
  v_mfma_f32_16x16x32_bf16 v[204:207], a[212:215], a[12:15], v[204:207]
  ds_read_b64_tr_b16 a[190:191], v37 offset:25088
  v_mul_f32 v139, v139, v243
  v_mfma_f32_16x16x32_bf16 v[224:227], a[224:227], a[8:11], v[224:227]
  v_mul_f32 v140, v140, v244
  v_mul_f32 v141, v141, v245
  v_mul_f32 v142, v142, v246
  v_mfma_f32_16x16x32_bf16 v[228:231], a[224:227], a[12:15], v[228:231]
  buffer_store_dwordx4 v[104:107], v1, s[8:11], s24 offen offset:1024 sc1
  v_mul_f32 v143, v143, v247
  v_mfma_f32_16x16x32_bf16 v[232:235], a[228:231], a[8:11], v[232:235]
  v_cvt_pk_bf16_f32 v136, v136, v137
  v_cvt_pk_bf16_f32 v137, v138, v139
  v_cvt_pk_bf16_f32 v138, v140, v141
  v_mfma_f32_16x16x32_bf16 v[236:239], a[228:231], a[12:15], v[236:239]
  s_waitcnt lgkmcnt(0)
  v_cvt_pk_bf16_f32 v139, v142, v143
  v_mfma_f32_16x16x32_bf16 v[176:179], a[160:163], a[16:19], v[176:179]
  ds_read_b64_tr_b16 a[200:201], v38 offset:16384
  buffer_store_dwordx4 v[112:115], v1, s[8:11], s24 offen offset:2048 sc1
  v_mul_f32 v144, v144, v240
  v_mfma_f32_16x16x32_bf16 v[180:183], a[160:163], a[20:23], v[180:183]
  ds_read_b64_tr_b16 a[202:203], v38 offset:16896
  v_mul_f32 v145, v145, v241
  v_mul_f32 v146, v146, v242
  v_mfma_f32_16x16x32_bf16 v[20:23], a[240:243], a[160:163], v[20:23]
  ds_read_b64_tr_b16 a[204:205], v39 offset:16384
  v_mul_f32 v147, v147, v243
  v_mul_f32 v148, v148, v244
  v_mfma_f32_16x16x32_bf16 v[184:187], a[164:167], a[16:19], v[184:187]
  ds_read_b64_tr_b16 a[206:207], v39 offset:16896
  v_mul_f32 v149, v149, v245
  v_mfma_f32_16x16x32_bf16 v[188:191], a[164:167], a[20:23], v[188:191]
  ds_read_b64_tr_b16 a[216:217], v38 offset:24576
  buffer_store_dwordx4 v[120:123], v1, s[8:11], s24 offen offset:3072 sc1
  v_mul_f32 v150, v150, v246
  v_mfma_f32_16x16x32_bf16 v[20:23], a[244:247], a[164:167], v[20:23]
  ds_read_b64_tr_b16 a[218:219], v38 offset:25088
  v_mul_f32 v151, v151, v247
  v_cvt_pk_bf16_f32 v144, v144, v145
  v_mfma_f32_16x16x32_bf16 v[208:211], a[176:179], a[16:19], v[208:211]
  ds_read_b64_tr_b16 a[220:221], v39 offset:24576
  v_cvt_pk_bf16_f32 v145, v146, v147
  v_cvt_pk_bf16_f32 v146, v148, v149
  v_mfma_f32_16x16x32_bf16 v[212:215], a[176:179], a[20:23], v[212:215]
  ds_read_b64_tr_b16 a[222:223], v39 offset:25088
  buffer_store_dwordx4 v[128:131], v3, s[8:11], s24 offen offset:0 sc1
  v_mfma_f32_16x16x32_bf16 v[20:23], a[248:251], a[176:179], v[20:23]
  ds_read_b64_tr_b16 a[208:209], v40 offset:16384
  v_cvt_pk_bf16_f32 v147, v150, v151
  v_mul_f32 v152, v152, v240
  v_mfma_f32_16x16x32_bf16 v[216:219], a[180:183], a[16:19], v[216:219]
  ds_read_b64_tr_b16 a[210:211], v40 offset:16896
  v_mul_f32 v153, v153, v241
  v_mul_f32 v154, v154, v242
  v_mfma_f32_16x16x32_bf16 v[220:223], a[180:183], a[20:23], v[220:223]
  ds_read_b64_tr_b16 a[212:213], v41 offset:16384
  v_mul_f32 v155, v155, v243
  v_mfma_f32_16x16x32_bf16 v[20:23], a[252:255], a[180:183], v[20:23]
  ds_read_b64_tr_b16 a[214:215], v41 offset:16896
  buffer_store_dwordx4 v[136:139], v3, s[8:11], s24 offen offset:1024 sc1
  v_mul_f32 v156, v156, v244
  v_mfma_f32_16x16x32_bf16 v[192:195], a[168:171], a[16:19], v[192:195]
  ds_read_b64_tr_b16 a[224:225], v40 offset:24576
  v_mul_f32 v157, v157, v245
  v_mul_f32 v158, v158, v246
  v_mfma_f32_16x16x32_bf16 v[196:199], a[168:171], a[20:23], v[196:199]
  ds_read_b64_tr_b16 a[226:227], v40 offset:25088
  s_add_u32 m0, s66, 53248
  v_mul_f32 v159, v159, v247
  v_mfma_f32_16x16x32_bf16 v[200:203], a[172:175], a[16:19], v[200:203]
  ds_read_b64_tr_b16 a[228:229], v41 offset:24576
  v_cvt_pk_bf16_f32 v152, v152, v153
  v_mfma_f32_16x16x32_bf16 v[204:207], a[172:175], a[20:23], v[204:207]
  ds_read_b64_tr_b16 a[230:231], v41 offset:25088
  buffer_load_dwordx4 v8, s[40:43], s71 offen offset:0 lds
  v_cvt_pk_bf16_f32 v153, v154, v155
  v_mfma_f32_16x16x32_bf16 v[224:227], a[184:187], a[16:19], v[224:227]
  v_cvt_pk_bf16_f32 v154, v156, v157
  v_cvt_pk_bf16_f32 v155, v158, v159
  v_mfma_f32_16x16x32_bf16 v[228:231], a[184:187], a[20:23], v[228:231]
  v_mul_f32 v160, v160, v240
  v_mul_f32 v161, v161, v241
  v_mul_f32 v162, v162, v242
  v_mfma_f32_16x16x32_bf16 v[232:235], a[188:191], a[16:19], v[232:235]
  buffer_load_dwordx4 v9, s[40:43], s71 offen offset:1024 lds
  v_mul_f32 v163, v163, v243
  v_mul_f32 v164, v164, v244
  v_mfma_f32_16x16x32_bf16 v[236:239], a[188:191], a[20:23], v[236:239]
  s_waitcnt vmcnt(26) lgkmcnt(0)
  s_barrier
  v_mul_f32 v165, v165, v245
  v_mul_f32 v166, v166, v246
  v_mfma_f32_16x16x32_bf16 v[176:179], a[200:203], a[24:27], v[176:179]
  ds_read_b64_tr_b16 a[160:161], v34 offset:36864
  ds_read_b64_tr_b16 a[162:163], v34 offset:37376
  v_mul_f32 v167, v167, v247
  v_mfma_f32_16x16x32_bf16 v[180:183], a[200:203], a[28:31], v[180:183]
  ds_read_b64_tr_b16 a[164:165], v35 offset:36864
  v_cvt_pk_bf16_f32 v160, v160, v161
  v_cvt_pk_bf16_f32 v161, v162, v163
  v_mfma_f32_16x16x32_bf16 v[184:187], a[204:207], a[24:27], v[184:187]
  ds_read_b64_tr_b16 a[166:167], v35 offset:37376
  buffer_load_dwordx4 v10, s[40:43], s71 offen offset:2048 lds
  v_cvt_pk_bf16_f32 v162, v164, v165
  v_mfma_f32_16x16x32_bf16 v[188:191], a[204:207], a[28:31], v[188:191]
  ds_read_b64_tr_b16 a[176:177], v34 offset:45056
  ds_read_b64_tr_b16 a[178:179], v34 offset:45568
  v_mfma_f32_16x16x32_bf16 v[208:211], a[216:219], a[24:27], v[208:211]
  ds_read_b64_tr_b16 a[180:181], v35 offset:45056
  v_cvt_pk_bf16_f32 v163, v166, v167
  v_mul_f32 v168, v168, v240
  v_mfma_f32_16x16x32_bf16 v[212:215], a[216:219], a[28:31], v[212:215]
  ds_read_b64_tr_b16 a[182:183], v35 offset:45568
  buffer_load_dwordx4 v11, s[40:43], s71 offen offset:3072 lds
  v_mul_f32 v169, v169, v241
  v_mfma_f32_16x16x32_bf16 v[216:219], a[220:223], a[24:27], v[216:219]
  ds_read_b64_tr_b16 a[168:169], v36 offset:36864
  ds_read_b64_tr_b16 a[170:171], v36 offset:37376
  v_mul_f32 v170, v170, v242
  v_mfma_f32_16x16x32_bf16 v[220:223], a[220:223], a[28:31], v[220:223]
  ds_read_b64_tr_b16 a[172:173], v37 offset:36864
  s_add_u32 s71, s71, 196608
  v_mul_f32 v171, v171, v243
  v_mfma_f32_16x16x32_bf16 v[192:195], a[208:211], a[24:27], v[192:195]
  ds_read_b64_tr_b16 a[174:175], v37 offset:37376
  s_cmp_eq_u32 s91, 2
  s_cselect_b32 s71, s88, s71
  v_mfma_f32_16x16x32_bf16 v[196:199], a[208:211], a[28:31], v[196:199]
  ds_read_b64_tr_b16 a[184:185], v36 offset:45056
  ds_read_b64_tr_b16 a[186:187], v36 offset:45568
  v_mul_f32 v172, v172, v244
  v_mfma_f32_16x16x32_bf16 v[200:203], a[212:215], a[24:27], v[200:203]
  ds_read_b64_tr_b16 a[188:189], v37 offset:45056
  s_waitcnt vmcnt(19)
  v_cmp_ne_u32 vcc, s64, v73
  s_cbranch_vccnz O_slow2
O_ok2:
  v_mfma_f32_16x16x32_bf16 v[204:207], a[212:215], a[28:31], v[204:207]
  ds_read_b64_tr_b16 a[190:191], v37 offset:45568
  buffer_store_dwordx4 v[144:147], v3, s[8:11], s24 offen offset:2048 sc1
  v_mfma_f32_16x16x32_bf16 v[224:227], a[224:227], a[24:27], v[224:227]
  buffer_store_dwordx4 v[152:155], v3, s[8:11], s24 offen offset:3072 sc1
  v_mul_f32 v173, v173, v245
  v_mul_f32 v174, v174, v246
  v_mfma_f32_16x16x32_bf16 v[228:231], a[224:227], a[28:31], v[228:231]
  v_mul_f32 v175, v175, v247
  v_cvt_pk_bf16_f32 v168, v168, v169
  v_cvt_pk_bf16_f32 v169, v170, v171
  v_mfma_f32_16x16x32_bf16 v[232:235], a[228:231], a[24:27], v[232:235]
  s_add_u32 m0, s66, 73728
  v_cvt_pk_bf16_f32 v170, v172, v173
  v_cvt_pk_bf16_f32 v171, v174, v175
  v_mfma_f32_16x16x32_bf16 v[236:239], a[228:231], a[28:31], v[236:239]
  s_waitcnt lgkmcnt(0)
  v_mfma_f32_16x16x32_bf16 v[176:179], a[160:163], a[32:35], v[176:179]
  ds_read_b64_tr_b16 a[200:201], v38 offset:36864
  buffer_load_dwordx4 v8, s[40:43], s71 offen offset:0 lds
  v_mfma_f32_16x16x32_bf16 v[180:183], a[160:163], a[36:39], v[180:183]
  ds_read_b64_tr_b16 a[202:203], v38 offset:37376
  v_mfma_f32_16x16x32_bf16 v[20:23], a[240:243], a[160:163], v[20:23]
  ds_read_b64_tr_b16 a[204:205], v39 offset:36864
  v_mfma_f32_16x16x32_bf16 v[184:187], a[164:167], a[32:35], v[184:187]
  ds_read_b64_tr_b16 a[206:207], v39 offset:37376
  buffer_load_dwordx4 v9, s[40:43], s71 offen offset:1024 lds
  v_mfma_f32_16x16x32_bf16 v[188:191], a[164:167], a[36:39], v[188:191]
  ds_read_b64_tr_b16 a[216:217], v38 offset:45056
  v_mfma_f32_16x16x32_bf16 v[20:23], a[244:247], a[164:167], v[20:23]
  ds_read_b64_tr_b16 a[218:219], v38 offset:45568
  v_mfma_f32_16x16x32_bf16 v[208:211], a[176:179], a[32:35], v[208:211]
  ds_read_b64_tr_b16 a[220:221], v39 offset:45056
  v_mfma_f32_16x16x32_bf16 v[212:215], a[176:179], a[36:39], v[212:215]
  ds_read_b64_tr_b16 a[222:223], v39 offset:45568
  buffer_load_dwordx4 v10, s[40:43], s71 offen offset:2048 lds
  v_mfma_f32_16x16x32_bf16 v[20:23], a[248:251], a[176:179], v[20:23]
  ds_read_b64_tr_b16 a[208:209], v40 offset:36864
  v_mfma_f32_16x16x32_bf16 v[216:219], a[180:183], a[32:35], v[216:219]
  ds_read_b64_tr_b16 a[210:211], v40 offset:37376
  v_mfma_f32_16x16x32_bf16 v[220:223], a[180:183], a[36:39], v[220:223]
  ds_read_b64_tr_b16 a[212:213], v41 offset:36864
  v_mfma_f32_16x16x32_bf16 v[20:23], a[252:255], a[180:183], v[20:23]
  ds_read_b64_tr_b16 a[214:215], v41 offset:37376
  buffer_load_dwordx4 v11, s[40:43], s71 offen offset:3072 lds
  v_mfma_f32_16x16x32_bf16 v[192:195], a[168:171], a[32:35], v[192:195]
  ds_read_b64_tr_b16 a[224:225], v40 offset:45056
  s_add_u32 s71, s71, 196608
  v_mfma_f32_16x16x32_bf16 v[196:199], a[168:171], a[36:39], v[196:199]
  ds_read_b64_tr_b16 a[226:227], v40 offset:45568
  s_cmp_eq_u32 s91, 1
  s_cselect_b32 s71, s88, s71
  v_mfma_f32_16x16x32_bf16 v[200:203], a[172:175], a[32:35], v[200:203]
  ds_read_b64_tr_b16 a[228:229], v41 offset:45056
  buffer_store_dwordx4 v[160:163], v1, s[8:11], s25 offen offset:0 sc1
  v_mfma_f32_16x16x32_bf16 v[204:207], a[172:175], a[36:39], v[204:207]
  ds_read_b64_tr_b16 a[230:231], v41 offset:45568
  v_mfma_f32_16x16x32_bf16 v[224:227], a[184:187], a[32:35], v[224:227]
  v_mfma_f32_16x16x32_bf16 v[228:231], a[184:187], a[36:39], v[228:231]
  buffer_store_dwordx4 v[168:171], v1, s[8:11], s25 offen offset:1024 sc1
  v_mfma_f32_16x16x32_bf16 v[232:235], a[188:191], a[32:35], v[232:235]
  v_mfma_f32_16x16x32_bf16 v[236:239], a[188:191], a[36:39], v[236:239]
  s_waitcnt lgkmcnt(0)
  s_add_u32 m0, s66, 90112
  v_mfma_f32_16x16x32_bf16 v[176:179], a[200:203], a[40:43], v[176:179]
  ds_read_b64_tr_b16 a[160:161], v34 offset:53248
  ds_read_b64_tr_b16 a[162:163], v34 offset:53760
  v_mfma_f32_16x16x32_bf16 v[180:183], a[200:203], a[44:47], v[180:183]
  ds_read_b64_tr_b16 a[164:165], v35 offset:53248
  buffer_load_dwordx4 v8, s[40:43], s71 offen offset:0 lds
  v_mfma_f32_16x16x32_bf16 v[184:187], a[204:207], a[40:43], v[184:187]
  ds_read_b64_tr_b16 a[166:167], v35 offset:53760
  v_mfma_f32_16x16x32_bf16 v[188:191], a[204:207], a[44:47], v[188:191]
  ds_read_b64_tr_b16 a[176:177], v34 offset:61440
  ds_read_b64_tr_b16 a[178:179], v34 offset:61952
  v_mfma_f32_16x16x32_bf16 v[208:211], a[216:219], a[40:43], v[208:211]
  ds_read_b64_tr_b16 a[180:181], v35 offset:61440
  v_mfma_f32_16x16x32_bf16 v[212:215], a[216:219], a[44:47], v[212:215]
  ds_read_b64_tr_b16 a[182:183], v35 offset:61952
  buffer_load_dwordx4 v9, s[40:43], s71 offen offset:1024 lds
  v_mfma_f32_16x16x32_bf16 v[216:219], a[220:223], a[40:43], v[216:219]
  ds_read_b64_tr_b16 a[168:169], v36 offset:53248
  ds_read_b64_tr_b16 a[170:171], v36 offset:53760
  v_mfma_f32_16x16x32_bf16 v[220:223], a[220:223], a[44:47], v[220:223]
  ds_read_b64_tr_b16 a[172:173], v37 offset:53248
  v_mfma_f32_16x16x32_bf16 v[192:195], a[208:211], a[40:43], v[192:195]
  ds_read_b64_tr_b16 a[174:175], v37 offset:53760
  buffer_load_dwordx4 v10, s[40:43], s71 offen offset:2048 lds
  v_mfma_f32_16x16x32_bf16 v[196:199], a[208:211], a[44:47], v[196:199]
  ds_read_b64_tr_b16 a[184:185], v36 offset:61440
  ds_read_b64_tr_b16 a[186:187], v36 offset:61952
  v_mfma_f32_16x16x32_bf16 v[200:203], a[212:215], a[40:43], v[200:203]
  ds_read_b64_tr_b16 a[188:189], v37 offset:61440
  v_mfma_f32_16x16x32_bf16 v[204:207], a[212:215], a[44:47], v[204:207]
  ds_read_b64_tr_b16 a[190:191], v37 offset:61952
  v_mfma_f32_16x16x32_bf16 v[224:227], a[224:227], a[40:43], v[224:227]
  buffer_load_dwordx4 v11, s[40:43], s71 offen offset:3072 lds
  s_add_u32 s71, s71, 196608
  v_mfma_f32_16x16x32_bf16 v[228:231], a[224:227], a[44:47], v[228:231]
  s_add_u32 s81, s77, 0
  v_mfma_f32_16x16x32_bf16 v[232:235], a[228:231], a[40:43], v[232:235]
  v_mfma_f32_16x16x32_bf16 v[236:239], a[228:231], a[44:47], v[236:239]
  s_waitcnt lgkmcnt(0)
  buffer_load_dwordx4 a[0:3], v1, s[8:11], s81 offen offset:0 sc1
  v_mfma_f32_16x16x32_bf16 v[176:179], a[160:163], a[48:51], v[176:179]
  ds_read_b64_tr_b16 a[200:201], v38 offset:53248
  v_mfma_f32_16x16x32_bf16 v[180:183], a[160:163], a[52:55], v[180:183]
  ds_read_b64_tr_b16 a[202:203], v38 offset:53760
  v_mfma_f32_16x16x32_bf16 v[20:23], a[240:243], a[160:163], v[20:23]
  ds_read_b64_tr_b16 a[204:205], v39 offset:53248
  v_mfma_f32_16x16x32_bf16 v[184:187], a[164:167], a[48:51], v[184:187]
  ds_read_b64_tr_b16 a[206:207], v39 offset:53760
  buffer_load_dwordx4 a[4:7], v1, s[8:11], s81 offen offset:1024 sc1
  v_mfma_f32_16x16x32_bf16 v[188:191], a[164:167], a[52:55], v[188:191]
  ds_read_b64_tr_b16 a[216:217], v38 offset:61440
  v_mfma_f32_16x16x32_bf16 v[20:23], a[244:247], a[164:167], v[20:23]
  ds_read_b64_tr_b16 a[218:219], v38 offset:61952
  v_mfma_f32_16x16x32_bf16 v[208:211], a[176:179], a[48:51], v[208:211]
  ds_read_b64_tr_b16 a[220:221], v39 offset:61440
  v_mfma_f32_16x16x32_bf16 v[212:215], a[176:179], a[52:55], v[212:215]
  ds_read_b64_tr_b16 a[222:223], v39 offset:61952
  buffer_load_dwordx4 a[8:11], v1, s[8:11], s81 offen offset:2048 sc1
  v_mfma_f32_16x16x32_bf16 v[20:23], a[248:251], a[176:179], v[20:23]
  ds_read_b64_tr_b16 a[208:209], v40 offset:53248
  v_mfma_f32_16x16x32_bf16 v[216:219], a[180:183], a[48:51], v[216:219]
  ds_read_b64_tr_b16 a[210:211], v40 offset:53760
  v_mfma_f32_16x16x32_bf16 v[220:223], a[180:183], a[52:55], v[220:223]
  ds_read_b64_tr_b16 a[212:213], v41 offset:53248
  buffer_load_dwordx4 a[12:15], v1, s[8:11], s81 offen offset:3072 sc1
  v_mfma_f32_16x16x32_bf16 v[20:23], a[252:255], a[180:183], v[20:23]
  ds_read_b64_tr_b16 a[214:215], v41 offset:53760
  v_mfma_f32_16x16x32_bf16 v[192:195], a[168:171], a[48:51], v[192:195]
  ds_read_b64_tr_b16 a[224:225], v40 offset:61440
  v_mfma_f32_16x16x32_bf16 v[196:199], a[168:171], a[52:55], v[196:199]
  ds_read_b64_tr_b16 a[226:227], v40 offset:61952
  v_mfma_f32_16x16x32_bf16 v[200:203], a[172:175], a[48:51], v[200:203]
  ds_read_b64_tr_b16 a[228:229], v41 offset:61440
  buffer_load_dwordx4 a[16:19], v3, s[8:11], s81 offen offset:0 sc1
  v_mfma_f32_16x16x32_bf16 v[204:207], a[172:175], a[52:55], v[204:207]
  ds_read_b64_tr_b16 a[230:231], v41 offset:61952
  s_add_u32 s81, s77, 40960
  v_mfma_f32_16x16x32_bf16 v[224:227], a[184:187], a[48:51], v[224:227]
  v_mfma_f32_16x16x32_bf16 v[228:231], a[184:187], a[52:55], v[228:231]
  buffer_load_dwordx4 a[20:23], v1, s[8:11], s81 offen offset:0 sc1
  v_mfma_f32_16x16x32_bf16 v[232:235], a[188:191], a[48:51], v[232:235]
  v_mfma_f32_16x16x32_bf16 v[236:239], a[188:191], a[52:55], v[236:239]
  s_waitcnt lgkmcnt(0)
  s_barrier
  v_mfma_f32_16x16x32_bf16 v[176:179], a[200:203], a[56:59], v[176:179]
  ds_read_b64_tr_b16 a[160:161], v26 offset:0
  ds_read_b64_tr_b16 a[162:163], v26 offset:512
  v_mfma_f32_16x16x32_bf16 v[180:183], a[200:203], a[60:63], v[180:183]
  ds_read_b64_tr_b16 a[164:165], v27 offset:0
  buffer_load_dwordx4 a[24:27], v1, s[8:11], s81 offen offset:1024 sc1
  v_mfma_f32_16x16x32_bf16 v[184:187], a[204:207], a[56:59], v[184:187]
  ds_read_b64_tr_b16 a[166:167], v27 offset:512
  v_mfma_f32_16x16x32_bf16 v[188:191], a[204:207], a[60:63], v[188:191]
  ds_read_b64_tr_b16 a[176:177], v26 offset:8192
  ds_read_b64_tr_b16 a[178:179], v26 offset:8704
  v_mfma_f32_16x16x32_bf16 v[208:211], a[216:219], a[56:59], v[208:211]
  ds_read_b64_tr_b16 a[180:181], v27 offset:8192
  v_mfma_f32_16x16x32_bf16 v[212:215], a[216:219], a[60:63], v[212:215]
  ds_read_b64_tr_b16 a[182:183], v27 offset:8704
  buffer_load_dwordx4 a[28:31], v1, s[8:11], s81 offen offset:2048 sc1
  v_mfma_f32_16x16x32_bf16 v[216:219], a[220:223], a[56:59], v[216:219]
  ds_read_b64_tr_b16 a[168:169], v28 offset:0
  ds_read_b64_tr_b16 a[170:171], v28 offset:512
  v_mfma_f32_16x16x32_bf16 v[220:223], a[220:223], a[60:63], v[220:223]
  ds_read_b64_tr_b16 a[172:173], v29 offset:0
  v_mfma_f32_16x16x32_bf16 v[192:195], a[208:211], a[56:59], v[192:195]
  ds_read_b64_tr_b16 a[174:175], v29 offset:512
  buffer_load_dwordx4 a[32:35], v1, s[8:11], s81 offen offset:3072 sc1
  v_mfma_f32_16x16x32_bf16 v[196:199], a[208:211], a[60:63], v[196:199]
  ds_read_b64_tr_b16 a[184:185], v28 offset:8192
  ds_read_b64_tr_b16 a[186:187], v28 offset:8704
  v_mfma_f32_16x16x32_bf16 v[200:203], a[212:215], a[56:59], v[200:203]
  ds_read_b64_tr_b16 a[188:189], v29 offset:8192
  v_mfma_f32_16x16x32_bf16 v[204:207], a[212:215], a[60:63], v[204:207]
  ds_read_b64_tr_b16 a[190:191], v29 offset:8704
  v_mfma_f32_16x16x32_bf16 v[224:227], a[224:227], a[56:59], v[224:227]
  buffer_load_dwordx4 a[36:39], v3, s[8:11], s81 offen offset:0 sc1
  v_mfma_f32_16x16x32_bf16 v[228:231], a[224:227], a[60:63], v[228:231]
  v_mfma_f32_16x16x32_bf16 v[232:235], a[228:231], a[56:59], v[232:235]
  v_mfma_f32_16x16x32_bf16 v[236:239], a[228:231], a[60:63], v[236:239]
  s_waitcnt lgkmcnt(0)
  s_waitcnt vmcnt(14)
  buffer_store_dword v71, v72, s[8:11], s28 offen sc1
  v_mfma_f32_16x16x32_bf16 v[176:179], a[160:163], a[64:67], v[176:179]
  ds_read_b64_tr_b16 a[200:201], v30 offset:0
  v_mfma_f32_16x16x32_bf16 v[180:183], a[160:163], a[68:71], v[180:183]
  ds_read_b64_tr_b16 a[202:203], v30 offset:512
  s_add_u32 m0, s66, 110592
  v_mfma_f32_16x16x32_bf16 v[20:23], a[240:243], a[160:163], v[20:23]
  ds_read_b64_tr_b16 a[204:205], v31 offset:0
  s_mul_i32 s75, s70, 160
  v_mfma_f32_16x16x32_bf16 v[184:187], a[164:167], a[64:67], v[184:187]
  ds_read_b64_tr_b16 a[206:207], v31 offset:512
  buffer_load_dwordx4 v44, s[48:51], s70 offen offset:0 lds
  v_mfma_f32_16x16x32_bf16 v[188:191], a[164:167], a[68:71], v[188:191]
  ds_read_b64_tr_b16 a[216:217], v30 offset:8192
  buffer_load_dwordx4 v45, s[48:51], s70 offen offset:1024 lds
  v_mfma_f32_16x16x32_bf16 v[20:23], a[244:247], a[164:167], v[20:23]
  ds_read_b64_tr_b16 a[218:219], v30 offset:8704
  v_mfma_f32_16x16x32_bf16 v[208:211], a[176:179], a[64:67], v[208:211]
  ds_read_b64_tr_b16 a[220:221], v31 offset:8192
  v_mfma_f32_16x16x32_bf16 v[212:215], a[176:179], a[68:71], v[212:215]
  ds_read_b64_tr_b16 a[222:223], v31 offset:8704
  buffer_load_dwordx4 v46, s[48:51], s70 offen offset:2048 lds
  v_mfma_f32_16x16x32_bf16 v[20:23], a[248:251], a[176:179], v[20:23]
  ds_read_b64_tr_b16 a[208:209], v32 offset:0
  v_mfma_f32_16x16x32_bf16 v[216:219], a[180:183], a[64:67], v[216:219]
  ds_read_b64_tr_b16 a[210:211], v32 offset:512
  v_mfma_f32_16x16x32_bf16 v[220:223], a[180:183], a[68:71], v[220:223]
  ds_read_b64_tr_b16 a[212:213], v33 offset:0
  v_mfma_f32_16x16x32_bf16 v[20:23], a[252:255], a[180:183], v[20:23]
  ds_read_b64_tr_b16 a[214:215], v33 offset:512
  buffer_load_dwordx4 v47, s[48:51], s70 offen offset:3072 lds
  v_mfma_f32_16x16x32_bf16 v[192:195], a[168:171], a[64:67], v[192:195]
  ds_read_b64_tr_b16 a[224:225], v32 offset:8192
  s_add_u32 s70, s70, 128
  v_mfma_f32_16x16x32_bf16 v[196:199], a[168:171], a[68:71], v[196:199]
  ds_read_b64_tr_b16 a[226:227], v32 offset:8704
  s_and_b32 s70, s70, 0x7ff
  v_mfma_f32_16x16x32_bf16 v[200:203], a[172:175], a[64:67], v[200:203]
  ds_read_b64_tr_b16 a[228:229], v33 offset:8192
  s_add_u32 s81, s77, 81920
  v_mfma_f32_16x16x32_bf16 v[204:207], a[172:175], a[68:71], v[204:207]
  ds_read_b64_tr_b16 a[230:231], v33 offset:8704
  buffer_load_dwordx4 a[40:43], v1, s[8:11], s81 offen offset:0 sc1
  v_mfma_f32_16x16x32_bf16 v[224:227], a[184:187], a[64:67], v[224:227]
  v_mfma_f32_16x16x32_bf16 v[228:231], a[184:187], a[68:71], v[228:231]
  v_mfma_f32_16x16x32_bf16 v[232:235], a[188:191], a[64:67], v[232:235]
  buffer_load_dwordx4 a[44:47], v1, s[8:11], s81 offen offset:1024 sc1
  v_mfma_f32_16x16x32_bf16 v[236:239], a[188:191], a[68:71], v[236:239]
  s_waitcnt lgkmcnt(0)
  v_mfma_f32_16x16x32_bf16 v[176:179], a[200:203], a[72:75], v[176:179]
  ds_read_b64_tr_b16 a[160:161], v26 offset:16384
  ds_read_b64_tr_b16 a[162:163], v26 offset:16896
  v_mfma_f32_16x16x32_bf16 v[180:183], a[200:203], a[76:79], v[180:183]
  ds_read_b64_tr_b16 a[164:165], v27 offset:16384
  v_mfma_f32_16x16x32_bf16 v[184:187], a[204:207], a[72:75], v[184:187]
  ds_read_b64_tr_b16 a[166:167], v27 offset:16896
  buffer_load_dwordx4 a[48:51], v1, s[8:11], s81 offen offset:2048 sc1
  v_mfma_f32_16x16x32_bf16 v[188:191], a[204:207], a[76:79], v[188:191]
  ds_read_b64_tr_b16 a[176:177], v26 offset:24576
  ds_read_b64_tr_b16 a[178:179], v26 offset:25088
  v_mfma_f32_16x16x32_bf16 v[208:211], a[216:219], a[72:75], v[208:211]
  ds_read_b64_tr_b16 a[180:181], v27 offset:24576
  v_mfma_f32_16x16x32_bf16 v[212:215], a[216:219], a[76:79], v[212:215]
  ds_read_b64_tr_b16 a[182:183], v27 offset:25088
  buffer_load_dwordx4 a[52:55], v1, s[8:11], s81 offen offset:3072 sc1
  v_mfma_f32_16x16x32_bf16 v[216:219], a[220:223], a[72:75], v[216:219]
  ds_read_b64_tr_b16 a[168:169], v28 offset:16384
  ds_read_b64_tr_b16 a[170:171], v28 offset:16896
  v_mfma_f32_16x16x32_bf16 v[220:223], a[220:223], a[76:79], v[220:223]
  ds_read_b64_tr_b16 a[172:173], v29 offset:16384
  v_mfma_f32_16x16x32_bf16 v[192:195], a[208:211], a[72:75], v[192:195]
  ds_read_b64_tr_b16 a[174:175], v29 offset:16896
  v_mfma_f32_16x16x32_bf16 v[196:199], a[208:211], a[76:79], v[196:199]
  ds_read_b64_tr_b16 a[184:185], v28 offset:24576
  ds_read_b64_tr_b16 a[186:187], v28 offset:25088
  v_mfma_f32_16x16x32_bf16 v[200:203], a[212:215], a[72:75], v[200:203]
  ds_read_b64_tr_b16 a[188:189], v29 offset:24576
  buffer_load_dwordx4 a[56:59], v3, s[8:11], s81 offen offset:0 sc1
  v_mfma_f32_16x16x32_bf16 v[204:207], a[212:215], a[76:79], v[204:207]
  ds_read_b64_tr_b16 a[190:191], v29 offset:25088
  v_mfma_f32_16x16x32_bf16 v[224:227], a[224:227], a[72:75], v[224:227]
  v_mfma_f32_16x16x32_bf16 v[228:231], a[224:227], a[76:79], v[228:231]
  v_mfma_f32_16x16x32_bf16 v[232:235], a[228:231], a[72:75], v[232:235]
  v_mfma_f32_16x16x32_bf16 v[236:239], a[228:231], a[76:79], v[236:239]
  s_waitcnt lgkmcnt(0)
  s_add_u32 s81, s77, 122880
  v_mfma_f32_16x16x32_bf16 v[176:179], a[160:163], a[80:83], v[176:179]
  ds_read_b64_tr_b16 a[200:201], v30 offset:16384
  buffer_load_dwordx4 a[60:63], v1, s[8:11], s81 offen offset:0 sc1
  v_mfma_f32_16x16x32_bf16 v[180:183], a[160:163], a[84:87], v[180:183]
  ds_read_b64_tr_b16 a[202:203], v30 offset:16896
  buffer_load_dwordx4 a[64:67], v1, s[8:11], s81 offen offset:1024 sc1
  v_mfma_f32_16x16x32_bf16 v[20:23], a[240:243], a[160:163], v[20:23]
  ds_read_b64_tr_b16 a[204:205], v31 offset:16384
  v_mfma_f32_16x16x32_bf16 v[184:187], a[164:167], a[80:83], v[184:187]
  ds_read_b64_tr_b16 a[206:207], v31 offset:16896
  v_mfma_f32_16x16x32_bf16 v[188:191], a[164:167], a[84:87], v[188:191]
  ds_read_b64_tr_b16 a[216:217], v30 offset:24576
  buffer_load_dwordx4 a[68:71], v1, s[8:11], s81 offen offset:2048 sc1
  v_mfma_f32_16x16x32_bf16 v[20:23], a[244:247], a[164:167], v[20:23]
  ds_read_b64_tr_b16 a[218:219], v30 offset:25088
  v_mfma_f32_16x16x32_bf16 v[208:211], a[176:179], a[80:83], v[208:211]
  ds_read_b64_tr_b16 a[220:221], v31 offset:24576
  v_mfma_f32_16x16x32_bf16 v[212:215], a[176:179], a[84:87], v[212:215]
  ds_read_b64_tr_b16 a[222:223], v31 offset:25088
  v_mfma_f32_16x16x32_bf16 v[20:23], a[248:251], a[176:179], v[20:23]
  ds_read_b64_tr_b16 a[208:209], v32 offset:16384
  buffer_load_dwordx4 a[72:75], v1, s[8:11], s81 offen offset:3072 sc1
  v_mfma_f32_16x16x32_bf16 v[216:219], a[180:183], a[80:83], v[216:219]
  ds_read_b64_tr_b16 a[210:211], v32 offset:16896
  v_mfma_f32_16x16x32_bf16 v[220:223], a[180:183], a[84:87], v[220:223]
  ds_read_b64_tr_b16 a[212:213], v33 offset:16384
  v_mfma_f32_16x16x32_bf16 v[20:23], a[252:255], a[180:183], v[20:23]
  ds_read_b64_tr_b16 a[214:215], v33 offset:16896
  buffer_load_dwordx4 a[76:79], v3, s[8:11], s81 offen offset:0 sc1
  v_mfma_f32_16x16x32_bf16 v[192:195], a[168:171], a[80:83], v[192:195]
  ds_read_b64_tr_b16 a[224:225], v32 offset:24576
  v_mfma_f32_16x16x32_bf16 v[196:199], a[168:171], a[84:87], v[196:199]
  ds_read_b64_tr_b16 a[226:227], v32 offset:25088
  v_mfma_f32_16x16x32_bf16 v[200:203], a[172:175], a[80:83], v[200:203]
  ds_read_b64_tr_b16 a[228:229], v33 offset:24576
  v_mfma_f32_16x16x32_bf16 v[204:207], a[172:175], a[84:87], v[204:207]
  ds_read_b64_tr_b16 a[230:231], v33 offset:25088
  buffer_load_dword v73, v88, s[8:11], s30 offen sc1
  v_mfma_f32_16x16x32_bf16 v[224:227], a[184:187], a[80:83], v[224:227]
  v_mfma_f32_16x16x32_bf16 v[228:231], a[184:187], a[84:87], v[228:231]
  v_mfma_f32_16x16x32_bf16 v[232:235], a[188:191], a[80:83], v[232:235]
  v_mfma_f32_16x16x32_bf16 v[236:239], a[188:191], a[84:87], v[236:239]
  s_waitcnt lgkmcnt(0)
  s_barrier
  v_mfma_f32_16x16x32_bf16 v[176:179], a[200:203], a[88:91], v[176:179]
  ds_read_b64_tr_b16 a[160:161], v26 offset:36864
  ds_read_b64_tr_b16 a[162:163], v26 offset:37376
  v_mfma_f32_16x16x32_bf16 v[180:183], a[200:203], a[92:95], v[180:183]
  ds_read_b64_tr_b16 a[164:165], v27 offset:36864
  s_add_u32 m0, s66, 0
  v_mfma_f32_16x16x32_bf16 v[184:187], a[204:207], a[88:91], v[184:187]
  ds_read_b64_tr_b16 a[166:167], v27 offset:37376
  s_mul_i32 s72, s70, 160
  v_mfma_f32_16x16x32_bf16 v[188:191], a[204:207], a[92:95], v[188:191]
  ds_read_b64_tr_b16 a[176:177], v26 offset:45056
  ds_read_b64_tr_b16 a[178:179], v26 offset:45568
  v_mfma_f32_16x16x32_bf16 v[208:211], a[216:219], a[88:91], v[208:211]
  ds_read_b64_tr_b16 a[180:181], v27 offset:45056
  buffer_load_dwordx4 v44, s[48:51], s70 offen offset:0 lds
  v_mfma_f32_16x16x32_bf16 v[212:215], a[216:219], a[92:95], v[212:215]
  ds_read_b64_tr_b16 a[182:183], v27 offset:45568
  buffer_load_dwordx4 v45, s[48:51], s70 offen offset:1024 lds
  v_mfma_f32_16x16x32_bf16 v[216:219], a[220:223], a[88:91], v[216:219]
  ds_read_b64_tr_b16 a[168:169], v28 offset:36864
  ds_read_b64_tr_b16 a[170:171], v28 offset:37376
  v_mfma_f32_16x16x32_bf16 v[220:223], a[220:223], a[92:95], v[220:223]
  ds_read_b64_tr_b16 a[172:173], v29 offset:36864
  v_mfma_f32_16x16x32_bf16 v[192:195], a[208:211], a[88:91], v[192:195]
  ds_read_b64_tr_b16 a[174:175], v29 offset:37376
  buffer_load_dwordx4 v46, s[48:51], s70 offen offset:2048 lds
  v_mfma_f32_16x16x32_bf16 v[196:199], a[208:211], a[92:95], v[196:199]
  ds_read_b64_tr_b16 a[184:185], v28 offset:45056
  ds_read_b64_tr_b16 a[186:187], v28 offset:45568
  v_mfma_f32_16x16x32_bf16 v[200:203], a[212:215], a[88:91], v[200:203]
  ds_read_b64_tr_b16 a[188:189], v29 offset:45056
  v_mfma_f32_16x16x32_bf16 v[204:207], a[212:215], a[92:95], v[204:207]
  ds_read_b64_tr_b16 a[190:191], v29 offset:45568
  v_mfma_f32_16x16x32_bf16 v[224:227], a[224:227], a[88:91], v[224:227]
  buffer_load_dwordx4 v47, s[48:51], s70 offen offset:3072 lds
  s_add_u32 s70, s70, 128
  v_mfma_f32_16x16x32_bf16 v[228:231], a[224:227], a[92:95], v[228:231]
  s_and_b32 s70, s70, 0x7ff
  v_mfma_f32_16x16x32_bf16 v[232:235], a[228:231], a[88:91], v[232:235]
  v_mfma_f32_16x16x32_bf16 v[236:239], a[228:231], a[92:95], v[236:239]
  s_waitcnt lgkmcnt(0)
  v_mfma_f32_16x16x32_bf16 v[176:179], a[160:163], a[96:99], v[176:179]
  ds_read_b64_tr_b16 a[200:201], v30 offset:36864
  v_mfma_f32_16x16x32_bf16 v[180:183], a[160:163], a[100:103], v[180:183]
  ds_read_b64_tr_b16 a[202:203], v30 offset:37376
  v_mfma_f32_16x16x32_bf16 v[20:23], a[240:243], a[160:163], v[20:23]
  ds_read_b64_tr_b16 a[204:205], v31 offset:36864
  v_mfma_f32_16x16x32_bf16 v[184:187], a[164:167], a[96:99], v[184:187]
  ds_read_b64_tr_b16 a[206:207], v31 offset:37376
  v_mfma_f32_16x16x32_bf16 v[188:191], a[164:167], a[100:103], v[188:191]
  ds_read_b64_tr_b16 a[216:217], v30 offset:45056
  v_mfma_f32_16x16x32_bf16 v[20:23], a[244:247], a[164:167], v[20:23]
  ds_read_b64_tr_b16 a[218:219], v30 offset:45568
  v_mfma_f32_16x16x32_bf16 v[208:211], a[176:179], a[96:99], v[208:211]
  ds_read_b64_tr_b16 a[220:221], v31 offset:45056
  v_mfma_f32_16x16x32_bf16 v[212:215], a[176:179], a[100:103], v[212:215]
  ds_read_b64_tr_b16 a[222:223], v31 offset:45568
  v_mfma_f32_16x16x32_bf16 v[20:23], a[248:251], a[176:179], v[20:23]
  ds_read_b64_tr_b16 a[208:209], v32 offset:36864
  v_mfma_f32_16x16x32_bf16 v[216:219], a[180:183], a[96:99], v[216:219]
  ds_read_b64_tr_b16 a[210:211], v32 offset:37376
  v_mfma_f32_16x16x32_bf16 v[220:223], a[180:183], a[100:103], v[220:223]
  ds_read_b64_tr_b16 a[212:213], v33 offset:36864
  v_mfma_f32_16x16x32_bf16 v[20:23], a[252:255], a[180:183], v[20:23]
  ds_read_b64_tr_b16 a[214:215], v33 offset:37376
  v_mfma_f32_16x16x32_bf16 v[192:195], a[168:171], a[96:99], v[192:195]
  ds_read_b64_tr_b16 a[224:225], v32 offset:45056
  v_mfma_f32_16x16x32_bf16 v[196:199], a[168:171], a[100:103], v[196:199]
  ds_read_b64_tr_b16 a[226:227], v32 offset:45568
  v_mfma_f32_16x16x32_bf16 v[200:203], a[172:175], a[96:99], v[200:203]
  ds_read_b64_tr_b16 a[228:229], v33 offset:45056
  v_mfma_f32_16x16x32_bf16 v[204:207], a[172:175], a[100:103], v[204:207]
  ds_read_b64_tr_b16 a[230:231], v33 offset:45568
  v_mfma_f32_16x16x32_bf16 v[224:227], a[184:187], a[96:99], v[224:227]
  v_mfma_f32_16x16x32_bf16 v[228:231], a[184:187], a[100:103], v[228:231]
  v_mfma_f32_16x16x32_bf16 v[232:235], a[188:191], a[96:99], v[232:235]
  v_mfma_f32_16x16x32_bf16 v[236:239], a[188:191], a[100:103], v[236:239]
  s_waitcnt lgkmcnt(0)
  s_add_u32 s81, s77, 163840
  v_mfma_f32_16x16x32_bf16 v[176:179], a[200:203], a[104:107], v[176:179]
  ds_read_b64_tr_b16 a[160:161], v26 offset:53248
  ds_read_b64_tr_b16 a[162:163], v26 offset:53760
  v_mfma_f32_16x16x32_bf16 v[180:183], a[200:203], a[108:111], v[180:183]
  ds_read_b64_tr_b16 a[164:165], v27 offset:53248
  buffer_load_dwordx4 a[80:83], v1, s[8:11], s81 offen offset:0 sc1
  v_mfma_f32_16x16x32_bf16 v[184:187], a[204:207], a[104:107], v[184:187]
  ds_read_b64_tr_b16 a[166:167], v27 offset:53760
  buffer_load_dwordx4 a[84:87], v1, s[8:11], s81 offen offset:1024 sc1
  v_mfma_f32_16x16x32_bf16 v[188:191], a[204:207], a[108:111], v[188:191]
  ds_read_b64_tr_b16 a[176:177], v26 offset:61440
  ds_read_b64_tr_b16 a[178:179], v26 offset:61952
  v_mfma_f32_16x16x32_bf16 v[208:211], a[216:219], a[104:107], v[208:211]
  ds_read_b64_tr_b16 a[180:181], v27 offset:61440
  v_mfma_f32_16x16x32_bf16 v[212:215], a[216:219], a[108:111], v[212:215]
  ds_read_b64_tr_b16 a[182:183], v27 offset:61952
  buffer_load_dwordx4 a[88:91], v1, s[8:11], s81 offen offset:2048 sc1
  v_mfma_f32_16x16x32_bf16 v[216:219], a[220:223], a[104:107], v[216:219]
  ds_read_b64_tr_b16 a[168:169], v28 offset:53248
  ds_read_b64_tr_b16 a[170:171], v28 offset:53760
  v_mfma_f32_16x16x32_bf16 v[220:223], a[220:223], a[108:111], v[220:223]
  ds_read_b64_tr_b16 a[172:173], v29 offset:53248
  v_mfma_f32_16x16x32_bf16 v[192:195], a[208:211], a[104:107], v[192:195]
  ds_read_b64_tr_b16 a[174:175], v29 offset:53760
  v_mfma_f32_16x16x32_bf16 v[196:199], a[208:211], a[108:111], v[196:199]
  ds_read_b64_tr_b16 a[184:185], v28 offset:61440
  ds_read_b64_tr_b16 a[186:187], v28 offset:61952
  v_mfma_f32_16x16x32_bf16 v[200:203], a[212:215], a[104:107], v[200:203]
  ds_read_b64_tr_b16 a[188:189], v29 offset:61440
  buffer_load_dwordx4 a[92:95], v1, s[8:11], s81 offen offset:3072 sc1
  v_mfma_f32_16x16x32_bf16 v[204:207], a[212:215], a[108:111], v[204:207]
  ds_read_b64_tr_b16 a[190:191], v29 offset:61952
  v_mfma_f32_16x16x32_bf16 v[224:227], a[224:227], a[104:107], v[224:227]
  buffer_load_dwordx4 a[96:99], v3, s[8:11], s81 offen offset:0 sc1
  v_mfma_f32_16x16x32_bf16 v[228:231], a[224:227], a[108:111], v[228:231]
  v_mfma_f32_16x16x32_bf16 v[232:235], a[228:231], a[104:107], v[232:235]
  v_mfma_f32_16x16x32_bf16 v[236:239], a[228:231], a[108:111], v[236:239]
  s_waitcnt lgkmcnt(0)
  v_mfma_f32_16x16x32_bf16 v[176:179], a[160:163], a[112:115], v[176:179]
  ds_read_b64_tr_b16 a[200:201], v30 offset:53248
  s_waitcnt vmcnt(9)
  v_cmp_ne_u32 vcc, s64, v73
  s_cbranch_vccnz O_slow3
O_ok3:
  v_mfma_f32_16x16x32_bf16 v[180:183], a[160:163], a[116:119], v[180:183]
  ds_read_b64_tr_b16 a[202:203], v30 offset:53760
  s_add_u32 m0, s67, 126976
  v_mfma_f32_16x16x32_bf16 v[20:23], a[240:243], a[160:163], v[20:23]
  ds_read_b64_tr_b16 a[204:205], v31 offset:53248
  buffer_load_dwordx4 v54, s[8:11], s75 offen offset:0 sc1 lds
  v_mfma_f32_16x16x32_bf16 v[184:187], a[164:167], a[112:115], v[184:187]
  ds_read_b64_tr_b16 a[206:207], v31 offset:53760
  buffer_load_dwordx4 v54, s[8:11], s75 offen offset:1024 sc1 lds
  v_mfma_f32_16x16x32_bf16 v[188:191], a[164:167], a[116:119], v[188:191]
  ds_read_b64_tr_b16 a[216:217], v30 offset:61440
  v_mfma_f32_16x16x32_bf16 v[20:23], a[244:247], a[164:167], v[20:23]
  ds_read_b64_tr_b16 a[218:219], v30 offset:61952
  v_mfma_f32_16x16x32_bf16 v[208:211], a[176:179], a[112:115], v[208:211]
  ds_read_b64_tr_b16 a[220:221], v31 offset:61440
  v_mfma_f32_16x16x32_bf16 v[212:215], a[176:179], a[116:119], v[212:215]
  ds_read_b64_tr_b16 a[222:223], v31 offset:61952
  buffer_load_dwordx4 v54, s[8:11], s75 offen offset:2048 sc1 lds
  v_mfma_f32_16x16x32_bf16 v[20:23], a[248:251], a[176:179], v[20:23]
  ds_read_b64_tr_b16 a[208:209], v32 offset:53248
  v_mfma_f32_16x16x32_bf16 v[216:219], a[180:183], a[112:115], v[216:219]
  ds_read_b64_tr_b16 a[210:211], v32 offset:53760
  v_mfma_f32_16x16x32_bf16 v[220:223], a[180:183], a[116:119], v[220:223]
  ds_read_b64_tr_b16 a[212:213], v33 offset:53248
  buffer_load_dwordx4 v54, s[8:11], s75 offen offset:3072 sc1 lds
  v_mfma_f32_16x16x32_bf16 v[20:23], a[252:255], a[180:183], v[20:23]
  ds_read_b64_tr_b16 a[214:215], v33 offset:53760
  s_add_u32 m0, s67, 131072
  v_mfma_f32_16x16x32_bf16 v[192:195], a[168:171], a[112:115], v[192:195]
  ds_read_b64_tr_b16 a[224:225], v32 offset:61440
  v_mfma_f32_16x16x32_bf16 v[196:199], a[168:171], a[116:119], v[196:199]
  ds_read_b64_tr_b16 a[226:227], v32 offset:61952
  v_mfma_f32_16x16x32_bf16 v[200:203], a[172:175], a[112:115], v[200:203]
  ds_read_b64_tr_b16 a[228:229], v33 offset:61440
  buffer_load_dwordx4 v55, s[8:11], s75 offen sc1 lds
  v_mfma_f32_16x16x32_bf16 v[204:207], a[172:175], a[116:119], v[204:207]
  ds_read_b64_tr_b16 a[230:231], v33 offset:61952
  v_mfma_f32_16x16x32_bf16 v[224:227], a[184:187], a[112:115], v[224:227]
  s_add_u32 m0, s67, 16384
  v_mfma_f32_16x16x32_bf16 v[228:231], a[184:187], a[116:119], v[228:231]
  v_mfma_f32_16x16x32_bf16 v[232:235], a[188:191], a[112:115], v[232:235]
  buffer_load_dwordx4 v54, s[8:11], s72 offen offset:0 sc1 lds
  v_mfma_f32_16x16x32_bf16 v[236:239], a[188:191], a[116:119], v[236:239]
  s_waitcnt lgkmcnt(0)
  s_barrier
  v_mfma_f32_16x16x32_bf16 v[176:179], a[200:203], a[120:123], v[176:179]
  ds_read_b64_tr_b16 a[160:161], v34 offset:0
  ds_read_b64_tr_b16 a[162:163], v34 offset:512
  v_mfma_f32_16x16x32_bf16 v[180:183], a[200:203], a[124:127], v[180:183]
  ds_read_b64_tr_b16 a[164:165], v35 offset:0
  buffer_load_dwordx4 v54, s[8:11], s72 offen offset:1024 sc1 lds
  v_mfma_f32_16x16x32_bf16 v[184:187], a[204:207], a[120:123], v[184:187]
  ds_read_b64_tr_b16 a[166:167], v35 offset:512
  v_mfma_f32_16x16x32_bf16 v[188:191], a[204:207], a[124:127], v[188:191]
  ds_read_b64_tr_b16 a[176:177], v34 offset:8192
  ds_read_b64_tr_b16 a[178:179], v34 offset:8704
  v_mfma_f32_16x16x32_bf16 v[208:211], a[216:219], a[120:123], v[208:211]
  ds_read_b64_tr_b16 a[180:181], v35 offset:8192
  v_mfma_f32_16x16x32_bf16 v[212:215], a[216:219], a[124:127], v[212:215]
  ds_read_b64_tr_b16 a[182:183], v35 offset:8704
  buffer_load_dwordx4 v54, s[8:11], s72 offen offset:2048 sc1 lds
  v_mfma_f32_16x16x32_bf16 v[216:219], a[220:223], a[120:123], v[216:219]
  ds_read_b64_tr_b16 a[168:169], v36 offset:0
  ds_read_b64_tr_b16 a[170:171], v36 offset:512
  v_mfma_f32_16x16x32_bf16 v[220:223], a[220:223], a[124:127], v[220:223]
  ds_read_b64_tr_b16 a[172:173], v37 offset:0
  v_mfma_f32_16x16x32_bf16 v[192:195], a[208:211], a[120:123], v[192:195]
  ds_read_b64_tr_b16 a[174:175], v37 offset:512
  buffer_load_dwordx4 v54, s[8:11], s72 offen offset:3072 sc1 lds
  v_mfma_f32_16x16x32_bf16 v[196:199], a[208:211], a[124:127], v[196:199]
  ds_read_b64_tr_b16 a[184:185], v36 offset:8192
  ds_read_b64_tr_b16 a[186:187], v36 offset:8704
  v_mfma_f32_16x16x32_bf16 v[200:203], a[212:215], a[120:123], v[200:203]
  ds_read_b64_tr_b16 a[188:189], v37 offset:8192
  s_add_u32 m0, s67, 20480
  v_mfma_f32_16x16x32_bf16 v[204:207], a[212:215], a[124:127], v[204:207]
  ds_read_b64_tr_b16 a[190:191], v37 offset:8704
  v_mfma_f32_16x16x32_bf16 v[224:227], a[224:227], a[120:123], v[224:227]
  buffer_load_dwordx4 v55, s[8:11], s72 offen sc1 lds
  v_mfma_f32_16x16x32_bf16 v[228:231], a[224:227], a[124:127], v[228:231]
  v_mfma_f32_16x16x32_bf16 v[232:235], a[228:231], a[120:123], v[232:235]
  s_add_u32 m0, s66, 36864
  s_mul_i32 s73, s70, 160
  v_mfma_f32_16x16x32_bf16 v[236:239], a[228:231], a[124:127], v[236:239]
  s_waitcnt lgkmcnt(0)
  v_mfma_f32_16x16x32_bf16 v[176:179], a[160:163], a[128:131], v[176:179]
  ds_read_b64_tr_b16 a[200:201], v38 offset:0
  buffer_load_dwordx4 v44, s[48:51], s70 offen offset:0 lds
  v_mfma_f32_16x16x32_bf16 v[180:183], a[160:163], a[132:135], v[180:183]
  ds_read_b64_tr_b16 a[202:203], v38 offset:512
  v_mfma_f32_16x16x32_bf16 v[20:23], a[240:243], a[160:163], v[20:23]
  ds_read_b64_tr_b16 a[204:205], v39 offset:0
  v_mfma_f32_16x16x32_bf16 v[184:187], a[164:167], a[128:131], v[184:187]
  ds_read_b64_tr_b16 a[206:207], v39 offset:512
  buffer_load_dwordx4 v45, s[48:51], s70 offen offset:1024 lds
  v_mfma_f32_16x16x32_bf16 v[188:191], a[164:167], a[132:135], v[188:191]
  ds_read_b64_tr_b16 a[216:217], v38 offset:8192
  v_mfma_f32_16x16x32_bf16 v[20:23], a[244:247], a[164:167], v[20:23]
  ds_read_b64_tr_b16 a[218:219], v38 offset:8704
  v_mfma_f32_16x16x32_bf16 v[208:211], a[176:179], a[128:131], v[208:211]
  ds_read_b64_tr_b16 a[220:221], v39 offset:8192
  v_mfma_f32_16x16x32_bf16 v[212:215], a[176:179], a[132:135], v[212:215]
  ds_read_b64_tr_b16 a[222:223], v39 offset:8704
  buffer_load_dwordx4 v46, s[48:51], s70 offen offset:2048 lds
  v_mfma_f32_16x16x32_bf16 v[20:23], a[248:251], a[176:179], v[20:23]
  ds_read_b64_tr_b16 a[208:209], v40 offset:0
  v_mfma_f32_16x16x32_bf16 v[216:219], a[180:183], a[128:131], v[216:219]
  ds_read_b64_tr_b16 a[210:211], v40 offset:512
  v_mfma_f32_16x16x32_bf16 v[220:223], a[180:183], a[132:135], v[220:223]
  ds_read_b64_tr_b16 a[212:213], v41 offset:0
  buffer_load_dwordx4 v47, s[48:51], s70 offen offset:3072 lds
  v_mfma_f32_16x16x32_bf16 v[20:23], a[252:255], a[180:183], v[20:23]
  ds_read_b64_tr_b16 a[214:215], v41 offset:512
  s_add_u32 s70, s70, 128
  v_mfma_f32_16x16x32_bf16 v[192:195], a[168:171], a[128:131], v[192:195]
  ds_read_b64_tr_b16 a[224:225], v40 offset:8192
  s_and_b32 s70, s70, 0x7ff
  v_mfma_f32_16x16x32_bf16 v[196:199], a[168:171], a[132:135], v[196:199]
  ds_read_b64_tr_b16 a[226:227], v40 offset:8704
  s_add_u32 m0, s67, 53248
  v_mfma_f32_16x16x32_bf16 v[200:203], a[172:175], a[128:131], v[200:203]
  ds_read_b64_tr_b16 a[228:229], v41 offset:8192
  buffer_load_dwordx4 v54, s[8:11], s73 offen offset:0 sc1 lds
  v_mfma_f32_16x16x32_bf16 v[204:207], a[172:175], a[132:135], v[204:207]
  ds_read_b64_tr_b16 a[230:231], v41 offset:8704
  v_mfma_f32_16x16x32_bf16 v[224:227], a[184:187], a[128:131], v[224:227]
  v_mfma_f32_16x16x32_bf16 v[228:231], a[184:187], a[132:135], v[228:231]
  v_mfma_f32_16x16x32_bf16 v[232:235], a[188:191], a[128:131], v[232:235]
  buffer_load_dwordx4 v54, s[8:11], s73 offen offset:1024 sc1 lds
  v_mfma_f32_16x16x32_bf16 v[236:239], a[188:191], a[132:135], v[236:239]
  s_waitcnt lgkmcnt(0)
  v_mfma_f32_16x16x32_bf16 v[176:179], a[200:203], a[136:139], v[176:179]
  ds_read_b64_tr_b16 a[160:161], v34 offset:16384
  ds_read_b64_tr_b16 a[162:163], v34 offset:16896
  v_mfma_f32_16x16x32_bf16 v[180:183], a[200:203], a[140:143], v[180:183]
  ds_read_b64_tr_b16 a[164:165], v35 offset:16384
  buffer_load_dwordx4 v54, s[8:11], s73 offen offset:2048 sc1 lds
  v_mfma_f32_16x16x32_bf16 v[184:187], a[204:207], a[136:139], v[184:187]
  ds_read_b64_tr_b16 a[166:167], v35 offset:16896
  v_mfma_f32_16x16x32_bf16 v[188:191], a[204:207], a[140:143], v[188:191]
  ds_read_b64_tr_b16 a[176:177], v34 offset:24576
  ds_read_b64_tr_b16 a[178:179], v34 offset:25088
  v_mfma_f32_16x16x32_bf16 v[208:211], a[216:219], a[136:139], v[208:211]
  ds_read_b64_tr_b16 a[180:181], v35 offset:24576
  v_mfma_f32_16x16x32_bf16 v[212:215], a[216:219], a[140:143], v[212:215]
  ds_read_b64_tr_b16 a[182:183], v35 offset:25088
  buffer_load_dwordx4 v54, s[8:11], s73 offen offset:3072 sc1 lds
  v_mfma_f32_16x16x32_bf16 v[216:219], a[220:223], a[136:139], v[216:219]
  ds_read_b64_tr_b16 a[168:169], v36 offset:16384
  ds_read_b64_tr_b16 a[170:171], v36 offset:16896
  v_mfma_f32_16x16x32_bf16 v[220:223], a[220:223], a[140:143], v[220:223]
  ds_read_b64_tr_b16 a[172:173], v37 offset:16384
  s_add_u32 m0, s67, 57344
  v_mfma_f32_16x16x32_bf16 v[192:195], a[208:211], a[136:139], v[192:195]
  ds_read_b64_tr_b16 a[174:175], v37 offset:16896
  buffer_load_dwordx4 v55, s[8:11], s73 offen sc1 lds
  v_mfma_f32_16x16x32_bf16 v[196:199], a[208:211], a[140:143], v[196:199]
  ds_read_b64_tr_b16 a[184:185], v36 offset:24576
  ds_read_b64_tr_b16 a[186:187], v36 offset:25088
  v_mfma_f32_16x16x32_bf16 v[200:203], a[212:215], a[136:139], v[200:203]
  ds_read_b64_tr_b16 a[188:189], v37 offset:24576
  s_add_u32 s81, s77, 204800
  v_mfma_f32_16x16x32_bf16 v[204:207], a[212:215], a[140:143], v[204:207]
  ds_read_b64_tr_b16 a[190:191], v37 offset:25088
  v_mfma_f32_16x16x32_bf16 v[224:227], a[224:227], a[136:139], v[224:227]
  buffer_load_dwordx4 a[100:103], v1, s[8:11], s81 offen offset:0 sc1
  v_mfma_f32_16x16x32_bf16 v[228:231], a[224:227], a[140:143], v[228:231]
  v_mfma_f32_16x16x32_bf16 v[232:235], a[228:231], a[136:139], v[232:235]
  v_mfma_f32_16x16x32_bf16 v[236:239], a[228:231], a[140:143], v[236:239]
  s_waitcnt lgkmcnt(0)
  v_mfma_f32_16x16x32_bf16 v[176:179], a[160:163], a[144:147], v[176:179]
  ds_read_b64_tr_b16 a[200:201], v38 offset:16384
  buffer_load_dwordx4 a[104:107], v1, s[8:11], s81 offen offset:1024 sc1
  v_mfma_f32_16x16x32_bf16 v[180:183], a[160:163], a[148:151], v[180:183]
  ds_read_b64_tr_b16 a[202:203], v38 offset:16896
  v_mfma_f32_16x16x32_bf16 v[20:23], a[240:243], a[160:163], v[20:23]
  ds_read_b64_tr_b16 a[204:205], v39 offset:16384
  v_mfma_f32_16x16x32_bf16 v[184:187], a[164:167], a[144:147], v[184:187]
  ds_read_b64_tr_b16 a[206:207], v39 offset:16896
  buffer_load_dwordx4 a[108:111], v1, s[8:11], s81 offen offset:2048 sc1
  v_mfma_f32_16x16x32_bf16 v[188:191], a[164:167], a[148:151], v[188:191]
  ds_read_b64_tr_b16 a[216:217], v38 offset:24576
  v_mfma_f32_16x16x32_bf16 v[20:23], a[244:247], a[164:167], v[20:23]
  ds_read_b64_tr_b16 a[218:219], v38 offset:25088
  v_mfma_f32_16x16x32_bf16 v[208:211], a[176:179], a[144:147], v[208:211]
  ds_read_b64_tr_b16 a[220:221], v39 offset:24576
  v_mfma_f32_16x16x32_bf16 v[212:215], a[176:179], a[148:151], v[212:215]
  ds_read_b64_tr_b16 a[222:223], v39 offset:25088
  buffer_load_dwordx4 a[112:115], v1, s[8:11], s81 offen offset:3072 sc1
  v_mfma_f32_16x16x32_bf16 v[20:23], a[248:251], a[176:179], v[20:23]
  ds_read_b64_tr_b16 a[208:209], v40 offset:16384
  v_mfma_f32_16x16x32_bf16 v[216:219], a[180:183], a[144:147], v[216:219]
  ds_read_b64_tr_b16 a[210:211], v40 offset:16896
  v_mfma_f32_16x16x32_bf16 v[220:223], a[180:183], a[148:151], v[220:223]
  ds_read_b64_tr_b16 a[212:213], v41 offset:16384
  buffer_load_dwordx4 a[116:119], v3, s[8:11], s81 offen offset:0 sc1
  v_mfma_f32_16x16x32_bf16 v[20:23], a[252:255], a[180:183], v[20:23]
  ds_read_b64_tr_b16 a[214:215], v41 offset:16896
  v_mfma_f32_16x16x32_bf16 v[192:195], a[168:171], a[144:147], v[192:195]
  ds_read_b64_tr_b16 a[224:225], v40 offset:24576
  s_add_u32 s81, s77, 245760
  v_mfma_f32_16x16x32_bf16 v[196:199], a[168:171], a[148:151], v[196:199]
  ds_read_b64_tr_b16 a[226:227], v40 offset:25088
  s_nop 1
  v_cvt_pk_bf16_f32 v21, v20, v20
  v_mfma_f32_16x16x32_bf16 v[200:203], a[172:175], a[144:147], v[200:203]
  ds_read_b64_tr_b16 a[228:229], v41 offset:24576
  v_and_b32 v21, 0xffff0000, v21
  v_mfma_f32_16x16x32_bf16 v[204:207], a[172:175], a[148:151], v[204:207]
  ds_read_b64_tr_b16 a[230:231], v41 offset:25088
  v_sub_f32 v21, v20, v21
  v_mfma_f32_16x16x32_bf16 v[224:227], a[184:187], a[144:147], v[224:227]
  v_cvt_pk_bf16_f32 v21, v20, v21
  ds_write_b32 v68, v21 offset:4096
  v_mfma_f32_16x16x32_bf16 v[228:231], a[184:187], a[148:151], v[228:231]
  buffer_load_dwordx4 a[120:123], v1, s[8:11], s81 offen offset:0 sc1
  v_mfma_f32_16x16x32_bf16 v[232:235], a[188:191], a[144:147], v[232:235]
  buffer_load_dwordx4 a[124:127], v1, s[8:11], s81 offen offset:1024 sc1
  v_mfma_f32_16x16x32_bf16 v[236:239], a[188:191], a[148:151], v[236:239]
  s_waitcnt vmcnt(21) lgkmcnt(0)
  s_barrier
  v_mfma_f32_16x16x32_bf16 v[176:179], a[200:203], a[152:155], v[176:179]
  ds_read_b128 v[240:243], v69 offset:4096
  v_mfma_f32_16x16x32_bf16 v[180:183], a[200:203], a[156:159], v[180:183]
  ds_read_b128 v[244:247], v69 offset:4608
  buffer_load_dwordx4 a[128:131], v1, s[8:11], s81 offen offset:2048 sc1
  v_mfma_f32_16x16x32_bf16 v[184:187], a[204:207], a[152:155], v[184:187]
  ds_read_b128 v[248:251], v70 offset:4096
  v_mfma_f32_16x16x32_bf16 v[188:191], a[204:207], a[156:159], v[188:191]
  ds_read_b128 v[252:255], v70 offset:4608
  v_mfma_f32_16x16x32_bf16 v[208:211], a[216:219], a[152:155], v[208:211]
  ds_read_b128 a[176:179], v53 offset:36864
  v_mfma_f32_16x16x32_bf16 v[212:215], a[216:219], a[156:159], v[212:215]
  ds_read_b128 a[160:163], v50 offset:36864
  buffer_load_dwordx4 a[132:135], v1, s[8:11], s81 offen offset:3072 sc1
  v_mfma_f32_16x16x32_bf16 v[216:219], a[220:223], a[152:155], v[216:219]
  ds_read_b128 a[164:167], v50 offset:37376
  v_mfma_f32_16x16x32_bf16 v[220:223], a[220:223], a[156:159], v[220:223]
  ds_read_b128 a[168:171], v50 offset:40960
  v_mfma_f32_16x16x32_bf16 v[192:195], a[208:211], a[152:155], v[192:195]
  ds_read_b128 a[172:175], v50 offset:41472
  buffer_load_dwordx4 a[136:139], v3, s[8:11], s81 offen offset:0 sc1
  v_mfma_f32_16x16x32_bf16 v[196:199], a[208:211], a[156:159], v[196:199]
  ds_read_b128 a[180:183], v53 offset:37888
  v_mfma_f32_16x16x32_bf16 v[200:203], a[212:215], a[152:155], v[200:203]
  ds_read_b128 a[184:187], v53 offset:38912
  s_add_u32 m0, s66, 73728
  v_mfma_f32_16x16x32_bf16 v[204:207], a[212:215], a[156:159], v[204:207]
  ds_read_b128 a[188:191], v53 offset:39936
  s_mul_i32 s74, s70, 160
  v_mfma_f32_16x16x32_bf16 v[224:227], a[224:227], a[152:155], v[224:227]
  ds_read_b128 a[192:195], v53 offset:40960
  buffer_load_dwordx4 v44, s[48:51], s70 offen offset:0 lds
  v_mfma_f32_16x16x32_bf16 v[228:231], a[224:227], a[156:159], v[228:231]
  v_mfma_f32_16x16x32_bf16 v[232:235], a[228:231], a[152:155], v[232:235]
  v_mfma_f32_16x16x32_bf16 v[236:239], a[228:231], a[156:159], v[236:239]
  s_waitcnt lgkmcnt(12)
  v_mfma_f32_16x16x16_bf16 v[176:179], v[240:241], v[64:65], v[176:179]
  buffer_load_dwordx4 v45, s[48:51], s70 offen offset:1024 lds
  s_waitcnt lgkmcnt(11)
  v_mfma_f32_16x16x16_bf16 v[208:211], v[244:245], v[64:65], v[208:211]
  v_mfma_f32_16x16x16_bf16 v[184:187], v[242:243], v[64:65], v[184:187]
  v_mfma_f32_16x16x16_bf16 v[216:219], v[246:247], v[64:65], v[216:219]
  buffer_load_dwordx4 v46, s[48:51], s70 offen offset:2048 lds
  v_mfma_f32_16x16x16_bf16 v[180:183], v[240:241], v[66:67], v[180:183]
  s_nop 0
  v_mul_f32 v80, v176, v176
  s_nop 1
  v_mul_f32 v208, v176, v208
  v_mfma_f32_16x16x16_bf16 v[212:215], v[244:245], v[66:67], v[212:215]
  v_fma_f32 v80, v80, v59, v57
  v_mul_f32 v176, v80, v176
  v_mfma_f32_16x16x16_bf16 v[188:191], v[242:243], v[66:67], v[188:191]
  v_exp_f32 v176, v176
  v_mfma_f32_16x16x16_bf16 v[220:223], v[246:247], v[66:67], v[220:223]
  buffer_load_dwordx4 v47, s[48:51], s70 offen offset:3072 lds
  s_add_u32 s70, s70, 128
  s_waitcnt lgkmcnt(10)
  v_mfma_f32_16x16x16_bf16 v[192:195], v[248:249], v[64:65], v[192:195]
  s_and_b32 s70, s70, 0x7ff
  s_add_u32 m0, s67, 90112
  s_waitcnt lgkmcnt(9)
  v_mfma_f32_16x16x16_bf16 v[224:227], v[252:253], v[64:65], v[224:227]
  v_mul_f32 v81, v177, v177
  v_mul_f32 v209, v177, v209
  v_mfma_f32_16x16x16_bf16 v[200:203], v[250:251], v[64:65], v[200:203]
  buffer_load_dwordx4 v54, s[8:11], s74 offen offset:0 sc1 lds
  v_fma_f32 v81, v81, v59, v57
  v_mfma_f32_16x16x16_bf16 v[232:235], v[254:255], v[64:65], v[232:235]
  v_mul_f32 v177, v81, v177
  v_mul_f32 v82, v178, v178
  v_mfma_f32_16x16x16_bf16 v[196:199], v[248:249], v[66:67], v[196:199]
  v_exp_f32 v177, v177
  v_mfma_f32_16x16x16_bf16 v[228:231], v[252:253], v[66:67], v[228:231]
  v_mul_f32 v210, v178, v210
  v_fma_f32 v82, v82, v59, v57
  v_mfma_f32_16x16x16_bf16 v[204:207], v[250:251], v[66:67], v[204:207]
  buffer_load_dwordx4 v54, s[8:11], s74 offen offset:1024 sc1 lds
  v_mul_f32 v178, v82, v178
  v_mfma_f32_16x16x16_bf16 v[236:239], v[254:255], v[66:67], v[236:239]
  s_waitcnt lgkmcnt(0)
  v_mul_f32 v83, v179, v179
  v_mfma_f32_16x16x32_bf16 v[96:99], a[176:179], a[160:163], 0
  ds_read_b128 a[216:219], v53 offset:47104
  v_mul_f32 v211, v179, v211
  v_mfma_f32_16x16x32_bf16 v[116:119], a[176:179], a[164:167], 0
  ds_read_b128 a[200:203], v51 offset:36864
  v_fma_f32 v83, v83, v59, v57
  v_mfma_f32_16x16x32_bf16 v[136:139], a[176:179], a[168:171], 0
  ds_read_b128 a[204:207], v51 offset:37376
  buffer_load_dwordx4 v54, s[8:11], s74 offen offset:2048 sc1 lds
  v_mfma_f32_16x16x32_bf16 v[156:159], a[176:179], a[172:175], 0
  ds_read_b128 a[208:211], v51 offset:40960
  v_mul_f32 v179, v83, v179
  v_mfma_f32_16x16x32_bf16 v[100:103], a[180:183], a[160:163], 0
  ds_read_b128 a[212:215], v51 offset:41472
  v_fma_f32 v176, v176, v58, v58
  v_mfma_f32_16x16x32_bf16 v[120:123], a[180:183], a[164:167], 0
  ds_read_b128 a[220:223], v53 offset:48128
  buffer_load_dwordx4 v54, s[8:11], s74 offen offset:3072 sc1 lds
  v_mfma_f32_16x16x32_bf16 v[140:143], a[180:183], a[168:171], 0
  ds_read_b128 a[224:227], v53 offset:49152
  s_add_u32 m0, s67, 94208
  v_mfma_f32_16x16x32_bf16 v[160:163], a[180:183], a[172:175], 0
  ds_read_b128 a[228:231], v53 offset:50176
  v_fma_f32 v177, v177, v58, v58
  v_mfma_f32_16x16x32_bf16 v[104:107], a[184:187], a[160:163], 0
  ds_read_b128 a[232:235], v53 offset:51200
  v_mul_f32 v80, v184, v184
  v_mfma_f32_16x16x32_bf16 v[124:127], a[184:187], a[164:167], 0
  buffer_load_dwordx4 v55, s[8:11], s74 offen sc1 lds
  v_mul_f32 v216, v184, v216
  v_mfma_f32_16x16x32_bf16 v[144:147], a[184:187], a[168:171], 0
  s_add_u32 s81, s77, 286720
  v_fma_f32 v80, v80, v59, v57
  v_mfma_f32_16x16x32_bf16 v[164:167], a[184:187], a[172:175], 0
  v_exp_f32 v178, v178
  v_mfma_f32_16x16x32_bf16 v[108:111], a[188:191], a[160:163], 0
  buffer_load_dwordx4 a[140:143], v1, s[8:11], s81 offen offset:0 sc1
  v_fma_f32 v178, v178, v58, v58
  v_mfma_f32_16x16x32_bf16 v[128:131], a[188:191], a[164:167], 0
  v_exp_f32 v179, v179
  v_mfma_f32_16x16x32_bf16 v[148:151], a[188:191], a[168:171], 0
  v_rcp_f32 v176, v176
  v_mfma_f32_16x16x32_bf16 v[168:171], a[188:191], a[172:175], 0
  v_rcp_f32 v177, v177
  v_mfma_f32_16x16x32_bf16 v[112:115], a[192:195], a[160:163], 0
  buffer_load_dwordx4 a[144:147], v1, s[8:11], s81 offen offset:1024 sc1
  v_fma_f32 v179, v179, v58, v58
  v_mfma_f32_16x16x32_bf16 v[132:135], a[192:195], a[164:167], 0
  v_rcp_f32 v178, v178
  v_mfma_f32_16x16x32_bf16 v[152:155], a[192:195], a[168:171], 0
  v_rcp_f32 v179, v179
  v_mfma_f32_16x16x32_bf16 v[172:175], a[192:195], a[172:175], 0
  s_waitcnt vmcnt(30) lgkmcnt(0)
  s_barrier
  v_mul_f32 v208, v208, v176
  v_mfma_f32_16x16x32_bf16 v[96:99], a[216:219], a[200:203], v[96:99]
  ds_read_b128 a[176:179], v52 offset:0
  buffer_load_dwordx4 a[148:151], v1, s[8:11], s81 offen offset:2048 sc1
  v_mfma_f32_16x16x32_bf16 v[116:119], a[216:219], a[204:207], v[116:119]
  ds_read_b128 a[160:163], v48 offset:0
  v_mul_f32 v209, v209, v177
  v_mfma_f32_16x16x32_bf16 v[136:139], a[216:219], a[208:211], v[136:139]
  ds_read_b128 a[164:167], v48 offset:512
  v_mul_f32 v210, v210, v178
  v_mfma_f32_16x16x32_bf16 v[156:159], a[216:219], a[212:215], v[156:159]
  ds_read_b128 a[168:171], v48 offset:4096
  buffer_load_dwordx4 a[152:155], v1, s[8:11], s81 offen offset:3072 sc1
  v_mfma_f32_16x16x32_bf16 v[100:103], a[220:223], a[200:203], v[100:103]
  ds_read_b128 a[172:175], v48 offset:4608
  v_mul_f32 v211, v211, v179
  v_mfma_f32_16x16x32_bf16 v[120:123], a[220:223], a[204:207], v[120:123]
  ds_read_b128 a[180:183], v52 offset:1024
  v_cvt_pk_bf16_f32 v176, v208, v209
  v_mfma_f32_16x16x32_bf16 v[140:143], a[220:223], a[208:211], v[140:143]
  ds_read_b128 a[184:187], v52 offset:2048
  v_cvt_pk_bf16_f32 v177, v210, v211
  v_mfma_f32_16x16x32_bf16 v[160:163], a[220:223], a[212:215], v[160:163]
  ds_read_b128 a[188:191], v52 offset:3072
  buffer_load_dwordx4 a[156:159], v3, s[8:11], s81 offen offset:0 sc1
  v_mfma_f32_16x16x32_bf16 v[104:107], a[224:227], a[200:203], v[104:107]
  ds_read_b128 a[192:195], v52 offset:4096
  s_add_u32 m0, s66, 110592
  v_mfma_f32_16x16x32_bf16 v[124:127], a[224:227], a[204:207], v[124:127]
  s_mul_i32 s75, s70, 160
  v_mul_f32 v184, v80, v184
  v_mfma_f32_16x16x32_bf16 v[144:147], a[224:227], a[208:211], v[144:147]
  buffer_load_dwordx4 v44, s[48:51], s70 offen offset:0 lds
  v_mul_f32 v81, v185, v185
  v_mfma_f32_16x16x32_bf16 v[164:167], a[224:227], a[212:215], v[164:167]
  v_exp_f32 v184, v184
  v_mfma_f32_16x16x32_bf16 v[108:111], a[228:231], a[200:203], v[108:111]
  v_mul_f32 v217, v185, v217
  v_fma_f32 v81, v81, v59, v57
  v_mfma_f32_16x16x32_bf16 v[128:131], a[228:231], a[204:207], v[128:131]
  v_mul_f32 v185, v81, v185
  v_mul_f32 v82, v186, v186
  v_mfma_f32_16x16x32_bf16 v[148:151], a[228:231], a[208:211], v[148:151]
  buffer_load_dwordx4 v45, s[48:51], s70 offen offset:1024 lds
  v_mul_f32 v218, v186, v218
  v_mfma_f32_16x16x32_bf16 v[168:171], a[228:231], a[212:215], v[168:171]
  v_exp_f32 v185, v185
  v_mfma_f32_16x16x32_bf16 v[112:115], a[232:235], a[200:203], v[112:115]
  v_fma_f32 v82, v82, v59, v57
  v_mul_f32 v186, v82, v186
  v_mfma_f32_16x16x32_bf16 v[132:135], a[232:235], a[204:207], v[132:135]
  v_exp_f32 v186, v186
  v_mfma_f32_16x16x32_bf16 v[152:155], a[232:235], a[208:211], v[152:155]
  buffer_load_dwordx4 v46, s[48:51], s70 offen offset:2048 lds
  v_mul_f32 v83, v187, v187
  v_mfma_f32_16x16x32_bf16 v[172:175], a[232:235], a[212:215], v[172:175]
  s_waitcnt lgkmcnt(0)
  v_mul_f32 v219, v187, v219
  v_mfma_f32_16x16x32_bf16 v[96:99], a[176:179], a[160:163], v[96:99]
  ds_read_b128 a[216:219], v52 offset:10240
  v_fma_f32 v83, v83, v59, v57
  v_mfma_f32_16x16x32_bf16 v[116:119], a[176:179], a[164:167], v[116:119]
  ds_read_b128 a[200:203], v49 offset:0
  buffer_load_dwordx4 v47, s[48:51], s70 offen offset:3072 lds
  v_mfma_f32_16x16x32_bf16 v[136:139], a[176:179], a[168:171], v[136:139]
  ds_read_b128 a[204:207], v49 offset:512
  s_add_u32 s70, s70, 128
  v_mfma_f32_16x16x32_bf16 v[156:159], a[176:179], a[172:175], v[156:159]
  ds_read_b128 a[208:211], v49 offset:4096
  s_and_b32 s70, s70, 0x7ff
  v_mfma_f32_16x16x32_bf16 v[100:103], a[180:183], a[160:163], v[100:103]
  ds_read_b128 a[212:215], v49 offset:4608
  s_add_u32 m0, s67, 126976
  v_mfma_f32_16x16x32_bf16 v[120:123], a[180:183], a[164:167], v[120:123]
  ds_read_b128 a[220:223], v52 offset:11264
  buffer_load_dwordx4 v54, s[8:11], s75 offen offset:0 sc1 lds
  v_mfma_f32_16x16x32_bf16 v[140:143], a[180:183], a[168:171], v[140:143]
  ds_read_b128 a[224:227], v52 offset:12288
  v_mul_f32 v187, v83, v187
  v_mfma_f32_16x16x32_bf16 v[160:163], a[180:183], a[172:175], v[160:163]
  ds_read_b128 a[228:231], v52 offset:13312
  v_fma_f32 v184, v184, v58, v58
  v_mfma_f32_16x16x32_bf16 v[104:107], a[184:187], a[160:163], v[104:107]
  ds_read_b128 a[232:235], v52 offset:14336
  buffer_load_dwordx4 v54, s[8:11], s75 offen offset:1024 sc1 lds
  v_mfma_f32_16x16x32_bf16 v[124:127], a[184:187], a[164:167], v[124:127]
  v_exp_f32 v187, v187
  v_mfma_f32_16x16x32_bf16 v[144:147], a[184:187], a[168:171], v[144:147]
  v_rcp_f32 v184, v184
  v_mfma_f32_16x16x32_bf16 v[164:167], a[184:187], a[172:175], v[164:167]
  v_fma_f32 v185, v185, v58, v58
  v_fma_f32 v186, v186, v58, v58
  v_mfma_f32_16x16x32_bf16 v[108:111], a[188:191], a[160:163], v[108:111]
  buffer_load_dwordx4 v54, s[8:11], s75 offen offset:2048 sc1 lds
  v_fma_f32 v187, v187, v58, v58
  v_mfma_f32_16x16x32_bf16 v[128:131], a[188:191], a[164:167], v[128:131]
  v_rcp_f32 v185, v185
  v_mfma_f32_16x16x32_bf16 v[148:151], a[188:191], a[168:171], v[148:151]
  v_rcp_f32 v186, v186
  v_mfma_f32_16x16x32_bf16 v[168:171], a[188:191], a[172:175], v[168:171]
  v_rcp_f32 v187, v187
  v_mfma_f32_16x16x32_bf16 v[112:115], a[192:195], a[160:163], v[112:115]
  buffer_load_dwordx4 v54, s[8:11], s75 offen offset:3072 sc1 lds
  s_add_u32 m0, s67, 131072
  v_mfma_f32_16x16x32_bf16 v[132:135], a[192:195], a[164:167], v[132:135]
  v_mul_f32 v216, v216, v184
  v_mul_f32 v217, v217, v185
  v_mfma_f32_16x16x32_bf16 v[152:155], a[192:195], a[168:171], v[152:155]
  v_mul_f32 v218, v218, v186
  v_mul_f32 v219, v219, v187
  v_mfma_f32_16x16x32_bf16 v[172:175], a[192:195], a[172:175], v[172:175]
  s_waitcnt vmcnt(32) lgkmcnt(0)
  s_barrier
  buffer_load_dwordx4 v55, s[8:11], s75 offen sc1 lds
  v_mfma_f32_16x16x32_bf16 v[96:99], a[216:219], a[200:203], v[96:99]
  ds_read_b128 a[176:179], v52 offset:36864
  v_cvt_pk_bf16_f32 v178, v216, v217
  v_mfma_f32_16x16x32_bf16 v[116:119], a[216:219], a[204:207], v[116:119]
  ds_read_b128 a[160:163], v48 offset:36864
  s_add_u32 m0, s66, 0
  v_mfma_f32_16x16x32_bf16 v[136:139], a[216:219], a[208:211], v[136:139]
  ds_read_b128 a[164:167], v48 offset:37376
  s_mul_i32 s72, s70, 160
  v_mfma_f32_16x16x32_bf16 v[156:159], a[216:219], a[212:215], v[156:159]
  ds_read_b128 a[168:171], v48 offset:40960
  buffer_load_dwordx4 v44, s[48:51], s70 offen offset:0 lds
  v_mfma_f32_16x16x32_bf16 v[100:103], a[220:223], a[200:203], v[100:103]
  ds_read_b128 a[172:175], v48 offset:41472
  v_cvt_pk_bf16_f32 v179, v218, v219
  v_mfma_f32_16x16x32_bf16 v[120:123], a[220:223], a[204:207], v[120:123]
  ds_read_b128 a[180:183], v52 offset:37888
  v_mfma_f32_16x16x32_bf16 v[140:143], a[220:223], a[208:211], v[140:143]
  ds_read_b128 a[184:187], v52 offset:38912
  buffer_load_dwordx4 v45, s[48:51], s70 offen offset:1024 lds
  v_mfma_f32_16x16x32_bf16 v[160:163], a[220:223], a[212:215], v[160:163]
  ds_read_b128 a[188:191], v52 offset:39936
  v_mfma_f32_16x16x32_bf16 v[104:107], a[224:227], a[200:203], v[104:107]
  ds_read_b128 a[192:195], v52 offset:40960
  v_mfma_f32_16x16x32_bf16 v[124:127], a[224:227], a[204:207], v[124:127]
  v_mfma_f32_16x16x32_bf16 v[144:147], a[224:227], a[208:211], v[144:147]
  buffer_load_dwordx4 v46, s[48:51], s70 offen offset:2048 lds
  v_mfma_f32_16x16x32_bf16 v[164:167], a[224:227], a[212:215], v[164:167]
  v_mfma_f32_16x16x32_bf16 v[108:111], a[228:231], a[200:203], v[108:111]
  v_mfma_f32_16x16x32_bf16 v[128:131], a[228:231], a[204:207], v[128:131]
  v_mfma_f32_16x16x32_bf16 v[148:151], a[228:231], a[208:211], v[148:151]
  buffer_load_dwordx4 v47, s[48:51], s70 offen offset:3072 lds
  s_add_u32 s70, s70, 128
  v_mfma_f32_16x16x32_bf16 v[168:171], a[228:231], a[212:215], v[168:171]
  s_and_b32 s70, s70, 0x7ff
  v_mul_f32 v80, v180, v180
  v_mfma_f32_16x16x32_bf16 v[112:115], a[232:235], a[200:203], v[112:115]
  v_mul_f32 v212, v180, v212
  v_fma_f32 v80, v80, v63, v61
  v_mfma_f32_16x16x32_bf16 v[132:135], a[232:235], a[204:207], v[132:135]
  buffer_store_dwordx4 v[176:179], v1, s[8:11], s26 offen offset:0 sc1
  v_mul_f32 v180, v80, v180
  v_mfma_f32_16x16x32_bf16 v[152:155], a[232:235], a[208:211], v[152:155]
  v_exp_f32 v180, v180
  v_mfma_f32_16x16x32_bf16 v[172:175], a[232:235], a[212:215], v[172:175]
  s_waitcnt lgkmcnt(0)
  s_add_u32 m0, s67, 16384
  v_mfma_f32_16x16x32_bf16 v[96:99], a[176:179], a[160:163], v[96:99]
  ds_read_b128 a[216:219], v52 offset:47104
  v_mul_f32 v81, v181, v181
  v_mfma_f32_16x16x32_bf16 v[116:119], a[176:179], a[164:167], v[116:119]
  ds_read_b128 a[200:203], v49 offset:36864
  buffer_load_dwordx4 v54, s[8:11], s72 offen offset:0 sc1 lds
  v_mfma_f32_16x16x32_bf16 v[136:139], a[176:179], a[168:171], v[136:139]
  ds_read_b128 a[204:207], v49 offset:37376
  v_mul_f32 v213, v181, v213
  v_mfma_f32_16x16x32_bf16 v[156:159], a[176:179], a[172:175], v[156:159]
  ds_read_b128 a[208:211], v49 offset:40960
  v_fma_f32 v81, v81, v63, v61
  v_mfma_f32_16x16x32_bf16 v[100:103], a[180:183], a[160:163], v[100:103]
  ds_read_b128 a[212:215], v49 offset:41472
  buffer_load_dwordx4 v54, s[8:11], s72 offen offset:1024 sc1 lds
  v_mfma_f32_16x16x32_bf16 v[120:123], a[180:183], a[164:167], v[120:123]
  ds_read_b128 a[220:223], v52 offset:48128
  v_mul_f32 v181, v81, v181
  v_mfma_f32_16x16x32_bf16 v[140:143], a[180:183], a[168:171], v[140:143]
  ds_read_b128 a[224:227], v52 offset:49152
  v_mul_f32 v82, v182, v182
  v_mfma_f32_16x16x32_bf16 v[160:163], a[180:183], a[172:175], v[160:163]
  ds_read_b128 a[228:231], v52 offset:50176
  v_mul_f32 v214, v182, v214
  v_mfma_f32_16x16x32_bf16 v[104:107], a[184:187], a[160:163], v[104:107]
  ds_read_b128 a[232:235], v52 offset:51200
  buffer_load_dwordx4 v54, s[8:11], s72 offen offset:2048 sc1 lds
  v_mfma_f32_16x16x32_bf16 v[124:127], a[184:187], a[164:167], v[124:127]
  v_exp_f32 v181, v181
  v_mfma_f32_16x16x32_bf16 v[144:147], a[184:187], a[168:171], v[144:147]
  v_fma_f32 v82, v82, v63, v61
  v_mul_f32 v182, v82, v182
  v_mfma_f32_16x16x32_bf16 v[164:167], a[184:187], a[172:175], v[164:167]
  v_exp_f32 v182, v182
  v_mfma_f32_16x16x32_bf16 v[108:111], a[188:191], a[160:163], v[108:111]
  buffer_load_dwordx4 v54, s[8:11], s72 offen offset:3072 sc1 lds
  s_add_u32 m0, s67, 20480
  v_mfma_f32_16x16x32_bf16 v[128:131], a[188:191], a[164:167], v[128:131]
  v_mul_f32 v83, v183, v183
  v_mul_f32 v215, v183, v215
  v_mfma_f32_16x16x32_bf16 v[148:151], a[188:191], a[168:171], v[148:151]
  v_fma_f32 v83, v83, v63, v61
  v_mul_f32 v183, v83, v183
  v_mfma_f32_16x16x32_bf16 v[168:171], a[188:191], a[172:175], v[168:171]
  buffer_load_dwordx4 v55, s[8:11], s72 offen sc1 lds
  v_fma_f32 v180, v180, v62, v62
  v_mfma_f32_16x16x32_bf16 v[112:115], a[192:195], a[160:163], v[112:115]
  v_exp_f32 v183, v183
  v_mfma_f32_16x16x32_bf16 v[132:135], a[192:195], a[164:167], v[132:135]
  v_mov_b32 v8, -1
  v_mov_b32 v9, -1
  v_mfma_f32_16x16x32_bf16 v[152:155], a[192:195], a[168:171], v[152:155]
  v_mov_b32 v10, -1
  v_mov_b32 v11, -1
  v_mfma_f32_16x16x32_bf16 v[172:175], a[192:195], a[172:175], v[172:175]
  s_waitcnt vmcnt(24) lgkmcnt(0)
  s_barrier
  buffer_store_dwordx4 v[8:11], v1, s[8:11], s78 offen offset:0 sc1
  v_mfma_f32_16x16x32_bf16 v[96:99], a[216:219], a[200:203], v[96:99]
  ds_read_b128 a[176:179], v53 offset:0
  s_add_u32 m0, s66, 36864
  v_mfma_f32_16x16x32_bf16 v[116:119], a[216:219], a[204:207], v[116:119]
  ds_read_b128 a[160:163], v50 offset:0
  s_mul_i32 s73, s70, 160
  v_mfma_f32_16x16x32_bf16 v[136:139], a[216:219], a[208:211], v[136:139]
  ds_read_b128 a[164:167], v50 offset:512
  buffer_load_dwordx4 v44, s[48:51], s70 offen offset:0 lds
  v_mfma_f32_16x16x32_bf16 v[156:159], a[216:219], a[212:215], v[156:159]
  ds_read_b128 a[168:171], v50 offset:4096
  v_fma_f32 v181, v181, v62, v62
  v_mfma_f32_16x16x32_bf16 v[100:103], a[220:223], a[200:203], v[100:103]
  ds_read_b128 a[172:175], v50 offset:4608
  v_fma_f32 v182, v182, v62, v62
  v_mfma_f32_16x16x32_bf16 v[120:123], a[220:223], a[204:207], v[120:123]
  ds_read_b128 a[180:183], v53 offset:1024
  buffer_load_dwordx4 v45, s[48:51], s70 offen offset:1024 lds
  v_mfma_f32_16x16x32_bf16 v[140:143], a[220:223], a[208:211], v[140:143]
  ds_read_b128 a[184:187], v53 offset:2048
  v_fma_f32 v183, v183, v62, v62
  v_mfma_f32_16x16x32_bf16 v[160:163], a[220:223], a[212:215], v[160:163]
  ds_read_b128 a[188:191], v53 offset:3072
  v_mul_f32 v80, v188, v188
  v_mfma_f32_16x16x32_bf16 v[104:107], a[224:227], a[200:203], v[104:107]
  ds_read_b128 a[192:195], v53 offset:4096
  v_mul_f32 v220, v188, v220
  v_mfma_f32_16x16x32_bf16 v[124:127], a[224:227], a[204:207], v[124:127]
  buffer_load_dwordx4 v46, s[48:51], s70 offen offset:2048 lds
  v_fma_f32 v80, v80, v63, v61
  v_mfma_f32_16x16x32_bf16 v[144:147], a[224:227], a[208:211], v[144:147]
  v_rcp_f32 v180, v180
  v_mfma_f32_16x16x32_bf16 v[164:167], a[224:227], a[212:215], v[164:167]
  v_rcp_f32 v181, v181
  v_mfma_f32_16x16x32_bf16 v[108:111], a[228:231], a[200:203], v[108:111]
  buffer_load_dwordx4 v47, s[48:51], s70 offen offset:3072 lds
  s_add_u32 s70, s70, 128
  v_mfma_f32_16x16x32_bf16 v[128:131], a[228:231], a[204:207], v[128:131]
  s_and_b32 s70, s70, 0x7ff
  v_mul_f32 v212, v212, v180
  v_mfma_f32_16x16x32_bf16 v[148:151], a[228:231], a[208:211], v[148:151]
  v_rcp_f32 v182, v182
  v_mfma_f32_16x16x32_bf16 v[168:171], a[228:231], a[212:215], v[168:171]
  v_rcp_f32 v183, v183
  v_mfma_f32_16x16x32_bf16 v[112:115], a[232:235], a[200:203], v[112:115]
  buffer_store_dwordx4 v[8:11], v1, s[8:11], s78 offen offset:1024 sc1
  v_mul_f32 v213, v213, v181
  v_mfma_f32_16x16x32_bf16 v[132:135], a[232:235], a[204:207], v[132:135]
  v_mul_f32 v214, v214, v182
  v_mul_f32 v215, v215, v183
  v_mfma_f32_16x16x32_bf16 v[152:155], a[232:235], a[208:211], v[152:155]
  s_add_u32 m0, s67, 53248
  v_cvt_pk_bf16_f32 v180, v212, v213
  v_mfma_f32_16x16x32_bf16 v[172:175], a[232:235], a[212:215], v[172:175]
  s_waitcnt lgkmcnt(0)
  v_cvt_pk_bf16_f32 v181, v214, v215
  v_mfma_f32_16x16x32_bf16 v[96:99], a[176:179], a[160:163], v[96:99]
  ds_read_b128 a[216:219], v53 offset:10240
  buffer_load_dwordx4 v54, s[8:11], s73 offen offset:0 sc1 lds
  v_mfma_f32_16x16x32_bf16 v[116:119], a[176:179], a[164:167], v[116:119]
  ds_read_b128 a[200:203], v51 offset:0
  v_mul_f32 v188, v80, v188
  v_mfma_f32_16x16x32_bf16 v[136:139], a[176:179], a[168:171], v[136:139]
  ds_read_b128 a[204:207], v51 offset:512
  buffer_load_dwordx4 v54, s[8:11], s73 offen offset:1024 sc1 lds
  v_mfma_f32_16x16x32_bf16 v[156:159], a[176:179], a[172:175], v[156:159]
  ds_read_b128 a[208:211], v51 offset:4096
  v_mul_f32 v81, v189, v189
  v_mfma_f32_16x16x32_bf16 v[100:103], a[180:183], a[160:163], v[100:103]
  ds_read_b128 a[212:215], v51 offset:4608
  v_mul_f32 v221, v189, v221
  v_mfma_f32_16x16x32_bf16 v[120:123], a[180:183], a[164:167], v[120:123]
  ds_read_b128 a[220:223], v53 offset:11264
  v_fma_f32 v81, v81, v63, v61
  v_mfma_f32_16x16x32_bf16 v[140:143], a[180:183], a[168:171], v[140:143]
  ds_read_b128 a[224:227], v53 offset:12288
  buffer_load_dwordx4 v54, s[8:11], s73 offen offset:2048 sc1 lds
  v_mfma_f32_16x16x32_bf16 v[160:163], a[180:183], a[172:175], v[160:163]
  ds_read_b128 a[228:231], v53 offset:13312
  v_mul_f32 v189, v81, v189
  v_mfma_f32_16x16x32_bf16 v[104:107], a[184:187], a[160:163], v[104:107]
  ds_read_b128 a[232:235], v53 offset:14336
  v_mul_f32 v82, v190, v190
  v_mfma_f32_16x16x32_bf16 v[124:127], a[184:187], a[164:167], v[124:127]
  buffer_load_dwordx4 v54, s[8:11], s73 offen offset:3072 sc1 lds
  s_add_u32 m0, s67, 57344
  v_mfma_f32_16x16x32_bf16 v[144:147], a[184:187], a[168:171], v[144:147]
  v_exp_f32 v188, v188
  v_mfma_f32_16x16x32_bf16 v[164:167], a[184:187], a[172:175], v[164:167]
  v_exp_f32 v189, v189
  v_mfma_f32_16x16x32_bf16 v[108:111], a[188:191], a[160:163], v[108:111]
  v_mul_f32 v222, v190, v222
  v_fma_f32 v82, v82, v63, v61
  v_mfma_f32_16x16x32_bf16 v[128:131], a[188:191], a[164:167], v[128:131]
  buffer_load_dwordx4 v55, s[8:11], s73 offen sc1 lds
  v_mul_f32 v190, v82, v190
  v_mfma_f32_16x16x32_bf16 v[148:151], a[188:191], a[168:171], v[148:151]
  v_exp_f32 v190, v190
  v_mfma_f32_16x16x32_bf16 v[168:171], a[188:191], a[172:175], v[168:171]
  v_mul_f32 v83, v191, v191
  v_mul_f32 v223, v191, v223
  v_mfma_f32_16x16x32_bf16 v[112:115], a[192:195], a[160:163], v[112:115]
  v_fma_f32 v83, v83, v63, v61
  v_mul_f32 v191, v83, v191
  v_mfma_f32_16x16x32_bf16 v[132:135], a[192:195], a[164:167], v[132:135]
  buffer_store_dwordx4 v[8:11], v1, s[8:11], s78 offen offset:2048 sc1
  v_fma_f32 v188, v188, v62, v62
  v_mfma_f32_16x16x32_bf16 v[152:155], a[192:195], a[168:171], v[152:155]
  v_exp_f32 v191, v191
  v_mfma_f32_16x16x32_bf16 v[172:175], a[192:195], a[172:175], v[172:175]
  s_waitcnt vmcnt(22) lgkmcnt(0)
  s_barrier
  v_fma_f32 v189, v189, v62, v62
  v_mfma_f32_16x16x32_bf16 v[96:99], a[216:219], a[200:203], v[96:99]
  ds_read_b128 a[176:179], v53 offset:36864
  s_add_u32 m0, s66, 73728
  v_mfma_f32_16x16x32_bf16 v[116:119], a[216:219], a[204:207], v[116:119]
  ds_read_b128 a[160:163], v50 offset:36864
  s_mul_i32 s74, s70, 160
  v_mfma_f32_16x16x32_bf16 v[136:139], a[216:219], a[208:211], v[136:139]
  ds_read_b128 a[164:167], v50 offset:37376
  buffer_load_dwordx4 v44, s[48:51], s70 offen offset:0 lds
  v_mfma_f32_16x16x32_bf16 v[156:159], a[216:219], a[212:215], v[156:159]
  ds_read_b128 a[168:171], v50 offset:40960
  buffer_load_dwordx4 v45, s[48:51], s70 offen offset:1024 lds
  v_mfma_f32_16x16x32_bf16 v[100:103], a[220:223], a[200:203], v[100:103]
  ds_read_b128 a[172:175], v50 offset:41472
  v_fma_f32 v190, v190, v62, v62
  v_mfma_f32_16x16x32_bf16 v[120:123], a[220:223], a[204:207], v[120:123]
  ds_read_b128 a[180:183], v53 offset:37888
  v_fma_f32 v191, v191, v62, v62
  v_mfma_f32_16x16x32_bf16 v[140:143], a[220:223], a[208:211], v[140:143]
  ds_read_b128 a[184:187], v53 offset:38912
  v_mfma_f32_16x16x32_bf16 v[160:163], a[220:223], a[212:215], v[160:163]
  ds_read_b128 a[188:191], v53 offset:39936
  buffer_load_dwordx4 v46, s[48:51], s70 offen offset:2048 lds
  v_mfma_f32_16x16x32_bf16 v[104:107], a[224:227], a[200:203], v[104:107]
  ds_read_b128 a[192:195], v53 offset:40960
  v_mfma_f32_16x16x32_bf16 v[124:127], a[224:227], a[204:207], v[124:127]
  v_rcp_f32 v188, v188
  v_mfma_f32_16x16x32_bf16 v[144:147], a[224:227], a[208:211], v[144:147]
  buffer_load_dwordx4 v47, s[48:51], s70 offen offset:3072 lds
  s_add_u32 s70, s70, 128
  v_mfma_f32_16x16x32_bf16 v[164:167], a[224:227], a[212:215], v[164:167]
  s_and_b32 s70, s70, 0x7ff
  v_mul_f32 v220, v220, v188
  v_mfma_f32_16x16x32_bf16 v[108:111], a[228:231], a[200:203], v[108:111]
  s_add_u32 m0, s67, 90112
  v_mfma_f32_16x16x32_bf16 v[128:131], a[228:231], a[204:207], v[128:131]
  v_rcp_f32 v189, v189
  v_mfma_f32_16x16x32_bf16 v[148:151], a[228:231], a[208:211], v[148:151]
  buffer_load_dwordx4 v54, s[8:11], s74 offen offset:0 sc1 lds
  v_mul_f32 v221, v221, v189
  v_mfma_f32_16x16x32_bf16 v[168:171], a[228:231], a[212:215], v[168:171]
  v_rcp_f32 v190, v190
  v_mfma_f32_16x16x32_bf16 v[112:115], a[232:235], a[200:203], v[112:115]
  v_rcp_f32 v191, v191
  v_mfma_f32_16x16x32_bf16 v[132:135], a[232:235], a[204:207], v[132:135]
  buffer_load_dwordx4 v54, s[8:11], s74 offen offset:1024 sc1 lds
  v_mul_f32 v222, v222, v190
  v_mfma_f32_16x16x32_bf16 v[152:155], a[232:235], a[208:211], v[152:155]
  v_mul_f32 v223, v223, v191
  v_cvt_pk_bf16_f32 v182, v220, v221
  v_mfma_f32_16x16x32_bf16 v[172:175], a[232:235], a[212:215], v[172:175]
  s_waitcnt lgkmcnt(0)
  v_cvt_pk_bf16_f32 v183, v222, v223
  v_mfma_f32_16x16x32_bf16 v[96:99], a[176:179], a[160:163], v[96:99]
  ds_read_b128 a[216:219], v53 offset:47104
  v_mfma_f32_16x16x32_bf16 v[116:119], a[176:179], a[164:167], v[116:119]
  ds_read_b128 a[200:203], v51 offset:36864
  buffer_load_dwordx4 v54, s[8:11], s74 offen offset:2048 sc1 lds
  v_mfma_f32_16x16x32_bf16 v[136:139], a[176:179], a[168:171], v[136:139]
  ds_read_b128 a[204:207], v51 offset:37376
  v_mfma_f32_16x16x32_bf16 v[156:159], a[176:179], a[172:175], v[156:159]
  ds_read_b128 a[208:211], v51 offset:40960
  v_mul_f32 v80, v192, v192
  v_mfma_f32_16x16x32_bf16 v[100:103], a[180:183], a[160:163], v[100:103]
  ds_read_b128 a[212:215], v51 offset:41472
  v_mul_f32 v224, v192, v224
  v_mfma_f32_16x16x32_bf16 v[120:123], a[180:183], a[164:167], v[120:123]
  ds_read_b128 a[220:223], v53 offset:48128
  buffer_load_dwordx4 v54, s[8:11], s74 offen offset:3072 sc1 lds
  v_mfma_f32_16x16x32_bf16 v[140:143], a[180:183], a[168:171], v[140:143]
  ds_read_b128 a[224:227], v53 offset:49152
  s_add_u32 m0, s67, 94208
  v_mfma_f32_16x16x32_bf16 v[160:163], a[180:183], a[172:175], v[160:163]
  ds_read_b128 a[228:231], v53 offset:50176
  v_fma_f32 v80, v80, v59, v57
  v_mfma_f32_16x16x32_bf16 v[104:107], a[184:187], a[160:163], v[104:107]
  ds_read_b128 a[232:235], v53 offset:51200
  buffer_load_dwordx4 v55, s[8:11], s74 offen sc1 lds
  v_mfma_f32_16x16x32_bf16 v[124:127], a[184:187], a[164:167], v[124:127]
  v_mul_f32 v192, v80, v192
  v_mul_f32 v81, v193, v193
  v_mfma_f32_16x16x32_bf16 v[144:147], a[184:187], a[168:171], v[144:147]
  v_exp_f32 v192, v192
  v_mfma_f32_16x16x32_bf16 v[164:167], a[184:187], a[172:175], v[164:167]
  v_mul_f32 v225, v193, v225
  v_fma_f32 v81, v81, v59, v57
  v_mfma_f32_16x16x32_bf16 v[108:111], a[188:191], a[160:163], v[108:111]
  buffer_store_dwordx4 v[8:11], v1, s[8:11], s78 offen offset:3072 sc1
  v_mul_f32 v193, v81, v193
  v_mfma_f32_16x16x32_bf16 v[128:131], a[188:191], a[164:167], v[128:131]
  v_exp_f32 v193, v193
  v_mfma_f32_16x16x32_bf16 v[148:151], a[188:191], a[168:171], v[148:151]
  v_mul_f32 v82, v194, v194
  v_mul_f32 v226, v194, v226
  v_mfma_f32_16x16x32_bf16 v[168:171], a[188:191], a[172:175], v[168:171]
  buffer_store_dwordx4 v[180:183], v1, s[8:11], s26 offen offset:1024 sc1
  v_fma_f32 v82, v82, v59, v57
  v_mfma_f32_16x16x32_bf16 v[112:115], a[192:195], a[160:163], v[112:115]
  v_mul_f32 v194, v82, v194
  v_mul_f32 v83, v195, v195
  v_mfma_f32_16x16x32_bf16 v[132:135], a[192:195], a[164:167], v[132:135]
  v_exp_f32 v194, v194
  v_mfma_f32_16x16x32_bf16 v[152:155], a[192:195], a[168:171], v[152:155]
  v_mul_f32 v227, v195, v227
  v_fma_f32 v83, v83, v59, v57
  v_mfma_f32_16x16x32_bf16 v[172:175], a[192:195], a[172:175], v[172:175]
  s_waitcnt vmcnt(23) lgkmcnt(0)
  s_barrier
  v_mul_f32 v195, v83, v195
  v_mfma_f32_16x16x32_bf16 v[96:99], a[216:219], a[200:203], v[96:99]
  ds_read_b128 a[176:179], v52 offset:0
  s_add_u32 m0, s66, 110592
  v_mfma_f32_16x16x32_bf16 v[116:119], a[216:219], a[204:207], v[116:119]
  ds_read_b128 a[160:163], v48 offset:0
  s_mul_i32 s75, s70, 160
  v_mfma_f32_16x16x32_bf16 v[136:139], a[216:219], a[208:211], v[136:139]
  ds_read_b128 a[164:167], v48 offset:512
  buffer_load_dwordx4 v44, s[48:51], s70 offen offset:0 lds
  v_mfma_f32_16x16x32_bf16 v[156:159], a[216:219], a[212:215], v[156:159]
  ds_read_b128 a[168:171], v48 offset:4096
  buffer_load_dwordx4 v45, s[48:51], s70 offen offset:1024 lds
  v_mfma_f32_16x16x32_bf16 v[100:103], a[220:223], a[200:203], v[100:103]
  ds_read_b128 a[172:175], v48 offset:4608
  v_fma_f32 v192, v192, v58, v58
  v_mfma_f32_16x16x32_bf16 v[120:123], a[220:223], a[204:207], v[120:123]
  ds_read_b128 a[180:183], v52 offset:1024
  v_fma_f32 v193, v193, v58, v58
  v_mfma_f32_16x16x32_bf16 v[140:143], a[220:223], a[208:211], v[140:143]
  ds_read_b128 a[184:187], v52 offset:2048
  buffer_load_dwordx4 v46, s[48:51], s70 offen offset:2048 lds
  v_mfma_f32_16x16x32_bf16 v[160:163], a[220:223], a[212:215], v[160:163]
  ds_read_b128 a[188:191], v52 offset:3072
  v_fma_f32 v194, v194, v58, v58
  v_mfma_f32_16x16x32_bf16 v[104:107], a[224:227], a[200:203], v[104:107]
  ds_read_b128 a[192:195], v52 offset:4096
  v_mul_f32 v80, v200, v200
  v_mfma_f32_16x16x32_bf16 v[124:127], a[224:227], a[204:207], v[124:127]
  v_exp_f32 v195, v195
  v_mfma_f32_16x16x32_bf16 v[144:147], a[224:227], a[208:211], v[144:147]
  buffer_load_dwordx4 v47, s[48:51], s70 offen offset:3072 lds
  s_add_u32 s70, s70, 128
  v_mfma_f32_16x16x32_bf16 v[164:167], a[224:227], a[212:215], v[164:167]
  s_and_b32 s70, s70, 0x7ff
  v_fma_f32 v195, v195, v58, v58
  v_mfma_f32_16x16x32_bf16 v[108:111], a[228:231], a[200:203], v[108:111]
  v_rcp_f32 v192, v192
  v_mfma_f32_16x16x32_bf16 v[128:131], a[228:231], a[204:207], v[128:131]
  buffer_store_dwordx4 v[8:11], v3, s[8:11], s78 offen offset:0 sc1
  v_mul_f32 v224, v224, v192
  v_mfma_f32_16x16x32_bf16 v[148:151], a[228:231], a[208:211], v[148:151]
  v_rcp_f32 v193, v193
  v_mfma_f32_16x16x32_bf16 v[168:171], a[228:231], a[212:215], v[168:171]
  s_add_u32 m0, s67, 126976
  v_mul_f32 v225, v225, v193
  v_mfma_f32_16x16x32_bf16 v[112:115], a[232:235], a[200:203], v[112:115]
  v_rcp_f32 v194, v194
  v_mfma_f32_16x16x32_bf16 v[132:135], a[232:235], a[204:207], v[132:135]
  buffer_load_dwordx4 v54, s[8:11], s75 offen offset:0 sc1 lds
  v_mul_f32 v226, v226, v194
  v_mfma_f32_16x16x32_bf16 v[152:155], a[232:235], a[208:211], v[152:155]
  v_rcp_f32 v195, v195
  v_mfma_f32_16x16x32_bf16 v[172:175], a[232:235], a[212:215], v[172:175]
  s_waitcnt lgkmcnt(0)
  v_mul_f32 v227, v227, v195
  v_mfma_f32_16x16x32_bf16 v[96:99], a[176:179], a[160:163], v[96:99]
  ds_read_b128 a[216:219], v52 offset:10240
  buffer_load_dwordx4 v54, s[8:11], s75 offen offset:1024 sc1 lds
  v_mfma_f32_16x16x32_bf16 v[116:119], a[176:179], a[164:167], v[116:119]
  ds_read_b128 a[200:203], v49 offset:0
  v_cvt_pk_bf16_f32 v192, v224, v225
  v_mfma_f32_16x16x32_bf16 v[136:139], a[176:179], a[168:171], v[136:139]
  ds_read_b128 a[204:207], v49 offset:512
  v_cvt_pk_bf16_f32 v193, v226, v227
  v_mfma_f32_16x16x32_bf16 v[156:159], a[176:179], a[172:175], v[156:159]
  ds_read_b128 a[208:211], v49 offset:4096
  buffer_load_dwordx4 v54, s[8:11], s75 offen offset:2048 sc1 lds
  v_mfma_f32_16x16x32_bf16 v[100:103], a[180:183], a[160:163], v[100:103]
  ds_read_b128 a[212:215], v49 offset:4608
  v_mul_f32 v232, v200, v232
  v_mfma_f32_16x16x32_bf16 v[120:123], a[180:183], a[164:167], v[120:123]
  ds_read_b128 a[220:223], v52 offset:11264
  v_fma_f32 v80, v80, v59, v57
  v_mfma_f32_16x16x32_bf16 v[140:143], a[180:183], a[168:171], v[140:143]
  ds_read_b128 a[224:227], v52 offset:12288
  v_mul_f32 v200, v80, v200
  v_mfma_f32_16x16x32_bf16 v[160:163], a[180:183], a[172:175], v[160:163]
  ds_read_b128 a[228:231], v52 offset:13312
  buffer_load_dwordx4 v54, s[8:11], s75 offen offset:3072 sc1 lds
  v_mfma_f32_16x16x32_bf16 v[104:107], a[184:187], a[160:163], v[104:107]
  ds_read_b128 a[232:235], v52 offset:14336
  s_add_u32 m0, s67, 131072
  v_mfma_f32_16x16x32_bf16 v[124:127], a[184:187], a[164:167], v[124:127]
  v_exp_f32 v200, v200
  v_mfma_f32_16x16x32_bf16 v[144:147], a[184:187], a[168:171], v[144:147]
  buffer_load_dwordx4 v55, s[8:11], s75 offen sc1 lds
  v_mul_f32 v81, v201, v201
  v_mfma_f32_16x16x32_bf16 v[164:167], a[184:187], a[172:175], v[164:167]
  v_mul_f32 v233, v201, v233
  v_fma_f32 v81, v81, v59, v57
  v_mfma_f32_16x16x32_bf16 v[108:111], a[188:191], a[160:163], v[108:111]
  v_mul_f32 v201, v81, v201
  v_mul_f32 v82, v202, v202
  v_mfma_f32_16x16x32_bf16 v[128:131], a[188:191], a[164:167], v[128:131]
  v_exp_f32 v201, v201
  v_mfma_f32_16x16x32_bf16 v[148:151], a[188:191], a[168:171], v[148:151]
  buffer_store_dwordx4 v[8:11], v3, s[8:11], s78 offen offset:1024 sc1
  v_mul_f32 v234, v202, v234
  v_mfma_f32_16x16x32_bf16 v[168:171], a[188:191], a[172:175], v[168:171]
  v_fma_f32 v82, v82, v59, v57
  v_mul_f32 v202, v82, v202
  v_mfma_f32_16x16x32_bf16 v[112:115], a[192:195], a[160:163], v[112:115]
  v_exp_f32 v202, v202
  v_mfma_f32_16x16x32_bf16 v[132:135], a[192:195], a[164:167], v[132:135]
  v_mul_f32 v83, v203, v203
  v_mul_f32 v235, v203, v235
  v_mfma_f32_16x16x32_bf16 v[152:155], a[192:195], a[168:171], v[152:155]
  v_fma_f32 v83, v83, v59, v57
  v_mul_f32 v203, v83, v203
  v_mfma_f32_16x16x32_bf16 v[172:175], a[192:195], a[172:175], v[172:175]
  s_waitcnt vmcnt(23) lgkmcnt(0)
  s_barrier
  v_fma_f32 v200, v200, v58, v58
  v_mfma_f32_16x16x32_bf16 v[96:99], a[216:219], a[200:203], v[96:99]
  ds_read_b128 a[176:179], v52 offset:36864
  buffer_load_dword v73, v89, s[8:11], s31 offen sc1
  v_mfma_f32_16x16x32_bf16 v[116:119], a[216:219], a[204:207], v[116:119]
  ds_read_b128 a[160:163], v48 offset:36864
  s_add_u32 m0, s66, 0
  v_mfma_f32_16x16x32_bf16 v[136:139], a[216:219], a[208:211], v[136:139]
  ds_read_b128 a[164:167], v48 offset:37376
  s_mul_i32 s72, s70, 160
  v_mfma_f32_16x16x32_bf16 v[156:159], a[216:219], a[212:215], v[156:159]
  ds_read_b128 a[168:171], v48 offset:40960
  buffer_load_dwordx4 v44, s[48:51], s70 offen offset:0 lds
  v_mfma_f32_16x16x32_bf16 v[100:103], a[220:223], a[200:203], v[100:103]
  ds_read_b128 a[172:175], v48 offset:41472
  buffer_load_dwordx4 v45, s[48:51], s70 offen offset:1024 lds
  v_mfma_f32_16x16x32_bf16 v[120:123], a[220:223], a[204:207], v[120:123]
  ds_read_b128 a[180:183], v52 offset:37888
  v_fma_f32 v201, v201, v58, v58
  v_mfma_f32_16x16x32_bf16 v[140:143], a[220:223], a[208:211], v[140:143]
  ds_read_b128 a[184:187], v52 offset:38912
  v_fma_f32 v202, v202, v58, v58
  v_mfma_f32_16x16x32_bf16 v[160:163], a[220:223], a[212:215], v[160:163]
  ds_read_b128 a[188:191], v52 offset:39936
  buffer_load_dwordx4 v46, s[48:51], s70 offen offset:2048 lds
  v_mfma_f32_16x16x32_bf16 v[104:107], a[224:227], a[200:203], v[104:107]
  ds_read_b128 a[192:195], v52 offset:40960
  v_mfma_f32_16x16x32_bf16 v[124:127], a[224:227], a[204:207], v[124:127]
  v_exp_f32 v203, v203
  v_mfma_f32_16x16x32_bf16 v[144:147], a[224:227], a[208:211], v[144:147]
  v_rcp_f32 v200, v200
  v_mfma_f32_16x16x32_bf16 v[164:167], a[224:227], a[212:215], v[164:167]
  buffer_load_dwordx4 v47, s[48:51], s70 offen offset:3072 lds
  s_add_u32 s70, s70, 128
  v_mfma_f32_16x16x32_bf16 v[108:111], a[228:231], a[200:203], v[108:111]
  s_and_b32 s70, s70, 0x7ff
  s_add_u32 m0, s67, 16384
  v_mfma_f32_16x16x32_bf16 v[128:131], a[228:231], a[204:207], v[128:131]
  v_rcp_f32 v201, v201
  v_mfma_f32_16x16x32_bf16 v[148:151], a[228:231], a[208:211], v[148:151]
  buffer_load_dwordx4 v54, s[8:11], s72 offen offset:0 sc1 lds
  v_fma_f32 v203, v203, v58, v58
  v_mfma_f32_16x16x32_bf16 v[168:171], a[228:231], a[212:215], v[168:171]
  v_rcp_f32 v202, v202
  v_mfma_f32_16x16x32_bf16 v[112:115], a[232:235], a[200:203], v[112:115]
  v_rcp_f32 v203, v203
  v_mfma_f32_16x16x32_bf16 v[132:135], a[232:235], a[204:207], v[132:135]
  v_mul_f32 v232, v232, v200
  v_mul_f32 v233, v233, v201
  v_mfma_f32_16x16x32_bf16 v[152:155], a[232:235], a[208:211], v[152:155]
  buffer_load_dwordx4 v54, s[8:11], s72 offen offset:1024 sc1 lds
  v_mul_f32 v234, v234, v202
  v_mfma_f32_16x16x32_bf16 v[172:175], a[232:235], a[212:215], v[172:175]
  s_waitcnt lgkmcnt(0)
  v_mul_f32 v235, v235, v203
  v_mfma_f32_16x16x32_bf16 v[96:99], a[176:179], a[160:163], v[96:99]
  ds_read_b128 a[216:219], v52 offset:47104
  v_cvt_pk_bf16_f32 v194, v232, v233
  v_mfma_f32_16x16x32_bf16 v[116:119], a[176:179], a[164:167], v[116:119]
  ds_read_b128 a[200:203], v49 offset:36864
  buffer_load_dwordx4 v54, s[8:11], s72 offen offset:2048 sc1 lds
  v_mfma_f32_16x16x32_bf16 v[136:139], a[176:179], a[168:171], v[136:139]
  ds_read_b128 a[204:207], v49 offset:37376
  v_cvt_pk_bf16_f32 v195, v234, v235
  v_mfma_f32_16x16x32_bf16 v[156:159], a[176:179], a[172:175], v[156:159]
  ds_read_b128 a[208:211], v49 offset:40960
  v_mfma_f32_16x16x32_bf16 v[100:103], a[180:183], a[160:163], v[100:103]
  ds_read_b128 a[212:215], v49 offset:41472
  v_mfma_f32_16x16x32_bf16 v[120:123], a[180:183], a[164:167], v[120:123]
  ds_read_b128 a[220:223], v52 offset:48128
  buffer_load_dwordx4 v54, s[8:11], s72 offen offset:3072 sc1 lds
  v_mfma_f32_16x16x32_bf16 v[140:143], a[180:183], a[168:171], v[140:143]
  ds_read_b128 a[224:227], v52 offset:49152
  s_add_u32 m0, s67, 20480
  v_mfma_f32_16x16x32_bf16 v[160:163], a[180:183], a[172:175], v[160:163]
  ds_read_b128 a[228:231], v52 offset:50176
  v_mfma_f32_16x16x32_bf16 v[104:107], a[184:187], a[160:163], v[104:107]
  ds_read_b128 a[232:235], v52 offset:51200
  v_mfma_f32_16x16x32_bf16 v[124:127], a[184:187], a[164:167], v[124:127]
  buffer_load_dwordx4 v55, s[8:11], s72 offen sc1 lds
  v_mfma_f32_16x16x32_bf16 v[144:147], a[184:187], a[168:171], v[144:147]
  v_mfma_f32_16x16x32_bf16 v[164:167], a[184:187], a[172:175], v[164:167]
  v_mul_f32 v80, v196, v196
  v_mul_f32 v228, v196, v228
  v_mfma_f32_16x16x32_bf16 v[108:111], a[188:191], a[160:163], v[108:111]
  buffer_store_dwordx4 v[8:11], v3, s[8:11], s78 offen offset:2048 sc1
  v_fma_f32 v80, v80, v63, v61
  v_mfma_f32_16x16x32_bf16 v[128:131], a[188:191], a[164:167], v[128:131]
  v_mul_f32 v196, v80, v196
  v_mul_f32 v81, v197, v197
  v_mfma_f32_16x16x32_bf16 v[148:151], a[188:191], a[168:171], v[148:151]
  v_exp_f32 v196, v196
  v_mfma_f32_16x16x32_bf16 v[168:171], a[188:191], a[172:175], v[168:171]
  v_mul_f32 v229, v197, v229
  v_fma_f32 v81, v81, v63, v61
  v_mfma_f32_16x16x32_bf16 v[112:115], a[192:195], a[160:163], v[112:115]
  buffer_store_dwordx4 v[192:195], v1, s[8:11], s27 offen offset:0 sc1
  v_mul_f32 v197, v81, v197
  v_mfma_f32_16x16x32_bf16 v[132:135], a[192:195], a[164:167], v[132:135]
  v_exp_f32 v197, v197
  v_mfma_f32_16x16x32_bf16 v[152:155], a[192:195], a[168:171], v[152:155]
  v_mul_f32 v82, v198, v198
  v_mul_f32 v230, v198, v230
  v_mfma_f32_16x16x32_bf16 v[172:175], a[192:195], a[172:175], v[172:175]
  s_waitcnt vmcnt(25) lgkmcnt(0)
  s_barrier
  v_fma_f32 v82, v82, v63, v61
  v_mfma_f32_16x16x32_bf16 v[96:99], a[216:219], a[200:203], v[96:99]
  ds_read_b128 a[176:179], v53 offset:0
  s_add_u32 m0, s66, 36864
  v_mfma_f32_16x16x32_bf16 v[116:119], a[216:219], a[204:207], v[116:119]
  ds_read_b128 a[160:163], v50 offset:0
  s_mul_i32 s73, s70, 160
  v_mfma_f32_16x16x32_bf16 v[136:139], a[216:219], a[208:211], v[136:139]
  ds_read_b128 a[164:167], v50 offset:512
  buffer_load_dwordx4 v44, s[48:51], s70 offen offset:0 lds
  v_mfma_f32_16x16x32_bf16 v[156:159], a[216:219], a[212:215], v[156:159]
  ds_read_b128 a[168:171], v50 offset:4096
  buffer_load_dwordx4 v45, s[48:51], s70 offen offset:1024 lds
  v_mfma_f32_16x16x32_bf16 v[100:103], a[220:223], a[200:203], v[100:103]
  ds_read_b128 a[172:175], v50 offset:4608
  v_mul_f32 v198, v82, v198
  v_mfma_f32_16x16x32_bf16 v[120:123], a[220:223], a[204:207], v[120:123]
  ds_read_b128 a[180:183], v53 offset:1024
  v_mul_f32 v83, v199, v199
  v_mfma_f32_16x16x32_bf16 v[140:143], a[220:223], a[208:211], v[140:143]
  ds_read_b128 a[184:187], v53 offset:2048
  buffer_load_dwordx4 v46, s[48:51], s70 offen offset:2048 lds
  v_mfma_f32_16x16x32_bf16 v[160:163], a[220:223], a[212:215], v[160:163]
  ds_read_b128 a[188:191], v53 offset:3072
  v_mul_f32 v231, v199, v231
  v_mfma_f32_16x16x32_bf16 v[104:107], a[224:227], a[200:203], v[104:107]
  ds_read_b128 a[192:195], v53 offset:4096
  v_fma_f32 v83, v83, v63, v61
  v_mfma_f32_16x16x32_bf16 v[124:127], a[224:227], a[204:207], v[124:127]
  v_exp_f32 v198, v198
  v_mfma_f32_16x16x32_bf16 v[144:147], a[224:227], a[208:211], v[144:147]
  buffer_load_dwordx4 v47, s[48:51], s70 offen offset:3072 lds
  s_add_u32 s70, s70, 128
  v_mfma_f32_16x16x32_bf16 v[164:167], a[224:227], a[212:215], v[164:167]
  s_and_b32 s70, s70, 0x7ff
  v_mul_f32 v199, v83, v199
  v_mfma_f32_16x16x32_bf16 v[108:111], a[228:231], a[200:203], v[108:111]
  v_exp_f32 v199, v199
  v_mfma_f32_16x16x32_bf16 v[128:131], a[228:231], a[204:207], v[128:131]
  buffer_store_dwordx4 v[8:11], v3, s[8:11], s78 offen offset:3072 sc1
  v_fma_f32 v196, v196, v62, v62
  v_mfma_f32_16x16x32_bf16 v[148:151], a[228:231], a[208:211], v[148:151]
  v_rcp_f32 v196, v196
  v_mfma_f32_16x16x32_bf16 v[168:171], a[228:231], a[212:215], v[168:171]
  s_add_u32 m0, s67, 53248
  v_fma_f32 v197, v197, v62, v62
  v_mfma_f32_16x16x32_bf16 v[112:115], a[232:235], a[200:203], v[112:115]
  v_rcp_f32 v197, v197
  v_mfma_f32_16x16x32_bf16 v[132:135], a[232:235], a[204:207], v[132:135]
  buffer_load_dwordx4 v54, s[8:11], s73 offen offset:0 sc1 lds
  v_fma_f32 v198, v198, v62, v62
  v_mfma_f32_16x16x32_bf16 v[152:155], a[232:235], a[208:211], v[152:155]
  v_rcp_f32 v198, v198
  v_mfma_f32_16x16x32_bf16 v[172:175], a[232:235], a[212:215], v[172:175]
  s_waitcnt lgkmcnt(0)
  v_fma_f32 v199, v199, v62, v62
  v_mfma_f32_16x16x32_bf16 v[96:99], a[176:179], a[160:163], v[96:99]
  ds_read_b128 a[216:219], v53 offset:10240
  buffer_load_dwordx4 v54, s[8:11], s73 offen offset:1024 sc1 lds
  v_mfma_f32_16x16x32_bf16 v[116:119], a[176:179], a[164:167], v[116:119]
  ds_read_b128 a[200:203], v51 offset:0
  v_mul_f32 v228, v228, v196
  v_mfma_f32_16x16x32_bf16 v[136:139], a[176:179], a[168:171], v[136:139]
  ds_read_b128 a[204:207], v51 offset:512
  v_mul_f32 v229, v229, v197
  v_mfma_f32_16x16x32_bf16 v[156:159], a[176:179], a[172:175], v[156:159]
  ds_read_b128 a[208:211], v51 offset:4096
  buffer_load_dwordx4 v54, s[8:11], s73 offen offset:2048 sc1 lds
  v_mfma_f32_16x16x32_bf16 v[100:103], a[180:183], a[160:163], v[100:103]
  ds_read_b128 a[212:215], v51 offset:4608
  v_mul_f32 v230, v230, v198
  v_mfma_f32_16x16x32_bf16 v[120:123], a[180:183], a[164:167], v[120:123]
  ds_read_b128 a[220:223], v53 offset:11264
  v_cvt_pk_bf16_f32 v196, v228, v229
  v_mfma_f32_16x16x32_bf16 v[140:143], a[180:183], a[168:171], v[140:143]
  ds_read_b128 a[224:227], v53 offset:12288
  v_mul_f32 v80, v204, v204
  v_mfma_f32_16x16x32_bf16 v[160:163], a[180:183], a[172:175], v[160:163]
  ds_read_b128 a[228:231], v53 offset:13312
  buffer_load_dwordx4 v54, s[8:11], s73 offen offset:3072 sc1 lds
  v_mfma_f32_16x16x32_bf16 v[104:107], a[184:187], a[160:163], v[104:107]
  ds_read_b128 a[232:235], v53 offset:14336
  s_add_u32 m0, s67, 57344
  v_mfma_f32_16x16x32_bf16 v[124:127], a[184:187], a[164:167], v[124:127]
  v_rcp_f32 v199, v199
  v_mfma_f32_16x16x32_bf16 v[144:147], a[184:187], a[168:171], v[144:147]
  buffer_load_dwordx4 v55, s[8:11], s73 offen sc1 lds
  v_mul_f32 v231, v231, v199
  v_mfma_f32_16x16x32_bf16 v[164:167], a[184:187], a[172:175], v[164:167]
  v_cvt_pk_bf16_f32 v197, v230, v231
  v_mul_f32 v236, v204, v236
  v_mfma_f32_16x16x32_bf16 v[108:111], a[188:191], a[160:163], v[108:111]
  v_fma_f32 v80, v80, v63, v61
  v_mul_f32 v204, v80, v204
  v_mfma_f32_16x16x32_bf16 v[128:131], a[188:191], a[164:167], v[128:131]
  s_add_u32 s83, s78, 8192
  v_mul_f32 v81, v205, v205
  v_mfma_f32_16x16x32_bf16 v[148:151], a[188:191], a[168:171], v[148:151]
  buffer_store_dwordx4 v[8:11], v1, s[8:11], s83 offen offset:0 sc1
  v_mul_f32 v237, v205, v237
  v_mfma_f32_16x16x32_bf16 v[168:171], a[188:191], a[172:175], v[168:171]
  v_exp_f32 v204, v204
  v_mfma_f32_16x16x32_bf16 v[112:115], a[192:195], a[160:163], v[112:115]
  v_fma_f32 v81, v81, v63, v61
  v_mul_f32 v205, v81, v205
  v_mfma_f32_16x16x32_bf16 v[132:135], a[192:195], a[164:167], v[132:135]
  v_exp_f32 v205, v205
  v_mfma_f32_16x16x32_bf16 v[152:155], a[192:195], a[168:171], v[152:155]
  v_mul_f32 v82, v206, v206
  v_mul_f32 v238, v206, v238
  v_mfma_f32_16x16x32_bf16 v[172:175], a[192:195], a[172:175], v[172:175]
  s_waitcnt vmcnt(24) lgkmcnt(0)
  s_barrier
  v_fma_f32 v82, v82, v63, v61
  v_mfma_f32_16x16x32_bf16 v[96:99], a[216:219], a[200:203], v[96:99]
  ds_read_b128 a[176:179], v53 offset:36864
  s_waitcnt vmcnt(22)
  v_cmp_ne_u32 vcc, s64, v73
  s_cbranch_vccnz O_slow4
O_ok4:
  v_mfma_f32_16x16x32_bf16 v[116:119], a[216:219], a[204:207], v[116:119]
  ds_read_b128 a[160:163], v50 offset:36864
  s_add_u32 m0, s66, 73728
  v_mfma_f32_16x16x32_bf16 v[136:139], a[216:219], a[208:211], v[136:139]
  ds_read_b128 a[164:167], v50 offset:37376
  s_mul_i32 s74, s70, 160
  v_mfma_f32_16x16x32_bf16 v[156:159], a[216:219], a[212:215], v[156:159]
  ds_read_b128 a[168:171], v50 offset:40960
  buffer_load_dwordx4 v44, s[48:51], s70 offen offset:0 lds
  v_mfma_f32_16x16x32_bf16 v[100:103], a[220:223], a[200:203], v[100:103]
  ds_read_b128 a[172:175], v50 offset:41472
  buffer_load_dwordx4 v45, s[48:51], s70 offen offset:1024 lds
  v_mfma_f32_16x16x32_bf16 v[120:123], a[220:223], a[204:207], v[120:123]
  ds_read_b128 a[180:183], v53 offset:37888
  v_mul_f32 v206, v82, v206
  v_mfma_f32_16x16x32_bf16 v[140:143], a[220:223], a[208:211], v[140:143]
  ds_read_b128 a[184:187], v53 offset:38912
  v_mul_f32 v83, v207, v207
  v_mfma_f32_16x16x32_bf16 v[160:163], a[220:223], a[212:215], v[160:163]
  ds_read_b128 a[188:191], v53 offset:39936
  buffer_load_dwordx4 v46, s[48:51], s70 offen offset:2048 lds
  v_mfma_f32_16x16x32_bf16 v[104:107], a[224:227], a[200:203], v[104:107]
  ds_read_b128 a[192:195], v53 offset:40960
  v_mul_f32 v239, v207, v239
  v_mfma_f32_16x16x32_bf16 v[124:127], a[224:227], a[204:207], v[124:127]
  v_exp_f32 v206, v206
  v_mfma_f32_16x16x32_bf16 v[144:147], a[224:227], a[208:211], v[144:147]
  v_fma_f32 v83, v83, v63, v61
  v_mul_f32 v207, v83, v207
  v_mfma_f32_16x16x32_bf16 v[164:167], a[224:227], a[212:215], v[164:167]
  buffer_load_dwordx4 v47, s[48:51], s70 offen offset:3072 lds
  s_add_u32 s70, s70, 128
  v_mfma_f32_16x16x32_bf16 v[108:111], a[228:231], a[200:203], v[108:111]
  s_and_b32 s70, s70, 0x7ff
  s_add_u32 m0, s67, 90112
  v_mfma_f32_16x16x32_bf16 v[128:131], a[228:231], a[204:207], v[128:131]
  v_exp_f32 v207, v207
  v_mfma_f32_16x16x32_bf16 v[148:151], a[228:231], a[208:211], v[148:151]
  buffer_load_dwordx4 v54, s[8:11], s74 offen offset:0 sc1 lds
  v_fma_f32 v204, v204, v62, v62
  v_mfma_f32_16x16x32_bf16 v[168:171], a[228:231], a[212:215], v[168:171]
  v_rcp_f32 v204, v204
  v_mfma_f32_16x16x32_bf16 v[112:115], a[232:235], a[200:203], v[112:115]
  v_fma_f32 v205, v205, v62, v62
  v_fma_f32 v206, v206, v62, v62
  v_mfma_f32_16x16x32_bf16 v[132:135], a[232:235], a[204:207], v[132:135]
  v_rcp_f32 v205, v205
  v_mfma_f32_16x16x32_bf16 v[152:155], a[232:235], a[208:211], v[152:155]
  buffer_load_dwordx4 v54, s[8:11], s74 offen offset:1024 sc1 lds
  v_fma_f32 v207, v207, v62, v62
  v_mfma_f32_16x16x32_bf16 v[172:175], a[232:235], a[212:215], v[172:175]
  s_waitcnt lgkmcnt(0)
  v_mul_f32 v236, v236, v204
  v_mfma_f32_16x16x32_bf16 v[96:99], a[176:179], a[160:163], v[96:99]
  ds_read_b128 a[216:219], v53 offset:47104
  v_mul_f32 v237, v237, v205
  v_mfma_f32_16x16x32_bf16 v[116:119], a[176:179], a[164:167], v[116:119]
  ds_read_b128 a[200:203], v51 offset:36864
  buffer_load_dwordx4 v54, s[8:11], s74 offen offset:2048 sc1 lds
  v_mfma_f32_16x16x32_bf16 v[136:139], a[176:179], a[168:171], v[136:139]
  ds_read_b128 a[204:207], v51 offset:37376
  v_cvt_pk_bf16_f32 v198, v236, v237
  v_mfma_f32_16x16x32_bf16 v[156:159], a[176:179], a[172:175], v[156:159]
  ds_read_b128 a[208:211], v51 offset:40960
  v_mfma_f32_16x16x32_bf16 v[100:103], a[180:183], a[160:163], v[100:103]
  ds_read_b128 a[212:215], v51 offset:41472
  v_mfma_f32_16x16x32_bf16 v[120:123], a[180:183], a[164:167], v[120:123]
  ds_read_b128 a[220:223], v53 offset:48128
  buffer_load_dwordx4 v54, s[8:11], s74 offen offset:3072 sc1 lds
  v_mfma_f32_16x16x32_bf16 v[140:143], a[180:183], a[168:171], v[140:143]
  ds_read_b128 a[224:227], v53 offset:49152
  s_add_u32 m0, s67, 94208
  v_mfma_f32_16x16x32_bf16 v[160:163], a[180:183], a[172:175], v[160:163]
  ds_read_b128 a[228:231], v53 offset:50176
  v_mfma_f32_16x16x32_bf16 v[104:107], a[184:187], a[160:163], v[104:107]
  ds_read_b128 a[232:235], v53 offset:51200
  v_mfma_f32_16x16x32_bf16 v[124:127], a[184:187], a[164:167], v[124:127]
  buffer_load_dwordx4 v55, s[8:11], s74 offen sc1 lds
  v_mfma_f32_16x16x32_bf16 v[144:147], a[184:187], a[168:171], v[144:147]
  v_rcp_f32 v206, v206
  v_mfma_f32_16x16x32_bf16 v[164:167], a[184:187], a[172:175], v[164:167]
  v_rcp_f32 v207, v207
  v_mfma_f32_16x16x32_bf16 v[108:111], a[188:191], a[160:163], v[108:111]
  buffer_store_dwordx4 v[8:11], v1, s[8:11], s83 offen offset:1024 sc1
  v_mul_f32 v238, v238, v206
  v_mfma_f32_16x16x32_bf16 v[128:131], a[188:191], a[164:167], v[128:131]
  v_mul_f32 v239, v239, v207
  v_cvt_pk_bf16_f32 v199, v238, v239
  v_mfma_f32_16x16x32_bf16 v[148:151], a[188:191], a[168:171], v[148:151]
  v_mfma_f32_16x16x32_bf16 v[168:171], a[188:191], a[172:175], v[168:171]
  v_mfma_f32_16x16x32_bf16 v[112:115], a[192:195], a[160:163], v[112:115]
  v_mfma_f32_16x16x32_bf16 v[132:135], a[192:195], a[164:167], v[132:135]
  v_mfma_f32_16x16x32_bf16 v[152:155], a[192:195], a[168:171], v[152:155]
  v_mfma_f32_16x16x32_bf16 v[172:175], a[192:195], a[172:175], v[172:175]
  s_waitcnt vmcnt(23) lgkmcnt(0)
  s_barrier
  buffer_store_dwordx4 v[196:199], v1, s[8:11], s27 offen offset:1024 sc1
  v_mfma_f32_16x16x32_bf16 v[96:99], a[216:219], a[200:203], v[96:99]
  ds_read_b128 a[176:179], v52 offset:0
  s_add_u32 s82, s76, 0
  v_mfma_f32_16x16x32_bf16 v[116:119], a[216:219], a[204:207], v[116:119]
  ds_read_b128 a[160:163], v48 offset:0
  buffer_load_dwordx4 v[176:179], v76, s[8:11], s82 offen sc1
  v_mfma_f32_16x16x32_bf16 v[136:139], a[216:219], a[208:211], v[136:139]
  ds_read_b128 a[164:167], v48 offset:512
  v_and_b32 v84, 15, v2
  v_mfma_f32_16x16x32_bf16 v[156:159], a[216:219], a[212:215], v[156:159]
  ds_read_b128 a[168:171], v48 offset:4096
  buffer_load_dwordx4 v[180:183], v77, s[8:11], s82 offen sc1
  v_mfma_f32_16x16x32_bf16 v[100:103], a[220:223], a[200:203], v[100:103]
  ds_read_b128 a[172:175], v48 offset:4608
  v_lshrrev_b32 v85, 4, v2
  v_mfma_f32_16x16x32_bf16 v[120:123], a[220:223], a[204:207], v[120:123]
  ds_read_b128 a[180:183], v52 offset:1024
  v_lshlrev_b32 v85, 2, v85
  v_mfma_f32_16x16x32_bf16 v[140:143], a[220:223], a[208:211], v[140:143]
  ds_read_b128 a[184:187], v52 offset:2048
  v_sub_u32 v84, v84, v85
  v_mfma_f32_16x16x32_bf16 v[160:163], a[220:223], a[212:215], v[160:163]
  ds_read_b128 a[188:191], v52 offset:3072
  buffer_load_dwordx4 v[184:187], v78, s[8:11], s82 offen sc1
  v_mfma_f32_16x16x32_bf16 v[104:107], a[224:227], a[200:203], v[104:107]
  ds_read_b128 a[192:195], v52 offset:4096
  v_lshlrev_b32 v85, 4, v84
  v_mfma_f32_16x16x32_bf16 v[124:127], a[224:227], a[204:207], v[124:127]
  v_mov_b32 v86, 0x3f80
  v_lshlrev_b32 v85, v85, v86
  v_mfma_f32_16x16x32_bf16 v[144:147], a[224:227], a[208:211], v[144:147]
  buffer_load_dwordx4 v[188:191], v79, s[8:11], s82 offen sc1
  v_lshrrev_b32 v84, 1, v84
  v_mfma_f32_16x16x32_bf16 v[164:167], a[224:227], a[212:215], v[164:167]
  v_mov_b32 v56, 0
  v_mov_b32 v57, 0
  v_mfma_f32_16x16x32_bf16 v[108:111], a[228:231], a[200:203], v[108:111]
  s_add_u32 m0, s66, 110592
  s_mul_i32 s75, s70, 160
  v_mfma_f32_16x16x32_bf16 v[128:131], a[228:231], a[204:207], v[128:131]
  v_mov_b32 v60, 0
  v_mov_b32 v61, 0
  v_mfma_f32_16x16x32_bf16 v[148:151], a[228:231], a[208:211], v[148:151]
  buffer_load_dwordx4 v44, s[48:51], s70 offen offset:0 lds
  v_mfma_f32_16x16x32_bf16 v[168:171], a[228:231], a[212:215], v[168:171]
  v_cmp_eq_u32 vcc, 0, v84
  s_nop 1
  v_cndmask_b32 v58, 0, v85, vcc
  v_mfma_f32_16x16x32_bf16 v[112:115], a[232:235], a[200:203], v[112:115]
  v_cmp_eq_u32 vcc, 1, v84
  s_nop 1
  v_cndmask_b32 v59, 0, v85, vcc
  v_mfma_f32_16x16x32_bf16 v[132:135], a[232:235], a[204:207], v[132:135]
  buffer_load_dwordx4 v45, s[48:51], s70 offen offset:1024 lds
  v_mfma_f32_16x16x32_bf16 v[152:155], a[232:235], a[208:211], v[152:155]
  s_bitcmp1_b32 s3, 0
  s_cselect_b64 vcc, -1, 0
  v_cndmask_b32 v62, v58, v56, vcc
  v_cndmask_b32 v63, v59, v57, vcc
  v_cndmask_b32 v64, v60, v58, vcc
  v_cndmask_b32 v65, v61, v59, vcc
  v_mfma_f32_16x16x32_bf16 v[172:175], a[232:235], a[212:215], v[172:175]
  s_waitcnt lgkmcnt(0)
  s_add_u32 s4, s76, 32768
  v_mfma_f32_16x16x32_bf16 v[96:99], a[176:179], a[160:163], v[96:99]
  ds_read_b128 a[216:219], v52 offset:10240
  s_add_u32 s5, s76, 36864
  v_mfma_f32_16x16x32_bf16 v[116:119], a[176:179], a[164:167], v[116:119]
  ds_read_b128 a[200:203], v49 offset:0
  buffer_load_dwordx4 v46, s[48:51], s70 offen offset:2048 lds
  v_mfma_f32_16x16x32_bf16 v[136:139], a[176:179], a[168:171], v[136:139]
  ds_read_b128 a[204:207], v49 offset:512
  s_add_u32 s6, s76, 40960
  v_mfma_f32_16x16x32_bf16 v[156:159], a[176:179], a[172:175], v[156:159]
  ds_read_b128 a[208:211], v49 offset:4096
  s_add_u32 s7, s76, 45056
  v_mfma_f32_16x16x32_bf16 v[100:103], a[180:183], a[160:163], v[100:103]
  ds_read_b128 a[212:215], v49 offset:4608
  v_lshlrev_b32 v24, 16, v4
  v_mfma_f32_16x16x32_bf16 v[120:123], a[180:183], a[164:167], v[120:123]
  ds_read_b128 a[220:223], v52 offset:11264
  buffer_load_dwordx4 v47, s[48:51], s70 offen offset:3072 lds
  v_mfma_f32_16x16x32_bf16 v[140:143], a[180:183], a[168:171], v[140:143]
  ds_read_b128 a[224:227], v52 offset:12288
  s_add_u32 s70, s70, 128
  v_mfma_f32_16x16x32_bf16 v[160:163], a[180:183], a[172:175], v[160:163]
  ds_read_b128 a[228:231], v52 offset:13312
  s_and_b32 s70, s70, 0x7ff
  v_mfma_f32_16x16x32_bf16 v[104:107], a[184:187], a[160:163], v[104:107]
  ds_read_b128 a[232:235], v52 offset:14336
  s_add_u32 m0, s67, 126976
  v_mfma_f32_16x16x32_bf16 v[124:127], a[184:187], a[164:167], v[124:127]
  buffer_load_dwordx4 v54, s[8:11], s75 offen offset:0 sc1 lds
  v_and_b32 v25, 0xffff0000, v4
  v_mfma_f32_16x16x32_bf16 v[144:147], a[184:187], a[168:171], v[144:147]
  v_lshlrev_b32 v26, 16, v5
  v_and_b32 v27, 0xffff0000, v5
  v_mfma_f32_16x16x32_bf16 v[164:167], a[184:187], a[172:175], v[164:167]
  v_lshlrev_b32 v28, 16, v6
  v_and_b32 v29, 0xffff0000, v6
  v_mfma_f32_16x16x32_bf16 v[108:111], a[188:191], a[160:163], v[108:111]
  buffer_load_dwordx4 v54, s[8:11], s75 offen offset:1024 sc1 lds
  v_lshlrev_b32 v30, 16, v7
  v_mfma_f32_16x16x32_bf16 v[128:131], a[188:191], a[164:167], v[128:131]
  v_and_b32 v31, 0xffff0000, v7
  v_lshlrev_b32 v32, 16, v12
  v_mfma_f32_16x16x32_bf16 v[148:151], a[188:191], a[168:171], v[148:151]
  v_and_b32 v33, 0xffff0000, v12
  v_lshlrev_b32 v34, 16, v13
  v_mfma_f32_16x16x32_bf16 v[168:171], a[188:191], a[172:175], v[168:171]
  buffer_load_dwordx4 v54, s[8:11], s75 offen offset:2048 sc1 lds
  v_and_b32 v35, 0xffff0000, v13
  v_mfma_f32_16x16x32_bf16 v[112:115], a[192:195], a[160:163], v[112:115]
  v_lshlrev_b32 v36, 16, v14
  v_and_b32 v37, 0xffff0000, v14
  v_mfma_f32_16x16x32_bf16 v[132:135], a[192:195], a[164:167], v[132:135]
  v_lshlrev_b32 v38, 16, v15
  v_and_b32 v39, 0xffff0000, v15
  v_mfma_f32_16x16x32_bf16 v[152:155], a[192:195], a[168:171], v[152:155]
  v_lshlrev_b32 v40, 16, v18
  v_and_b32 v41, 0xffff0000, v18
  v_mfma_f32_16x16x32_bf16 v[172:175], a[192:195], a[172:175], v[172:175]
  s_waitcnt vmcnt(23) lgkmcnt(0)
  s_barrier
  buffer_load_dwordx4 v54, s[8:11], s75 offen offset:3072 sc1 lds
  v_mfma_f32_16x16x32_bf16 v[96:99], a[216:219], a[200:203], v[96:99]
  ds_read_b128 a[176:179], v52 offset:36864
  s_add_u32 m0, s67, 131072
  v_mfma_f32_16x16x32_bf16 v[116:119], a[216:219], a[204:207], v[116:119]
  ds_read_b128 a[160:163], v48 offset:36864
  v_lshlrev_b32 v42, 16, v19
  v_mfma_f32_16x16x32_bf16 v[136:139], a[216:219], a[208:211], v[136:139]
  ds_read_b128 a[164:167], v48 offset:37376
  v_and_b32 v43, 0xffff0000, v19
  v_mfma_f32_16x16x32_bf16 v[156:159], a[216:219], a[212:215], v[156:159]
  ds_read_b128 a[168:171], v48 offset:40960
  buffer_load_dwordx4 v55, s[8:11], s75 offen sc1 lds
  v_mfma_f32_16x16x32_bf16 v[100:103], a[220:223], a[200:203], v[100:103]
  ds_read_b128 a[172:175], v48 offset:41472
  s_add_u32 m0, s66, 0
  v_mfma_f32_16x16x32_bf16 v[120:123], a[220:223], a[204:207], v[120:123]
  ds_read_b128 a[180:183], v52 offset:37888
  s_mul_i32 s72, s70, 160
  v_mfma_f32_16x16x32_bf16 v[140:143], a[220:223], a[208:211], v[140:143]
  ds_read_b128 a[184:187], v52 offset:38912
  buffer_load_dwordx4 v44, s[48:51], s70 offen offset:0 lds
  v_mfma_f32_16x16x32_bf16 v[160:163], a[220:223], a[212:215], v[160:163]
  ds_read_b128 a[188:191], v52 offset:39936
  v_add_u32 v70, s37, v1
  v_mfma_f32_16x16x32_bf16 v[104:107], a[224:227], a[200:203], v[104:107]
  ds_read_b128 a[192:195], v52 offset:40960
  v_mfma_f32_16x16x32_bf16 v[124:127], a[224:227], a[204:207], v[124:127]
  v_mfma_f32_16x16x32_bf16 v[144:147], a[224:227], a[208:211], v[144:147]
  buffer_load_dwordx4 v45, s[48:51], s70 offen offset:1024 lds
  v_mfma_f32_16x16x32_bf16 v[164:167], a[224:227], a[212:215], v[164:167]
  v_mfma_f32_16x16x32_bf16 v[108:111], a[228:231], a[200:203], v[108:111]
  v_mfma_f32_16x16x32_bf16 v[128:131], a[228:231], a[204:207], v[128:131]
  buffer_load_dwordx4 v46, s[48:51], s70 offen offset:2048 lds
  v_mfma_f32_16x16x32_bf16 v[148:151], a[228:231], a[208:211], v[148:151]
  v_mfma_f32_16x16x32_bf16 v[168:171], a[228:231], a[212:215], v[168:171]
  v_mfma_f32_16x16x32_bf16 v[112:115], a[232:235], a[200:203], v[112:115]
  v_mfma_f32_16x16x32_bf16 v[132:135], a[232:235], a[204:207], v[132:135]
  buffer_load_dwordx4 v47, s[48:51], s70 offen offset:3072 lds
  s_add_u32 s70, s70, 128
  v_mfma_f32_16x16x32_bf16 v[152:155], a[232:235], a[208:211], v[152:155]
  s_and_b32 s70, s70, 0x7ff
  v_mfma_f32_16x16x32_bf16 v[172:175], a[232:235], a[212:215], v[172:175]
  s_waitcnt lgkmcnt(0)
  s_add_u32 m0, s67, 16384
  v_mfma_f32_16x16x32_bf16 v[96:99], a[176:179], a[160:163], v[96:99]
  ds_read_b128 a[216:219], v52 offset:47104
  v_mfma_f32_16x16x32_bf16 v[116:119], a[176:179], a[164:167], v[116:119]
  ds_read_b128 a[200:203], v49 offset:36864
  buffer_load_dwordx4 v54, s[8:11], s72 offen offset:0 sc1 lds
  v_mfma_f32_16x16x32_bf16 v[136:139], a[176:179], a[168:171], v[136:139]
  ds_read_b128 a[204:207], v49 offset:37376
  v_mfma_f32_16x16x32_bf16 v[156:159], a[176:179], a[172:175], v[156:159]
  ds_read_b128 a[208:211], v49 offset:40960
  v_mfma_f32_16x16x32_bf16 v[100:103], a[180:183], a[160:163], v[100:103]
  ds_read_b128 a[212:215], v49 offset:41472
  buffer_load_dwordx4 v54, s[8:11], s72 offen offset:1024 sc1 lds
  v_mfma_f32_16x16x32_bf16 v[120:123], a[180:183], a[164:167], v[120:123]
  ds_read_b128 a[220:223], v52 offset:48128
  v_mfma_f32_16x16x32_bf16 v[140:143], a[180:183], a[168:171], v[140:143]
  ds_read_b128 a[224:227], v52 offset:49152
  v_mfma_f32_16x16x32_bf16 v[160:163], a[180:183], a[172:175], v[160:163]
  ds_read_b128 a[228:231], v52 offset:50176
  v_mfma_f32_16x16x32_bf16 v[104:107], a[184:187], a[160:163], v[104:107]
  ds_read_b128 a[232:235], v52 offset:51200
  buffer_load_dwordx4 v54, s[8:11], s72 offen offset:2048 sc1 lds
  v_mfma_f32_16x16x32_bf16 v[124:127], a[184:187], a[164:167], v[124:127]
  v_mfma_f32_16x16x32_bf16 v[144:147], a[184:187], a[168:171], v[144:147]
  v_mfma_f32_16x16x32_bf16 v[164:167], a[184:187], a[172:175], v[164:167]
  buffer_load_dwordx4 v54, s[8:11], s72 offen offset:3072 sc1 lds
  s_add_u32 m0, s67, 20480
  v_mfma_f32_16x16x32_bf16 v[108:111], a[188:191], a[160:163], v[108:111]
  v_mfma_f32_16x16x32_bf16 v[128:131], a[188:191], a[164:167], v[128:131]
  v_mfma_f32_16x16x32_bf16 v[148:151], a[188:191], a[168:171], v[148:151]
  v_mfma_f32_16x16x32_bf16 v[168:171], a[188:191], a[172:175], v[168:171]
  buffer_load_dwordx4 v55, s[8:11], s72 offen sc1 lds
  v_mfma_f32_16x16x32_bf16 v[112:115], a[192:195], a[160:163], v[112:115]
  v_mfma_f32_16x16x32_bf16 v[132:135], a[192:195], a[164:167], v[132:135]
  v_mfma_f32_16x16x32_bf16 v[152:155], a[192:195], a[168:171], v[152:155]
  v_mfma_f32_16x16x32_bf16 v[172:175], a[192:195], a[172:175], v[172:175]
  s_waitcnt vmcnt(24) lgkmcnt(0)
  s_barrier
  s_waitcnt vmcnt(22)
  buffer_store_dword v71, v72, s[8:11], s29 offen sc1
  v_mfma_f32_16x16x32_bf16 v[96:99], a[216:219], a[200:203], v[96:99]
  ds_read_b128 a[176:179], v53 offset:0
  s_add_u32 m0, s66, 36864
  v_mfma_f32_16x16x32_bf16 v[116:119], a[216:219], a[204:207], v[116:119]
  ds_read_b128 a[160:163], v50 offset:0
  s_mul_i32 s73, s70, 160
  v_mfma_f32_16x16x32_bf16 v[136:139], a[216:219], a[208:211], v[136:139]
  ds_read_b128 a[164:167], v50 offset:512
  buffer_load_dwordx4 v44, s[48:51], s70 offen offset:0 lds
  v_mfma_f32_16x16x32_bf16 v[156:159], a[216:219], a[212:215], v[156:159]
  ds_read_b128 a[168:171], v50 offset:4096
  buffer_load_dwordx4 v45, s[48:51], s70 offen offset:1024 lds
  v_mfma_f32_16x16x32_bf16 v[100:103], a[220:223], a[200:203], v[100:103]
  ds_read_b128 a[172:175], v50 offset:4608
  v_mfma_f32_16x16x32_bf16 v[120:123], a[220:223], a[204:207], v[120:123]
  ds_read_b128 a[180:183], v53 offset:1024
  v_mfma_f32_16x16x32_bf16 v[140:143], a[220:223], a[208:211], v[140:143]
  ds_read_b128 a[184:187], v53 offset:2048
  buffer_load_dwordx4 v46, s[48:51], s70 offen offset:2048 lds
  v_mfma_f32_16x16x32_bf16 v[160:163], a[220:223], a[212:215], v[160:163]
  ds_read_b128 a[188:191], v53 offset:3072
  v_mfma_f32_16x16x32_bf16 v[104:107], a[224:227], a[200:203], v[104:107]
  ds_read_b128 a[192:195], v53 offset:4096
  v_mfma_f32_16x16x32_bf16 v[124:127], a[224:227], a[204:207], v[124:127]
  v_mfma_f32_16x16x32_bf16 v[144:147], a[224:227], a[208:211], v[144:147]
  buffer_load_dwordx4 v47, s[48:51], s70 offen offset:3072 lds
  s_add_u32 s70, s70, 128
  v_mfma_f32_16x16x32_bf16 v[164:167], a[224:227], a[212:215], v[164:167]
  s_and_b32 s70, s70, 0x7ff
  v_mfma_f32_16x16x32_bf16 v[108:111], a[228:231], a[200:203], v[108:111]
  s_add_u32 m0, s67, 53248
  v_mfma_f32_16x16x32_bf16 v[128:131], a[228:231], a[204:207], v[128:131]
  v_mfma_f32_16x16x32_bf16 v[148:151], a[228:231], a[208:211], v[148:151]
  buffer_load_dwordx4 v54, s[8:11], s73 offen offset:0 sc1 lds
  v_mfma_f32_16x16x32_bf16 v[168:171], a[228:231], a[212:215], v[168:171]
  v_mfma_f32_16x16x32_bf16 v[112:115], a[232:235], a[200:203], v[112:115]
  v_mfma_f32_16x16x32_bf16 v[132:135], a[232:235], a[204:207], v[132:135]
  buffer_load_dwordx4 v54, s[8:11], s73 offen offset:1024 sc1 lds
  v_mfma_f32_16x16x32_bf16 v[152:155], a[232:235], a[208:211], v[152:155]
  v_mfma_f32_16x16x32_bf16 v[172:175], a[232:235], a[212:215], v[172:175]
  s_waitcnt lgkmcnt(0)
  v_mfma_f32_16x16x32_bf16 v[96:99], a[176:179], a[160:163], v[96:99]
  ds_read_b128 a[216:219], v53 offset:10240
  v_mfma_f32_16x16x32_bf16 v[116:119], a[176:179], a[164:167], v[116:119]
  ds_read_b128 a[200:203], v51 offset:0
  buffer_load_dwordx4 v54, s[8:11], s73 offen offset:2048 sc1 lds
  v_mfma_f32_16x16x32_bf16 v[136:139], a[176:179], a[168:171], v[136:139]
  ds_read_b128 a[204:207], v51 offset:512
  v_mfma_f32_16x16x32_bf16 v[156:159], a[176:179], a[172:175], v[156:159]
  ds_read_b128 a[208:211], v51 offset:4096
  v_mfma_f32_16x16x32_bf16 v[100:103], a[180:183], a[160:163], v[100:103]
  ds_read_b128 a[212:215], v51 offset:4608
  buffer_load_dwordx4 v54, s[8:11], s73 offen offset:3072 sc1 lds
  v_mfma_f32_16x16x32_bf16 v[120:123], a[180:183], a[164:167], v[120:123]
  ds_read_b128 a[220:223], v53 offset:11264
  s_add_u32 m0, s67, 57344
  v_mfma_f32_16x16x32_bf16 v[140:143], a[180:183], a[168:171], v[140:143]
  ds_read_b128 a[224:227], v53 offset:12288
  v_mfma_f32_16x16x32_bf16 v[160:163], a[180:183], a[172:175], v[160:163]
  ds_read_b128 a[228:231], v53 offset:13312
  v_mfma_f32_16x16x32_bf16 v[104:107], a[184:187], a[160:163], v[104:107]
  ds_read_b128 a[232:235], v53 offset:14336
  buffer_load_dwordx4 v55, s[8:11], s73 offen sc1 lds
  v_mfma_f32_16x16x32_bf16 v[124:127], a[184:187], a[164:167], v[124:127]
  v_mfma_f32_16x16x32_bf16 v[144:147], a[184:187], a[168:171], v[144:147]
  s_add_u32 s82, s76, 4096
  v_mfma_f32_16x16x32_bf16 v[164:167], a[184:187], a[172:175], v[164:167]
  v_mfma_f32_16x16x32_bf16 v[108:111], a[188:191], a[160:163], v[108:111]
  buffer_load_dwordx4 v[192:195], v76, s[8:11], s82 offen sc1
  v_mfma_f32_16x16x32_bf16 v[128:131], a[188:191], a[164:167], v[128:131]
  v_mfma_f32_16x16x32_bf16 v[148:151], a[188:191], a[168:171], v[148:151]
  v_mfma_f32_16x16x32_bf16 v[168:171], a[188:191], a[172:175], v[168:171]
  buffer_load_dwordx4 v[196:199], v77, s[8:11], s82 offen sc1
  v_mfma_f32_16x16x32_bf16 v[112:115], a[192:195], a[160:163], v[112:115]
  v_mfma_f32_16x16x32_bf16 v[132:135], a[192:195], a[164:167], v[132:135]
  v_mfma_f32_16x16x32_bf16 v[152:155], a[192:195], a[168:171], v[152:155]
  v_mfma_f32_16x16x32_bf16 v[172:175], a[192:195], a[172:175], v[172:175]
  s_waitcnt vmcnt(21) lgkmcnt(0)
  s_barrier
  buffer_load_dwordx4 v[200:203], v78, s[8:11], s82 offen sc1
  v_mfma_f32_16x16x32_bf16 v[96:99], a[216:219], a[200:203], v[96:99]
  ds_read_b128 a[176:179], v53 offset:36864
  v_mfma_f32_16x16x32_bf16 v[116:119], a[216:219], a[204:207], v[116:119]
  ds_read_b128 a[160:163], v50 offset:36864
  v_mfma_f32_16x16x32_bf16 v[136:139], a[216:219], a[208:211], v[136:139]
  ds_read_b128 a[164:167], v50 offset:37376
  buffer_load_dwordx4 v[204:207], v79, s[8:11], s82 offen sc1
  v_mfma_f32_16x16x32_bf16 v[156:159], a[216:219], a[212:215], v[156:159]
  ds_read_b128 a[168:171], v50 offset:40960
  v_mfma_f32_16x16x32_bf16 v[100:103], a[220:223], a[200:203], v[100:103]
  ds_read_b128 a[172:175], v50 offset:41472
  s_add_u32 m0, s66, 73728
  v_mfma_f32_16x16x32_bf16 v[120:123], a[220:223], a[204:207], v[120:123]
  ds_read_b128 a[180:183], v53 offset:37888
  s_mul_i32 s74, s70, 160
  v_mfma_f32_16x16x32_bf16 v[140:143], a[220:223], a[208:211], v[140:143]
  ds_read_b128 a[184:187], v53 offset:38912
  buffer_load_dwordx4 v44, s[48:51], s70 offen offset:0 lds
  v_mfma_f32_16x16x32_bf16 v[160:163], a[220:223], a[212:215], v[160:163]
  ds_read_b128 a[188:191], v53 offset:39936
  v_mfma_f32_16x16x32_bf16 v[104:107], a[224:227], a[200:203], v[104:107]
  ds_read_b128 a[192:195], v53 offset:40960
  v_mfma_f32_16x16x32_bf16 v[124:127], a[224:227], a[204:207], v[124:127]
  v_mfma_f32_16x16x32_bf16 v[144:147], a[224:227], a[208:211], v[144:147]
  buffer_load_dwordx4 v45, s[48:51], s70 offen offset:1024 lds
  v_mfma_f32_16x16x32_bf16 v[164:167], a[224:227], a[212:215], v[164:167]
  v_mfma_f32_16x16x32_bf16 v[108:111], a[228:231], a[200:203], v[108:111]
  v_mfma_f32_16x16x32_bf16 v[128:131], a[228:231], a[204:207], v[128:131]
  buffer_load_dwordx4 v46, s[48:51], s70 offen offset:2048 lds
  v_mfma_f32_16x16x32_bf16 v[148:151], a[228:231], a[208:211], v[148:151]
  v_mfma_f32_16x16x32_bf16 v[168:171], a[228:231], a[212:215], v[168:171]
  v_mfma_f32_16x16x32_bf16 v[112:115], a[232:235], a[200:203], v[112:115]
  v_mfma_f32_16x16x32_bf16 v[132:135], a[232:235], a[204:207], v[132:135]
  buffer_load_dwordx4 v47, s[48:51], s70 offen offset:3072 lds
  s_add_u32 s70, s70, 128
  v_mfma_f32_16x16x32_bf16 v[152:155], a[232:235], a[208:211], v[152:155]
  s_and_b32 s70, s70, 0x7ff
  s_add_u32 m0, s67, 90112
  v_mfma_f32_16x16x32_bf16 v[172:175], a[232:235], a[212:215], v[172:175]
  s_waitcnt lgkmcnt(0)
  v_add_u32 v44, s66, v1
  v_mfma_f32_16x16x32_bf16 v[96:99], a[176:179], a[160:163], v[96:99]
  ds_read_b128 a[216:219], v53 offset:47104
  buffer_load_dwordx4 v54, s[8:11], s74 offen offset:0 sc1 lds
  v_mfma_f32_16x16x32_bf16 v[116:119], a[176:179], a[164:167], v[116:119]
  ds_read_b128 a[200:203], v51 offset:36864
  v_add_u32 v45, 110592, v44
  v_mfma_f32_16x16x32_bf16 v[136:139], a[176:179], a[168:171], v[136:139]
  ds_read_b128 a[204:207], v51 offset:37376
  v_mfma_f32_16x16x32_bf16 v[156:159], a[176:179], a[172:175], v[156:159]
  ds_read_b128 a[208:211], v51 offset:40960
  v_mfma_f32_16x16x32_bf16 v[100:103], a[180:183], a[160:163], v[100:103]
  ds_read_b128 a[212:215], v51 offset:41472
  buffer_load_dwordx4 v54, s[8:11], s74 offen offset:1024 sc1 lds
  v_mfma_f32_16x16x32_bf16 v[120:123], a[180:183], a[164:167], v[120:123]
  ds_read_b128 a[220:223], v53 offset:48128
  v_mfma_f32_16x16x32_bf16 v[140:143], a[180:183], a[168:171], v[140:143]
  ds_read_b128 a[224:227], v53 offset:49152
  v_mfma_f32_16x16x32_bf16 v[160:163], a[180:183], a[172:175], v[160:163]
  ds_read_b128 a[228:231], v53 offset:50176
  v_mfma_f32_16x16x32_bf16 v[104:107], a[184:187], a[160:163], v[104:107]
  ds_read_b128 a[232:235], v53 offset:51200
  buffer_load_dwordx4 v54, s[8:11], s74 offen offset:2048 sc1 lds
  v_mfma_f32_16x16x32_bf16 v[124:127], a[184:187], a[164:167], v[124:127]
  v_mfma_f32_16x16x32_bf16 v[144:147], a[184:187], a[168:171], v[144:147]
  v_mfma_f32_16x16x32_bf16 v[164:167], a[184:187], a[172:175], v[164:167]
  buffer_load_dwordx4 v54, s[8:11], s74 offen offset:3072 sc1 lds
  s_add_u32 m0, s67, 94208
  v_mfma_f32_16x16x32_bf16 v[108:111], a[188:191], a[160:163], v[108:111]
  v_mfma_f32_16x16x32_bf16 v[128:131], a[188:191], a[164:167], v[128:131]
  v_mfma_f32_16x16x32_bf16 v[148:151], a[188:191], a[168:171], v[148:151]
  v_mfma_f32_16x16x32_bf16 v[168:171], a[188:191], a[172:175], v[168:171]
  buffer_load_dwordx4 v55, s[8:11], s74 offen sc1 lds
  v_mfma_f32_16x16x32_bf16 v[112:115], a[192:195], a[160:163], v[112:115]
  v_lshlrev_b32 v88, 7, v2
  v_mfma_f32_16x16x32_bf16 v[132:135], a[192:195], a[164:167], v[132:135]
  v_mfma_f32_16x16x32_bf16 v[152:155], a[192:195], a[168:171], v[152:155]
  buffer_load_dword v73, v91, s[8:11], s31 offen sc1
  v_mfma_f32_16x16x32_bf16 v[172:175], a[192:195], a[172:175], v[172:175]
  s_waitcnt vmcnt(24) lgkmcnt(0)
  s_barrier
  v_mfma_f32_16x16x32_bf16 v[96:99], a[216:219], a[200:203], v[96:99]
  ds_read_b128 a[176:179], v52 offset:0
  s_add_u32 s82, s76, 8192
  v_mfma_f32_16x16x32_bf16 v[116:119], a[216:219], a[204:207], v[116:119]
  ds_read_b128 a[160:163], v48 offset:0
  v_mfma_f32_16x16x32_bf16 v[136:139], a[216:219], a[208:211], v[136:139]
  ds_read_b128 a[164:167], v48 offset:512
  buffer_load_dwordx4 v[208:211], v76, s[8:11], s82 offen sc1
  v_mfma_f32_16x16x32_bf16 v[156:159], a[216:219], a[212:215], v[156:159]
  ds_read_b128 a[168:171], v48 offset:4096
  buffer_load_dwordx4 v[212:215], v77, s[8:11], s82 offen sc1
  v_mfma_f32_16x16x32_bf16 v[100:103], a[220:223], a[200:203], v[100:103]
  ds_read_b128 a[172:175], v48 offset:4608
  v_mfma_f32_16x16x32_bf16 v[120:123], a[220:223], a[204:207], v[120:123]
  ds_read_b128 a[180:183], v52 offset:1024
  v_mfma_f32_16x16x32_bf16 v[140:143], a[220:223], a[208:211], v[140:143]
  ds_read_b128 a[184:187], v52 offset:2048
  buffer_load_dwordx4 v[216:219], v78, s[8:11], s82 offen sc1
  v_mfma_f32_16x16x32_bf16 v[160:163], a[220:223], a[212:215], v[160:163]
  ds_read_b128 a[188:191], v52 offset:3072
  v_mfma_f32_16x16x32_bf16 v[104:107], a[224:227], a[200:203], v[104:107]
  ds_read_b128 a[192:195], v52 offset:4096
  v_mfma_f32_16x16x32_bf16 v[124:127], a[224:227], a[204:207], v[124:127]
  v_mfma_f32_16x16x32_bf16 v[144:147], a[224:227], a[208:211], v[144:147]
  buffer_load_dwordx4 v[220:223], v79, s[8:11], s82 offen sc1
  v_mfma_f32_16x16x32_bf16 v[164:167], a[224:227], a[212:215], v[164:167]
  s_add_u32 s82, s76, 12288
  v_mfma_f32_16x16x32_bf16 v[108:111], a[228:231], a[200:203], v[108:111]
  v_mfma_f32_16x16x32_bf16 v[128:131], a[228:231], a[204:207], v[128:131]
  buffer_load_dwordx4 v[224:227], v76, s[8:11], s82 offen sc1
  v_mfma_f32_16x16x32_bf16 v[148:151], a[228:231], a[208:211], v[148:151]
  v_mfma_f32_16x16x32_bf16 v[168:171], a[228:231], a[212:215], v[168:171]
  v_mfma_f32_16x16x32_bf16 v[112:115], a[232:235], a[200:203], v[112:115]
  v_mfma_f32_16x16x32_bf16 v[132:135], a[232:235], a[204:207], v[132:135]
  buffer_load_dwordx4 v[228:231], v77, s[8:11], s82 offen sc1
  v_mfma_f32_16x16x32_bf16 v[152:155], a[232:235], a[208:211], v[152:155]
  v_mfma_f32_16x16x32_bf16 v[172:175], a[232:235], a[212:215], v[172:175]
  s_waitcnt lgkmcnt(0)
  v_mfma_f32_16x16x32_bf16 v[96:99], a[176:179], a[160:163], v[96:99]
  ds_read_b128 a[216:219], v52 offset:10240
  buffer_load_dwordx4 v[232:235], v78, s[8:11], s82 offen sc1
  v_mfma_f32_16x16x32_bf16 v[116:119], a[176:179], a[164:167], v[116:119]
  ds_read_b128 a[200:203], v49 offset:0
  v_mfma_f32_16x16x32_bf16 v[136:139], a[176:179], a[168:171], v[136:139]
  ds_read_b128 a[204:207], v49 offset:512
  v_mfma_f32_16x16x32_bf16 v[156:159], a[176:179], a[172:175], v[156:159]
  ds_read_b128 a[208:211], v49 offset:4096
  v_mfma_f32_16x16x32_bf16 v[100:103], a[180:183], a[160:163], v[100:103]
  ds_read_b128 a[212:215], v49 offset:4608
  buffer_load_dwordx4 v[236:239], v79, s[8:11], s82 offen sc1
  v_mfma_f32_16x16x32_bf16 v[120:123], a[180:183], a[164:167], v[120:123]
  ds_read_b128 a[220:223], v52 offset:11264
  v_mfma_f32_16x16x32_bf16 v[140:143], a[180:183], a[168:171], v[140:143]
  ds_read_b128 a[224:227], v52 offset:12288
  s_add_u32 s81, s77, 327680
  v_mfma_f32_16x16x32_bf16 v[160:163], a[180:183], a[172:175], v[160:163]
  ds_read_b128 a[228:231], v52 offset:13312
  s_add_u32 m0, s66, 110592
  v_mfma_f32_16x16x32_bf16 v[104:107], a[184:187], a[160:163], v[104:107]
  ds_read_b128 a[232:235], v52 offset:14336
  buffer_load_dwordx4 v1, s[8:11], s81 offen offset:0 sc1 lds
  v_mfma_f32_16x16x32_bf16 v[124:127], a[184:187], a[164:167], v[124:127]
  v_mfma_f32_16x16x32_bf16 v[144:147], a[184:187], a[168:171], v[144:147]
  v_mfma_f32_16x16x32_bf16 v[164:167], a[184:187], a[172:175], v[164:167]
  buffer_load_dwordx4 v1, s[8:11], s81 offen offset:1024 sc1 lds
  v_mfma_f32_16x16x32_bf16 v[108:111], a[188:191], a[160:163], v[108:111]
  v_mfma_f32_16x16x32_bf16 v[128:131], a[188:191], a[164:167], v[128:131]
  v_mfma_f32_16x16x32_bf16 v[148:151], a[188:191], a[168:171], v[148:151]
  v_mfma_f32_16x16x32_bf16 v[168:171], a[188:191], a[172:175], v[168:171]
  buffer_load_dwordx4 v1, s[8:11], s81 offen offset:2048 sc1 lds
  v_mfma_f32_16x16x32_bf16 v[112:115], a[192:195], a[160:163], v[112:115]
  v_mfma_f32_16x16x32_bf16 v[132:135], a[192:195], a[164:167], v[132:135]
  v_mfma_f32_16x16x32_bf16 v[152:155], a[192:195], a[168:171], v[152:155]
  buffer_load_dwordx4 v1, s[8:11], s81 offen offset:3072 sc1 lds
  s_add_u32 m0, s66, 143360
  v_mfma_f32_16x16x32_bf16 v[172:175], a[192:195], a[172:175], v[172:175]
  s_waitcnt vmcnt(26) lgkmcnt(0)
  s_barrier
  v_mfma_f32_16x16x32_bf16 v[96:99], a[216:219], a[200:203], v[96:99]
  ds_read_b128 a[176:179], v52 offset:36864
  v_mfma_f32_16x16x32_bf16 v[116:119], a[216:219], a[204:207], v[116:119]
  ds_read_b128 a[160:163], v48 offset:36864
  v_mfma_f32_16x16x32_bf16 v[136:139], a[216:219], a[208:211], v[136:139]
  ds_read_b128 a[164:167], v48 offset:37376
  buffer_load_dwordx4 v3, s[8:11], s81 offen sc1 lds
  v_mfma_f32_16x16x32_bf16 v[156:159], a[216:219], a[212:215], v[156:159]
  ds_read_b128 a[168:171], v48 offset:40960
  v_mfma_f32_16x16x32_bf16 v[100:103], a[220:223], a[200:203], v[100:103]
  ds_read_b128 a[172:175], v48 offset:41472
  s_add_u32 s81, s77, 368640
  v_mfma_f32_16x16x32_bf16 v[120:123], a[220:223], a[204:207], v[120:123]
  ds_read_b128 a[180:183], v52 offset:37888
  s_add_u32 m0, s66, 126976
  v_mfma_f32_16x16x32_bf16 v[140:143], a[220:223], a[208:211], v[140:143]
  ds_read_b128 a[184:187], v52 offset:38912
  buffer_load_dwordx4 v1, s[8:11], s81 offen offset:0 sc1 lds
  v_mfma_f32_16x16x32_bf16 v[160:163], a[220:223], a[212:215], v[160:163]
  ds_read_b128 a[188:191], v52 offset:39936
  v_mfma_f32_16x16x32_bf16 v[104:107], a[224:227], a[200:203], v[104:107]
  ds_read_b128 a[192:195], v52 offset:40960
  v_mfma_f32_16x16x32_bf16 v[124:127], a[224:227], a[204:207], v[124:127]
  buffer_load_dwordx4 v1, s[8:11], s81 offen offset:1024 sc1 lds
  v_mfma_f32_16x16x32_bf16 v[144:147], a[224:227], a[208:211], v[144:147]
  v_mfma_f32_16x16x32_bf16 v[164:167], a[224:227], a[212:215], v[164:167]
  v_mfma_f32_16x16x32_bf16 v[108:111], a[228:231], a[200:203], v[108:111]
  v_mfma_f32_16x16x32_bf16 v[128:131], a[228:231], a[204:207], v[128:131]
  buffer_load_dwordx4 v1, s[8:11], s81 offen offset:2048 sc1 lds
  v_mfma_f32_16x16x32_bf16 v[148:151], a[228:231], a[208:211], v[148:151]
  v_mfma_f32_16x16x32_bf16 v[168:171], a[228:231], a[212:215], v[168:171]
  v_mfma_f32_16x16x32_bf16 v[112:115], a[232:235], a[200:203], v[112:115]
  buffer_load_dwordx4 v1, s[8:11], s81 offen offset:3072 sc1 lds
  s_add_u32 m0, s66, 144384
  v_mfma_f32_16x16x32_bf16 v[132:135], a[232:235], a[204:207], v[132:135]
  v_mfma_f32_16x16x32_bf16 v[152:155], a[232:235], a[208:211], v[152:155]
  v_mfma_f32_16x16x32_bf16 v[172:175], a[232:235], a[212:215], v[172:175]
  s_waitcnt lgkmcnt(0)
  v_mfma_f32_16x16x32_bf16 v[96:99], a[176:179], a[160:163], v[96:99]
  ds_read_b128 a[216:219], v52 offset:47104
  buffer_load_dwordx4 v3, s[8:11], s81 offen sc1 lds
  v_mfma_f32_16x16x32_bf16 v[116:119], a[176:179], a[164:167], v[116:119]
  ds_read_b128 a[200:203], v49 offset:36864
  v_mfma_f32_16x16x32_bf16 v[136:139], a[176:179], a[168:171], v[136:139]
  ds_read_b128 a[204:207], v49 offset:37376
  s_add_u32 s81, s77, 409600
  v_mfma_f32_16x16x32_bf16 v[156:159], a[176:179], a[172:175], v[156:159]
  ds_read_b128 a[208:211], v49 offset:40960
  s_add_u32 m0, s66, 0
  v_mfma_f32_16x16x32_bf16 v[100:103], a[180:183], a[160:163], v[100:103]
  ds_read_b128 a[212:215], v49 offset:41472
  buffer_load_dwordx4 v1, s[8:11], s81 offen offset:0 sc1 lds
  v_mfma_f32_16x16x32_bf16 v[120:123], a[180:183], a[164:167], v[120:123]
  ds_read_b128 a[220:223], v52 offset:48128
  v_mfma_f32_16x16x32_bf16 v[140:143], a[180:183], a[168:171], v[140:143]
  ds_read_b128 a[224:227], v52 offset:49152
  v_mfma_f32_16x16x32_bf16 v[160:163], a[180:183], a[172:175], v[160:163]
  ds_read_b128 a[228:231], v52 offset:50176
  buffer_load_dwordx4 v1, s[8:11], s81 offen offset:1024 sc1 lds
  v_mfma_f32_16x16x32_bf16 v[104:107], a[184:187], a[160:163], v[104:107]
  ds_read_b128 a[232:235], v52 offset:51200
  v_mfma_f32_16x16x32_bf16 v[124:127], a[184:187], a[164:167], v[124:127]
  v_mfma_f32_16x16x32_bf16 v[144:147], a[184:187], a[168:171], v[144:147]
  v_mfma_f32_16x16x32_bf16 v[164:167], a[184:187], a[172:175], v[164:167]
  buffer_load_dwordx4 v1, s[8:11], s81 offen offset:2048 sc1 lds
  v_mfma_f32_16x16x32_bf16 v[108:111], a[188:191], a[160:163], v[108:111]
  v_mfma_f32_16x16x32_bf16 v[128:131], a[188:191], a[164:167], v[128:131]
  v_mfma_f32_16x16x32_bf16 v[148:151], a[188:191], a[168:171], v[148:151]
  buffer_load_dwordx4 v1, s[8:11], s81 offen offset:3072 sc1 lds
  s_add_u32 m0, s66, 145408
  v_mfma_f32_16x16x32_bf16 v[168:171], a[188:191], a[172:175], v[168:171]
  v_mfma_f32_16x16x32_bf16 v[112:115], a[192:195], a[160:163], v[112:115]
  v_mfma_f32_16x16x32_bf16 v[132:135], a[192:195], a[164:167], v[132:135]
  v_mfma_f32_16x16x32_bf16 v[152:155], a[192:195], a[168:171], v[152:155]
  buffer_load_dwordx4 v3, s[8:11], s81 offen sc1 lds
  s_waitcnt vmcnt(23)
  v_cmp_ne_u32 vcc, s64, v73
  s_cbranch_vccnz O_slow5
O_ok5:
  v_mfma_f32_16x16x32_bf16 v[172:175], a[192:195], a[172:175], v[172:175]
  s_waitcnt lgkmcnt(0)
  s_barrier
  s_add_u32 s81, s77, 450560
  v_mfma_f32_16x16x32_bf16 v[96:99], a[216:219], a[200:203], v[96:99]
  ds_read_b128 a[176:179], v53 offset:0
  s_add_u32 m0, s66, 16384
  v_mfma_f32_16x16x32_bf16 v[116:119], a[216:219], a[204:207], v[116:119]
  ds_read_b128 a[160:163], v50 offset:0
  buffer_load_dwordx4 v1, s[8:11], s81 offen offset:0 sc1 lds
  v_mfma_f32_16x16x32_bf16 v[136:139], a[216:219], a[208:211], v[136:139]
  ds_read_b128 a[164:167], v50 offset:512
  v_mfma_f32_16x16x32_bf16 v[156:159], a[216:219], a[212:215], v[156:159]
  ds_read_b128 a[168:171], v50 offset:4096
  v_mfma_f32_16x16x32_bf16 v[100:103], a[220:223], a[200:203], v[100:103]
  ds_read_b128 a[172:175], v50 offset:4608
  v_mfma_f32_16x16x32_bf16 v[120:123], a[220:223], a[204:207], v[120:123]
  ds_read_b128 a[180:183], v53 offset:1024
  buffer_load_dwordx4 v1, s[8:11], s81 offen offset:1024 sc1 lds
  v_mfma_f32_16x16x32_bf16 v[140:143], a[220:223], a[208:211], v[140:143]
  ds_read_b128 a[184:187], v53 offset:2048
  v_mfma_f32_16x16x32_bf16 v[160:163], a[220:223], a[212:215], v[160:163]
  ds_read_b128 a[188:191], v53 offset:3072
  v_mfma_f32_16x16x32_bf16 v[104:107], a[224:227], a[200:203], v[104:107]
  ds_read_b128 a[192:195], v53 offset:4096
  v_mfma_f32_16x16x32_bf16 v[124:127], a[224:227], a[204:207], v[124:127]
  buffer_load_dwordx4 v1, s[8:11], s81 offen offset:2048 sc1 lds
  v_mfma_f32_16x16x32_bf16 v[144:147], a[224:227], a[208:211], v[144:147]
  v_mfma_f32_16x16x32_bf16 v[164:167], a[224:227], a[212:215], v[164:167]
  v_mfma_f32_16x16x32_bf16 v[108:111], a[228:231], a[200:203], v[108:111]
  buffer_load_dwordx4 v1, s[8:11], s81 offen offset:3072 sc1 lds
  s_add_u32 m0, s66, 146432
  v_mfma_f32_16x16x32_bf16 v[128:131], a[228:231], a[204:207], v[128:131]
  v_mfma_f32_16x16x32_bf16 v[148:151], a[228:231], a[208:211], v[148:151]
  v_mfma_f32_16x16x32_bf16 v[168:171], a[228:231], a[212:215], v[168:171]
  v_mfma_f32_16x16x32_bf16 v[112:115], a[232:235], a[200:203], v[112:115]
  buffer_load_dwordx4 v3, s[8:11], s81 offen sc1 lds
  v_mfma_f32_16x16x32_bf16 v[132:135], a[232:235], a[204:207], v[132:135]
  s_add_u32 s82, s76, 16384
  v_mfma_f32_16x16x32_bf16 v[152:155], a[232:235], a[208:211], v[152:155]
  v_mfma_f32_16x16x32_bf16 v[172:175], a[232:235], a[212:215], v[172:175]
  s_waitcnt lgkmcnt(0)
  buffer_load_dwordx4 v[240:243], v76, s[8:11], s82 offen sc1
  v_mfma_f32_16x16x32_bf16 v[96:99], a[176:179], a[160:163], v[96:99]
  ds_read_b128 a[216:219], v53 offset:10240
  v_mfma_f32_16x16x32_bf16 v[116:119], a[176:179], a[164:167], v[116:119]
  ds_read_b128 a[200:203], v51 offset:0
  v_mfma_f32_16x16x32_bf16 v[136:139], a[176:179], a[168:171], v[136:139]
  ds_read_b128 a[204:207], v51 offset:512
  v_mfma_f32_16x16x32_bf16 v[156:159], a[176:179], a[172:175], v[156:159]
  ds_read_b128 a[208:211], v51 offset:4096
  buffer_load_dwordx4 v[244:247], v77, s[8:11], s82 offen sc1
  v_mfma_f32_16x16x32_bf16 v[100:103], a[180:183], a[160:163], v[100:103]
  ds_read_b128 a[212:215], v51 offset:4608
  v_mfma_f32_16x16x32_bf16 v[120:123], a[180:183], a[164:167], v[120:123]
  ds_read_b128 a[220:223], v53 offset:11264
  v_mfma_f32_16x16x32_bf16 v[140:143], a[180:183], a[168:171], v[140:143]
  ds_read_b128 a[224:227], v53 offset:12288
  v_mfma_f32_16x16x32_bf16 v[160:163], a[180:183], a[172:175], v[160:163]
  ds_read_b128 a[228:231], v53 offset:13312
  buffer_load_dwordx4 v[248:251], v78, s[8:11], s82 offen sc1
  v_mfma_f32_16x16x32_bf16 v[104:107], a[184:187], a[160:163], v[104:107]
  ds_read_b128 a[232:235], v53 offset:14336
  v_mfma_f32_16x16x32_bf16 v[124:127], a[184:187], a[164:167], v[124:127]
  v_mfma_f32_16x16x32_bf16 v[144:147], a[184:187], a[168:171], v[144:147]
  buffer_load_dwordx4 v[252:255], v79, s[8:11], s82 offen sc1
  v_mfma_f32_16x16x32_bf16 v[164:167], a[184:187], a[172:175], v[164:167]
  v_mfma_f32_16x16x32_bf16 v[108:111], a[188:191], a[160:163], v[108:111]
  s_add_u32 s82, s76, 20480
  v_mfma_f32_16x16x32_bf16 v[128:131], a[188:191], a[164:167], v[128:131]
  v_mfma_f32_16x16x32_bf16 v[148:151], a[188:191], a[168:171], v[148:151]
  buffer_load_dwordx4 a[240:243], v76, s[8:11], s82 offen sc1
  v_mfma_f32_16x16x32_bf16 v[168:171], a[188:191], a[172:175], v[168:171]
  v_mfma_f32_16x16x32_bf16 v[112:115], a[192:195], a[160:163], v[112:115]
  v_mfma_f32_16x16x32_bf16 v[132:135], a[192:195], a[164:167], v[132:135]
  buffer_load_dwordx4 a[244:247], v77, s[8:11], s82 offen sc1
  v_mfma_f32_16x16x32_bf16 v[152:155], a[192:195], a[168:171], v[152:155]
  v_mfma_f32_16x16x32_bf16 v[172:175], a[192:195], a[172:175], v[172:175]
  s_waitcnt lgkmcnt(0)
  v_mfma_f32_16x16x32_bf16 v[96:99], a[216:219], a[200:203], v[96:99]
  v_mfma_f32_16x16x32_bf16 v[116:119], a[216:219], a[204:207], v[116:119]
  buffer_load_dwordx4 a[248:251], v78, s[8:11], s82 offen sc1
  v_mfma_f32_16x16x32_bf16 v[136:139], a[216:219], a[208:211], v[136:139]
  v_mfma_f32_16x16x32_bf16 v[156:159], a[216:219], a[212:215], v[156:159]
  v_mfma_f32_16x16x32_bf16 v[100:103], a[220:223], a[200:203], v[100:103]
  v_mfma_f32_16x16x32_bf16 v[120:123], a[220:223], a[204:207], v[120:123]
  buffer_load_dwordx4 a[252:255], v79, s[8:11], s82 offen sc1
  v_mfma_f32_16x16x32_bf16 v[140:143], a[220:223], a[208:211], v[140:143]
  v_mfma_f32_16x16x32_bf16 v[160:163], a[220:223], a[212:215], v[160:163]
  v_mfma_f32_16x16x32_bf16 v[104:107], a[224:227], a[200:203], v[104:107]
  v_mfma_f32_16x16x32_bf16 v[124:127], a[224:227], a[204:207], v[124:127]
  v_mfma_f32_16x16x32_bf16 v[144:147], a[224:227], a[208:211], v[144:147]
  v_mfma_f32_16x16x32_bf16 v[164:167], a[224:227], a[212:215], v[164:167]
  v_mfma_f32_16x16x32_bf16 v[108:111], a[228:231], a[200:203], v[108:111]
  v_mfma_f32_16x16x32_bf16 v[128:131], a[228:231], a[204:207], v[128:131]
  v_mfma_f32_16x16x32_bf16 v[148:151], a[228:231], a[208:211], v[148:151]
  v_mfma_f32_16x16x32_bf16 v[168:171], a[228:231], a[212:215], v[168:171]
  v_mfma_f32_16x16x32_bf16 v[112:115], a[232:235], a[200:203], v[112:115]
  v_mfma_f32_16x16x32_bf16 v[132:135], a[232:235], a[204:207], v[132:135]
  v_mfma_f32_16x16x32_bf16 v[152:155], a[232:235], a[208:211], v[152:155]
  v_mfma_f32_16x16x32_bf16 v[172:175], a[232:235], a[212:215], v[172:175]
  v_mfma_f32_16x16x32_bf16 a[160:163], a[0:3], v[176:179], 0
  s_add_u32 s83, s78, 8192
  v_cvt_pk_bf16_f32 v96, v96, v97
  v_mfma_f32_16x16x32_bf16 a[180:183], a[0:3], v[180:183], 0
  v_cvt_pk_bf16_f32 v97, v98, v99
  v_cvt_pk_bf16_f32 v98, v100, v101
  v_mfma_f32_16x16x32_bf16 a[200:203], a[0:3], v[184:187], 0
  v_cvt_pk_bf16_f32 v99, v102, v103
  buffer_store_dwordx4 v[96:99], v1, s[8:11], s78 offen offset:0 sc1
  v_mfma_f32_16x16x32_bf16 v[4:7], a[0:3], v[188:191], 0
  ds_write_b128 v70, v[96:99] offset:36864
  v_cvt_pk_bf16_f32 v104, v104, v105
  v_mfma_f32_16x16x32_bf16 a[164:167], a[4:7], v[176:179], 0
  v_cvt_pk_bf16_f32 v105, v106, v107
  v_cvt_pk_bf16_f32 v106, v108, v109
  v_mfma_f32_16x16x32_bf16 a[184:187], a[4:7], v[180:183], 0
  v_cvt_pk_bf16_f32 v107, v110, v111
  buffer_store_dwordx4 v[104:107], v1, s[8:11], s78 offen offset:1024 sc1
  v_mfma_f32_16x16x32_bf16 a[204:207], a[4:7], v[184:187], 0
  ds_write_b128 v70, v[104:107] offset:37888
  v_cvt_pk_bf16_f32 v116, v116, v117
  v_mfma_f32_16x16x32_bf16 v[8:11], a[4:7], v[188:191], 0
  v_cvt_pk_bf16_f32 v117, v118, v119
  v_cvt_pk_bf16_f32 v118, v120, v121
  v_mfma_f32_16x16x32_bf16 a[168:171], a[8:11], v[176:179], 0
  v_cvt_pk_bf16_f32 v119, v122, v123
  buffer_store_dwordx4 v[116:119], v1, s[8:11], s78 offen offset:2048 sc1
  v_mfma_f32_16x16x32_bf16 a[188:191], a[8:11], v[180:183], 0
  ds_write_b128 v70, v[116:119] offset:38912
  v_cvt_pk_bf16_f32 v124, v124, v125
  v_mfma_f32_16x16x32_bf16 a[208:211], a[8:11], v[184:187], 0
  v_cvt_pk_bf16_f32 v125, v126, v127
  v_cvt_pk_bf16_f32 v126, v128, v129
  v_mfma_f32_16x16x32_bf16 v[12:15], a[8:11], v[188:191], 0
  v_cvt_pk_bf16_f32 v127, v130, v131
  buffer_store_dwordx4 v[124:127], v1, s[8:11], s78 offen offset:3072 sc1
  v_mfma_f32_16x16x32_bf16 a[172:175], a[12:15], v[176:179], 0
  ds_write_b128 v70, v[124:127] offset:39936
  v_cvt_pk_bf16_f32 v136, v136, v137
  v_mfma_f32_16x16x32_bf16 a[192:195], a[12:15], v[180:183], 0
  v_cvt_pk_bf16_f32 v137, v138, v139
  v_cvt_pk_bf16_f32 v138, v140, v141
  v_mfma_f32_16x16x32_bf16 a[212:215], a[12:15], v[184:187], 0
  v_cvt_pk_bf16_f32 v139, v142, v143
  buffer_store_dwordx4 v[136:139], v3, s[8:11], s78 offen offset:0 sc1
  v_mfma_f32_16x16x32_bf16 v[16:19], a[12:15], v[188:191], 0
  ds_write_b128 v70, v[136:139] offset:40960
  v_cvt_pk_bf16_f32 v144, v144, v145
  v_mfma_f32_16x16x32_bf16 a[176:179], a[16:19], v[176:179], 0
  v_cvt_pk_bf16_f32 v145, v146, v147
  v_cvt_pk_bf16_f32 v146, v148, v149
  v_mfma_f32_16x16x32_bf16 a[196:199], a[16:19], v[180:183], 0
  v_cvt_pk_bf16_f32 v147, v150, v151
  buffer_store_dwordx4 v[144:147], v3, s[8:11], s78 offen offset:1024 sc1
  v_mfma_f32_16x16x32_bf16 a[216:219], a[16:19], v[184:187], 0
  ds_write_b128 v70, v[144:147] offset:41984
  v_cvt_pk_bf16_f32 v156, v156, v157
  v_mfma_f32_16x16x32_bf16 v[20:23], a[16:19], v[188:191], 0
  v_cvt_pk_bf16_f32 v157, v158, v159
  v_cvt_pk_bf16_f32 v158, v160, v161
  v_mfma_f32_16x16x32_bf16 a[160:163], a[20:23], v[192:195], a[160:163]
  v_cvt_pk_bf16_f32 v159, v162, v163
  buffer_store_dwordx4 v[156:159], v3, s[8:11], s78 offen offset:2048 sc1
  v_mfma_f32_16x16x32_bf16 a[180:183], a[20:23], v[196:199], a[180:183]
  ds_write_b128 v70, v[156:159] offset:43008
  v_cvt_pk_bf16_f32 v164, v164, v165
  v_mfma_f32_16x16x32_bf16 a[200:203], a[20:23], v[200:203], a[200:203]
  v_cvt_pk_bf16_f32 v165, v166, v167
  v_cvt_pk_bf16_f32 v166, v168, v169
  v_mfma_f32_16x16x32_bf16 v[4:7], a[20:23], v[204:207], v[4:7]
  v_cvt_pk_bf16_f32 v167, v170, v171
  buffer_store_dwordx4 v[164:167], v3, s[8:11], s78 offen offset:3072 sc1
  v_mfma_f32_16x16x32_bf16 a[164:167], a[24:27], v[192:195], a[164:167]
  ds_write_b128 v70, v[164:167] offset:44032
  v_cvt_pk_bf16_f32 v112, v112, v113
  v_mfma_f32_16x16x32_bf16 a[184:187], a[24:27], v[196:199], a[184:187]
  v_cvt_pk_bf16_f32 v113, v114, v115
  v_cvt_pk_bf16_f32 v114, v132, v133
  v_mfma_f32_16x16x32_bf16 a[204:207], a[24:27], v[200:203], a[204:207]
  v_cvt_pk_bf16_f32 v115, v134, v135
  buffer_store_dwordx4 v[112:115], v1, s[8:11], s83 offen offset:0 sc1
  v_mfma_f32_16x16x32_bf16 v[8:11], a[24:27], v[204:207], v[8:11]
  ds_write_b128 v70, v[112:115] offset:45056
  v_cvt_pk_bf16_f32 v152, v152, v153
  v_mfma_f32_16x16x32_bf16 a[168:171], a[28:31], v[192:195], a[168:171]
  v_cvt_pk_bf16_f32 v153, v154, v155
  v_cvt_pk_bf16_f32 v154, v172, v173
  v_mfma_f32_16x16x32_bf16 a[188:191], a[28:31], v[196:199], a[188:191]
  v_cvt_pk_bf16_f32 v155, v174, v175
  buffer_store_dwordx4 v[152:155], v1, s[8:11], s83 offen offset:1024 sc1
  v_mfma_f32_16x16x32_bf16 a[208:211], a[28:31], v[200:203], a[208:211]
  ds_write_b128 v70, v[152:155] offset:46080
  s_add_u32 s82, s76, 24576
  v_mfma_f32_16x16x32_bf16 v[12:15], a[28:31], v[204:207], v[12:15]
  buffer_load_dwordx4 v[176:179], v76, s[8:11], s82 offen sc1
  v_mfma_f32_16x16x32_bf16 a[172:175], a[32:35], v[192:195], a[172:175]
  buffer_load_dwordx4 v[180:183], v77, s[8:11], s82 offen sc1
  v_mfma_f32_16x16x32_bf16 a[192:195], a[32:35], v[196:199], a[192:195]
  v_mfma_f32_16x16x32_bf16 a[212:215], a[32:35], v[200:203], a[212:215]
  v_mfma_f32_16x16x32_bf16 v[16:19], a[32:35], v[204:207], v[16:19]
  v_mfma_f32_16x16x32_bf16 a[176:179], a[36:39], v[192:195], a[176:179]
  buffer_load_dwordx4 v[184:187], v78, s[8:11], s82 offen sc1
  v_mfma_f32_16x16x32_bf16 a[196:199], a[36:39], v[196:199], a[196:199]
  v_mfma_f32_16x16x32_bf16 a[216:219], a[36:39], v[200:203], a[216:219]
  v_mfma_f32_16x16x32_bf16 v[20:23], a[36:39], v[204:207], v[20:23]
  s_waitcnt lgkmcnt(0)
  s_barrier
  buffer_load_dwordx4 v[188:191], v79, s[8:11], s82 offen sc1
  s_waitcnt vmcnt(49)
  v_mfma_f32_16x16x32_bf16 a[160:163], a[40:43], v[208:211], a[160:163]
  s_waitcnt vmcnt(48)
  v_mfma_f32_16x16x32_bf16 a[180:183], a[40:43], v[212:215], a[180:183]
  s_add_u32 s82, s76, 28672
  s_waitcnt vmcnt(47)
  v_mfma_f32_16x16x32_bf16 a[200:203], a[40:43], v[216:219], a[200:203]
  s_waitcnt vmcnt(46)
  v_mfma_f32_16x16x32_bf16 v[4:7], a[40:43], v[220:223], v[4:7]
  buffer_load_dwordx4 v[192:195], v76, s[8:11], s82 offen sc1
  v_mfma_f32_16x16x32_bf16 a[164:167], a[44:47], v[208:211], a[164:167]
  v_mfma_f32_16x16x32_bf16 a[184:187], a[44:47], v[212:215], a[184:187]
  v_mfma_f32_16x16x32_bf16 a[204:207], a[44:47], v[216:219], a[204:207]
  v_mfma_f32_16x16x32_bf16 v[8:11], a[44:47], v[220:223], v[8:11]
  buffer_load_dwordx4 v[196:199], v77, s[8:11], s82 offen sc1
  v_mfma_f32_16x16x32_bf16 a[168:171], a[48:51], v[208:211], a[168:171]
  v_mfma_f32_16x16x32_bf16 a[188:191], a[48:51], v[212:215], a[188:191]
  v_mfma_f32_16x16x32_bf16 a[208:211], a[48:51], v[216:219], a[208:211]
  buffer_load_dwordx4 v[200:203], v78, s[8:11], s82 offen sc1
  v_mfma_f32_16x16x32_bf16 v[12:15], a[48:51], v[220:223], v[12:15]
  v_mfma_f32_16x16x32_bf16 a[172:175], a[52:55], v[208:211], a[172:175]
  v_mfma_f32_16x16x32_bf16 a[192:195], a[52:55], v[212:215], a[192:195]
  v_mfma_f32_16x16x32_bf16 a[212:215], a[52:55], v[216:219], a[212:215]
  buffer_load_dwordx4 v[204:207], v79, s[8:11], s82 offen sc1
  v_mfma_f32_16x16x32_bf16 v[16:19], a[52:55], v[220:223], v[16:19]
  v_mfma_f32_16x16x32_bf16 a[176:179], a[56:59], v[208:211], a[176:179]
  v_mfma_f32_16x16x32_bf16 a[196:199], a[56:59], v[212:215], a[196:199]
  buffer_store_dword v71, v72, s[8:11], s38 offen sc1
  v_mfma_f32_16x16x32_bf16 a[216:219], a[56:59], v[216:219], a[216:219]
  v_mfma_f32_16x16x32_bf16 v[20:23], a[56:59], v[220:223], v[20:23]
  s_waitcnt vmcnt(50)
  v_mfma_f32_16x16x32_bf16 a[160:163], a[60:63], v[224:227], a[160:163]
  s_waitcnt vmcnt(49)
  v_mfma_f32_16x16x32_bf16 a[180:183], a[60:63], v[228:231], a[180:183]
  buffer_load_dwordx4 v[208:211], v76, s[8:11], s4 offen sc1
  buffer_load_dwordx4 v[212:215], v76, s[8:11], s5 offen sc1
  s_waitcnt vmcnt(50)
  v_mfma_f32_16x16x32_bf16 a[200:203], a[60:63], v[232:235], a[200:203]
  s_waitcnt vmcnt(49)
  v_mfma_f32_16x16x32_bf16 v[4:7], a[60:63], v[236:239], v[4:7]
  v_mfma_f32_16x16x32_bf16 a[164:167], a[64:67], v[224:227], a[164:167]
  v_mfma_f32_16x16x32_bf16 a[184:187], a[64:67], v[228:231], a[184:187]
  buffer_load_dwordx4 v[216:219], v76, s[8:11], s6 offen sc1
  v_mfma_f32_16x16x32_bf16 a[204:207], a[64:67], v[232:235], a[204:207]
  v_mfma_f32_16x16x32_bf16 v[8:11], a[64:67], v[236:239], v[8:11]
  v_mfma_f32_16x16x32_bf16 a[168:171], a[68:71], v[224:227], a[168:171]
  v_mfma_f32_16x16x32_bf16 a[188:191], a[68:71], v[228:231], a[188:191]
  buffer_load_dwordx4 v[220:223], v76, s[8:11], s7 offen sc1
  v_mfma_f32_16x16x32_bf16 a[208:211], a[68:71], v[232:235], a[208:211]
  v_mfma_f32_16x16x32_bf16 v[12:15], a[68:71], v[236:239], v[12:15]
  v_mfma_f32_16x16x32_bf16 a[172:175], a[72:75], v[224:227], a[172:175]
  v_mfma_f32_16x16x32_bf16 a[192:195], a[72:75], v[228:231], a[192:195]
  v_mfma_f32_16x16x32_bf16 a[212:215], a[72:75], v[232:235], a[212:215]
  v_mfma_f32_16x16x32_bf16 v[16:19], a[72:75], v[236:239], v[16:19]
  v_mfma_f32_16x16x32_bf16 a[176:179], a[76:79], v[224:227], a[176:179]
  v_mfma_f32_16x16x32_bf16 a[196:199], a[76:79], v[228:231], a[196:199]
  v_mfma_f32_16x16x32_bf16 a[216:219], a[76:79], v[232:235], a[216:219]
  v_mfma_f32_16x16x32_bf16 v[20:23], a[76:79], v[236:239], v[20:23]
  buffer_load_dwordx4 v[224:227], v77, s[8:11], s4 offen sc1
  buffer_load_dwordx4 v[228:231], v77, s[8:11], s5 offen sc1
  s_waitcnt vmcnt(32)
  v_mfma_f32_16x16x32_bf16 a[160:163], a[80:83], v[240:243], a[160:163]
  s_waitcnt vmcnt(31)
  v_mfma_f32_16x16x32_bf16 a[180:183], a[80:83], v[244:247], a[180:183]
  s_waitcnt vmcnt(30)
  v_mfma_f32_16x16x32_bf16 a[200:203], a[80:83], v[248:251], a[200:203]
  s_waitcnt vmcnt(29)
  v_mfma_f32_16x16x32_bf16 v[4:7], a[80:83], v[252:255], v[4:7]
  buffer_load_dwordx4 v[232:235], v77, s[8:11], s6 offen sc1
  v_mfma_f32_16x16x32_bf16 a[164:167], a[84:87], v[240:243], a[164:167]
  v_mfma_f32_16x16x32_bf16 a[184:187], a[84:87], v[244:247], a[184:187]
  v_mfma_f32_16x16x32_bf16 a[204:207], a[84:87], v[248:251], a[204:207]
  v_mfma_f32_16x16x32_bf16 v[8:11], a[84:87], v[252:255], v[8:11]
  buffer_load_dwordx4 v[236:239], v77, s[8:11], s7 offen sc1
  v_mfma_f32_16x16x32_bf16 a[168:171], a[88:91], v[240:243], a[168:171]
  v_mfma_f32_16x16x32_bf16 a[188:191], a[88:91], v[244:247], a[188:191]
  v_mfma_f32_16x16x32_bf16 a[208:211], a[88:91], v[248:251], a[208:211]
  buffer_load_dwordx4 a[60:63], v78, s[8:11], s4 offen sc1
  v_mfma_f32_16x16x32_bf16 v[12:15], a[88:91], v[252:255], v[12:15]
  v_mfma_f32_16x16x32_bf16 a[172:175], a[92:95], v[240:243], a[172:175]
  v_mfma_f32_16x16x32_bf16 a[192:195], a[92:95], v[244:247], a[192:195]
  v_mfma_f32_16x16x32_bf16 a[212:215], a[92:95], v[248:251], a[212:215]
  buffer_load_dwordx4 a[64:67], v78, s[8:11], s5 offen sc1
  v_mfma_f32_16x16x32_bf16 v[16:19], a[92:95], v[252:255], v[16:19]
  v_mfma_f32_16x16x32_bf16 a[176:179], a[96:99], v[240:243], a[176:179]
  v_mfma_f32_16x16x32_bf16 a[196:199], a[96:99], v[244:247], a[196:199]
  buffer_load_dwordx4 a[68:71], v78, s[8:11], s6 offen sc1
  v_mfma_f32_16x16x32_bf16 a[216:219], a[96:99], v[248:251], a[216:219]
  v_mfma_f32_16x16x32_bf16 v[20:23], a[96:99], v[252:255], v[20:23]
  v_add_u32 v84, s79, v1
  s_waitcnt vmcnt(33)
  v_mfma_f32_16x16x32_bf16 a[160:163], a[100:103], a[240:243], a[160:163]
  v_add_u32 v85, s79, v0
  s_waitcnt vmcnt(32)
  v_mfma_f32_16x16x32_bf16 a[180:183], a[100:103], a[244:247], a[180:183]
  ds_read_b128 v[132:135], v84 offset:0
  buffer_load_dwordx4 a[72:75], v78, s[8:11], s7 offen sc1
  s_waitcnt vmcnt(32)
  v_mfma_f32_16x16x32_bf16 a[200:203], a[100:103], a[248:251], a[200:203]
  ds_read_b128 v[136:139], v84 offset:1024
  s_waitcnt vmcnt(31)
  v_mfma_f32_16x16x32_bf16 v[4:7], a[100:103], a[252:255], v[4:7]
  ds_read_b128 v[140:143], v85 offset:0
  v_mfma_f32_16x16x32_bf16 a[164:167], a[104:107], a[240:243], a[164:167]
  ds_read_b128 a[220:223], v45 offset:0
  v_mfma_f32_16x16x32_bf16 a[184:187], a[104:107], a[244:247], a[184:187]
  ds_read_b128 a[224:227], v45 offset:1024
  buffer_load_dwordx4 a[80:83], v79, s[8:11], s4 offen sc1
  v_mfma_f32_16x16x32_bf16 a[204:207], a[104:107], a[248:251], a[204:207]
  ds_read_b128 a[228:231], v45 offset:2048
  v_mfma_f32_16x16x32_bf16 v[8:11], a[104:107], a[252:255], v[8:11]
  ds_read_b128 a[232:235], v45 offset:3072
  v_mfma_f32_16x16x32_bf16 a[168:171], a[108:111], a[240:243], a[168:171]
  ds_read_b128 a[236:239], v45 offset:32768
  buffer_load_dwordx4 a[84:87], v79, s[8:11], s5 offen sc1
  v_mfma_f32_16x16x32_bf16 a[188:191], a[108:111], a[244:247], a[188:191]
  ds_read_b128 a[0:3], v45 offset:16384
  v_mfma_f32_16x16x32_bf16 a[208:211], a[108:111], a[248:251], a[208:211]
  ds_read_b128 a[4:7], v45 offset:17408
  v_mfma_f32_16x16x32_bf16 v[12:15], a[108:111], a[252:255], v[12:15]
  ds_read_b128 a[8:11], v45 offset:18432
  v_mfma_f32_16x16x32_bf16 a[172:175], a[112:115], a[240:243], a[172:175]
  ds_read_b128 a[12:15], v45 offset:19456
  buffer_load_dwordx4 a[88:91], v79, s[8:11], s6 offen sc1
  v_mfma_f32_16x16x32_bf16 a[192:195], a[112:115], a[244:247], a[192:195]
  ds_read_b128 a[16:19], v45 offset:33792
  v_mfma_f32_16x16x32_bf16 a[212:215], a[112:115], a[248:251], a[212:215]
  v_mfma_f32_16x16x32_bf16 v[16:19], a[112:115], a[252:255], v[16:19]
  buffer_load_dwordx4 a[92:95], v79, s[8:11], s7 offen sc1
  v_mfma_f32_16x16x32_bf16 a[176:179], a[116:119], a[240:243], a[176:179]
  v_mfma_f32_16x16x32_bf16 a[196:199], a[116:119], a[244:247], a[196:199]
  v_mfma_f32_16x16x32_bf16 a[216:219], a[116:119], a[248:251], a[216:219]
  v_mfma_f32_16x16x32_bf16 v[20:23], a[116:119], a[252:255], v[20:23]
  s_waitcnt vmcnt(24)
  v_mfma_f32_16x16x32_bf16 a[160:163], a[120:123], v[176:179], a[160:163]
  s_waitcnt vmcnt(23)
  v_mfma_f32_16x16x32_bf16 a[180:183], a[120:123], v[180:183], a[180:183]
  s_waitcnt vmcnt(22)
  v_mfma_f32_16x16x32_bf16 a[200:203], a[120:123], v[184:187], a[200:203]
  s_waitcnt vmcnt(21)
  v_mfma_f32_16x16x32_bf16 v[4:7], a[120:123], v[188:191], v[4:7]
  v_mfma_f32_16x16x32_bf16 a[164:167], a[124:127], v[176:179], a[164:167]
  v_mfma_f32_16x16x32_bf16 a[184:187], a[124:127], v[180:183], a[184:187]
  v_mfma_f32_16x16x32_bf16 a[204:207], a[124:127], v[184:187], a[204:207]
  v_mfma_f32_16x16x32_bf16 v[8:11], a[124:127], v[188:191], v[8:11]
  v_mfma_f32_16x16x32_bf16 a[168:171], a[128:131], v[176:179], a[168:171]
  v_mfma_f32_16x16x32_bf16 a[188:191], a[128:131], v[180:183], a[188:191]
  ds_read_b128 a[20:23], v44 offset:0
  v_mfma_f32_16x16x32_bf16 a[208:211], a[128:131], v[184:187], a[208:211]
  ds_read_b128 a[24:27], v44 offset:1024
  v_mfma_f32_16x16x32_bf16 v[12:15], a[128:131], v[188:191], v[12:15]
  ds_read_b128 a[28:31], v44 offset:2048
  v_mfma_f32_16x16x32_bf16 a[172:175], a[132:135], v[176:179], a[172:175]
  ds_read_b128 a[32:35], v44 offset:3072
  v_mfma_f32_16x16x32_bf16 a[192:195], a[132:135], v[180:183], a[192:195]
  ds_read_b128 a[36:39], v45 offset:34816
  v_mfma_f32_16x16x32_bf16 a[212:215], a[132:135], v[184:187], a[212:215]
  ds_read_b128 a[40:43], v44 offset:16384
  v_mfma_f32_16x16x32_bf16 v[16:19], a[132:135], v[188:191], v[16:19]
  ds_read_b128 a[44:47], v44 offset:17408
  v_mfma_f32_16x16x32_bf16 a[176:179], a[136:139], v[176:179], a[176:179]
  ds_read_b128 a[48:51], v44 offset:18432
  v_mfma_f32_16x16x32_bf16 a[196:199], a[136:139], v[180:183], a[196:199]
  ds_read_b128 a[52:55], v44 offset:19456
  v_mfma_f32_16x16x32_bf16 a[216:219], a[136:139], v[184:187], a[216:219]
  ds_read_b128 a[56:59], v45 offset:35840
  v_mfma_f32_16x16x32_bf16 v[20:23], a[136:139], v[188:191], v[20:23]
  s_waitcnt vmcnt(20)
  v_mfma_f32_16x16x32_bf16 a[160:163], a[140:143], v[192:195], a[160:163]
  s_waitcnt vmcnt(19)
  v_mfma_f32_16x16x32_bf16 a[180:183], a[140:143], v[196:199], a[180:183]
  s_waitcnt vmcnt(18)
  v_mfma_f32_16x16x32_bf16 a[200:203], a[140:143], v[200:203], a[200:203]
  s_waitcnt vmcnt(17)
  v_mfma_f32_16x16x32_bf16 v[4:7], a[140:143], v[204:207], v[4:7]
  v_mfma_f32_16x16x32_bf16 a[164:167], a[144:147], v[192:195], a[164:167]
  v_mfma_f32_16x16x32_bf16 a[184:187], a[144:147], v[196:199], a[184:187]
  v_mfma_f32_16x16x32_bf16 a[204:207], a[144:147], v[200:203], a[204:207]
  v_mfma_f32_16x16x32_bf16 v[8:11], a[144:147], v[204:207], v[8:11]
  v_mfma_f32_16x16x32_bf16 a[168:171], a[148:151], v[192:195], a[168:171]
  v_mfma_f32_16x16x32_bf16 a[188:191], a[148:151], v[196:199], a[188:191]
  buffer_load_dwordx4 v[96:99], v1, s[8:11], s96 offen offset:0 sc1
  buffer_load_dwordx4 v[100:103], v1, s[8:11], s96 offen offset:1024 sc1
  v_mfma_f32_16x16x32_bf16 a[208:211], a[148:151], v[200:203], a[208:211]
  v_mfma_f32_16x16x32_bf16 v[12:15], a[148:151], v[204:207], v[12:15]
  v_mfma_f32_16x16x32_bf16 a[172:175], a[152:155], v[192:195], a[172:175]
  v_mfma_f32_16x16x32_bf16 a[192:195], a[152:155], v[196:199], a[192:195]
  buffer_load_dwordx4 v[104:107], v0, s[8:11], s96 offen offset:0 sc1
  v_mfma_f32_16x16x32_bf16 a[212:215], a[152:155], v[200:203], a[212:215]
  v_mfma_f32_16x16x32_bf16 v[16:19], a[152:155], v[204:207], v[16:19]
  v_mfma_f32_16x16x32_bf16 a[176:179], a[156:159], v[192:195], a[176:179]
  v_mfma_f32_16x16x32_bf16 a[196:199], a[156:159], v[196:199], a[196:199]
  buffer_load_dwordx4 v[108:111], v1, s[8:11], s97 offen offset:0 sc1
  v_mfma_f32_16x16x32_bf16 a[216:219], a[156:159], v[200:203], a[216:219]
  v_mfma_f32_16x16x32_bf16 v[20:23], a[156:159], v[204:207], v[20:23]
  s_waitcnt vmcnt(19) lgkmcnt(15)
  v_mfma_f32_16x16x32_bf16 a[160:163], a[220:223], v[208:211], a[160:163]
  buffer_load_dwordx4 v[112:115], v1, s[8:11], s97 offen offset:1024 sc1
  v_mfma_f32_16x16x32_bf16 a[164:167], a[224:227], v[208:211], a[164:167]
  v_mfma_f32_16x16x32_bf16 a[168:171], a[228:231], v[208:211], a[168:171]
  v_mfma_f32_16x16x32_bf16 a[172:175], a[232:235], v[208:211], a[172:175]
  v_mfma_f32_16x16x32_bf16 a[176:179], a[236:239], v[208:211], a[176:179]
  buffer_load_dwordx4 v[116:119], v0, s[8:11], s97 offen offset:0 sc1
  s_waitcnt vmcnt(20) lgkmcnt(14)
  v_mfma_f32_16x16x32_bf16 a[160:163], a[0:3], v[212:215], a[160:163]
  s_waitcnt lgkmcnt(13)
  v_mfma_f32_16x16x32_bf16 a[164:167], a[4:7], v[212:215], a[164:167]
  s_waitcnt lgkmcnt(12)
  v_mfma_f32_16x16x32_bf16 a[168:171], a[8:11], v[212:215], a[168:171]
  buffer_load_dwordx4 v[120:123], v1, s[8:11], s99 offen offset:0 sc1
  s_waitcnt lgkmcnt(11)
  v_mfma_f32_16x16x32_bf16 a[172:175], a[12:15], v[212:215], a[172:175]
  s_waitcnt lgkmcnt(10)
  v_mfma_f32_16x16x32_bf16 a[176:179], a[16:19], v[212:215], a[176:179]
  s_waitcnt vmcnt(20) lgkmcnt(9)
  v_mfma_f32_16x16x32_bf16 a[160:163], a[20:23], v[216:219], a[160:163]
  s_waitcnt lgkmcnt(8)
  v_mfma_f32_16x16x32_bf16 a[164:167], a[24:27], v[216:219], a[164:167]
  buffer_load_dwordx4 v[124:127], v1, s[8:11], s99 offen offset:1024 sc1
  s_waitcnt lgkmcnt(7)
  v_mfma_f32_16x16x32_bf16 a[168:171], a[28:31], v[216:219], a[168:171]
  s_waitcnt lgkmcnt(6)
  v_mfma_f32_16x16x32_bf16 a[172:175], a[32:35], v[216:219], a[172:175]
  s_waitcnt lgkmcnt(5)
  v_mfma_f32_16x16x32_bf16 a[176:179], a[36:39], v[216:219], a[176:179]
  s_waitcnt vmcnt(20) lgkmcnt(4)
  v_mfma_f32_16x16x32_bf16 a[160:163], a[40:43], v[220:223], a[160:163]
  buffer_load_dwordx4 v[128:131], v0, s[8:11], s99 offen offset:0 sc1
  s_waitcnt lgkmcnt(3)
  v_mfma_f32_16x16x32_bf16 a[164:167], a[44:47], v[220:223], a[164:167]
  s_waitcnt lgkmcnt(2)
  v_mfma_f32_16x16x32_bf16 a[168:171], a[48:51], v[220:223], a[168:171]
  s_waitcnt lgkmcnt(1)
  v_mfma_f32_16x16x32_bf16 a[172:175], a[52:55], v[220:223], a[172:175]
  s_waitcnt lgkmcnt(0)
  v_mfma_f32_16x16x32_bf16 a[176:179], a[56:59], v[220:223], a[176:179]
  s_waitcnt vmcnt(20)
  v_mfma_f32_16x16x32_bf16 a[180:183], a[220:223], v[224:227], a[180:183]
  ds_write_b128 v92, a[160:163] offset:47104
  v_mfma_f32_16x16x32_bf16 a[184:187], a[224:227], v[224:227], a[184:187]
  ds_write_b128 v92, a[164:167] offset:48128
  v_mfma_f32_16x16x32_bf16 a[188:191], a[228:231], v[224:227], a[188:191]
  ds_write_b128 v92, a[168:171] offset:49152
  v_mfma_f32_16x16x32_bf16 a[192:195], a[232:235], v[224:227], a[192:195]
  ds_write_b128 v92, a[172:175] offset:50176
  v_mfma_f32_16x16x32_bf16 a[196:199], a[236:239], v[224:227], a[196:199]
  ds_write_b128 v92, a[176:179] offset:51200
  s_waitcnt vmcnt(19)
  v_mfma_f32_16x16x32_bf16 a[180:183], a[0:3], v[228:231], a[180:183]
  v_mfma_f32_16x16x32_bf16 a[184:187], a[4:7], v[228:231], a[184:187]
  v_mfma_f32_16x16x32_bf16 a[188:191], a[8:11], v[228:231], a[188:191]
  v_mfma_f32_16x16x32_bf16 a[192:195], a[12:15], v[228:231], a[192:195]
  v_mfma_f32_16x16x32_bf16 a[196:199], a[16:19], v[228:231], a[196:199]
  s_waitcnt vmcnt(18)
  v_mfma_f32_16x16x32_bf16 a[180:183], a[20:23], v[232:235], a[180:183]
  v_mfma_f32_16x16x32_bf16 a[184:187], a[24:27], v[232:235], a[184:187]
  v_mfma_f32_16x16x32_bf16 a[188:191], a[28:31], v[232:235], a[188:191]
  v_mfma_f32_16x16x32_bf16 a[192:195], a[32:35], v[232:235], a[192:195]
  v_mfma_f32_16x16x32_bf16 a[196:199], a[36:39], v[232:235], a[196:199]
  s_waitcnt vmcnt(17)
  v_mfma_f32_16x16x32_bf16 a[180:183], a[40:43], v[236:239], a[180:183]
  v_mfma_f32_16x16x32_bf16 a[184:187], a[44:47], v[236:239], a[184:187]
  v_mfma_f32_16x16x32_bf16 a[188:191], a[48:51], v[236:239], a[188:191]
  v_mfma_f32_16x16x32_bf16 a[192:195], a[52:55], v[236:239], a[192:195]
  v_mfma_f32_16x16x32_bf16 a[196:199], a[56:59], v[236:239], a[196:199]
  s_waitcnt vmcnt(16)
  v_mfma_f32_16x16x32_bf16 a[200:203], a[220:223], a[60:63], a[200:203]
  s_nop 1
  ds_write_b128 v93, a[180:183] offset:52224
  v_mfma_f32_16x16x32_bf16 a[204:207], a[224:227], a[60:63], a[204:207]
  ds_write_b128 v93, a[184:187] offset:53248
  v_mfma_f32_16x16x32_bf16 a[208:211], a[228:231], a[60:63], a[208:211]
  ds_write_b128 v93, a[188:191] offset:54272
  v_mfma_f32_16x16x32_bf16 a[212:215], a[232:235], a[60:63], a[212:215]
  ds_write_b128 v93, a[192:195] offset:55296
  v_mfma_f32_16x16x32_bf16 a[216:219], a[236:239], a[60:63], a[216:219]
  ds_write_b128 v93, a[196:199] offset:56320
  s_waitcnt vmcnt(15)
  v_mfma_f32_16x16x32_bf16 a[200:203], a[0:3], a[64:67], a[200:203]
  v_mfma_f32_16x16x32_bf16 a[204:207], a[4:7], a[64:67], a[204:207]
  v_mfma_f32_16x16x32_bf16 a[208:211], a[8:11], a[64:67], a[208:211]
  v_mfma_f32_16x16x32_bf16 a[212:215], a[12:15], a[64:67], a[212:215]
  v_mfma_f32_16x16x32_bf16 a[216:219], a[16:19], a[64:67], a[216:219]
  s_waitcnt vmcnt(14)
  v_mfma_f32_16x16x32_bf16 a[200:203], a[20:23], a[68:71], a[200:203]
  v_mfma_f32_16x16x32_bf16 a[204:207], a[24:27], a[68:71], a[204:207]
  v_mfma_f32_16x16x32_bf16 a[208:211], a[28:31], a[68:71], a[208:211]
  v_mfma_f32_16x16x32_bf16 a[212:215], a[32:35], a[68:71], a[212:215]
  v_mfma_f32_16x16x32_bf16 a[216:219], a[36:39], a[68:71], a[216:219]
  s_waitcnt vmcnt(13)
  v_mfma_f32_16x16x32_bf16 a[200:203], a[40:43], a[72:75], a[200:203]
  v_mfma_f32_16x16x32_bf16 a[204:207], a[44:47], a[72:75], a[204:207]
  v_mfma_f32_16x16x32_bf16 a[208:211], a[48:51], a[72:75], a[208:211]
  v_mfma_f32_16x16x32_bf16 a[212:215], a[52:55], a[72:75], a[212:215]
  v_mfma_f32_16x16x32_bf16 a[216:219], a[56:59], a[72:75], a[216:219]
  s_mov_b32 s16, 0xbfb8aa3b
  s_mov_b32 s17, 0xbfb8aa3b
  s_waitcnt vmcnt(12)
  v_mfma_f32_16x16x32_bf16 v[4:7], a[220:223], a[80:83], v[4:7]
  ds_write_b128 v94, a[200:203] offset:57344
  s_mov_b32 s18, 1.0
  s_waitcnt vmcnt(11)
  v_mfma_f32_16x16x32_bf16 v[4:7], a[0:3], a[84:87], v[4:7]
  ds_write_b128 v94, a[204:207] offset:58368
  s_mov_b32 s19, 1.0
  s_waitcnt vmcnt(10)
  v_mfma_f32_16x16x32_bf16 v[4:7], a[20:23], a[88:91], v[4:7]
  ds_write_b128 v94, a[208:211] offset:59392
  s_waitcnt vmcnt(9)
  v_mfma_f32_16x16x32_bf16 v[4:7], a[40:43], a[92:95], v[4:7]
  ds_write_b128 v94, a[212:215] offset:60416
  v_mfma_f32_16x16x32_bf16 v[8:11], a[224:227], a[80:83], v[8:11]
  ds_write_b128 v94, a[216:219] offset:61440
  v_mfma_f32_16x16x32_bf16 v[8:11], a[4:7], a[84:87], v[8:11]
  v_mfma_f32_16x16x32_bf16 v[8:11], a[24:27], a[88:91], v[8:11]
  v_mfma_f32_16x16x32_bf16 v[8:11], a[44:47], a[92:95], v[8:11]
  v_mfma_f32_16x16x32_bf16 v[12:15], a[228:231], a[80:83], v[12:15]
  v_mfma_f32_16x16x32_bf16 v[12:15], a[8:11], a[84:87], v[12:15]
  v_mfma_f32_16x16x32_bf16 v[12:15], a[28:31], a[88:91], v[12:15]
  v_mfma_f32_16x16x32_bf16 v[12:15], a[48:51], a[92:95], v[12:15]
  s_waitcnt lgkmcnt(0)
  s_barrier
  ds_read_b128 v[176:179], v95 offset:47104
  v_mfma_f32_16x16x32_bf16 v[16:19], a[232:235], a[80:83], v[16:19]
  ds_read_b128 v[180:183], v95 offset:52224
  ds_read_b128 v[184:187], v95 offset:57344
  v_mfma_f32_16x16x32_bf16 v[16:19], a[12:15], a[84:87], v[16:19]
  ds_read_b128 v[188:191], v95 offset:48128
  ds_read_b128 v[192:195], v95 offset:53248
  v_mfma_f32_16x16x32_bf16 v[16:19], a[32:35], a[88:91], v[16:19]
  ds_read_b128 v[196:199], v95 offset:58368
  ds_read_b128 v[200:203], v95 offset:49152
  v_mfma_f32_16x16x32_bf16 v[16:19], a[52:55], a[92:95], v[16:19]
  ds_read_b128 v[204:207], v95 offset:54272
  ds_read_b128 v[208:211], v95 offset:59392
  v_mfma_f32_16x16x32_bf16 v[20:23], a[236:239], a[80:83], v[20:23]
  ds_read_b128 v[212:215], v95 offset:50176
  ds_read_b128 v[216:219], v95 offset:55296
  v_mfma_f32_16x16x32_bf16 v[20:23], a[16:19], a[84:87], v[20:23]
  ds_read_b128 v[220:223], v95 offset:60416
  ds_read_b128 v[224:227], v95 offset:51200
  v_mfma_f32_16x16x32_bf16 v[20:23], a[36:39], a[88:91], v[20:23]
  ds_read_b128 v[228:231], v95 offset:56320
  ds_read_b128 v[232:235], v95 offset:61440
  v_mfma_f32_16x16x32_bf16 v[20:23], a[56:59], a[92:95], v[20:23]
  s_waitcnt lgkmcnt(13)
  v_pk_add_f32 v[176:177], v[176:177], v[180:181]
  v_pk_add_f32 v[178:179], v[178:179], v[182:183]
  s_waitcnt lgkmcnt(12)
  v_pk_add_f32 v[4:5], v[4:5], v[184:185]
  v_pk_add_f32 v[6:7], v[6:7], v[186:187]
  v_pk_add_f32 v[4:5], v[4:5], v[176:177]
  v_pk_add_f32 v[6:7], v[6:7], v[178:179]
  v_pk_mul_f32 v[176:177], v[4:5], s[16:17]
  v_pk_mul_f32 v[178:179], v[6:7], s[16:17]
  v_exp_f32 v176, v176
  v_exp_f32 v177, v177
  v_exp_f32 v178, v178
  v_exp_f32 v179, v179
  s_waitcnt lgkmcnt(10)
  v_pk_add_f32 v[188:189], v[188:189], v[192:193]
  v_pk_add_f32 v[190:191], v[190:191], v[194:195]
  s_waitcnt lgkmcnt(9)
  v_pk_add_f32 v[8:9], v[8:9], v[196:197]
  v_pk_add_f32 v[10:11], v[10:11], v[198:199]
  v_pk_add_f32 v[8:9], v[8:9], v[188:189]
  v_pk_add_f32 v[10:11], v[10:11], v[190:191]
  v_pk_mul_f32 v[188:189], v[8:9], s[16:17]
  v_pk_mul_f32 v[190:191], v[10:11], s[16:17]
  v_exp_f32 v188, v188
  v_exp_f32 v189, v189
  v_exp_f32 v190, v190
  v_exp_f32 v191, v191
  s_waitcnt lgkmcnt(7)
  v_pk_add_f32 v[200:201], v[200:201], v[204:205]
  v_pk_add_f32 v[202:203], v[202:203], v[206:207]
  s_waitcnt lgkmcnt(6)
  v_pk_add_f32 v[12:13], v[12:13], v[208:209]
  v_pk_add_f32 v[14:15], v[14:15], v[210:211]
  v_pk_add_f32 v[12:13], v[12:13], v[200:201]
  v_pk_add_f32 v[14:15], v[14:15], v[202:203]
  v_pk_mul_f32 v[200:201], v[12:13], s[16:17]
  v_pk_mul_f32 v[202:203], v[14:15], s[16:17]
  v_exp_f32 v200, v200
  v_exp_f32 v201, v201
  v_exp_f32 v202, v202
  v_exp_f32 v203, v203
  s_waitcnt lgkmcnt(4)
  v_pk_add_f32 v[212:213], v[212:213], v[216:217]
  v_pk_add_f32 v[214:215], v[214:215], v[218:219]
  s_waitcnt lgkmcnt(3)
  v_pk_add_f32 v[16:17], v[16:17], v[220:221]
  v_pk_add_f32 v[18:19], v[18:19], v[222:223]
  v_pk_add_f32 v[16:17], v[16:17], v[212:213]
  v_pk_add_f32 v[18:19], v[18:19], v[214:215]
  v_pk_mul_f32 v[212:213], v[16:17], s[16:17]
  v_pk_mul_f32 v[214:215], v[18:19], s[16:17]
  v_exp_f32 v212, v212
  v_exp_f32 v213, v213
  v_exp_f32 v214, v214
  v_exp_f32 v215, v215
  s_waitcnt lgkmcnt(1)
  v_pk_add_f32 v[224:225], v[224:225], v[228:229]
  v_pk_add_f32 v[226:227], v[226:227], v[230:231]
  s_waitcnt lgkmcnt(0)
  v_pk_add_f32 v[20:21], v[20:21], v[232:233]
  v_pk_add_f32 v[22:23], v[22:23], v[234:235]
  v_pk_add_f32 v[20:21], v[20:21], v[224:225]
  v_pk_add_f32 v[22:23], v[22:23], v[226:227]
  v_pk_mul_f32 v[224:225], v[20:21], s[16:17]
  v_pk_mul_f32 v[226:227], v[22:23], s[16:17]
  v_exp_f32 v224, v224
  v_exp_f32 v225, v225
  v_exp_f32 v226, v226
  v_exp_f32 v227, v227
  v_pk_add_f32 v[176:177], v[176:177], s[18:19]
  v_pk_add_f32 v[178:179], v[178:179], s[18:19]
  v_rcp_f32 v176, v176
  v_rcp_f32 v177, v177
  v_rcp_f32 v178, v178
  v_rcp_f32 v179, v179
  v_pk_add_f32 v[188:189], v[188:189], s[18:19]
  v_pk_add_f32 v[190:191], v[190:191], s[18:19]
  v_rcp_f32 v188, v188
  v_rcp_f32 v189, v189
  v_rcp_f32 v190, v190
  v_rcp_f32 v191, v191
  v_pk_add_f32 v[200:201], v[200:201], s[18:19]
  v_pk_add_f32 v[202:203], v[202:203], s[18:19]
  v_rcp_f32 v200, v200
  v_rcp_f32 v201, v201
  v_rcp_f32 v202, v202
  v_rcp_f32 v203, v203
  v_pk_add_f32 v[212:213], v[212:213], s[18:19]
  v_pk_add_f32 v[214:215], v[214:215], s[18:19]
  v_rcp_f32 v212, v212
  v_rcp_f32 v213, v213
  v_rcp_f32 v214, v214
  v_rcp_f32 v215, v215
  v_pk_add_f32 v[224:225], v[224:225], s[18:19]
  v_pk_add_f32 v[226:227], v[226:227], s[18:19]
  v_rcp_f32 v224, v224
  v_rcp_f32 v225, v225
  v_rcp_f32 v226, v226
  v_rcp_f32 v227, v227
  v_pk_mul_f32 v[4:5], v[4:5], v[176:177]
  v_pk_mul_f32 v[6:7], v[6:7], v[178:179]
  v_pk_mul_f32 v[8:9], v[8:9], v[188:189]
  v_pk_mul_f32 v[10:11], v[10:11], v[190:191]
  v_pk_mul_f32 v[12:13], v[12:13], v[200:201]
  v_pk_mul_f32 v[14:15], v[14:15], v[202:203]
  v_pk_mul_f32 v[16:17], v[16:17], v[212:213]
  v_pk_mul_f32 v[18:19], v[18:19], v[214:215]
  v_pk_mul_f32 v[20:21], v[20:21], v[224:225]
  v_pk_mul_f32 v[22:23], v[22:23], v[226:227]
  s_waitcnt vmcnt(6)
  v_max3_u32 v73, v96, v100, v104
  s_waitcnt vmcnt(4)
  v_max3_u32 v73, v73, v108, v112
  s_waitcnt vmcnt(2)
  v_max3_u32 v73, v73, v116, v120
  s_waitcnt vmcnt(0)
  v_max3_u32 v73, v73, v124, v128
  v_cmp_eq_u32 vcc, -1, v73
  s_cbranch_vccnz O_slow0
O_ok0:
  v_mfma_f32_16x16x32_bf16 v[144:147], v[58:61], v[96:99], 0
  v_mfma_f32_16x16x32_bf16 v[144:147], v[58:61], v[108:111], v[144:147]
  v_mfma_f32_16x16x32_bf16 v[144:147], v[58:61], v[120:123], v[144:147]
  v_mfma_f32_16x16x32_bf16 v[144:147], v[58:61], v[132:135], v[144:147]
  v_mfma_f32_16x16x32_bf16 v[148:151], v[56:59], v[96:99], 0
  v_mfma_f32_16x16x32_bf16 v[148:151], v[56:59], v[108:111], v[148:151]
  s_nop 5
  v_fma_f32 v4, v4, v144, v24
  v_fma_f32 v5, v5, v145, v25
  v_mfma_f32_16x16x32_bf16 v[148:151], v[56:59], v[120:123], v[148:151]
  v_fma_f32 v6, v6, v146, v26
  v_fma_f32 v7, v7, v147, v27
  v_mfma_f32_16x16x32_bf16 v[148:151], v[56:59], v[132:135], v[148:151]
  v_cvt_pk_bf16_f32 v4, v4, v5
  v_cvt_pk_bf16_f32 v5, v6, v7
  v_mfma_f32_16x16x32_bf16 v[152:155], v[58:61], v[100:103], 0
  buffer_store_dwordx2 v[4:5], v74, s[52:55], s80 offen offset:0
  v_mfma_f32_16x16x32_bf16 v[152:155], v[58:61], v[112:115], v[152:155]
  s_nop 2
  v_fma_f32 v8, v8, v148, v28
  v_fma_f32 v9, v9, v149, v29
  v_mfma_f32_16x16x32_bf16 v[152:155], v[58:61], v[124:127], v[152:155]
  v_fma_f32 v10, v10, v150, v30
  v_fma_f32 v11, v11, v151, v31
  v_mfma_f32_16x16x32_bf16 v[152:155], v[58:61], v[136:139], v[152:155]
  v_cvt_pk_bf16_f32 v8, v8, v9
  v_cvt_pk_bf16_f32 v9, v10, v11
  v_mfma_f32_16x16x32_bf16 v[156:159], v[56:59], v[100:103], 0
  buffer_store_dwordx2 v[8:9], v74, s[52:55], s80 offen offset:32
  v_mfma_f32_16x16x32_bf16 v[156:159], v[56:59], v[112:115], v[156:159]
  s_nop 2
  v_fma_f32 v12, v12, v152, v32
  v_fma_f32 v13, v13, v153, v33
  v_mfma_f32_16x16x32_bf16 v[156:159], v[56:59], v[124:127], v[156:159]
  v_fma_f32 v14, v14, v154, v34
  v_fma_f32 v15, v15, v155, v35
  v_mfma_f32_16x16x32_bf16 v[156:159], v[56:59], v[136:139], v[156:159]
  v_cvt_pk_bf16_f32 v12, v12, v13
  v_cvt_pk_bf16_f32 v13, v14, v15
  v_mfma_f32_16x16x32_bf16 v[160:163], v[62:65], v[104:107], 0
  buffer_store_dwordx2 v[12:13], v74, s[52:55], s80 offen offset:64
  v_mfma_f32_16x16x32_bf16 v[160:163], v[62:65], v[116:119], v[160:163]
  s_nop 2
  v_fma_f32 v16, v16, v156, v36
  v_fma_f32 v17, v17, v157, v37
  v_fma_f32 v18, v18, v158, v38
  v_mfma_f32_16x16x32_bf16 v[160:163], v[62:65], v[128:131], v[160:163]
  v_fma_f32 v19, v19, v159, v39
  v_cvt_pk_bf16_f32 v16, v16, v17
  v_cvt_pk_bf16_f32 v17, v18, v19
  v_mfma_f32_16x16x32_bf16 v[160:163], v[62:65], v[140:143], v[160:163]
  buffer_store_dwordx2 v[16:17], v74, s[52:55], s80 offen offset:96
  s_nop 6
  v_fma_f32 v20, v20, v160, v40
  v_fma_f32 v21, v21, v161, v41
  v_fma_f32 v22, v22, v162, v42
  v_fma_f32 v23, v23, v163, v43
  v_cvt_pk_bf16_f32 v20, v20, v21
  v_cvt_pk_bf16_f32 v21, v22, v23
  buffer_store_dwordx2 v[20:21], v74, s[52:55], s80 offen offset:128
  s_endpgm
O_slow0:
  buffer_load_dwordx4 v[96:99], v1, s[8:11], s96 offen offset:0 sc1
  buffer_load_dwordx4 v[100:103], v1, s[8:11], s96 offen offset:1024 sc1
  buffer_load_dwordx4 v[104:107], v0, s[8:11], s96 offen offset:0 sc1
  buffer_load_dwordx4 v[108:111], v1, s[8:11], s97 offen offset:0 sc1
  buffer_load_dwordx4 v[112:115], v1, s[8:11], s97 offen offset:1024 sc1
  buffer_load_dwordx4 v[116:119], v0, s[8:11], s97 offen offset:0 sc1
  buffer_load_dwordx4 v[120:123], v1, s[8:11], s99 offen offset:0 sc1
  buffer_load_dwordx4 v[124:127], v1, s[8:11], s99 offen offset:1024 sc1
  buffer_load_dwordx4 v[128:131], v0, s[8:11], s99 offen offset:0 sc1
  s_waitcnt vmcnt(0)
  v_max3_u32 v73, v96, v100, v104
  v_max3_u32 v73, v73, v108, v112
  v_max3_u32 v73, v73, v116, v120
  v_max3_u32 v73, v73, v124, v128
  v_cmp_eq_u32 vcc, -1, v73
  s_cbranch_vccz O_ok0
  s_sub_u32 s65, s65, 1
  s_cmp_gt_i32 s65, 0
  s_cbranch_scc1 O_slow0
  s_branch O_ok0
O_slow1:
  buffer_load_dwordx4 v[56:59], v75, s[8:11], s22 offen offset:0 sc1
  buffer_load_dwordx4 v[60:63], v75, s[8:11], s22 offen offset:64 sc1
  buffer_load_dwordx4 v[208:211], v1, s[8:11], s23 offen sc1
  buffer_load_dwordx4 v[212:215], v238, s[8:11], s23 offen offset:1024 sc1
  s_waitcnt vmcnt(0)
  v_xor_b32 v73, s64, v59
  v_xad_u32 v73, v63, s64, v73
  v_xad_u32 v73, v209, s64, v73
  v_xad_u32 v73, v211, s64, v73
  v_xad_u32 v73, v213, s64, v73
  v_xad_u32 v73, v215, s64, v73
  v_cmp_ne_u32 vcc, 0, v73
  s_cbranch_vccz O_ok1
  s_sub_u32 s65, s65, 1
  s_cmp_gt_i32 s65, 0
  s_cbranch_scc1 O_slow1
  s_branch O_ok1
O_slow2:
  buffer_load_dword v73, v90, s[8:11], s32 offen sc1
  s_waitcnt vmcnt(0)
  v_cmp_ne_u32 vcc, s64, v73
  s_cbranch_vccz O_ok2
  s_sub_u32 s65, s65, 1
  s_cmp_gt_i32 s65, 0
  s_cbranch_scc1 O_slow2
  s_branch O_ok2
O_slow3:
  buffer_load_dword v73, v88, s[8:11], s30 offen sc1
  s_waitcnt vmcnt(0)
  v_cmp_ne_u32 vcc, s64, v73
  s_cbranch_vccz O_ok3
  s_sub_u32 s65, s65, 1
  s_cmp_gt_i32 s65, 0
  s_cbranch_scc1 O_slow3
  s_branch O_ok3
O_slow4:
  buffer_load_dword v73, v89, s[8:11], s31 offen sc1
  s_waitcnt vmcnt(0)
  v_cmp_ne_u32 vcc, s64, v73
  s_cbranch_vccz O_ok4
  s_sub_u32 s65, s65, 1
  s_cmp_gt_i32 s65, 0
  s_cbranch_scc1 O_slow4
  s_branch O_ok4
O_slow5:
  buffer_load_dword v73, v91, s[8:11], s31 offen sc1
  s_waitcnt vmcnt(0)
  v_cmp_ne_u32 vcc, s64, v73
  s_cbranch_vccz O_ok5
  s_sub_u32 s65, s65, 1
  s_cmp_gt_i32 s65, 0
  s_cbranch_scc1 O_slow5
  s_branch O_ok5
L_end:
  s_endpgm
.section .rodata,"a"
.p2align 6
.amdhsa_kernel recurrent_scan__spectral_fnet__glu_gated_geglu__prompt_kernel
  .amdhsa_next_free_vgpr 512
  .amdhsa_next_free_sgpr 102
  .amdhsa_accum_offset 256
  .amdhsa_group_segment_fixed_size 0
  .amdhsa_kernarg_size 96
  .amdhsa_user_sgpr_count 2
  .amdhsa_user_sgpr_kernarg_segment_ptr 1
  .amdhsa_system_sgpr_workgroup_id_x 1
.end_amdhsa_kernel
```
